```python
import torch

def _softmax(x, axis=-1):
    return torch.softmax(x, dim=axis)

def _gelu(x):
    return torch.nn.functional.gelu(x, approximate='tanh')

def _silu(x):
    return torch.nn.functional.silu(x)

def _sigmoid(x):
    return torch.sigmoid(x)

def _layernorm(x, axis=-1, eps=1e-05):
    m = x.mean(dim=axis, keepdim=True)
    v = x.var(dim=axis, keepdim=True, unbiased=False)
    return (x - m) / torch.sqrt(v + eps)

def _scatter_add(tgt, idx, src, axis=0):
    return tgt.clone().index_add_(axis, idx, src)

def _segment_sum(src, seg, n):
    out = torch.zeros((n,) + src.shape[1:], dtype=src.dtype)
    return out.index_add_(0, seg, src)

def _pad(x, pw):
    flat = tuple((v for pair in reversed(pw) for v in pair))
    return torch.nn.functional.pad(x, flat)
kernel_name = 'concat_heads__memory_aug_recurrent_mem_tr__linear_attn_block__prompt'

def setup_inputs():

    _w = lambda a: (lambda t: t.to(torch.bfloat16) if t.is_floating_point() else t)(torch.as_tensor(a))

    def _A_setup():
        B, S, Dm = (1, 2048, 448)
        H, Dh = (16, 256)
        M, seg = (8, 32)
        seg = min(seg, S)
        S = S // seg * seg
        return {'x': _w((lambda *s: torch.randn(*s, dtype=torch.bfloat16) * 0.05)(B, S, Dm)), 'mem0': _w((lambda *s: torch.randn(*s, dtype=torch.bfloat16) * 0.8)(B, M, Dm)), 'Wq': _w((lambda *s: torch.randn(*s, dtype=torch.bfloat16) * 1.6)(Dm, H, Dh) * Dm ** (-0.5)), 'Wk': _w((lambda *s: torch.randn(*s, dtype=torch.bfloat16) * 1.6)(Dm, H, Dh) * Dm ** (-0.5)), 'Wv': _w((lambda *s: torch.randn(*s, dtype=torch.bfloat16) * 0.8)(Dm, H, Dh) * Dm ** (-0.5)), 'Wo': _w((lambda *s: torch.randn(*s, dtype=torch.bfloat16) * 0.8)(H, Dh, Dm) * (H * Dh) ** (-0.5)), 'seg_len': seg}
    _A_in = _A_setup()

    def _B_setup():
        B, S, D = (1, 2048, 448)
        return {'x': _w((lambda *s: torch.randn(*s, dtype=torch.bfloat16) * 0.05)(B, S, D)), 'wqkv': _w((lambda *s: torch.randn(*s, dtype=torch.bfloat16) * 1.6)(D, 3 * D)), 'wo': _w((lambda *s: torch.randn(*s, dtype=torch.bfloat16) * 0.1)(D, D))}
    _B_in = _B_setup()
    return {'A_x': _A_in['x'], 'A_mem0': _A_in['mem0'], 'A_Wq': _A_in['Wq'], 'A_Wk': _A_in['Wk'], 'A_Wv': _A_in['Wv'], 'A_Wo': _A_in['Wo'], 'A_seg_len': _A_in['seg_len'], 'B_x': _B_in['x'], 'B_wqkv': _B_in['wqkv'], 'B_wo': _B_in['wo']}

def reference(A_x, A_mem0, A_Wq, A_Wk, A_Wv, A_Wo, A_seg_len, B_x, B_wqkv, B_wo):

    def _A_ref(x, mem0, Wq, Wk, Wv, Wo, seg_len):
        B, S, Dm = x.shape
        H, Dh = (Wq.shape[1], Wq.shape[2])
        M = mem0.shape[1]
        scale = Dh ** (-0.5)
        n_seg = S // seg_len
        L = M + seg_len
        idx = torch.arange(L)
        mask = (idx[:, None] < M) | (idx[:, None] >= idx[None, :])
        mem = mem0
        outs = []
        for s in range(n_seg):
            xs = x[:, s * seg_len:(s + 1) * seg_len, :].clone()
            h = torch.concatenate([mem, xs], axis=1)
            q = torch.einsum('btd,dhe->bhte', h, Wq)
            k = torch.einsum('btd,dhe->bhte', h, Wk)
            v = torch.einsum('btd,dhe->bhte', h, Wv)
            scores = torch.einsum('bhqe,bhke->bhqk', q, k) * scale
            scores = torch.where(mask[None, None], scores, -1000000000.0)
            p = _softmax(scores, axis=-1)
            o = torch.einsum('bhqk,bhke->bhqe', p, v)
            o = torch.einsum('bhte,hed->btd', o, Wo)
            mem = o[:, :M, :].clone()
            outs.append(o[:, M:, :])
        return torch.concatenate(outs, axis=1)

    def _B_ref(x, wqkv, wo):
        B, S, D = x.shape
        H = 16
        Dh = D // H
        qkv = (lambda x, *d: x.permute(*d))((x @ wqkv).reshape(B, S, 3, H, Dh), 2, 0, 3, 1, 4)
        q, k, v = (qkv[0], qkv[1], qkv[2])
        phi = lambda t: torch.where(t > 0, t + 1, torch.exp(t)) + 1e-06
        pq, pk = (phi(q), phi(k))
        kv = torch.einsum('bhsd,bhse->bhde', pk, v)
        z = torch.einsum('bhsd->bhd', pk)
        num = torch.einsum('bhqd,bhde->bhqe', pq, kv)
        den = torch.einsum('bhqd,bhd->bhq', pq, z)[..., None] + 1e-06
        o = num / den
        return (lambda x, *d: x.permute(*d))(o, 0, 2, 1, 3).reshape(B, S, D) @ wo
    a = _A_ref(A_x, A_mem0, A_Wq, A_Wk, A_Wv, A_Wo, A_seg_len)
    b = _B_ref(B_x, B_wqkv, B_wo)
    return torch.concatenate([a, b], axis=-1)
```

```asm
; @launch grid=(256,1,1) block=(256,1,1) lds=163840
.amdgcn_target "amdgcn-amd-amdhsa--gfx950"
.text
.globl concat_heads__memory_aug_recurrent_mem_tr__linear_attn_block__prompt_kernel
.p2align 8
.type concat_heads__memory_aug_recurrent_mem_tr__linear_attn_block__prompt_kernel,@function
concat_heads__memory_aug_recurrent_mem_tr__linear_attn_block__prompt_kernel:
    s_cmp_ge_u32 s2, 256
    s_cbranch_scc1 P_end

    s_load_dwordx16 s[4:19], s[0:1], 0
    s_load_dwordx8 s[20:27], s[0:1], 64
    s_load_dwordx2 s[28:29], s[0:1], 96
    v_lshrrev_b32 v1, 6, v0
    v_and_b32 v186, 63, v0
    v_readfirstlane_b32 s31, v1
    v_lshlrev_b32 v184, 4, v186
    s_and_b32 s80, s2, 7
    s_lshl_b32 s80, s80, 2
    s_lshr_b32 s81, s2, 6
    s_add_u32 s80, s80, s81
    s_xor_b32 s80, s80, 0
    s_and_b32 s36, s80, 15
    s_lshr_b32 s39, s80, 4
    s_bfe_u32 s37, s2, 0x20004
    s_bfe_u32 s38, s2, 0x10003
    s_mul_i32 s70, s31, 24576
    s_add_u32 s70, s70, 65536
    v_lshrrev_b32 v185, 4, v186
    v_xor_b32 v185, v185, v186
    v_and_b32 v185, 7, v185
    v_lshlrev_b32 v2, 4, v185
    s_lshl_b32 s88, s38, 1
    s_xor_b32 s88, s88, s37
    s_and_b32 s88, s88, 0
    s_lshl_b32 s89, s88, 7
    v_or_b32 v2, s89, v2
    v_xor_b32 v3, 64, v2
    v_mov_b32 v168, 0
    v_bfe_u32 v185, v186, 5, 1
    v_lshl_add_u32 v168, v185, 15, v168
    v_bfe_u32 v185, v186, 4, 1
    v_lshl_add_u32 v168, v185, 16, v168
    v_bfe_u32 v185, v186, 3, 1
    v_lshl_add_u32 v168, v185, 13, v168
    v_add_u32 v169, 131072, v168
    v_add_u32 v168, v2, v168
    v_add_u32 v169, v3, v169
    v_mov_b32 v176, 0
    v_bfe_u32 v185, v186, 0, 4
    v_lshl_add_u32 v176, v185, 7, v176
    v_bfe_u32 v4, v186, 1, 3
    v_lshrrev_b32 v5, 4, v186
    v_xor_b32 v4, v4, v5
    v_lshl_add_u32 v176, v4, 4, v176
    s_waitcnt lgkmcnt(0)
    s_cmp_lg_u32 s39, 0
    s_cselect_b32 s80, s12, s8
    s_cselect_b32 s81, s13, s9
    s_mul_i32 s82, s38, 1835008
    s_lshl_b32 s83, s31, 19
    s_add_u32 s82, s82, s83
    s_lshl_b32 s83, s36, 9
    s_add_u32 s82, s82, s83
    s_add_u32 s40, s80, s82
    s_addc_u32 s41, s81, 0
    s_add_u32 s42, s40, 16384
    s_addc_u32 s43, s41, 0
    s_add_u32 s44, s40, 262144
    s_addc_u32 s45, s41, 0
    s_add_u32 s46, s40, 278528
    s_addc_u32 s47, s41, 0
    s_getreg_b32 s30, hwreg(HW_REG_XCC_ID)
    s_and_b32 s30, s30, 7
    v_mov_b32 v4, -1
    v_mov_b32 v5, -1
    v_mov_b32 v6, -1
    v_mov_b32 v7, -1
    s_lshl_b32 s80, s39, 4
    s_add_u32 s80, s80, s36
    s_lshl_b32 s80, s80, 3
    s_bfe_u32 s81, s2, 0x30003
    s_add_u32 s80, s80, s81
    s_mul_i32 s80, s80, 128
    s_add_u32 s80, s80, 15204352
    v_mov_b32 v8, s80
    s_lshl_b32 s87, s31, 2
    s_add_u32 s87, s87, s80
    s_lshl_b32 s80, s2, 2
    s_add_u32 s80, s80, 15237120
    v_mov_b32 v141, s80
    s_mov_b32 s35, 1048576
    s_cmp_lg_u32 s31, 3
    s_cbranch_scc1 P_nofill
    s_mov_b64 exec, 1
    global_store_dwordx4 v8, v[4:7], s[28:29] sc1
    global_store_dword v141, v4, s[28:29] sc1
    s_mov_b64 exec, -1
    s_cmp_eq_u32 s2, 63
    s_cbranch_scc1 P_nofill
    s_cmp_ge_u32 s2, 241
    s_cbranch_scc1 P_nofill
    s_lshl_b32 s80, s2, 13
    s_add_u32 s80, s80, 13111296
    s_add_u32 s80, s28, s80
    s_addc_u32 s81, s29, 0
    global_store_dwordx4 v184, v[4:7], s[80:81] offset:-4096 sc1
    global_store_dwordx4 v184, v[4:7], s[80:81] offset:-3072 sc1
    global_store_dwordx4 v184, v[4:7], s[80:81] offset:-2048 sc1
    global_store_dwordx4 v184, v[4:7], s[80:81] offset:-1024 sc1
    global_store_dwordx4 v184, v[4:7], s[80:81] offset:0 sc1
    global_store_dwordx4 v184, v[4:7], s[80:81] offset:1024 sc1
    global_store_dwordx4 v184, v[4:7], s[80:81] offset:2048 sc1
    global_store_dwordx4 v184, v[4:7], s[80:81] offset:3072 sc1
P_nofill:
    s_cmp_lg_u32 s39, 0
    s_cbranch_scc1 P_B
    s_cmp_eq_u32 s31, 3
    s_cbranch_scc1 P_A3
P_A:
    s_mul_i32 s82, s37, 917504
    s_lshl_b32 s83, s36, 9
    s_add_u32 s82, s82, s83
    v_mov_b32 v170, 0
    v_bfe_u32 v185, v186, 5, 1
    v_lshl_add_u32 v170, v185, 17, v170
    v_bfe_u32 v185, v186, 4, 1
    v_lshl_add_u32 v170, v185, 16, v170
    v_bfe_u32 v185, v186, 3, 1
    v_lshl_add_u32 v170, v185, 14, v170
    v_add_u32 v171, 262144, v170
    v_add_u32 v170, v2, v170
    v_add_u32 v171, v3, v171
    s_mul_i32 s83, s31, s31
    s_lshl_b32 s83, s83, 13
    s_add_u32 s83, s83, s82
    s_add_u32 s48, s10, s83
    s_addc_u32 s49, s11, 0
    s_lshl_b32 s84, s31, 11
    v_xor_b32 v177, 64, v176
    s_lshl_b32 s80, s36, 2
    s_add_u32 s80, s80, s37
    s_mul_i32 s80, s80, 100352
    s_mul_i32 s81, s38, 7168
    s_add_u32 s80, s80, s81
    s_lshl_b32 s81, s31, 11
    s_add_u32 s80, s80, s81
    s_add_u32 s81, s80, 0
    s_add_u32 s56, s28, s81
    s_addc_u32 s57, s29, 0
    s_add_u32 s81, s80, 14336
    s_add_u32 s58, s28, s81
    s_addc_u32 s59, s29, 0
    s_add_u32 s81, s80, 28672
    s_add_u32 s60, s28, s81
    s_addc_u32 s61, s29, 0
    s_add_u32 s81, s80, 43008
    s_add_u32 s62, s28, s81
    s_addc_u32 s63, s29, 0
    s_add_u32 s81, s80, 57344
    s_add_u32 s64, s28, s81
    s_addc_u32 s65, s29, 0
    s_add_u32 s81, s80, 71680
    s_add_u32 s66, s28, s81
    s_addc_u32 s67, s29, 0
    s_add_u32 s81, s80, 86016
    s_add_u32 s68, s28, s81
    s_addc_u32 s69, s29, 0
    s_add_u32 m0, s84, 0
    s_nop 0
    global_load_lds_dwordx4 v170, s[48:49] offset:0
    s_add_u32 m0, s84, 1024
    s_nop 0
    global_load_lds_dwordx4 v171, s[48:49] offset:0
    s_add_u32 m0, s70, 0
    s_nop 0
    global_load_lds_dwordx4 v168, s[40:41] offset:0
    s_add_u32 m0, s70, 1024
    s_nop 0
    global_load_lds_dwordx4 v169, s[40:41] offset:0
    s_add_u32 m0, s70, 2048
    s_nop 0
    global_load_lds_dwordx4 v168, s[42:43] offset:0
    s_add_u32 m0, s70, 3072
    s_nop 0
    global_load_lds_dwordx4 v169, s[42:43] offset:0
    s_add_u32 m0, s70, 4096
    s_nop 0
    global_load_lds_dwordx4 v168, s[44:45] offset:0
    s_add_u32 m0, s70, 5120
    s_nop 0
    global_load_lds_dwordx4 v169, s[44:45] offset:0
    s_add_u32 m0, s70, 6144
    s_nop 0
    global_load_lds_dwordx4 v168, s[46:47] offset:0
    s_add_u32 m0, s70, 7168
    s_nop 0
    global_load_lds_dwordx4 v169, s[46:47] offset:0
    v_xor_b32 v170, 128, v170
    v_xor_b32 v171, 128, v171
    s_add_u32 m0, s84, 14336
    s_nop 0
    global_load_lds_dwordx4 v170, s[48:49] offset:0
    s_add_u32 m0, s84, 15360
    s_nop 0
    global_load_lds_dwordx4 v171, s[48:49] offset:0
    v_xor_b32 v168, 128, v168
    v_xor_b32 v169, 128, v169
    s_add_u32 m0, s70, 8192
    s_nop 0
    global_load_lds_dwordx4 v168, s[40:41] offset:0
    s_add_u32 m0, s70, 9216
    s_nop 0
    global_load_lds_dwordx4 v169, s[40:41] offset:0
    s_add_u32 m0, s70, 10240
    s_nop 0
    global_load_lds_dwordx4 v168, s[42:43] offset:0
    s_add_u32 m0, s70, 11264
    s_nop 0
    global_load_lds_dwordx4 v169, s[42:43] offset:0
    s_add_u32 m0, s70, 12288
    s_nop 0
    global_load_lds_dwordx4 v168, s[44:45] offset:0
    s_add_u32 m0, s70, 13312
    s_nop 0
    global_load_lds_dwordx4 v169, s[44:45] offset:0
    s_add_u32 m0, s70, 14336
    s_nop 0
    global_load_lds_dwordx4 v168, s[46:47] offset:0
    s_add_u32 m0, s70, 15360
    s_nop 0
    global_load_lds_dwordx4 v169, s[46:47] offset:0
    v_add_u32 v187, s70, v176
    v_xor_b32 v188, 64, v187
    v_mov_b32 v0, 0
    v_mov_b32 v1, 0
    v_mov_b32 v2, 0
    v_mov_b32 v3, 0
    v_mov_b32 v4, 0
    v_mov_b32 v5, 0
    v_mov_b32 v6, 0
    v_mov_b32 v7, 0
    v_mov_b32 v8, 0
    v_mov_b32 v9, 0
    v_mov_b32 v10, 0
    v_mov_b32 v11, 0
    v_mov_b32 v12, 0
    v_mov_b32 v13, 0
    v_mov_b32 v14, 0
    v_mov_b32 v15, 0
    v_mov_b32 v16, 0
    v_mov_b32 v17, 0
    v_mov_b32 v18, 0
    v_mov_b32 v19, 0
    v_mov_b32 v20, 0
    v_mov_b32 v21, 0
    v_mov_b32 v22, 0
    v_mov_b32 v23, 0
    v_mov_b32 v24, 0
    v_mov_b32 v25, 0
    v_mov_b32 v26, 0
    v_mov_b32 v27, 0
    v_mov_b32 v28, 0
    v_mov_b32 v29, 0
    v_mov_b32 v30, 0
    v_mov_b32 v31, 0
    v_mov_b32 v32, 0
    v_mov_b32 v33, 0
    v_mov_b32 v34, 0
    v_mov_b32 v35, 0
    v_mov_b32 v36, 0
    v_mov_b32 v37, 0
    v_mov_b32 v38, 0
    v_mov_b32 v39, 0
    v_mov_b32 v40, 0
    v_mov_b32 v41, 0
    v_mov_b32 v42, 0
    v_mov_b32 v43, 0
    v_mov_b32 v44, 0
    v_mov_b32 v45, 0
    v_mov_b32 v46, 0
    v_mov_b32 v47, 0
    v_mov_b32 v48, 0
    v_mov_b32 v49, 0
    v_mov_b32 v50, 0
    v_mov_b32 v51, 0
    v_mov_b32 v52, 0
    v_mov_b32 v53, 0
    v_mov_b32 v54, 0
    v_mov_b32 v55, 0
    v_mov_b32 v56, 0
    v_mov_b32 v57, 0
    v_mov_b32 v58, 0
    v_mov_b32 v59, 0
    v_mov_b32 v60, 0
    v_mov_b32 v61, 0
    v_mov_b32 v62, 0
    v_mov_b32 v63, 0
    v_mov_b32 v64, 0
    v_mov_b32 v65, 0
    v_mov_b32 v66, 0
    v_mov_b32 v67, 0
    v_mov_b32 v68, 0
    v_mov_b32 v69, 0
    v_mov_b32 v70, 0
    v_mov_b32 v71, 0
    v_mov_b32 v72, 0
    v_mov_b32 v73, 0
    v_mov_b32 v74, 0
    v_mov_b32 v75, 0
    v_mov_b32 v76, 0
    v_mov_b32 v77, 0
    v_mov_b32 v78, 0
    v_mov_b32 v79, 0
    v_mov_b32 v80, 0
    v_mov_b32 v81, 0
    v_mov_b32 v82, 0
    v_mov_b32 v83, 0
    v_mov_b32 v84, 0
    v_mov_b32 v85, 0
    v_mov_b32 v86, 0
    v_mov_b32 v87, 0
    v_mov_b32 v88, 0
    v_mov_b32 v89, 0
    v_mov_b32 v90, 0
    v_mov_b32 v91, 0
    v_mov_b32 v92, 0
    v_mov_b32 v93, 0
    v_mov_b32 v94, 0
    v_mov_b32 v95, 0
    v_mov_b32 v96, 0
    v_mov_b32 v97, 0
    v_mov_b32 v98, 0
    v_mov_b32 v99, 0
    v_mov_b32 v100, 0
    v_mov_b32 v101, 0
    v_mov_b32 v102, 0
    v_mov_b32 v103, 0
    v_mov_b32 v104, 0
    v_mov_b32 v105, 0
    v_mov_b32 v106, 0
    v_mov_b32 v107, 0
    v_mov_b32 v108, 0
    v_mov_b32 v109, 0
    v_mov_b32 v110, 0
    v_mov_b32 v111, 0
    s_waitcnt vmcnt(10)
    s_barrier
    ds_read_b128 v[112:115], v187 offset:0
    ds_read_b128 v[116:119], v187 offset:2048
    ds_read_b128 v[120:123], v187 offset:4096
    ds_read_b128 v[124:127], v187 offset:6144
    ds_read_b128 v[144:147], v176 offset:0
    ds_read_b128 v[148:151], v176 offset:2048
    ds_read_b128 v[152:155], v176 offset:4096
    ds_read_b128 v[156:159], v176 offset:6144
    ds_read_b128 v[160:163], v176 offset:8192
    s_waitcnt lgkmcnt(4)
    v_mfma_f32_16x16x32_bf16 v[0:3], v[112:115], v[144:147], v[0:3]
    ds_read_b128 v[164:167], v176 offset:10240
    v_mfma_f32_16x16x32_bf16 v[28:31], v[116:119], v[144:147], v[28:31]
    v_mfma_f32_16x16x32_bf16 v[56:59], v[120:123], v[144:147], v[56:59]
    v_mfma_f32_16x16x32_bf16 v[84:87], v[124:127], v[144:147], v[84:87]
    v_xor_b32 v170, 384, v170
    v_xor_b32 v171, 384, v171
    s_add_u32 m0, s84, 28672
    s_nop 0
    global_load_lds_dwordx4 v170, s[48:49] offset:0
    s_add_u32 m0, s84, 29696
    s_nop 0
    global_load_lds_dwordx4 v171, s[48:49] offset:0
    s_waitcnt lgkmcnt(4)
    v_mfma_f32_16x16x32_bf16 v[4:7], v[112:115], v[148:151], v[4:7]
    ds_read_b128 v[144:147], v176 offset:12288
    v_mfma_f32_16x16x32_bf16 v[32:35], v[116:119], v[148:151], v[32:35]
    v_mfma_f32_16x16x32_bf16 v[60:63], v[120:123], v[148:151], v[60:63]
    v_mfma_f32_16x16x32_bf16 v[88:91], v[124:127], v[148:151], v[88:91]
    v_xor_b32 v168, 384, v168
    v_xor_b32 v169, 384, v169
    s_add_u32 m0, s70, 16384
    s_nop 0
    global_load_lds_dwordx4 v168, s[40:41] offset:0
    s_add_u32 m0, s70, 17408
    s_nop 0
    global_load_lds_dwordx4 v169, s[40:41] offset:0
    s_waitcnt lgkmcnt(4)
    v_mfma_f32_16x16x32_bf16 v[8:11], v[112:115], v[152:155], v[8:11]
    ds_read_b128 v[128:131], v188 offset:0
    ds_read_b128 v[132:135], v188 offset:2048
    ds_read_b128 v[136:139], v188 offset:4096
    ds_read_b128 v[140:143], v188 offset:6144
    ds_read_b128 v[148:151], v177 offset:0
    v_mfma_f32_16x16x32_bf16 v[36:39], v[116:119], v[152:155], v[36:39]
    v_mfma_f32_16x16x32_bf16 v[64:67], v[120:123], v[152:155], v[64:67]
    v_mfma_f32_16x16x32_bf16 v[92:95], v[124:127], v[152:155], v[92:95]
    s_add_u32 m0, s70, 18432
    s_nop 0
    global_load_lds_dwordx4 v168, s[42:43] offset:0
    s_add_u32 m0, s70, 19456
    s_nop 0
    global_load_lds_dwordx4 v169, s[42:43] offset:0
    s_waitcnt lgkmcnt(8)
    v_mfma_f32_16x16x32_bf16 v[12:15], v[112:115], v[156:159], v[12:15]
    ds_read_b128 v[152:155], v177 offset:2048
    v_mfma_f32_16x16x32_bf16 v[40:43], v[116:119], v[156:159], v[40:43]
    v_mfma_f32_16x16x32_bf16 v[68:71], v[120:123], v[156:159], v[68:71]
    v_mfma_f32_16x16x32_bf16 v[96:99], v[124:127], v[156:159], v[96:99]
    s_add_u32 m0, s70, 20480
    s_nop 0
    global_load_lds_dwordx4 v168, s[44:45] offset:0
    s_add_u32 m0, s70, 21504
    s_nop 0
    global_load_lds_dwordx4 v169, s[44:45] offset:0
    s_waitcnt lgkmcnt(8)
    v_mfma_f32_16x16x32_bf16 v[16:19], v[112:115], v[160:163], v[16:19]
    ds_read_b128 v[156:159], v177 offset:4096
    v_mfma_f32_16x16x32_bf16 v[44:47], v[116:119], v[160:163], v[44:47]
    v_mfma_f32_16x16x32_bf16 v[72:75], v[120:123], v[160:163], v[72:75]
    v_mfma_f32_16x16x32_bf16 v[100:103], v[124:127], v[160:163], v[100:103]
    s_add_u32 m0, s70, 22528
    s_nop 0
    global_load_lds_dwordx4 v168, s[46:47] offset:0
    s_add_u32 m0, s70, 23552
    s_nop 0
    global_load_lds_dwordx4 v169, s[46:47] offset:0
    s_waitcnt lgkmcnt(8)
    v_mfma_f32_16x16x32_bf16 v[20:23], v[112:115], v[164:167], v[20:23]
    ds_read_b128 v[160:163], v177 offset:6144
    v_mfma_f32_16x16x32_bf16 v[48:51], v[116:119], v[164:167], v[48:51]
    v_mfma_f32_16x16x32_bf16 v[76:79], v[120:123], v[164:167], v[76:79]
    v_mfma_f32_16x16x32_bf16 v[104:107], v[124:127], v[164:167], v[104:107]
    s_waitcnt lgkmcnt(8)
    v_mfma_f32_16x16x32_bf16 v[24:27], v[112:115], v[144:147], v[24:27]
    ds_read_b128 v[164:167], v177 offset:8192
    v_mfma_f32_16x16x32_bf16 v[52:55], v[116:119], v[144:147], v[52:55]
    v_mfma_f32_16x16x32_bf16 v[80:83], v[120:123], v[144:147], v[80:83]
    v_mfma_f32_16x16x32_bf16 v[108:111], v[124:127], v[144:147], v[108:111]
    s_waitcnt lgkmcnt(4)
    v_mfma_f32_16x16x32_bf16 v[0:3], v[128:131], v[148:151], v[0:3]
    ds_read_b128 v[144:147], v177 offset:10240
    v_mfma_f32_16x16x32_bf16 v[28:31], v[132:135], v[148:151], v[28:31]
    v_mfma_f32_16x16x32_bf16 v[56:59], v[136:139], v[148:151], v[56:59]
    v_mfma_f32_16x16x32_bf16 v[84:87], v[140:143], v[148:151], v[84:87]
    s_waitcnt lgkmcnt(4)
    v_mfma_f32_16x16x32_bf16 v[4:7], v[128:131], v[152:155], v[4:7]
    ds_read_b128 v[148:151], v177 offset:12288
    v_mfma_f32_16x16x32_bf16 v[32:35], v[132:135], v[152:155], v[32:35]
    v_mfma_f32_16x16x32_bf16 v[60:63], v[136:139], v[152:155], v[60:63]
    v_mfma_f32_16x16x32_bf16 v[88:91], v[140:143], v[152:155], v[88:91]
    s_waitcnt lgkmcnt(4)
    v_mfma_f32_16x16x32_bf16 v[8:11], v[128:131], v[156:159], v[8:11]
    v_mfma_f32_16x16x32_bf16 v[36:39], v[132:135], v[156:159], v[36:39]
    v_mfma_f32_16x16x32_bf16 v[64:67], v[136:139], v[156:159], v[64:67]
    v_mfma_f32_16x16x32_bf16 v[92:95], v[140:143], v[156:159], v[92:95]
    s_waitcnt lgkmcnt(3)
    v_mfma_f32_16x16x32_bf16 v[12:15], v[128:131], v[160:163], v[12:15]
    v_mfma_f32_16x16x32_bf16 v[40:43], v[132:135], v[160:163], v[40:43]
    v_mfma_f32_16x16x32_bf16 v[68:71], v[136:139], v[160:163], v[68:71]
    v_mfma_f32_16x16x32_bf16 v[96:99], v[140:143], v[160:163], v[96:99]
    s_waitcnt lgkmcnt(2)
    v_mfma_f32_16x16x32_bf16 v[16:19], v[128:131], v[164:167], v[16:19]
    v_mfma_f32_16x16x32_bf16 v[44:47], v[132:135], v[164:167], v[44:47]
    v_mfma_f32_16x16x32_bf16 v[72:75], v[136:139], v[164:167], v[72:75]
    v_mfma_f32_16x16x32_bf16 v[100:103], v[140:143], v[164:167], v[100:103]
    s_waitcnt lgkmcnt(1)
    v_mfma_f32_16x16x32_bf16 v[20:23], v[128:131], v[144:147], v[20:23]
    v_mfma_f32_16x16x32_bf16 v[48:51], v[132:135], v[144:147], v[48:51]
    v_mfma_f32_16x16x32_bf16 v[76:79], v[136:139], v[144:147], v[76:79]
    v_mfma_f32_16x16x32_bf16 v[104:107], v[140:143], v[144:147], v[104:107]
    s_waitcnt lgkmcnt(0)
    v_mfma_f32_16x16x32_bf16 v[24:27], v[128:131], v[148:151], v[24:27]
    v_mfma_f32_16x16x32_bf16 v[52:55], v[132:135], v[148:151], v[52:55]
    v_mfma_f32_16x16x32_bf16 v[80:83], v[136:139], v[148:151], v[80:83]
    v_mfma_f32_16x16x32_bf16 v[108:111], v[140:143], v[148:151], v[108:111]
    s_waitcnt vmcnt(10)
    s_barrier
    ds_read_b128 v[112:115], v187 offset:8192
    ds_read_b128 v[116:119], v187 offset:10240
    ds_read_b128 v[120:123], v187 offset:12288
    ds_read_b128 v[124:127], v187 offset:14336
    ds_read_b128 v[152:155], v176 offset:14336
    ds_read_b128 v[156:159], v176 offset:16384
    ds_read_b128 v[160:163], v176 offset:18432
    ds_read_b128 v[164:167], v176 offset:20480
    ds_read_b128 v[144:147], v176 offset:22528
    s_waitcnt lgkmcnt(4)
    v_mfma_f32_16x16x32_bf16 v[0:3], v[112:115], v[152:155], v[0:3]
    ds_read_b128 v[148:151], v176 offset:24576
    v_mfma_f32_16x16x32_bf16 v[28:31], v[116:119], v[152:155], v[28:31]
    v_mfma_f32_16x16x32_bf16 v[56:59], v[120:123], v[152:155], v[56:59]
    v_mfma_f32_16x16x32_bf16 v[84:87], v[124:127], v[152:155], v[84:87]
    v_xor_b32 v170, 128, v170
    v_xor_b32 v171, 128, v171
    s_add_u32 m0, s84, 43008
    s_nop 0
    global_load_lds_dwordx4 v170, s[48:49] offset:0
    s_add_u32 m0, s84, 44032
    s_nop 0
    global_load_lds_dwordx4 v171, s[48:49] offset:0
    s_waitcnt lgkmcnt(4)
    v_mfma_f32_16x16x32_bf16 v[4:7], v[112:115], v[156:159], v[4:7]
    ds_read_b128 v[152:155], v176 offset:26624
    v_mfma_f32_16x16x32_bf16 v[32:35], v[116:119], v[156:159], v[32:35]
    v_mfma_f32_16x16x32_bf16 v[60:63], v[120:123], v[156:159], v[60:63]
    v_mfma_f32_16x16x32_bf16 v[88:91], v[124:127], v[156:159], v[88:91]
    v_xor_b32 v168, 128, v168
    v_xor_b32 v169, 128, v169
    s_add_u32 m0, s70, 0
    s_nop 0
    global_load_lds_dwordx4 v168, s[40:41] offset:0
    s_add_u32 m0, s70, 1024
    s_nop 0
    global_load_lds_dwordx4 v169, s[40:41] offset:0
    s_waitcnt lgkmcnt(4)
    v_mfma_f32_16x16x32_bf16 v[8:11], v[112:115], v[160:163], v[8:11]
    ds_read_b128 v[128:131], v188 offset:8192
    ds_read_b128 v[132:135], v188 offset:10240
    ds_read_b128 v[136:139], v188 offset:12288
    ds_read_b128 v[140:143], v188 offset:14336
    ds_read_b128 v[156:159], v177 offset:14336
    v_mfma_f32_16x16x32_bf16 v[36:39], v[116:119], v[160:163], v[36:39]
    v_mfma_f32_16x16x32_bf16 v[64:67], v[120:123], v[160:163], v[64:67]
    v_mfma_f32_16x16x32_bf16 v[92:95], v[124:127], v[160:163], v[92:95]
    s_add_u32 m0, s70, 2048
    s_nop 0
    global_load_lds_dwordx4 v168, s[42:43] offset:0
    s_add_u32 m0, s70, 3072
    s_nop 0
    global_load_lds_dwordx4 v169, s[42:43] offset:0
    s_waitcnt lgkmcnt(8)
    v_mfma_f32_16x16x32_bf16 v[12:15], v[112:115], v[164:167], v[12:15]
    ds_read_b128 v[160:163], v177 offset:16384
    v_mfma_f32_16x16x32_bf16 v[40:43], v[116:119], v[164:167], v[40:43]
    v_mfma_f32_16x16x32_bf16 v[68:71], v[120:123], v[164:167], v[68:71]
    v_mfma_f32_16x16x32_bf16 v[96:99], v[124:127], v[164:167], v[96:99]
    s_add_u32 m0, s70, 4096
    s_nop 0
    global_load_lds_dwordx4 v168, s[44:45] offset:0
    s_add_u32 m0, s70, 5120
    s_nop 0
    global_load_lds_dwordx4 v169, s[44:45] offset:0
    s_waitcnt lgkmcnt(8)
    v_mfma_f32_16x16x32_bf16 v[16:19], v[112:115], v[144:147], v[16:19]
    ds_read_b128 v[164:167], v177 offset:18432
    v_mfma_f32_16x16x32_bf16 v[44:47], v[116:119], v[144:147], v[44:47]
    v_mfma_f32_16x16x32_bf16 v[72:75], v[120:123], v[144:147], v[72:75]
    v_mfma_f32_16x16x32_bf16 v[100:103], v[124:127], v[144:147], v[100:103]
    s_add_u32 m0, s70, 6144
    s_nop 0
    global_load_lds_dwordx4 v168, s[46:47] offset:0
    s_add_u32 m0, s70, 7168
    s_nop 0
    global_load_lds_dwordx4 v169, s[46:47] offset:0
    s_waitcnt lgkmcnt(8)
    v_mfma_f32_16x16x32_bf16 v[20:23], v[112:115], v[148:151], v[20:23]
    ds_read_b128 v[144:147], v177 offset:20480
    v_mfma_f32_16x16x32_bf16 v[48:51], v[116:119], v[148:151], v[48:51]
    v_mfma_f32_16x16x32_bf16 v[76:79], v[120:123], v[148:151], v[76:79]
    v_mfma_f32_16x16x32_bf16 v[104:107], v[124:127], v[148:151], v[104:107]
    s_waitcnt lgkmcnt(8)
    v_mfma_f32_16x16x32_bf16 v[24:27], v[112:115], v[152:155], v[24:27]
    ds_read_b128 v[148:151], v177 offset:22528
    v_mfma_f32_16x16x32_bf16 v[52:55], v[116:119], v[152:155], v[52:55]
    v_mfma_f32_16x16x32_bf16 v[80:83], v[120:123], v[152:155], v[80:83]
    v_mfma_f32_16x16x32_bf16 v[108:111], v[124:127], v[152:155], v[108:111]
    s_waitcnt lgkmcnt(4)
    v_mfma_f32_16x16x32_bf16 v[0:3], v[128:131], v[156:159], v[0:3]
    ds_read_b128 v[152:155], v177 offset:24576
    v_mfma_f32_16x16x32_bf16 v[28:31], v[132:135], v[156:159], v[28:31]
    v_mfma_f32_16x16x32_bf16 v[56:59], v[136:139], v[156:159], v[56:59]
    v_mfma_f32_16x16x32_bf16 v[84:87], v[140:143], v[156:159], v[84:87]
    s_waitcnt lgkmcnt(4)
    v_mfma_f32_16x16x32_bf16 v[4:7], v[128:131], v[160:163], v[4:7]
    ds_read_b128 v[156:159], v177 offset:26624
    v_mfma_f32_16x16x32_bf16 v[32:35], v[132:135], v[160:163], v[32:35]
    v_mfma_f32_16x16x32_bf16 v[60:63], v[136:139], v[160:163], v[60:63]
    v_mfma_f32_16x16x32_bf16 v[88:91], v[140:143], v[160:163], v[88:91]
    s_waitcnt lgkmcnt(4)
    v_mfma_f32_16x16x32_bf16 v[8:11], v[128:131], v[164:167], v[8:11]
    v_mfma_f32_16x16x32_bf16 v[36:39], v[132:135], v[164:167], v[36:39]
    v_mfma_f32_16x16x32_bf16 v[64:67], v[136:139], v[164:167], v[64:67]
    v_mfma_f32_16x16x32_bf16 v[92:95], v[140:143], v[164:167], v[92:95]
    s_waitcnt lgkmcnt(3)
    v_mfma_f32_16x16x32_bf16 v[12:15], v[128:131], v[144:147], v[12:15]
    v_mfma_f32_16x16x32_bf16 v[40:43], v[132:135], v[144:147], v[40:43]
    v_mfma_f32_16x16x32_bf16 v[68:71], v[136:139], v[144:147], v[68:71]
    v_mfma_f32_16x16x32_bf16 v[96:99], v[140:143], v[144:147], v[96:99]
    s_waitcnt lgkmcnt(2)
    v_mfma_f32_16x16x32_bf16 v[16:19], v[128:131], v[148:151], v[16:19]
    v_mfma_f32_16x16x32_bf16 v[44:47], v[132:135], v[148:151], v[44:47]
    v_mfma_f32_16x16x32_bf16 v[72:75], v[136:139], v[148:151], v[72:75]
    v_mfma_f32_16x16x32_bf16 v[100:103], v[140:143], v[148:151], v[100:103]
    s_waitcnt lgkmcnt(1)
    v_mfma_f32_16x16x32_bf16 v[20:23], v[128:131], v[152:155], v[20:23]
    v_mfma_f32_16x16x32_bf16 v[48:51], v[132:135], v[152:155], v[48:51]
    v_mfma_f32_16x16x32_bf16 v[76:79], v[136:139], v[152:155], v[76:79]
    v_mfma_f32_16x16x32_bf16 v[104:107], v[140:143], v[152:155], v[104:107]
    s_waitcnt lgkmcnt(0)
    v_mfma_f32_16x16x32_bf16 v[24:27], v[128:131], v[156:159], v[24:27]
    v_mfma_f32_16x16x32_bf16 v[52:55], v[132:135], v[156:159], v[52:55]
    v_mfma_f32_16x16x32_bf16 v[80:83], v[136:139], v[156:159], v[80:83]
    v_mfma_f32_16x16x32_bf16 v[108:111], v[140:143], v[156:159], v[108:111]
    s_waitcnt vmcnt(10)
    s_barrier
    ds_read_b128 v[112:115], v187 offset:16384
    ds_read_b128 v[116:119], v187 offset:18432
    ds_read_b128 v[120:123], v187 offset:20480
    ds_read_b128 v[124:127], v187 offset:22528
    ds_read_b128 v[160:163], v176 offset:28672
    ds_read_b128 v[164:167], v176 offset:30720
    ds_read_b128 v[144:147], v176 offset:32768
    ds_read_b128 v[148:151], v176 offset:34816
    ds_read_b128 v[152:155], v176 offset:36864
    s_waitcnt lgkmcnt(4)
    v_mfma_f32_16x16x32_bf16 v[0:3], v[112:115], v[160:163], v[0:3]
    ds_read_b128 v[156:159], v176 offset:38912
    v_mfma_f32_16x16x32_bf16 v[28:31], v[116:119], v[160:163], v[28:31]
    v_mfma_f32_16x16x32_bf16 v[56:59], v[120:123], v[160:163], v[56:59]
    v_mfma_f32_16x16x32_bf16 v[84:87], v[124:127], v[160:163], v[84:87]
    s_waitcnt lgkmcnt(4)
    v_mfma_f32_16x16x32_bf16 v[4:7], v[112:115], v[164:167], v[4:7]
    ds_read_b128 v[160:163], v176 offset:40960
    v_mfma_f32_16x16x32_bf16 v[32:35], v[116:119], v[164:167], v[32:35]
    v_mfma_f32_16x16x32_bf16 v[60:63], v[120:123], v[164:167], v[60:63]
    v_mfma_f32_16x16x32_bf16 v[88:91], v[124:127], v[164:167], v[88:91]
    s_waitcnt lgkmcnt(4)
    v_mfma_f32_16x16x32_bf16 v[8:11], v[112:115], v[144:147], v[8:11]
    ds_read_b128 v[128:131], v188 offset:16384
    ds_read_b128 v[132:135], v188 offset:18432
    ds_read_b128 v[136:139], v188 offset:20480
    ds_read_b128 v[140:143], v188 offset:22528
    ds_read_b128 v[164:167], v177 offset:28672
    v_mfma_f32_16x16x32_bf16 v[36:39], v[116:119], v[144:147], v[36:39]
    v_mfma_f32_16x16x32_bf16 v[64:67], v[120:123], v[144:147], v[64:67]
    v_mfma_f32_16x16x32_bf16 v[92:95], v[124:127], v[144:147], v[92:95]
    s_waitcnt lgkmcnt(8)
    v_mfma_f32_16x16x32_bf16 v[12:15], v[112:115], v[148:151], v[12:15]
    ds_read_b128 v[144:147], v177 offset:30720
    v_mfma_f32_16x16x32_bf16 v[40:43], v[116:119], v[148:151], v[40:43]
    v_mfma_f32_16x16x32_bf16 v[68:71], v[120:123], v[148:151], v[68:71]
    v_mfma_f32_16x16x32_bf16 v[96:99], v[124:127], v[148:151], v[96:99]
    s_waitcnt lgkmcnt(8)
    v_mfma_f32_16x16x32_bf16 v[16:19], v[112:115], v[152:155], v[16:19]
    ds_read_b128 v[148:151], v177 offset:32768
    v_mfma_f32_16x16x32_bf16 v[44:47], v[116:119], v[152:155], v[44:47]
    v_mfma_f32_16x16x32_bf16 v[72:75], v[120:123], v[152:155], v[72:75]
    v_mfma_f32_16x16x32_bf16 v[100:103], v[124:127], v[152:155], v[100:103]
    s_waitcnt lgkmcnt(8)
    v_mfma_f32_16x16x32_bf16 v[20:23], v[112:115], v[156:159], v[20:23]
    ds_read_b128 v[152:155], v177 offset:34816
    v_mfma_f32_16x16x32_bf16 v[48:51], v[116:119], v[156:159], v[48:51]
    v_mfma_f32_16x16x32_bf16 v[76:79], v[120:123], v[156:159], v[76:79]
    v_mfma_f32_16x16x32_bf16 v[104:107], v[124:127], v[156:159], v[104:107]
    s_waitcnt lgkmcnt(8)
    v_mfma_f32_16x16x32_bf16 v[24:27], v[112:115], v[160:163], v[24:27]
    ds_read_b128 v[156:159], v177 offset:36864
    v_mfma_f32_16x16x32_bf16 v[52:55], v[116:119], v[160:163], v[52:55]
    v_mfma_f32_16x16x32_bf16 v[80:83], v[120:123], v[160:163], v[80:83]
    v_mfma_f32_16x16x32_bf16 v[108:111], v[124:127], v[160:163], v[108:111]
    s_waitcnt lgkmcnt(4)
    v_mfma_f32_16x16x32_bf16 v[0:3], v[128:131], v[164:167], v[0:3]
    ds_read_b128 v[160:163], v177 offset:38912
    v_mfma_f32_16x16x32_bf16 v[28:31], v[132:135], v[164:167], v[28:31]
    v_mfma_f32_16x16x32_bf16 v[56:59], v[136:139], v[164:167], v[56:59]
    v_mfma_f32_16x16x32_bf16 v[84:87], v[140:143], v[164:167], v[84:87]
    s_waitcnt lgkmcnt(4)
    v_mfma_f32_16x16x32_bf16 v[4:7], v[128:131], v[144:147], v[4:7]
    ds_read_b128 v[164:167], v177 offset:40960
    v_mfma_f32_16x16x32_bf16 v[32:35], v[132:135], v[144:147], v[32:35]
    v_mfma_f32_16x16x32_bf16 v[60:63], v[136:139], v[144:147], v[60:63]
    v_mfma_f32_16x16x32_bf16 v[88:91], v[140:143], v[144:147], v[88:91]
    s_waitcnt lgkmcnt(4)
    v_mfma_f32_16x16x32_bf16 v[8:11], v[128:131], v[148:151], v[8:11]
    v_mfma_f32_16x16x32_bf16 v[36:39], v[132:135], v[148:151], v[36:39]
    v_mfma_f32_16x16x32_bf16 v[64:67], v[136:139], v[148:151], v[64:67]
    v_mfma_f32_16x16x32_bf16 v[92:95], v[140:143], v[148:151], v[92:95]
    s_waitcnt lgkmcnt(3)
    v_mfma_f32_16x16x32_bf16 v[12:15], v[128:131], v[152:155], v[12:15]
    v_mfma_f32_16x16x32_bf16 v[40:43], v[132:135], v[152:155], v[40:43]
    v_mfma_f32_16x16x32_bf16 v[68:71], v[136:139], v[152:155], v[68:71]
    v_mfma_f32_16x16x32_bf16 v[96:99], v[140:143], v[152:155], v[96:99]
    s_waitcnt lgkmcnt(2)
    v_mfma_f32_16x16x32_bf16 v[16:19], v[128:131], v[156:159], v[16:19]
    v_mfma_f32_16x16x32_bf16 v[44:47], v[132:135], v[156:159], v[44:47]
    v_mfma_f32_16x16x32_bf16 v[72:75], v[136:139], v[156:159], v[72:75]
    v_mfma_f32_16x16x32_bf16 v[100:103], v[140:143], v[156:159], v[100:103]
    s_waitcnt lgkmcnt(1)
    v_mfma_f32_16x16x32_bf16 v[20:23], v[128:131], v[160:163], v[20:23]
    v_mfma_f32_16x16x32_bf16 v[48:51], v[132:135], v[160:163], v[48:51]
    v_mfma_f32_16x16x32_bf16 v[76:79], v[136:139], v[160:163], v[76:79]
    v_mfma_f32_16x16x32_bf16 v[104:107], v[140:143], v[160:163], v[104:107]
    s_waitcnt lgkmcnt(0)
    v_mfma_f32_16x16x32_bf16 v[24:27], v[128:131], v[164:167], v[24:27]
    v_mfma_f32_16x16x32_bf16 v[52:55], v[132:135], v[164:167], v[52:55]
    v_mfma_f32_16x16x32_bf16 v[80:83], v[136:139], v[164:167], v[80:83]
    v_mfma_f32_16x16x32_bf16 v[108:111], v[140:143], v[164:167], v[108:111]
    s_waitcnt vmcnt(0)
    s_barrier
    v_mov_b32 v185, 143360
    ds_read_b32 v185, v185
    ds_read_b128 v[112:115], v187 offset:0
    ds_read_b128 v[116:119], v187 offset:2048
    ds_read_b128 v[120:123], v187 offset:4096
    ds_read_b128 v[124:127], v187 offset:6144
    ds_read_b128 v[144:147], v176 offset:43008
    ds_read_b128 v[148:151], v176 offset:45056
    ds_read_b128 v[152:155], v176 offset:47104
    ds_read_b128 v[156:159], v176 offset:49152
    ds_read_b128 v[160:163], v176 offset:51200
    s_waitcnt lgkmcnt(4)
    v_mfma_f32_16x16x32_bf16 v[0:3], v[112:115], v[144:147], v[0:3]
    ds_read_b128 v[164:167], v176 offset:53248
    v_mfma_f32_16x16x32_bf16 v[28:31], v[116:119], v[144:147], v[28:31]
    v_mfma_f32_16x16x32_bf16 v[56:59], v[120:123], v[144:147], v[56:59]
    v_mfma_f32_16x16x32_bf16 v[84:87], v[124:127], v[144:147], v[84:87]
    s_waitcnt lgkmcnt(4)
    v_mfma_f32_16x16x32_bf16 v[4:7], v[112:115], v[148:151], v[4:7]
    ds_read_b128 v[144:147], v176 offset:55296
    v_mfma_f32_16x16x32_bf16 v[32:35], v[116:119], v[148:151], v[32:35]
    v_mfma_f32_16x16x32_bf16 v[60:63], v[120:123], v[148:151], v[60:63]
    v_mfma_f32_16x16x32_bf16 v[88:91], v[124:127], v[148:151], v[88:91]
    s_waitcnt lgkmcnt(4)
    v_mfma_f32_16x16x32_bf16 v[8:11], v[112:115], v[152:155], v[8:11]
    ds_read_b128 v[128:131], v188 offset:0
    ds_read_b128 v[132:135], v188 offset:2048
    ds_read_b128 v[136:139], v188 offset:4096
    ds_read_b128 v[140:143], v188 offset:6144
    ds_read_b128 v[148:151], v177 offset:43008
    v_mfma_f32_16x16x32_bf16 v[36:39], v[116:119], v[152:155], v[36:39]
    v_mfma_f32_16x16x32_bf16 v[64:67], v[120:123], v[152:155], v[64:67]
    v_mfma_f32_16x16x32_bf16 v[92:95], v[124:127], v[152:155], v[92:95]
    s_waitcnt lgkmcnt(8)
    v_mfma_f32_16x16x32_bf16 v[12:15], v[112:115], v[156:159], v[12:15]
    ds_read_b128 v[152:155], v177 offset:45056
    v_mfma_f32_16x16x32_bf16 v[40:43], v[116:119], v[156:159], v[40:43]
    v_mfma_f32_16x16x32_bf16 v[68:71], v[120:123], v[156:159], v[68:71]
    v_mfma_f32_16x16x32_bf16 v[96:99], v[124:127], v[156:159], v[96:99]
    s_waitcnt lgkmcnt(8)
    v_mfma_f32_16x16x32_bf16 v[16:19], v[112:115], v[160:163], v[16:19]
    ds_read_b128 v[156:159], v177 offset:47104
    v_mfma_f32_16x16x32_bf16 v[44:47], v[116:119], v[160:163], v[44:47]
    v_mfma_f32_16x16x32_bf16 v[72:75], v[120:123], v[160:163], v[72:75]
    v_mfma_f32_16x16x32_bf16 v[100:103], v[124:127], v[160:163], v[100:103]
    s_waitcnt lgkmcnt(8)
    v_mfma_f32_16x16x32_bf16 v[20:23], v[112:115], v[164:167], v[20:23]
    ds_read_b128 v[160:163], v177 offset:49152
    v_mfma_f32_16x16x32_bf16 v[48:51], v[116:119], v[164:167], v[48:51]
    v_mfma_f32_16x16x32_bf16 v[76:79], v[120:123], v[164:167], v[76:79]
    v_mfma_f32_16x16x32_bf16 v[104:107], v[124:127], v[164:167], v[104:107]
    s_waitcnt lgkmcnt(8)
    v_mfma_f32_16x16x32_bf16 v[24:27], v[112:115], v[144:147], v[24:27]
    ds_read_b128 v[164:167], v177 offset:51200
    v_mfma_f32_16x16x32_bf16 v[52:55], v[116:119], v[144:147], v[52:55]
    v_mfma_f32_16x16x32_bf16 v[80:83], v[120:123], v[144:147], v[80:83]
    v_mfma_f32_16x16x32_bf16 v[108:111], v[124:127], v[144:147], v[108:111]
    s_waitcnt lgkmcnt(4)
    v_mfma_f32_16x16x32_bf16 v[0:3], v[128:131], v[148:151], v[0:3]
    ds_read_b128 v[144:147], v177 offset:53248
    v_mfma_f32_16x16x32_bf16 v[28:31], v[132:135], v[148:151], v[28:31]
    v_mfma_f32_16x16x32_bf16 v[56:59], v[136:139], v[148:151], v[56:59]
    v_mfma_f32_16x16x32_bf16 v[84:87], v[140:143], v[148:151], v[84:87]
    s_waitcnt lgkmcnt(4)
    v_mfma_f32_16x16x32_bf16 v[4:7], v[128:131], v[152:155], v[4:7]
    ds_read_b128 v[148:151], v177 offset:55296
    v_mfma_f32_16x16x32_bf16 v[32:35], v[132:135], v[152:155], v[32:35]
    v_mfma_f32_16x16x32_bf16 v[60:63], v[136:139], v[152:155], v[60:63]
    v_mfma_f32_16x16x32_bf16 v[88:91], v[140:143], v[152:155], v[88:91]
    s_waitcnt lgkmcnt(4)
    v_mfma_f32_16x16x32_bf16 v[8:11], v[128:131], v[156:159], v[8:11]
    v_mfma_f32_16x16x32_bf16 v[36:39], v[132:135], v[156:159], v[36:39]
    v_mfma_f32_16x16x32_bf16 v[64:67], v[136:139], v[156:159], v[64:67]
    v_mfma_f32_16x16x32_bf16 v[92:95], v[140:143], v[156:159], v[92:95]
    s_waitcnt lgkmcnt(3)
    v_mfma_f32_16x16x32_bf16 v[12:15], v[128:131], v[160:163], v[12:15]
    v_mfma_f32_16x16x32_bf16 v[40:43], v[132:135], v[160:163], v[40:43]
    v_mfma_f32_16x16x32_bf16 v[68:71], v[136:139], v[160:163], v[68:71]
    v_mfma_f32_16x16x32_bf16 v[96:99], v[140:143], v[160:163], v[96:99]
    s_waitcnt lgkmcnt(2)
    v_mfma_f32_16x16x32_bf16 v[16:19], v[128:131], v[164:167], v[16:19]
    v_mfma_f32_16x16x32_bf16 v[44:47], v[132:135], v[164:167], v[44:47]
    v_mfma_f32_16x16x32_bf16 v[72:75], v[136:139], v[164:167], v[72:75]
    v_mfma_f32_16x16x32_bf16 v[100:103], v[140:143], v[164:167], v[100:103]
    s_waitcnt lgkmcnt(1)
    v_mfma_f32_16x16x32_bf16 v[20:23], v[128:131], v[144:147], v[20:23]
    v_mfma_f32_16x16x32_bf16 v[48:51], v[132:135], v[144:147], v[48:51]
    v_mfma_f32_16x16x32_bf16 v[76:79], v[136:139], v[144:147], v[76:79]
    v_mfma_f32_16x16x32_bf16 v[104:107], v[140:143], v[144:147], v[104:107]
    s_waitcnt lgkmcnt(0)
    v_mfma_f32_16x16x32_bf16 v[24:27], v[128:131], v[148:151], v[24:27]
    v_mfma_f32_16x16x32_bf16 v[52:55], v[132:135], v[148:151], v[52:55]
    v_mfma_f32_16x16x32_bf16 v[80:83], v[136:139], v[148:151], v[80:83]
    v_mfma_f32_16x16x32_bf16 v[108:111], v[140:143], v[148:151], v[108:111]
    s_nop 7
    s_mov_b32 s80, 1035512379
    v_readfirstlane_b32 s32, v185
    v_mul_f32 v0, s80, v0
    v_mul_f32 v1, s80, v1
    v_mul_f32 v2, s80, v2
    v_mul_f32 v3, s80, v3
    v_mul_f32 v28, s80, v28
    v_mul_f32 v29, s80, v29
    v_mul_f32 v30, s80, v30
    v_mul_f32 v31, s80, v31
    v_cvt_pk_bf16_f32 v0, v0, v1
    v_cvt_pk_bf16_f32 v1, v2, v3
    v_cvt_pk_bf16_f32 v2, v28, v29
    v_cvt_pk_bf16_f32 v3, v30, v31
    global_store_dwordx4 v184, v[0:3], s[56:57] offset:0 sc1
    v_mul_f32 v56, s80, v56
    v_mul_f32 v57, s80, v57
    v_mul_f32 v58, s80, v58
    v_mul_f32 v59, s80, v59
    v_mul_f32 v84, s80, v84
    v_mul_f32 v85, s80, v85
    v_mul_f32 v86, s80, v86
    v_mul_f32 v87, s80, v87
    v_cvt_pk_bf16_f32 v56, v56, v57
    v_cvt_pk_bf16_f32 v57, v58, v59
    v_cvt_pk_bf16_f32 v58, v84, v85
    v_cvt_pk_bf16_f32 v59, v86, v87
    global_store_dwordx4 v184, v[56:59], s[56:57] offset:1024 sc1
    v_mul_f32 v4, s80, v4
    v_mul_f32 v5, s80, v5
    v_mul_f32 v6, s80, v6
    v_mul_f32 v7, s80, v7
    v_mul_f32 v32, s80, v32
    v_mul_f32 v33, s80, v33
    v_mul_f32 v34, s80, v34
    v_mul_f32 v35, s80, v35
    v_cvt_pk_bf16_f32 v4, v4, v5
    v_cvt_pk_bf16_f32 v5, v6, v7
    v_cvt_pk_bf16_f32 v6, v32, v33
    v_cvt_pk_bf16_f32 v7, v34, v35
    global_store_dwordx4 v184, v[4:7], s[58:59] offset:0 sc1
    v_mul_f32 v60, s80, v60
    v_mul_f32 v61, s80, v61
    v_mul_f32 v62, s80, v62
    v_mul_f32 v63, s80, v63
    v_mul_f32 v88, s80, v88
    v_mul_f32 v89, s80, v89
    v_mul_f32 v90, s80, v90
    v_mul_f32 v91, s80, v91
    v_cvt_pk_bf16_f32 v60, v60, v61
    v_cvt_pk_bf16_f32 v61, v62, v63
    v_cvt_pk_bf16_f32 v62, v88, v89
    v_cvt_pk_bf16_f32 v63, v90, v91
    global_store_dwordx4 v184, v[60:63], s[58:59] offset:1024 sc1
    v_mul_f32 v8, s80, v8
    v_mul_f32 v9, s80, v9
    v_mul_f32 v10, s80, v10
    v_mul_f32 v11, s80, v11
    v_mul_f32 v36, s80, v36
    v_mul_f32 v37, s80, v37
    v_mul_f32 v38, s80, v38
    v_mul_f32 v39, s80, v39
    v_cvt_pk_bf16_f32 v8, v8, v9
    v_cvt_pk_bf16_f32 v9, v10, v11
    v_cvt_pk_bf16_f32 v10, v36, v37
    v_cvt_pk_bf16_f32 v11, v38, v39
    global_store_dwordx4 v184, v[8:11], s[60:61] offset:0 sc1
    v_mul_f32 v64, s80, v64
    v_mul_f32 v65, s80, v65
    v_mul_f32 v66, s80, v66
    v_mul_f32 v67, s80, v67
    v_mul_f32 v92, s80, v92
    v_mul_f32 v93, s80, v93
    v_mul_f32 v94, s80, v94
    v_mul_f32 v95, s80, v95
    v_cvt_pk_bf16_f32 v64, v64, v65
    v_cvt_pk_bf16_f32 v65, v66, v67
    v_cvt_pk_bf16_f32 v66, v92, v93
    v_cvt_pk_bf16_f32 v67, v94, v95
    global_store_dwordx4 v184, v[64:67], s[60:61] offset:1024 sc1
    v_mul_f32 v12, s80, v12
    v_mul_f32 v13, s80, v13
    v_mul_f32 v14, s80, v14
    v_mul_f32 v15, s80, v15
    v_mul_f32 v40, s80, v40
    v_mul_f32 v41, s80, v41
    v_mul_f32 v42, s80, v42
    v_mul_f32 v43, s80, v43
    v_cvt_pk_bf16_f32 v12, v12, v13
    v_cvt_pk_bf16_f32 v13, v14, v15
    v_cvt_pk_bf16_f32 v14, v40, v41
    v_cvt_pk_bf16_f32 v15, v42, v43
    global_store_dwordx4 v184, v[12:15], s[62:63] offset:0 sc1
    v_mul_f32 v68, s80, v68
    v_mul_f32 v69, s80, v69
    v_mul_f32 v70, s80, v70
    v_mul_f32 v71, s80, v71
    v_mul_f32 v96, s80, v96
    v_mul_f32 v97, s80, v97
    v_mul_f32 v98, s80, v98
    v_mul_f32 v99, s80, v99
    v_cvt_pk_bf16_f32 v68, v68, v69
    v_cvt_pk_bf16_f32 v69, v70, v71
    v_cvt_pk_bf16_f32 v70, v96, v97
    v_cvt_pk_bf16_f32 v71, v98, v99
    global_store_dwordx4 v184, v[68:71], s[62:63] offset:1024 sc1
    v_mul_f32 v16, s80, v16
    v_mul_f32 v17, s80, v17
    v_mul_f32 v18, s80, v18
    v_mul_f32 v19, s80, v19
    v_mul_f32 v44, s80, v44
    v_mul_f32 v45, s80, v45
    v_mul_f32 v46, s80, v46
    v_mul_f32 v47, s80, v47
    v_cvt_pk_bf16_f32 v16, v16, v17
    v_cvt_pk_bf16_f32 v17, v18, v19
    v_cvt_pk_bf16_f32 v18, v44, v45
    v_cvt_pk_bf16_f32 v19, v46, v47
    global_store_dwordx4 v184, v[16:19], s[64:65] offset:0 sc1
    v_mul_f32 v72, s80, v72
    v_mul_f32 v73, s80, v73
    v_mul_f32 v74, s80, v74
    v_mul_f32 v75, s80, v75
    v_mul_f32 v100, s80, v100
    v_mul_f32 v101, s80, v101
    v_mul_f32 v102, s80, v102
    v_mul_f32 v103, s80, v103
    v_cvt_pk_bf16_f32 v72, v72, v73
    v_cvt_pk_bf16_f32 v73, v74, v75
    v_cvt_pk_bf16_f32 v74, v100, v101
    v_cvt_pk_bf16_f32 v75, v102, v103
    global_store_dwordx4 v184, v[72:75], s[64:65] offset:1024 sc1
    v_mul_f32 v20, s80, v20
    v_mul_f32 v21, s80, v21
    v_mul_f32 v22, s80, v22
    v_mul_f32 v23, s80, v23
    v_mul_f32 v48, s80, v48
    v_mul_f32 v49, s80, v49
    v_mul_f32 v50, s80, v50
    v_mul_f32 v51, s80, v51
    v_cvt_pk_bf16_f32 v20, v20, v21
    v_cvt_pk_bf16_f32 v21, v22, v23
    v_cvt_pk_bf16_f32 v22, v48, v49
    v_cvt_pk_bf16_f32 v23, v50, v51
    global_store_dwordx4 v184, v[20:23], s[66:67] offset:0 sc1
    v_mul_f32 v76, s80, v76
    v_mul_f32 v77, s80, v77
    v_mul_f32 v78, s80, v78
    v_mul_f32 v79, s80, v79
    v_mul_f32 v104, s80, v104
    v_mul_f32 v105, s80, v105
    v_mul_f32 v106, s80, v106
    v_mul_f32 v107, s80, v107
    v_cvt_pk_bf16_f32 v76, v76, v77
    v_cvt_pk_bf16_f32 v77, v78, v79
    v_cvt_pk_bf16_f32 v78, v104, v105
    v_cvt_pk_bf16_f32 v79, v106, v107
    global_store_dwordx4 v184, v[76:79], s[66:67] offset:1024 sc1
    v_mul_f32 v24, s80, v24
    v_mul_f32 v25, s80, v25
    v_mul_f32 v26, s80, v26
    v_mul_f32 v27, s80, v27
    v_mul_f32 v52, s80, v52
    v_mul_f32 v53, s80, v53
    v_mul_f32 v54, s80, v54
    v_mul_f32 v55, s80, v55
    v_cvt_pk_bf16_f32 v24, v24, v25
    v_cvt_pk_bf16_f32 v25, v26, v27
    v_cvt_pk_bf16_f32 v26, v52, v53
    v_cvt_pk_bf16_f32 v27, v54, v55
    global_store_dwordx4 v184, v[24:27], s[68:69] offset:0 sc1
    v_mul_f32 v80, s80, v80
    v_mul_f32 v81, s80, v81
    v_mul_f32 v82, s80, v82
    v_mul_f32 v83, s80, v83
    v_mul_f32 v108, s80, v108
    v_mul_f32 v109, s80, v109
    v_mul_f32 v110, s80, v110
    v_mul_f32 v111, s80, v111
    v_cvt_pk_bf16_f32 v80, v80, v81
    v_cvt_pk_bf16_f32 v81, v82, v83
    v_cvt_pk_bf16_f32 v82, v108, v109
    v_cvt_pk_bf16_f32 v83, v110, v111
    global_store_dwordx4 v184, v[80:83], s[68:69] offset:1024 sc1
    s_branch L_fused
P_A3:
    s_mul_i32 s82, s37, 917504
    s_lshl_b32 s83, s36, 9
    s_add_u32 s82, s82, s83
    v_mov_b32 v170, 0
    v_bfe_u32 v185, v186, 5, 1
    v_lshl_add_u32 v170, v185, 17, v170
    v_bfe_u32 v185, v186, 4, 1
    v_lshl_add_u32 v170, v185, 16, v170
    v_bfe_u32 v185, v186, 3, 1
    v_lshl_add_u32 v170, v185, 14, v170
    v_add_u32 v171, 262144, v170
    v_add_u32 v170, v2, v170
    v_add_u32 v171, v3, v171
    v_mov_b32 v172, 0
    v_bfe_u32 v185, v186, 3, 3
    v_lshl_add_u32 v172, v185, 14, v172
    v_add_u32 v173, 131072, v172
    v_add_u32 v172, v2, v172
    v_add_u32 v173, v3, v173
    v_mov_b32 v174, 0
    v_bfe_u32 v185, v186, 3, 3
    v_lshl_add_u32 v174, v185, 13, v174
    v_add_u32 v175, 65536, v174
    v_add_u32 v174, v2, v174
    v_add_u32 v175, v3, v175
    s_add_u32 s83, s82, 40960
    s_add_u32 s48, s10, s83
    s_addc_u32 s49, s11, 0
    s_add_u32 s83, s82, 524288
    s_add_u32 s50, s10, s83
    s_addc_u32 s51, s11, 0
    s_add_u32 s83, s82, 532480
    s_add_u32 s52, s10, s83
    s_addc_u32 s53, s11, 0
    s_add_u32 s83, s82, 786432
    s_add_u32 s54, s10, s83
    s_addc_u32 s55, s11, 0
    v_xor_b32 v177, 64, v176
    s_lshl_b32 s80, s36, 2
    s_add_u32 s80, s80, s37
    s_mul_i32 s80, s80, 100352
    s_mul_i32 s81, s38, 7168
    s_add_u32 s80, s80, s81
    s_lshl_b32 s81, s31, 11
    s_add_u32 s80, s80, s81
    s_add_u32 s81, s80, 0
    s_add_u32 s56, s28, s81
    s_addc_u32 s57, s29, 0
    s_add_u32 s81, s80, 14336
    s_add_u32 s58, s28, s81
    s_addc_u32 s59, s29, 0
    s_add_u32 s81, s80, 28672
    s_add_u32 s60, s28, s81
    s_addc_u32 s61, s29, 0
    s_add_u32 s81, s80, 43008
    s_add_u32 s62, s28, s81
    s_addc_u32 s63, s29, 0
    s_add_u32 s81, s80, 57344
    s_add_u32 s64, s28, s81
    s_addc_u32 s65, s29, 0
    s_add_u32 s81, s80, 71680
    s_add_u32 s66, s28, s81
    s_addc_u32 s67, s29, 0
    s_add_u32 s81, s80, 86016
    s_add_u32 s68, s28, s81
    s_addc_u32 s69, s29, 0
    s_mov_b32 m0, 6144
    s_nop 0
    global_load_lds_dwordx4 v170, s[48:49] offset:0
    s_mov_b32 m0, 7168
    s_nop 0
    global_load_lds_dwordx4 v171, s[48:49] offset:0
    s_mov_b32 m0, 8192
    s_nop 0
    global_load_lds_dwordx4 v172, s[50:51] offset:0
    s_mov_b32 m0, 9216
    s_nop 0
    global_load_lds_dwordx4 v173, s[50:51] offset:0
    s_mov_b32 m0, 10240
    s_nop 0
    global_load_lds_dwordx4 v172, s[52:53] offset:0
    s_mov_b32 m0, 11264
    s_nop 0
    global_load_lds_dwordx4 v173, s[52:53] offset:0
    s_mov_b32 m0, 12288
    s_nop 0
    global_load_lds_dwordx4 v174, s[54:55] offset:0
    s_mov_b32 m0, 13312
    s_nop 0
    global_load_lds_dwordx4 v175, s[54:55] offset:0
    s_add_u32 m0, s70, 0
    s_nop 0
    global_load_lds_dwordx4 v168, s[40:41] offset:0
    s_add_u32 m0, s70, 1024
    s_nop 0
    global_load_lds_dwordx4 v169, s[40:41] offset:0
    s_add_u32 m0, s70, 2048
    s_nop 0
    global_load_lds_dwordx4 v168, s[42:43] offset:0
    s_add_u32 m0, s70, 3072
    s_nop 0
    global_load_lds_dwordx4 v169, s[42:43] offset:0
    v_xor_b32 v170, 128, v170
    v_xor_b32 v171, 128, v171
    v_xor_b32 v172, 128, v172
    v_xor_b32 v173, 128, v173
    v_xor_b32 v174, 128, v174
    v_xor_b32 v175, 128, v175
    s_mov_b32 m0, 20480
    s_nop 0
    global_load_lds_dwordx4 v170, s[48:49] offset:0
    s_mov_b32 m0, 21504
    s_nop 0
    global_load_lds_dwordx4 v171, s[48:49] offset:0
    s_mov_b32 m0, 22528
    s_nop 0
    global_load_lds_dwordx4 v172, s[50:51] offset:0
    s_mov_b32 m0, 23552
    s_nop 0
    global_load_lds_dwordx4 v173, s[50:51] offset:0
    s_mov_b32 m0, 24576
    s_nop 0
    global_load_lds_dwordx4 v172, s[52:53] offset:0
    s_mov_b32 m0, 25600
    s_nop 0
    global_load_lds_dwordx4 v173, s[52:53] offset:0
    s_mov_b32 m0, 26624
    s_nop 0
    global_load_lds_dwordx4 v174, s[54:55] offset:0
    s_mov_b32 m0, 27648
    s_nop 0
    global_load_lds_dwordx4 v175, s[54:55] offset:0
    v_xor_b32 v168, 128, v168
    v_xor_b32 v169, 128, v169
    s_add_u32 m0, s70, 8192
    s_nop 0
    global_load_lds_dwordx4 v168, s[40:41] offset:0
    s_add_u32 m0, s70, 9216
    s_nop 0
    global_load_lds_dwordx4 v169, s[40:41] offset:0
    s_add_u32 m0, s70, 10240
    s_nop 0
    global_load_lds_dwordx4 v168, s[42:43] offset:0
    s_add_u32 m0, s70, 11264
    s_nop 0
    global_load_lds_dwordx4 v169, s[42:43] offset:0
    v_add_u32 v187, s70, v176
    v_xor_b32 v188, 64, v187
    v_mov_b32 v0, 0
    v_mov_b32 v1, 0
    v_mov_b32 v2, 0
    v_mov_b32 v3, 0
    v_mov_b32 v4, 0
    v_mov_b32 v5, 0
    v_mov_b32 v6, 0
    v_mov_b32 v7, 0
    v_mov_b32 v8, 0
    v_mov_b32 v9, 0
    v_mov_b32 v10, 0
    v_mov_b32 v11, 0
    v_mov_b32 v12, 0
    v_mov_b32 v13, 0
    v_mov_b32 v14, 0
    v_mov_b32 v15, 0
    v_mov_b32 v16, 0
    v_mov_b32 v17, 0
    v_mov_b32 v18, 0
    v_mov_b32 v19, 0
    v_mov_b32 v20, 0
    v_mov_b32 v21, 0
    v_mov_b32 v22, 0
    v_mov_b32 v23, 0
    v_mov_b32 v24, 0
    v_mov_b32 v25, 0
    v_mov_b32 v26, 0
    v_mov_b32 v27, 0
    v_mov_b32 v28, 0
    v_mov_b32 v29, 0
    v_mov_b32 v30, 0
    v_mov_b32 v31, 0
    v_mov_b32 v32, 0
    v_mov_b32 v33, 0
    v_mov_b32 v34, 0
    v_mov_b32 v35, 0
    v_mov_b32 v36, 0
    v_mov_b32 v37, 0
    v_mov_b32 v38, 0
    v_mov_b32 v39, 0
    v_mov_b32 v40, 0
    v_mov_b32 v41, 0
    v_mov_b32 v42, 0
    v_mov_b32 v43, 0
    v_mov_b32 v44, 0
    v_mov_b32 v45, 0
    v_mov_b32 v46, 0
    v_mov_b32 v47, 0
    v_mov_b32 v48, 0
    v_mov_b32 v49, 0
    v_mov_b32 v50, 0
    v_mov_b32 v51, 0
    v_mov_b32 v52, 0
    v_mov_b32 v53, 0
    v_mov_b32 v54, 0
    v_mov_b32 v55, 0
    s_lshr_b32 s80, s2, 2
    s_mul_i32 s80, s80, 28672
    s_bfe_u32 s81, s2, 0x10001
    s_mul_i32 s81, s81, 3584
    s_add_u32 s80, s80, s81
    s_and_b32 s81, s2, 1
    s_mul_i32 s81, s81, 448
    s_add_u32 s80, s80, s81
    s_add_u32 s72, s4, s80
    s_addc_u32 s73, s5, 0
    s_add_u32 s74, s18, s80
    s_addc_u32 s75, s19, 0
    v_mov_b32 v189, 0
    v_bfe_u32 v185, v186, 2, 2
    v_mul_u32_u24 v185, 7168, v185
    v_add_u32 v189, v185, v189
    v_bfe_u32 v185, v186, 0, 2
    v_mul_u32_u24 v185, 896, v185
    v_add_u32 v189, v185, v189
    v_bfe_u32 v185, v186, 5, 1
    v_lshl_add_u32 v189, v185, 5, v189
    v_bfe_u32 v185, v186, 4, 1
    v_lshl_add_u32 v189, v185, 3, v189
    v_mov_b32 v190, 0
    v_bfe_u32 v185, v186, 2, 2
    v_mul_u32_u24 v185, 7168, v185
    v_add_u32 v190, v185, v190
    v_bfe_u32 v185, v186, 0, 2
    v_mul_u32_u24 v185, 896, v185
    v_add_u32 v190, v185, v190
    v_bfe_u32 v185, v186, 4, 2
    v_lshl_add_u32 v190, v185, 4, v190
    s_lshr_b32 s80, s2, 2
    s_mul_i32 s80, s80, 28672
    s_and_b32 s81, s2, 3
    s_mul_i32 s81, s81, 224
    s_add_u32 s80, s80, s81
    s_add_u32 s76, s4, s80
    s_addc_u32 s77, s5, 0
    v_lshrrev_b32 v91, 4, v186
    v_min_u32 v91, 2, v91
    v_mov_b32 v88, 0
    v_bfe_u32 v185, v186, 3, 1
    v_mul_u32_u24 v185, 7168, v185
    v_add_u32 v88, v185, v88
    v_bfe_u32 v185, v186, 2, 1
    v_mul_u32_u24 v185, 1792, v185
    v_add_u32 v88, v185, v88
    v_bfe_u32 v185, v186, 0, 1
    v_mul_u32_u24 v185, 896, v185
    v_add_u32 v88, v185, v88
    v_bfe_u32 v185, v186, 1, 1
    v_mul_u32_u24 v185, 3584, v185
    v_add_u32 v88, v185, v88
    v_bfe_u32 v185, v186, 4, 2
    v_lshl_add_u32 v88, v185, 5, v88
    v_mov_b32 v89, 128
    v_bfe_u32 v185, v186, 3, 1
    v_mul_u32_u24 v185, 7168, v185
    v_add_u32 v89, v185, v89
    v_bfe_u32 v185, v186, 2, 1
    v_mul_u32_u24 v185, 1792, v185
    v_add_u32 v89, v185, v89
    v_bfe_u32 v185, v186, 0, 1
    v_mul_u32_u24 v185, 896, v185
    v_add_u32 v89, v185, v89
    v_bfe_u32 v185, v186, 1, 1
    v_mul_u32_u24 v185, 3584, v185
    v_add_u32 v89, v185, v89
    v_lshl_add_u32 v89, v91, 5, v89
    v_mov_b32 v90, 1024
    v_bfe_u32 v185, v186, 0, 4
    v_lshl_add_u32 v90, v185, 4, v90
    v_lshl_add_u32 v90, v91, 8, v90
    s_getreg_b32 s86, hwreg(HW_REG_HW_ID, 8, 1)
    s_and_b32 s86, s86, 1
    s_lshl_b32 s80, s86, 16
    s_or_b32 s80, s80, 1
    v_mov_b32 v137, s80
    s_lshl_b32 s80, s30, 5
    v_mov_b32 v136, s80
    v_and_b32 v139, 7, v186
    v_lshlrev_b32 v139, 5, v139
    s_waitcnt vmcnt(24)
    s_mov_b64 exec, 1
    global_atomic_add v138, v136, v137, s[26:27] sc0
    s_mov_b64 exec, -1
    v_mov_b32 v142, 0
    v_bfe_u32 v143, v186, 4, 2
    v_lshl_add_u32 v142, v143, 5, v142
    v_bfe_u32 v143, v186, 1, 3
    v_mul_u32_u24 v143, 896, v143
    v_add_u32 v142, v143, v142
    v_bfe_u32 v143, v186, 0, 1
    v_lshl_add_u32 v142, v143, 4, v142
    global_load_dwordx2 v[192:193], v189, s[72:73] offset:0
    global_load_dwordx2 v[194:195], v189, s[72:73] offset:16
    global_load_dwordx4 v[220:223], v190, s[74:75] offset:0
    global_load_dwordx2 v[196:197], v189, s[72:73] offset:64
    global_load_dwordx2 v[198:199], v189, s[72:73] offset:80
    global_load_dwordx4 v[224:227], v190, s[74:75] offset:64
    global_load_dwordx2 v[200:201], v189, s[72:73] offset:128
    global_load_dwordx2 v[202:203], v189, s[72:73] offset:144
    global_load_dwordx4 v[228:231], v190, s[74:75] offset:128
    global_load_dwordx2 v[204:205], v189, s[72:73] offset:192
    global_load_dwordx2 v[206:207], v189, s[72:73] offset:208
    global_load_dwordx4 v[232:235], v190, s[74:75] offset:192
    global_load_dwordx2 v[208:209], v189, s[72:73] offset:256
    global_load_dwordx2 v[210:211], v189, s[72:73] offset:272
    global_load_dwordx4 v[236:239], v190, s[74:75] offset:256
    global_load_dwordx2 v[212:213], v189, s[72:73] offset:320
    global_load_dwordx2 v[214:215], v189, s[72:73] offset:336
    global_load_dwordx4 v[240:243], v190, s[74:75] offset:320
    global_load_dwordx2 v[216:217], v189, s[72:73] offset:384
    global_load_dwordx2 v[218:219], v189, s[72:73] offset:400
    global_load_dwordx4 v[244:247], v190, s[74:75] offset:384
    global_load_dwordx4 v[56:59], v88, s[76:77] offset:0
    global_load_dwordx4 v[60:63], v88, s[76:77] offset:16
    global_load_dwordx4 v[64:67], v89, s[76:77] offset:0
    global_load_dwordx4 v[68:71], v89, s[76:77] offset:16
    s_add_u32 s76, s76, 14336
    s_addc_u32 s77, s77, 0
    global_load_dwordx4 v[72:75], v88, s[76:77] offset:0
    global_load_dwordx4 v[76:79], v88, s[76:77] offset:16
    global_load_dwordx4 v[80:83], v89, s[76:77] offset:0
    global_load_dwordx4 v[84:87], v89, s[76:77] offset:16
    global_load_dwordx4 v[92:95], v142, s[6:7] offset:0
    global_load_dwordx4 v[96:99], v142, s[6:7] offset:128
    global_load_dwordx4 v[100:103], v142, s[6:7] offset:256
    global_load_dwordx4 v[104:107], v142, s[6:7] offset:384
    global_load_dwordx4 v[108:111], v142, s[6:7] offset:512
    global_load_dwordx4 v[120:123], v142, s[6:7] offset:640
    global_load_dwordx4 v[124:127], v142, s[6:7] offset:768
    s_waitcnt vmcnt(49)
    s_barrier
    ds_read_b128 v[112:115], v187 offset:0
    ds_read_b128 v[116:119], v187 offset:2048
    ds_read_b128 v[144:147], v176 offset:0
    ds_read_b128 v[148:151], v176 offset:2048
    ds_read_b128 v[152:155], v176 offset:4096
    ds_read_b128 v[156:159], v176 offset:6144
    ds_read_b128 v[160:163], v176 offset:8192
    s_waitcnt lgkmcnt(4)
    v_mfma_f32_16x16x32_bf16 v[0:3], v[112:115], v[144:147], v[0:3]
    ds_read_b128 v[164:167], v176 offset:10240
    v_mfma_f32_16x16x32_bf16 v[28:31], v[116:119], v[144:147], v[28:31]
    v_xor_b32 v170, 384, v170
    v_xor_b32 v171, 384, v171
    v_xor_b32 v172, 384, v172
    v_xor_b32 v173, 384, v173
    v_xor_b32 v174, 384, v174
    v_xor_b32 v175, 384, v175
    s_mov_b32 m0, 34816
    s_nop 0
    global_load_lds_dwordx4 v170, s[48:49] offset:0
    s_mov_b32 m0, 35840
    s_nop 0
    global_load_lds_dwordx4 v171, s[48:49] offset:0
    s_waitcnt lgkmcnt(4)
    v_mfma_f32_16x16x32_bf16 v[4:7], v[112:115], v[148:151], v[4:7]
    ds_read_b128 v[144:147], v176 offset:12288
    v_mfma_f32_16x16x32_bf16 v[32:35], v[116:119], v[148:151], v[32:35]
    s_mov_b32 m0, 36864
    s_nop 0
    global_load_lds_dwordx4 v172, s[50:51] offset:0
    s_mov_b32 m0, 37888
    s_nop 0
    global_load_lds_dwordx4 v173, s[50:51] offset:0
    s_waitcnt lgkmcnt(4)
    v_mfma_f32_16x16x32_bf16 v[8:11], v[112:115], v[152:155], v[8:11]
    ds_read_b128 v[128:131], v188 offset:0
    ds_read_b128 v[132:135], v188 offset:2048
    ds_read_b128 v[148:151], v177 offset:0
    v_mfma_f32_16x16x32_bf16 v[36:39], v[116:119], v[152:155], v[36:39]
    s_mov_b32 m0, 38912
    s_nop 0
    global_load_lds_dwordx4 v172, s[52:53] offset:0
    s_mov_b32 m0, 39936
    s_nop 0
    global_load_lds_dwordx4 v173, s[52:53] offset:0
    s_waitcnt lgkmcnt(6)
    v_mfma_f32_16x16x32_bf16 v[12:15], v[112:115], v[156:159], v[12:15]
    ds_read_b128 v[152:155], v177 offset:2048
    v_mfma_f32_16x16x32_bf16 v[40:43], v[116:119], v[156:159], v[40:43]
    s_mov_b32 m0, 40960
    s_nop 0
    global_load_lds_dwordx4 v174, s[54:55] offset:0
    s_mov_b32 m0, 41984
    s_nop 0
    global_load_lds_dwordx4 v175, s[54:55] offset:0
    s_waitcnt lgkmcnt(6)
    v_mfma_f32_16x16x32_bf16 v[16:19], v[112:115], v[160:163], v[16:19]
    ds_read_b128 v[156:159], v177 offset:4096
    v_mfma_f32_16x16x32_bf16 v[44:47], v[116:119], v[160:163], v[44:47]
    v_xor_b32 v168, 384, v168
    v_xor_b32 v169, 384, v169
    s_add_u32 m0, s70, 16384
    s_nop 0
    global_load_lds_dwordx4 v168, s[40:41] offset:0
    s_add_u32 m0, s70, 17408
    s_nop 0
    global_load_lds_dwordx4 v169, s[40:41] offset:0
    s_waitcnt lgkmcnt(6)
    v_mfma_f32_16x16x32_bf16 v[20:23], v[112:115], v[164:167], v[20:23]
    ds_read_b128 v[160:163], v177 offset:6144
    v_mfma_f32_16x16x32_bf16 v[48:51], v[116:119], v[164:167], v[48:51]
    s_add_u32 m0, s70, 18432
    s_nop 0
    global_load_lds_dwordx4 v168, s[42:43] offset:0
    s_add_u32 m0, s70, 19456
    s_nop 0
    global_load_lds_dwordx4 v169, s[42:43] offset:0
    s_waitcnt lgkmcnt(6)
    v_mfma_f32_16x16x32_bf16 v[24:27], v[112:115], v[144:147], v[24:27]
    ds_read_b128 v[164:167], v177 offset:8192
    v_mfma_f32_16x16x32_bf16 v[52:55], v[116:119], v[144:147], v[52:55]
    s_waitcnt lgkmcnt(4)
    v_mfma_f32_16x16x32_bf16 v[0:3], v[128:131], v[148:151], v[0:3]
    ds_read_b128 v[144:147], v177 offset:10240
    v_mfma_f32_16x16x32_bf16 v[28:31], v[132:135], v[148:151], v[28:31]
    s_waitcnt lgkmcnt(4)
    v_mfma_f32_16x16x32_bf16 v[4:7], v[128:131], v[152:155], v[4:7]
    ds_read_b128 v[148:151], v177 offset:12288
    v_mfma_f32_16x16x32_bf16 v[32:35], v[132:135], v[152:155], v[32:35]
    s_waitcnt lgkmcnt(4)
    v_mfma_f32_16x16x32_bf16 v[8:11], v[128:131], v[156:159], v[8:11]
    v_mfma_f32_16x16x32_bf16 v[36:39], v[132:135], v[156:159], v[36:39]
    s_waitcnt lgkmcnt(3)
    v_mfma_f32_16x16x32_bf16 v[12:15], v[128:131], v[160:163], v[12:15]
    v_mfma_f32_16x16x32_bf16 v[40:43], v[132:135], v[160:163], v[40:43]
    s_waitcnt lgkmcnt(2)
    v_mfma_f32_16x16x32_bf16 v[16:19], v[128:131], v[164:167], v[16:19]
    v_mfma_f32_16x16x32_bf16 v[44:47], v[132:135], v[164:167], v[44:47]
    s_waitcnt lgkmcnt(1)
    v_mfma_f32_16x16x32_bf16 v[20:23], v[128:131], v[144:147], v[20:23]
    v_mfma_f32_16x16x32_bf16 v[48:51], v[132:135], v[144:147], v[48:51]
    s_waitcnt lgkmcnt(0)
    v_mfma_f32_16x16x32_bf16 v[24:27], v[128:131], v[148:151], v[24:27]
    v_mfma_f32_16x16x32_bf16 v[52:55], v[132:135], v[148:151], v[52:55]
    s_waitcnt vmcnt(49)
    s_barrier
    ds_read_b128 v[112:115], v187 offset:8192
    ds_read_b128 v[116:119], v187 offset:10240
    ds_read_b128 v[152:155], v176 offset:14336
    ds_read_b128 v[156:159], v176 offset:16384
    ds_read_b128 v[160:163], v176 offset:18432
    ds_read_b128 v[164:167], v176 offset:20480
    ds_read_b128 v[144:147], v176 offset:22528
    s_waitcnt lgkmcnt(4)
    v_mfma_f32_16x16x32_bf16 v[0:3], v[112:115], v[152:155], v[0:3]
    ds_read_b128 v[148:151], v176 offset:24576
    v_mfma_f32_16x16x32_bf16 v[28:31], v[116:119], v[152:155], v[28:31]
    v_xor_b32 v170, 128, v170
    v_xor_b32 v171, 128, v171
    v_xor_b32 v172, 128, v172
    v_xor_b32 v173, 128, v173
    v_xor_b32 v174, 128, v174
    v_xor_b32 v175, 128, v175
    s_mov_b32 m0, 49152
    s_nop 0
    global_load_lds_dwordx4 v170, s[48:49] offset:0
    s_mov_b32 m0, 50176
    s_nop 0
    global_load_lds_dwordx4 v171, s[48:49] offset:0
    s_waitcnt lgkmcnt(4)
    v_mfma_f32_16x16x32_bf16 v[4:7], v[112:115], v[156:159], v[4:7]
    ds_read_b128 v[152:155], v176 offset:26624
    v_mfma_f32_16x16x32_bf16 v[32:35], v[116:119], v[156:159], v[32:35]
    s_mov_b32 m0, 51200
    s_nop 0
    global_load_lds_dwordx4 v172, s[50:51] offset:0
    s_mov_b32 m0, 52224
    s_nop 0
    global_load_lds_dwordx4 v173, s[50:51] offset:0
    s_waitcnt lgkmcnt(4)
    v_mfma_f32_16x16x32_bf16 v[8:11], v[112:115], v[160:163], v[8:11]
    ds_read_b128 v[128:131], v188 offset:8192
    ds_read_b128 v[132:135], v188 offset:10240
    ds_read_b128 v[156:159], v177 offset:14336
    v_mfma_f32_16x16x32_bf16 v[36:39], v[116:119], v[160:163], v[36:39]
    s_mov_b32 m0, 53248
    s_nop 0
    global_load_lds_dwordx4 v172, s[52:53] offset:0
    s_mov_b32 m0, 54272
    s_nop 0
    global_load_lds_dwordx4 v173, s[52:53] offset:0
    s_waitcnt lgkmcnt(6)
    v_mfma_f32_16x16x32_bf16 v[12:15], v[112:115], v[164:167], v[12:15]
    ds_read_b128 v[160:163], v177 offset:16384
    v_mfma_f32_16x16x32_bf16 v[40:43], v[116:119], v[164:167], v[40:43]
    s_mov_b32 m0, 55296
    s_nop 0
    global_load_lds_dwordx4 v174, s[54:55] offset:0
    s_mov_b32 m0, 56320
    s_nop 0
    global_load_lds_dwordx4 v175, s[54:55] offset:0
    s_waitcnt lgkmcnt(6)
    v_mfma_f32_16x16x32_bf16 v[16:19], v[112:115], v[144:147], v[16:19]
    ds_read_b128 v[164:167], v177 offset:18432
    v_mfma_f32_16x16x32_bf16 v[44:47], v[116:119], v[144:147], v[44:47]
    v_xor_b32 v168, 128, v168
    v_xor_b32 v169, 128, v169
    s_add_u32 m0, s70, 0
    s_nop 0
    global_load_lds_dwordx4 v168, s[40:41] offset:0
    s_add_u32 m0, s70, 1024
    s_nop 0
    global_load_lds_dwordx4 v169, s[40:41] offset:0
    s_waitcnt lgkmcnt(6)
    v_mfma_f32_16x16x32_bf16 v[20:23], v[112:115], v[148:151], v[20:23]
    ds_read_b128 v[144:147], v177 offset:20480
    v_mfma_f32_16x16x32_bf16 v[48:51], v[116:119], v[148:151], v[48:51]
    s_add_u32 m0, s70, 2048
    s_nop 0
    global_load_lds_dwordx4 v168, s[42:43] offset:0
    s_add_u32 m0, s70, 3072
    s_nop 0
    global_load_lds_dwordx4 v169, s[42:43] offset:0
    s_waitcnt lgkmcnt(6)
    v_mfma_f32_16x16x32_bf16 v[24:27], v[112:115], v[152:155], v[24:27]
    ds_read_b128 v[148:151], v177 offset:22528
    v_mfma_f32_16x16x32_bf16 v[52:55], v[116:119], v[152:155], v[52:55]
    s_waitcnt lgkmcnt(4)
    v_mfma_f32_16x16x32_bf16 v[0:3], v[128:131], v[156:159], v[0:3]
    ds_read_b128 v[152:155], v177 offset:24576
    v_mfma_f32_16x16x32_bf16 v[28:31], v[132:135], v[156:159], v[28:31]
    s_waitcnt lgkmcnt(4)
    v_mfma_f32_16x16x32_bf16 v[4:7], v[128:131], v[160:163], v[4:7]
    ds_read_b128 v[156:159], v177 offset:26624
    v_mfma_f32_16x16x32_bf16 v[32:35], v[132:135], v[160:163], v[32:35]
    s_waitcnt lgkmcnt(4)
    v_mfma_f32_16x16x32_bf16 v[8:11], v[128:131], v[164:167], v[8:11]
    v_mfma_f32_16x16x32_bf16 v[36:39], v[132:135], v[164:167], v[36:39]
    s_waitcnt lgkmcnt(3)
    v_mfma_f32_16x16x32_bf16 v[12:15], v[128:131], v[144:147], v[12:15]
    v_mfma_f32_16x16x32_bf16 v[40:43], v[132:135], v[144:147], v[40:43]
    s_waitcnt lgkmcnt(2)
    v_mfma_f32_16x16x32_bf16 v[16:19], v[128:131], v[148:151], v[16:19]
    v_mfma_f32_16x16x32_bf16 v[44:47], v[132:135], v[148:151], v[44:47]
    s_waitcnt lgkmcnt(1)
    v_mfma_f32_16x16x32_bf16 v[20:23], v[128:131], v[152:155], v[20:23]
    v_mfma_f32_16x16x32_bf16 v[48:51], v[132:135], v[152:155], v[48:51]
    s_waitcnt lgkmcnt(0)
    v_mfma_f32_16x16x32_bf16 v[24:27], v[128:131], v[156:159], v[24:27]
    v_mfma_f32_16x16x32_bf16 v[52:55], v[132:135], v[156:159], v[52:55]
    s_waitcnt vmcnt(12)
    s_barrier
    global_load_dword v140, v139, s[26:27] sc1
    s_mul_i32 s80, s2, 7168
    s_add_u32 s80, s80, 15732736
    s_add_u32 s72, s28, s80
    s_addc_u32 s73, s29, 0
    s_add_u32 s74, s72, 2097152
    s_addc_u32 s75, s73, 0
    v_swap_b32 v193, v194
    global_store_dwordx4 v184, v[192:195], s[72:73] offset:-4096 sc1
    global_store_dwordx4 v184, v[220:223], s[74:75] offset:-4096 sc1
    v_swap_b32 v197, v198
    global_store_dwordx4 v184, v[196:199], s[72:73] offset:-3072 sc1
    global_store_dwordx4 v184, v[224:227], s[74:75] offset:-3072 sc1
    v_swap_b32 v201, v202
    global_store_dwordx4 v184, v[200:203], s[72:73] offset:-2048 sc1
    global_store_dwordx4 v184, v[228:231], s[74:75] offset:-2048 sc1
    v_swap_b32 v205, v206
    global_store_dwordx4 v184, v[204:207], s[72:73] offset:-1024 sc1
    global_store_dwordx4 v184, v[232:235], s[74:75] offset:-1024 sc1
    v_swap_b32 v209, v210
    global_store_dwordx4 v184, v[208:211], s[72:73] offset:0 sc1
    global_store_dwordx4 v184, v[236:239], s[74:75] offset:0 sc1
    v_swap_b32 v213, v214
    global_store_dwordx4 v184, v[212:215], s[72:73] offset:1024 sc1
    global_store_dwordx4 v184, v[240:243], s[74:75] offset:1024 sc1
    v_swap_b32 v217, v218
    global_store_dwordx4 v184, v[216:219], s[72:73] offset:2048 sc1
    global_store_dwordx4 v184, v[244:247], s[74:75] offset:2048 sc1
    s_add_u32 s76, s72, 47185920
    s_addc_u32 s77, s73, 0
    global_store_dwordx4 v184, v[56:59], s[76:77] offset:-4096 sc1
    global_store_dwordx4 v184, v[60:63], s[76:77] offset:-2304 sc1
    global_store_dwordx4 v90, v[64:67], s[76:77] offset:-4096 sc1
    global_store_dwordx4 v90, v[68:71], s[76:77] offset:-2304 sc1
    global_store_dwordx4 v184, v[72:75], s[76:77] offset:-512 sc1
    global_store_dwordx4 v184, v[76:79], s[76:77] offset:1280 sc1
    global_store_dwordx4 v90, v[80:83], s[76:77] offset:-512 sc1
    global_store_dwordx4 v90, v[84:87], s[76:77] offset:1280 sc1
    s_cmp_lg_u32 s2, 63
    s_cbranch_scc1 P_nom0_1
    s_add_u32 s72, s28, 13627392
    s_addc_u32 s73, s29, 0
    v_min_u32 v92, 0xfffffffe, v92
    v_min_u32 v94, 0xfffffffe, v94
    global_store_dwordx4 v184, v[92:95], s[72:73] offset:-4096 sc1
    v_min_u32 v96, 0xfffffffe, v96
    v_min_u32 v98, 0xfffffffe, v98
    global_store_dwordx4 v184, v[96:99], s[72:73] offset:-3072 sc1
    v_min_u32 v100, 0xfffffffe, v100
    v_min_u32 v102, 0xfffffffe, v102
    global_store_dwordx4 v184, v[100:103], s[72:73] offset:-2048 sc1
    v_min_u32 v104, 0xfffffffe, v104
    v_min_u32 v106, 0xfffffffe, v106
    global_store_dwordx4 v184, v[104:107], s[72:73] offset:-1024 sc1
    v_min_u32 v108, 0xfffffffe, v108
    v_min_u32 v110, 0xfffffffe, v110
    global_store_dwordx4 v184, v[108:111], s[72:73] offset:0 sc1
    v_min_u32 v120, 0xfffffffe, v120
    v_min_u32 v122, 0xfffffffe, v122
    global_store_dwordx4 v184, v[120:123], s[72:73] offset:1024 sc1
    v_min_u32 v124, 0xfffffffe, v124
    v_min_u32 v126, 0xfffffffe, v126
    global_store_dwordx4 v184, v[124:127], s[72:73] offset:2048 sc1
P_nom0_1:
    ds_read_b128 v[112:115], v187 offset:16384
    ds_read_b128 v[116:119], v187 offset:18432
    ds_read_b128 v[160:163], v176 offset:28672
    ds_read_b128 v[164:167], v176 offset:30720
    ds_read_b128 v[144:147], v176 offset:32768
    ds_read_b128 v[148:151], v176 offset:34816
    ds_read_b128 v[152:155], v176 offset:36864
    s_waitcnt lgkmcnt(4)
    v_mfma_f32_16x16x32_bf16 v[0:3], v[112:115], v[160:163], v[0:3]
    ds_read_b128 v[156:159], v176 offset:38912
    v_mfma_f32_16x16x32_bf16 v[28:31], v[116:119], v[160:163], v[28:31]
    s_waitcnt lgkmcnt(4)
    v_mfma_f32_16x16x32_bf16 v[4:7], v[112:115], v[164:167], v[4:7]
    ds_read_b128 v[160:163], v176 offset:40960
    v_mfma_f32_16x16x32_bf16 v[32:35], v[116:119], v[164:167], v[32:35]
    s_waitcnt lgkmcnt(4)
    v_mfma_f32_16x16x32_bf16 v[8:11], v[112:115], v[144:147], v[8:11]
    ds_read_b128 v[128:131], v188 offset:16384
    ds_read_b128 v[132:135], v188 offset:18432
    ds_read_b128 v[164:167], v177 offset:28672
    v_mfma_f32_16x16x32_bf16 v[36:39], v[116:119], v[144:147], v[36:39]
    s_waitcnt lgkmcnt(6)
    v_mfma_f32_16x16x32_bf16 v[12:15], v[112:115], v[148:151], v[12:15]
    ds_read_b128 v[144:147], v177 offset:30720
    v_mfma_f32_16x16x32_bf16 v[40:43], v[116:119], v[148:151], v[40:43]
    s_waitcnt lgkmcnt(6)
    v_mfma_f32_16x16x32_bf16 v[16:19], v[112:115], v[152:155], v[16:19]
    ds_read_b128 v[148:151], v177 offset:32768
    v_mfma_f32_16x16x32_bf16 v[44:47], v[116:119], v[152:155], v[44:47]
    s_waitcnt lgkmcnt(6)
    v_mfma_f32_16x16x32_bf16 v[20:23], v[112:115], v[156:159], v[20:23]
    ds_read_b128 v[152:155], v177 offset:34816
    v_mfma_f32_16x16x32_bf16 v[48:51], v[116:119], v[156:159], v[48:51]
    s_waitcnt lgkmcnt(6)
    v_mfma_f32_16x16x32_bf16 v[24:27], v[112:115], v[160:163], v[24:27]
    ds_read_b128 v[156:159], v177 offset:36864
    v_mfma_f32_16x16x32_bf16 v[52:55], v[116:119], v[160:163], v[52:55]
    s_waitcnt lgkmcnt(4)
    v_mfma_f32_16x16x32_bf16 v[0:3], v[128:131], v[164:167], v[0:3]
    ds_read_b128 v[160:163], v177 offset:38912
    v_mfma_f32_16x16x32_bf16 v[28:31], v[132:135], v[164:167], v[28:31]
    s_waitcnt lgkmcnt(4)
    v_mfma_f32_16x16x32_bf16 v[4:7], v[128:131], v[144:147], v[4:7]
    ds_read_b128 v[164:167], v177 offset:40960
    v_mfma_f32_16x16x32_bf16 v[32:35], v[132:135], v[144:147], v[32:35]
    s_waitcnt lgkmcnt(4)
    v_mfma_f32_16x16x32_bf16 v[8:11], v[128:131], v[148:151], v[8:11]
    v_mfma_f32_16x16x32_bf16 v[36:39], v[132:135], v[148:151], v[36:39]
    s_waitcnt lgkmcnt(3)
    v_mfma_f32_16x16x32_bf16 v[12:15], v[128:131], v[152:155], v[12:15]
    v_mfma_f32_16x16x32_bf16 v[40:43], v[132:135], v[152:155], v[40:43]
    s_waitcnt lgkmcnt(2)
    v_mfma_f32_16x16x32_bf16 v[16:19], v[128:131], v[156:159], v[16:19]
    v_mfma_f32_16x16x32_bf16 v[44:47], v[132:135], v[156:159], v[44:47]
    s_waitcnt lgkmcnt(1)
    v_mfma_f32_16x16x32_bf16 v[20:23], v[128:131], v[160:163], v[20:23]
    v_mfma_f32_16x16x32_bf16 v[48:51], v[132:135], v[160:163], v[48:51]
    s_waitcnt lgkmcnt(0)
    v_mfma_f32_16x16x32_bf16 v[24:27], v[128:131], v[164:167], v[24:27]
    v_mfma_f32_16x16x32_bf16 v[52:55], v[132:135], v[164:167], v[52:55]
    s_waitcnt vmcnt(23)
    s_waitcnt vmcnt(22)
    s_mov_b32 s80, 0
    s_lshl_b32 s81, s30, 5
L_tk_2chk:
    v_readfirstlane_b32 s82, v138
    s_lshr_b32 s83, s82, 16
    s_and_b32 s82, s82, 0xffff
    s_cmp_lt_u32 s82, 32
    s_cbranch_scc1 L_tk_2got
    s_add_u32 s80, s80, 1
    s_mov_b32 s81, 0xffff
    s_cmp_ge_u32 s80, 8
    s_cbranch_scc1 L_tk_2pub
    s_add_u32 s81, s30, s80
    s_and_b32 s81, s81, 7
    s_lshl_b32 s81, s81, 5
    v_mov_b32 v136, s81
    s_mov_b64 exec, 1
    global_atomic_add v138, v136, v137, s[26:27] sc0
    s_mov_b64 exec, -1
    s_waitcnt vmcnt(0)
    s_branch L_tk_2chk
L_tk_2got:
    s_sub_u32 s82, s83, s82
    s_add_u32 s82, s82, 31
    s_cmp_lg_u32 s86, 0
    s_cselect_b32 s82, s83, s82
    s_add_u32 s81, s81, s82
    s_cmp_lg_u32 s80, 0
    s_cselect_b32 s80, 0x100, 0
    s_or_b32 s81, s81, s80
L_tk_2pub:
    v_mov_b32 v136, 143360
    v_mov_b32 v138, s81
    ds_write_b32 v136, v138
L_tk_2tc:
    v_and_b32 v140, 0xffff, v140
    v_cmp_gt_u32 vcc, 32, v140
    s_cbranch_vccz L_tk_2ok
    global_load_dword v140, v139, s[26:27] sc1
    s_sub_u32 s35, s35, 1
    s_cbranch_scc1 L_tk_2ok
    s_waitcnt vmcnt(0)
    s_branch L_tk_2tc
L_tk_2ok:
    s_waitcnt lgkmcnt(0)
    s_barrier
    v_mov_b32 v185, 143360
    ds_read_b32 v185, v185
    ds_read_b128 v[112:115], v187 offset:0
    ds_read_b128 v[116:119], v187 offset:2048
    ds_read_b128 v[144:147], v176 offset:43008
    ds_read_b128 v[148:151], v176 offset:45056
    ds_read_b128 v[152:155], v176 offset:47104
    ds_read_b128 v[156:159], v176 offset:49152
    ds_read_b128 v[160:163], v176 offset:51200
    s_waitcnt lgkmcnt(4)
    v_mfma_f32_16x16x32_bf16 v[0:3], v[112:115], v[144:147], v[0:3]
    ds_read_b128 v[164:167], v176 offset:53248
    v_mfma_f32_16x16x32_bf16 v[28:31], v[116:119], v[144:147], v[28:31]
    s_waitcnt lgkmcnt(4)
    v_mfma_f32_16x16x32_bf16 v[4:7], v[112:115], v[148:151], v[4:7]
    ds_read_b128 v[144:147], v176 offset:55296
    v_mfma_f32_16x16x32_bf16 v[32:35], v[116:119], v[148:151], v[32:35]
    s_waitcnt lgkmcnt(4)
    v_mfma_f32_16x16x32_bf16 v[8:11], v[112:115], v[152:155], v[8:11]
    ds_read_b128 v[128:131], v188 offset:0
    ds_read_b128 v[132:135], v188 offset:2048
    ds_read_b128 v[148:151], v177 offset:43008
    v_mfma_f32_16x16x32_bf16 v[36:39], v[116:119], v[152:155], v[36:39]
    s_waitcnt lgkmcnt(6)
    v_mfma_f32_16x16x32_bf16 v[12:15], v[112:115], v[156:159], v[12:15]
    ds_read_b128 v[152:155], v177 offset:45056
    v_mfma_f32_16x16x32_bf16 v[40:43], v[116:119], v[156:159], v[40:43]
    s_waitcnt lgkmcnt(6)
    v_mfma_f32_16x16x32_bf16 v[16:19], v[112:115], v[160:163], v[16:19]
    ds_read_b128 v[156:159], v177 offset:47104
    v_mfma_f32_16x16x32_bf16 v[44:47], v[116:119], v[160:163], v[44:47]
    s_waitcnt lgkmcnt(6)
    v_mfma_f32_16x16x32_bf16 v[20:23], v[112:115], v[164:167], v[20:23]
    ds_read_b128 v[160:163], v177 offset:49152
    v_mfma_f32_16x16x32_bf16 v[48:51], v[116:119], v[164:167], v[48:51]
    s_waitcnt lgkmcnt(6)
    v_mfma_f32_16x16x32_bf16 v[24:27], v[112:115], v[144:147], v[24:27]
    ds_read_b128 v[164:167], v177 offset:51200
    v_mfma_f32_16x16x32_bf16 v[52:55], v[116:119], v[144:147], v[52:55]
    s_waitcnt lgkmcnt(4)
    v_mfma_f32_16x16x32_bf16 v[0:3], v[128:131], v[148:151], v[0:3]
    ds_read_b128 v[144:147], v177 offset:53248
    v_mfma_f32_16x16x32_bf16 v[28:31], v[132:135], v[148:151], v[28:31]
    s_waitcnt lgkmcnt(4)
    v_mfma_f32_16x16x32_bf16 v[4:7], v[128:131], v[152:155], v[4:7]
    ds_read_b128 v[148:151], v177 offset:55296
    v_mfma_f32_16x16x32_bf16 v[32:35], v[132:135], v[152:155], v[32:35]
    s_waitcnt lgkmcnt(4)
    v_mfma_f32_16x16x32_bf16 v[8:11], v[128:131], v[156:159], v[8:11]
    v_mfma_f32_16x16x32_bf16 v[36:39], v[132:135], v[156:159], v[36:39]
    s_waitcnt lgkmcnt(3)
    v_mfma_f32_16x16x32_bf16 v[12:15], v[128:131], v[160:163], v[12:15]
    v_mfma_f32_16x16x32_bf16 v[40:43], v[132:135], v[160:163], v[40:43]
    s_waitcnt lgkmcnt(2)
    v_mfma_f32_16x16x32_bf16 v[16:19], v[128:131], v[164:167], v[16:19]
    v_mfma_f32_16x16x32_bf16 v[44:47], v[132:135], v[164:167], v[44:47]
    s_waitcnt lgkmcnt(1)
    v_mfma_f32_16x16x32_bf16 v[20:23], v[128:131], v[144:147], v[20:23]
    v_mfma_f32_16x16x32_bf16 v[48:51], v[132:135], v[144:147], v[48:51]
    s_waitcnt lgkmcnt(0)
    v_mfma_f32_16x16x32_bf16 v[24:27], v[128:131], v[148:151], v[24:27]
    v_mfma_f32_16x16x32_bf16 v[52:55], v[132:135], v[148:151], v[52:55]
    s_nop 7
    s_mov_b32 s80, 1035512379
    v_readfirstlane_b32 s32, v185
    v_mov_b32 v136, 0
    s_waitcnt vmcnt(0)
    s_mov_b64 exec, 1
    global_store_dword v141, v136, s[28:29] sc1
    s_mov_b64 exec, -1
    v_mul_f32 v0, s80, v0
    v_mul_f32 v1, s80, v1
    v_mul_f32 v2, s80, v2
    v_mul_f32 v3, s80, v3
    v_mul_f32 v28, s80, v28
    v_mul_f32 v29, s80, v29
    v_mul_f32 v30, s80, v30
    v_mul_f32 v31, s80, v31
    v_cvt_pk_bf16_f32 v0, v0, v1
    v_cvt_pk_bf16_f32 v1, v2, v3
    v_cvt_pk_bf16_f32 v2, v28, v29
    v_cvt_pk_bf16_f32 v3, v30, v31
    global_store_dwordx4 v184, v[0:3], s[56:57] offset:0 sc1
    v_mul_f32 v4, s80, v4
    v_mul_f32 v5, s80, v5
    v_mul_f32 v6, s80, v6
    v_mul_f32 v7, s80, v7
    v_mul_f32 v32, s80, v32
    v_mul_f32 v33, s80, v33
    v_mul_f32 v34, s80, v34
    v_mul_f32 v35, s80, v35
    v_cvt_pk_bf16_f32 v4, v4, v5
    v_cvt_pk_bf16_f32 v5, v6, v7
    v_cvt_pk_bf16_f32 v6, v32, v33
    v_cvt_pk_bf16_f32 v7, v34, v35
    global_store_dwordx4 v184, v[4:7], s[58:59] offset:0 sc1
    v_mul_f32 v8, s80, v8
    v_mul_f32 v9, s80, v9
    v_mul_f32 v10, s80, v10
    v_mul_f32 v11, s80, v11
    v_mul_f32 v36, s80, v36
    v_mul_f32 v37, s80, v37
    v_mul_f32 v38, s80, v38
    v_mul_f32 v39, s80, v39
    v_cvt_pk_bf16_f32 v8, v8, v9
    v_cvt_pk_bf16_f32 v9, v10, v11
    v_cvt_pk_bf16_f32 v10, v36, v37
    v_cvt_pk_bf16_f32 v11, v38, v39
    global_store_dwordx4 v184, v[8:11], s[60:61] offset:0 sc1
    v_mul_f32 v12, s80, v12
    v_mul_f32 v13, s80, v13
    v_mul_f32 v14, s80, v14
    v_mul_f32 v15, s80, v15
    v_mul_f32 v40, s80, v40
    v_mul_f32 v41, s80, v41
    v_mul_f32 v42, s80, v42
    v_mul_f32 v43, s80, v43
    v_cvt_pk_bf16_f32 v12, v12, v13
    v_cvt_pk_bf16_f32 v13, v14, v15
    v_cvt_pk_bf16_f32 v14, v40, v41
    v_cvt_pk_bf16_f32 v15, v42, v43
    global_store_dwordx4 v184, v[12:15], s[62:63] offset:0 sc1
    v_mul_f32 v16, s80, v16
    v_mul_f32 v17, s80, v17
    v_mul_f32 v18, s80, v18
    v_mul_f32 v19, s80, v19
    v_mul_f32 v44, s80, v44
    v_mul_f32 v45, s80, v45
    v_mul_f32 v46, s80, v46
    v_mul_f32 v47, s80, v47
    v_cvt_pk_bf16_f32 v16, v16, v17
    v_cvt_pk_bf16_f32 v17, v18, v19
    v_cvt_pk_bf16_f32 v18, v44, v45
    v_cvt_pk_bf16_f32 v19, v46, v47
    global_store_dwordx4 v184, v[16:19], s[64:65] offset:0 sc1
    v_mul_f32 v20, s80, v20
    v_mul_f32 v21, s80, v21
    v_mul_f32 v22, s80, v22
    v_mul_f32 v23, s80, v23
    v_mul_f32 v48, s80, v48
    v_mul_f32 v49, s80, v49
    v_mul_f32 v50, s80, v50
    v_mul_f32 v51, s80, v51
    v_cvt_pk_bf16_f32 v20, v20, v21
    v_cvt_pk_bf16_f32 v21, v22, v23
    v_cvt_pk_bf16_f32 v22, v48, v49
    v_cvt_pk_bf16_f32 v23, v50, v51
    global_store_dwordx4 v184, v[20:23], s[66:67] offset:0 sc1
    v_mul_f32 v24, s80, v24
    v_mul_f32 v25, s80, v25
    v_mul_f32 v26, s80, v26
    v_mul_f32 v27, s80, v27
    v_mul_f32 v52, s80, v52
    v_mul_f32 v53, s80, v53
    v_mul_f32 v54, s80, v54
    v_mul_f32 v55, s80, v55
    v_cvt_pk_bf16_f32 v24, v24, v25
    v_cvt_pk_bf16_f32 v25, v26, v27
    v_cvt_pk_bf16_f32 v26, v52, v53
    v_cvt_pk_bf16_f32 v27, v54, v55
    global_store_dwordx4 v184, v[24:27], s[68:69] offset:0 sc1
    s_branch L_fused
P_B:
    s_cmp_eq_u32 s31, 3
    s_cbranch_scc1 P_B3
    s_mul_i32 s82, s36, 229376
    s_mul_i32 s83, s37, 224
    s_add_u32 s82, s82, s83
    v_bfe_u32 v4, v186, 1, 3
    v_lshrrev_b32 v5, 4, v186
    v_xor_b32 v4, v4, v5
    v_mov_b32 v6, 0
    v_bfe_u32 v185, v186, 4, 2
    v_mul_u32_u24 v185, 896, v185
    v_add_u32 v6, v185, v6
    v_bfe_u32 v185, v186, 0, 1
    v_lshl_add_u32 v6, v185, 4, v6
    s_and_b32 s83, s31, 1
    s_lshl_b32 s83, s83, 2
    v_xor_b32 v4, s83, v4
    v_min_u32 v4, 6, v4
    v_lshl_add_u32 v170, v4, 5, v6
    v_add_u32 v171, 3584, v170
    s_mul_i32 s83, s31, 7168
    s_add_u32 s82, s82, s83
    s_add_u32 s50, s14, s82
    s_addc_u32 s51, s15, 0
    s_lshl_b32 s84, s31, 11
    v_mov_b32 v177, 0
    v_bfe_u32 v185, v186, 4, 2
    v_lshl_add_u32 v177, v185, 11, v177
    v_bfe_u32 v185, v186, 2, 2
    v_mul_u32_u24 v185, 288, v185
    v_add_u32 v177, v185, v177
    v_bfe_u32 v185, v186, 4, 1
    v_lshl_add_u32 v177, v185, 7, v177
    v_bfe_u32 v185, v186, 0, 2
    v_lshl_add_u32 v177, v185, 3, v177
    v_xor_b32 v178, 32, v177
    v_xor_b32 v179, 64, v177
    v_xor_b32 v180, 96, v177
    v_xor_b32 v181, 128, v177
    v_xor_b32 v182, 160, v177
    v_xor_b32 v183, 192, v177
    s_mul_i32 s80, s36, 28672
    s_mul_i32 s81, s38, 7168
    s_add_u32 s80, s80, s81
    s_lshl_b32 s81, s31, 11
    s_add_u32 s80, s80, s81
    s_add_u32 s80, s80, 6553600
    s_mul_i32 s85, s37, 7
    s_add_u32 s81, s85, 0
    s_lshr_b32 s83, s81, 1
    s_and_b32 s81, s81, 1
    s_lshl_b32 s83, s83, 5
    s_add_u32 s81, s81, s83
    s_mul_i32 s81, s81, 14336
    s_add_u32 s81, s81, s80
    s_add_u32 s56, s28, s81
    s_addc_u32 s57, s29, 0
    s_add_u32 s81, s85, 1
    s_lshr_b32 s83, s81, 1
    s_and_b32 s81, s81, 1
    s_lshl_b32 s83, s83, 5
    s_add_u32 s81, s81, s83
    s_mul_i32 s81, s81, 14336
    s_add_u32 s81, s81, s80
    s_add_u32 s58, s28, s81
    s_addc_u32 s59, s29, 0
    s_add_u32 s81, s85, 2
    s_lshr_b32 s83, s81, 1
    s_and_b32 s81, s81, 1
    s_lshl_b32 s83, s83, 5
    s_add_u32 s81, s81, s83
    s_mul_i32 s81, s81, 14336
    s_add_u32 s81, s81, s80
    s_add_u32 s60, s28, s81
    s_addc_u32 s61, s29, 0
    s_add_u32 s81, s85, 3
    s_lshr_b32 s83, s81, 1
    s_and_b32 s81, s81, 1
    s_lshl_b32 s83, s83, 5
    s_add_u32 s81, s81, s83
    s_mul_i32 s81, s81, 14336
    s_add_u32 s81, s81, s80
    s_add_u32 s62, s28, s81
    s_addc_u32 s63, s29, 0
    s_add_u32 s81, s85, 4
    s_lshr_b32 s83, s81, 1
    s_and_b32 s81, s81, 1
    s_lshl_b32 s83, s83, 5
    s_add_u32 s81, s81, s83
    s_mul_i32 s81, s81, 14336
    s_add_u32 s81, s81, s80
    s_add_u32 s64, s28, s81
    s_addc_u32 s65, s29, 0
    s_add_u32 s81, s85, 5
    s_lshr_b32 s83, s81, 1
    s_and_b32 s81, s81, 1
    s_lshl_b32 s83, s83, 5
    s_add_u32 s81, s81, s83
    s_mul_i32 s81, s81, 14336
    s_add_u32 s81, s81, s80
    s_add_u32 s66, s28, s81
    s_addc_u32 s67, s29, 0
    s_add_u32 s81, s85, 6
    s_lshr_b32 s83, s81, 1
    s_and_b32 s81, s81, 1
    s_lshl_b32 s83, s83, 5
    s_add_u32 s81, s81, s83
    s_mul_i32 s81, s81, 14336
    s_add_u32 s81, s81, s80
    s_add_u32 s68, s28, s81
    s_addc_u32 s69, s29, 0
    s_xor_b32 s89, s88, 0
    s_mul_i32 s89, s89, 57344
    s_add_u32 s48, s50, s89
    s_addc_u32 s49, s51, 0
    s_add_u32 m0, s84, 0
    s_nop 0
    global_load_lds_dwordx4 v170, s[48:49] offset:0
    s_add_u32 m0, s84, 1024
    s_nop 0
    global_load_lds_dwordx4 v171, s[48:49] offset:0
    s_add_u32 m0, s70, 0
    s_nop 0
    global_load_lds_dwordx4 v168, s[40:41] offset:0
    s_add_u32 m0, s70, 1024
    s_nop 0
    global_load_lds_dwordx4 v169, s[40:41] offset:0
    s_add_u32 m0, s70, 2048
    s_nop 0
    global_load_lds_dwordx4 v168, s[42:43] offset:0
    s_add_u32 m0, s70, 3072
    s_nop 0
    global_load_lds_dwordx4 v169, s[42:43] offset:0
    s_add_u32 m0, s70, 4096
    s_nop 0
    global_load_lds_dwordx4 v168, s[44:45] offset:0
    s_add_u32 m0, s70, 5120
    s_nop 0
    global_load_lds_dwordx4 v169, s[44:45] offset:0
    s_add_u32 m0, s70, 6144
    s_nop 0
    global_load_lds_dwordx4 v168, s[46:47] offset:0
    s_add_u32 m0, s70, 7168
    s_nop 0
    global_load_lds_dwordx4 v169, s[46:47] offset:0
    s_xor_b32 s89, s88, 1
    s_mul_i32 s89, s89, 57344
    s_add_u32 s48, s50, s89
    s_addc_u32 s49, s51, 0
    s_add_u32 m0, s84, 16384
    s_nop 0
    global_load_lds_dwordx4 v170, s[48:49] offset:0
    s_add_u32 m0, s84, 17408
    s_nop 0
    global_load_lds_dwordx4 v171, s[48:49] offset:0
    v_xor_b32 v168, 128, v168
    v_xor_b32 v169, 128, v169
    s_add_u32 m0, s70, 8192
    s_nop 0
    global_load_lds_dwordx4 v168, s[40:41] offset:0
    s_add_u32 m0, s70, 9216
    s_nop 0
    global_load_lds_dwordx4 v169, s[40:41] offset:0
    s_add_u32 m0, s70, 10240
    s_nop 0
    global_load_lds_dwordx4 v168, s[42:43] offset:0
    s_add_u32 m0, s70, 11264
    s_nop 0
    global_load_lds_dwordx4 v169, s[42:43] offset:0
    s_add_u32 m0, s70, 12288
    s_nop 0
    global_load_lds_dwordx4 v168, s[44:45] offset:0
    s_add_u32 m0, s70, 13312
    s_nop 0
    global_load_lds_dwordx4 v169, s[44:45] offset:0
    s_add_u32 m0, s70, 14336
    s_nop 0
    global_load_lds_dwordx4 v168, s[46:47] offset:0
    s_add_u32 m0, s70, 15360
    s_nop 0
    global_load_lds_dwordx4 v169, s[46:47] offset:0
    v_add_u32 v187, s70, v176
    v_xor_b32 v188, 64, v187
    v_mov_b32 v0, 0
    v_mov_b32 v1, 0
    v_mov_b32 v2, 0
    v_mov_b32 v3, 0
    v_mov_b32 v4, 0
    v_mov_b32 v5, 0
    v_mov_b32 v6, 0
    v_mov_b32 v7, 0
    v_mov_b32 v8, 0
    v_mov_b32 v9, 0
    v_mov_b32 v10, 0
    v_mov_b32 v11, 0
    v_mov_b32 v12, 0
    v_mov_b32 v13, 0
    v_mov_b32 v14, 0
    v_mov_b32 v15, 0
    v_mov_b32 v16, 0
    v_mov_b32 v17, 0
    v_mov_b32 v18, 0
    v_mov_b32 v19, 0
    v_mov_b32 v20, 0
    v_mov_b32 v21, 0
    v_mov_b32 v22, 0
    v_mov_b32 v23, 0
    v_mov_b32 v24, 0
    v_mov_b32 v25, 0
    v_mov_b32 v26, 0
    v_mov_b32 v27, 0
    v_mov_b32 v28, 0
    v_mov_b32 v29, 0
    v_mov_b32 v30, 0
    v_mov_b32 v31, 0
    v_mov_b32 v32, 0
    v_mov_b32 v33, 0
    v_mov_b32 v34, 0
    v_mov_b32 v35, 0
    v_mov_b32 v36, 0
    v_mov_b32 v37, 0
    v_mov_b32 v38, 0
    v_mov_b32 v39, 0
    v_mov_b32 v40, 0
    v_mov_b32 v41, 0
    v_mov_b32 v42, 0
    v_mov_b32 v43, 0
    v_mov_b32 v44, 0
    v_mov_b32 v45, 0
    v_mov_b32 v46, 0
    v_mov_b32 v47, 0
    v_mov_b32 v48, 0
    v_mov_b32 v49, 0
    v_mov_b32 v50, 0
    v_mov_b32 v51, 0
    v_mov_b32 v52, 0
    v_mov_b32 v53, 0
    v_mov_b32 v54, 0
    v_mov_b32 v55, 0
    v_mov_b32 v56, 0
    v_mov_b32 v57, 0
    v_mov_b32 v58, 0
    v_mov_b32 v59, 0
    v_mov_b32 v60, 0
    v_mov_b32 v61, 0
    v_mov_b32 v62, 0
    v_mov_b32 v63, 0
    v_mov_b32 v64, 0
    v_mov_b32 v65, 0
    v_mov_b32 v66, 0
    v_mov_b32 v67, 0
    v_mov_b32 v68, 0
    v_mov_b32 v69, 0
    v_mov_b32 v70, 0
    v_mov_b32 v71, 0
    v_mov_b32 v72, 0
    v_mov_b32 v73, 0
    v_mov_b32 v74, 0
    v_mov_b32 v75, 0
    v_mov_b32 v76, 0
    v_mov_b32 v77, 0
    v_mov_b32 v78, 0
    v_mov_b32 v79, 0
    v_mov_b32 v80, 0
    v_mov_b32 v81, 0
    v_mov_b32 v82, 0
    v_mov_b32 v83, 0
    v_mov_b32 v84, 0
    v_mov_b32 v85, 0
    v_mov_b32 v86, 0
    v_mov_b32 v87, 0
    v_mov_b32 v88, 0
    v_mov_b32 v89, 0
    v_mov_b32 v90, 0
    v_mov_b32 v91, 0
    v_mov_b32 v92, 0
    v_mov_b32 v93, 0
    v_mov_b32 v94, 0
    v_mov_b32 v95, 0
    v_mov_b32 v96, 0
    v_mov_b32 v97, 0
    v_mov_b32 v98, 0
    v_mov_b32 v99, 0
    v_mov_b32 v100, 0
    v_mov_b32 v101, 0
    v_mov_b32 v102, 0
    v_mov_b32 v103, 0
    v_mov_b32 v104, 0
    v_mov_b32 v105, 0
    v_mov_b32 v106, 0
    v_mov_b32 v107, 0
    v_mov_b32 v108, 0
    v_mov_b32 v109, 0
    v_mov_b32 v110, 0
    v_mov_b32 v111, 0
    s_waitcnt vmcnt(10)
    s_barrier
    ds_read_b128 v[112:115], v187 offset:0
    ds_read_b128 v[116:119], v187 offset:2048
    ds_read_b128 v[120:123], v187 offset:4096
    ds_read_b128 v[124:127], v187 offset:6144
    ds_read_b64_tr_b16 v[144:145], v177 offset:0
    ds_read_b64_tr_b16 v[146:147], v177 offset:1024
    ds_read_b64_tr_b16 v[148:149], v178 offset:0
    ds_read_b64_tr_b16 v[150:151], v178 offset:1024
    ds_read_b64_tr_b16 v[152:153], v179 offset:0
    ds_read_b64_tr_b16 v[154:155], v179 offset:1024
    ds_read_b64_tr_b16 v[156:157], v180 offset:0
    ds_read_b64_tr_b16 v[158:159], v180 offset:1024
    ds_read_b64_tr_b16 v[160:161], v181 offset:0
    ds_read_b64_tr_b16 v[162:163], v181 offset:1024
    s_waitcnt lgkmcnt(8)
    v_mfma_f32_16x16x32_bf16 v[0:3], v[112:115], v[144:147], v[0:3]
    ds_read_b64_tr_b16 v[164:165], v182 offset:0
    ds_read_b64_tr_b16 v[166:167], v182 offset:1024
    v_mfma_f32_16x16x32_bf16 v[28:31], v[116:119], v[144:147], v[28:31]
    v_mfma_f32_16x16x32_bf16 v[56:59], v[120:123], v[144:147], v[56:59]
    v_mfma_f32_16x16x32_bf16 v[84:87], v[124:127], v[144:147], v[84:87]
    s_xor_b32 s89, s88, 2
    s_mul_i32 s89, s89, 57344
    s_add_u32 s48, s50, s89
    s_addc_u32 s49, s51, 0
    s_add_u32 m0, s84, 32768
    s_nop 0
    global_load_lds_dwordx4 v170, s[48:49] offset:0
    s_add_u32 m0, s84, 33792
    s_nop 0
    global_load_lds_dwordx4 v171, s[48:49] offset:0
    s_waitcnt lgkmcnt(8)
    v_mfma_f32_16x16x32_bf16 v[4:7], v[112:115], v[148:151], v[4:7]
    ds_read_b64_tr_b16 v[144:145], v183 offset:0
    ds_read_b64_tr_b16 v[146:147], v183 offset:1024
    v_mfma_f32_16x16x32_bf16 v[32:35], v[116:119], v[148:151], v[32:35]
    v_mfma_f32_16x16x32_bf16 v[60:63], v[120:123], v[148:151], v[60:63]
    v_mfma_f32_16x16x32_bf16 v[88:91], v[124:127], v[148:151], v[88:91]
    v_xor_b32 v168, 384, v168
    v_xor_b32 v169, 384, v169
    s_add_u32 m0, s70, 16384
    s_nop 0
    global_load_lds_dwordx4 v168, s[40:41] offset:0
    s_add_u32 m0, s70, 17408
    s_nop 0
    global_load_lds_dwordx4 v169, s[40:41] offset:0
    s_waitcnt lgkmcnt(8)
    v_mfma_f32_16x16x32_bf16 v[8:11], v[112:115], v[152:155], v[8:11]
    ds_read_b128 v[128:131], v188 offset:0
    ds_read_b128 v[132:135], v188 offset:2048
    ds_read_b128 v[136:139], v188 offset:4096
    ds_read_b128 v[140:143], v188 offset:6144
    ds_read_b64_tr_b16 v[148:149], v177 offset:8192
    ds_read_b64_tr_b16 v[150:151], v177 offset:9216
    v_mfma_f32_16x16x32_bf16 v[36:39], v[116:119], v[152:155], v[36:39]
    v_mfma_f32_16x16x32_bf16 v[64:67], v[120:123], v[152:155], v[64:67]
    v_mfma_f32_16x16x32_bf16 v[92:95], v[124:127], v[152:155], v[92:95]
    s_add_u32 m0, s70, 18432
    s_nop 0
    global_load_lds_dwordx4 v168, s[42:43] offset:0
    s_add_u32 m0, s70, 19456
    s_nop 0
    global_load_lds_dwordx4 v169, s[42:43] offset:0
    s_waitcnt lgkmcnt(12)
    v_mfma_f32_16x16x32_bf16 v[12:15], v[112:115], v[156:159], v[12:15]
    ds_read_b64_tr_b16 v[152:153], v178 offset:8192
    ds_read_b64_tr_b16 v[154:155], v178 offset:9216
    v_mfma_f32_16x16x32_bf16 v[40:43], v[116:119], v[156:159], v[40:43]
    v_mfma_f32_16x16x32_bf16 v[68:71], v[120:123], v[156:159], v[68:71]
    v_mfma_f32_16x16x32_bf16 v[96:99], v[124:127], v[156:159], v[96:99]
    s_add_u32 m0, s70, 20480
    s_nop 0
    global_load_lds_dwordx4 v168, s[44:45] offset:0
    s_add_u32 m0, s70, 21504
    s_nop 0
    global_load_lds_dwordx4 v169, s[44:45] offset:0
    s_waitcnt lgkmcnt(12)
    v_mfma_f32_16x16x32_bf16 v[16:19], v[112:115], v[160:163], v[16:19]
    ds_read_b64_tr_b16 v[156:157], v179 offset:8192
    ds_read_b64_tr_b16 v[158:159], v179 offset:9216
    v_mfma_f32_16x16x32_bf16 v[44:47], v[116:119], v[160:163], v[44:47]
    v_mfma_f32_16x16x32_bf16 v[72:75], v[120:123], v[160:163], v[72:75]
    v_mfma_f32_16x16x32_bf16 v[100:103], v[124:127], v[160:163], v[100:103]
    s_add_u32 m0, s70, 22528
    s_nop 0
    global_load_lds_dwordx4 v168, s[46:47] offset:0
    s_add_u32 m0, s70, 23552
    s_nop 0
    global_load_lds_dwordx4 v169, s[46:47] offset:0
    s_waitcnt lgkmcnt(12)
    v_mfma_f32_16x16x32_bf16 v[20:23], v[112:115], v[164:167], v[20:23]
    ds_read_b64_tr_b16 v[160:161], v180 offset:8192
    ds_read_b64_tr_b16 v[162:163], v180 offset:9216
    v_mfma_f32_16x16x32_bf16 v[48:51], v[116:119], v[164:167], v[48:51]
    v_mfma_f32_16x16x32_bf16 v[76:79], v[120:123], v[164:167], v[76:79]
    v_mfma_f32_16x16x32_bf16 v[104:107], v[124:127], v[164:167], v[104:107]
    s_waitcnt lgkmcnt(12)
    v_mfma_f32_16x16x32_bf16 v[24:27], v[112:115], v[144:147], v[24:27]
    ds_read_b64_tr_b16 v[164:165], v181 offset:8192
    ds_read_b64_tr_b16 v[166:167], v181 offset:9216
    v_mfma_f32_16x16x32_bf16 v[52:55], v[116:119], v[144:147], v[52:55]
    v_mfma_f32_16x16x32_bf16 v[80:83], v[120:123], v[144:147], v[80:83]
    v_mfma_f32_16x16x32_bf16 v[108:111], v[124:127], v[144:147], v[108:111]
    s_waitcnt lgkmcnt(8)
    v_mfma_f32_16x16x32_bf16 v[0:3], v[128:131], v[148:151], v[0:3]
    ds_read_b64_tr_b16 v[144:145], v182 offset:8192
    ds_read_b64_tr_b16 v[146:147], v182 offset:9216
    v_mfma_f32_16x16x32_bf16 v[28:31], v[132:135], v[148:151], v[28:31]
    v_mfma_f32_16x16x32_bf16 v[56:59], v[136:139], v[148:151], v[56:59]
    v_mfma_f32_16x16x32_bf16 v[84:87], v[140:143], v[148:151], v[84:87]
    s_waitcnt lgkmcnt(8)
    v_mfma_f32_16x16x32_bf16 v[4:7], v[128:131], v[152:155], v[4:7]
    ds_read_b64_tr_b16 v[148:149], v183 offset:8192
    ds_read_b64_tr_b16 v[150:151], v183 offset:9216
    v_mfma_f32_16x16x32_bf16 v[32:35], v[132:135], v[152:155], v[32:35]
    v_mfma_f32_16x16x32_bf16 v[60:63], v[136:139], v[152:155], v[60:63]
    v_mfma_f32_16x16x32_bf16 v[88:91], v[140:143], v[152:155], v[88:91]
    s_waitcnt lgkmcnt(8)
    v_mfma_f32_16x16x32_bf16 v[8:11], v[128:131], v[156:159], v[8:11]
    v_mfma_f32_16x16x32_bf16 v[36:39], v[132:135], v[156:159], v[36:39]
    v_mfma_f32_16x16x32_bf16 v[64:67], v[136:139], v[156:159], v[64:67]
    v_mfma_f32_16x16x32_bf16 v[92:95], v[140:143], v[156:159], v[92:95]
    s_waitcnt lgkmcnt(6)
    v_mfma_f32_16x16x32_bf16 v[12:15], v[128:131], v[160:163], v[12:15]
    v_mfma_f32_16x16x32_bf16 v[40:43], v[132:135], v[160:163], v[40:43]
    v_mfma_f32_16x16x32_bf16 v[68:71], v[136:139], v[160:163], v[68:71]
    v_mfma_f32_16x16x32_bf16 v[96:99], v[140:143], v[160:163], v[96:99]
    s_waitcnt lgkmcnt(4)
    v_mfma_f32_16x16x32_bf16 v[16:19], v[128:131], v[164:167], v[16:19]
    v_mfma_f32_16x16x32_bf16 v[44:47], v[132:135], v[164:167], v[44:47]
    v_mfma_f32_16x16x32_bf16 v[72:75], v[136:139], v[164:167], v[72:75]
    v_mfma_f32_16x16x32_bf16 v[100:103], v[140:143], v[164:167], v[100:103]
    s_waitcnt lgkmcnt(2)
    v_mfma_f32_16x16x32_bf16 v[20:23], v[128:131], v[144:147], v[20:23]
    v_mfma_f32_16x16x32_bf16 v[48:51], v[132:135], v[144:147], v[48:51]
    v_mfma_f32_16x16x32_bf16 v[76:79], v[136:139], v[144:147], v[76:79]
    v_mfma_f32_16x16x32_bf16 v[104:107], v[140:143], v[144:147], v[104:107]
    s_waitcnt lgkmcnt(0)
    v_mfma_f32_16x16x32_bf16 v[24:27], v[128:131], v[148:151], v[24:27]
    v_mfma_f32_16x16x32_bf16 v[52:55], v[132:135], v[148:151], v[52:55]
    v_mfma_f32_16x16x32_bf16 v[80:83], v[136:139], v[148:151], v[80:83]
    v_mfma_f32_16x16x32_bf16 v[108:111], v[140:143], v[148:151], v[108:111]
    s_waitcnt vmcnt(10)
    s_barrier
    ds_read_b128 v[112:115], v187 offset:8192
    ds_read_b128 v[116:119], v187 offset:10240
    ds_read_b128 v[120:123], v187 offset:12288
    ds_read_b128 v[124:127], v187 offset:14336
    ds_read_b64_tr_b16 v[152:153], v177 offset:16384
    ds_read_b64_tr_b16 v[154:155], v177 offset:17408
    ds_read_b64_tr_b16 v[156:157], v178 offset:16384
    ds_read_b64_tr_b16 v[158:159], v178 offset:17408
    ds_read_b64_tr_b16 v[160:161], v179 offset:16384
    ds_read_b64_tr_b16 v[162:163], v179 offset:17408
    ds_read_b64_tr_b16 v[164:165], v180 offset:16384
    ds_read_b64_tr_b16 v[166:167], v180 offset:17408
    ds_read_b64_tr_b16 v[144:145], v181 offset:16384
    ds_read_b64_tr_b16 v[146:147], v181 offset:17408
    s_waitcnt lgkmcnt(8)
    v_mfma_f32_16x16x32_bf16 v[0:3], v[112:115], v[152:155], v[0:3]
    ds_read_b64_tr_b16 v[148:149], v182 offset:16384
    ds_read_b64_tr_b16 v[150:151], v182 offset:17408
    v_mfma_f32_16x16x32_bf16 v[28:31], v[116:119], v[152:155], v[28:31]
    v_mfma_f32_16x16x32_bf16 v[56:59], v[120:123], v[152:155], v[56:59]
    v_mfma_f32_16x16x32_bf16 v[84:87], v[124:127], v[152:155], v[84:87]
    s_xor_b32 s89, s88, 3
    s_mul_i32 s89, s89, 57344
    s_add_u32 s48, s50, s89
    s_addc_u32 s49, s51, 0
    s_add_u32 m0, s84, 49152
    s_nop 0
    global_load_lds_dwordx4 v170, s[48:49] offset:0
    s_add_u32 m0, s84, 50176
    s_nop 0
    global_load_lds_dwordx4 v171, s[48:49] offset:0
    s_waitcnt lgkmcnt(8)
    v_mfma_f32_16x16x32_bf16 v[4:7], v[112:115], v[156:159], v[4:7]
    ds_read_b64_tr_b16 v[152:153], v183 offset:16384
    ds_read_b64_tr_b16 v[154:155], v183 offset:17408
    v_mfma_f32_16x16x32_bf16 v[32:35], v[116:119], v[156:159], v[32:35]
    v_mfma_f32_16x16x32_bf16 v[60:63], v[120:123], v[156:159], v[60:63]
    v_mfma_f32_16x16x32_bf16 v[88:91], v[124:127], v[156:159], v[88:91]
    v_xor_b32 v168, 128, v168
    v_xor_b32 v169, 128, v169
    s_add_u32 m0, s70, 0
    s_nop 0
    global_load_lds_dwordx4 v168, s[40:41] offset:0
    s_add_u32 m0, s70, 1024
    s_nop 0
    global_load_lds_dwordx4 v169, s[40:41] offset:0
    s_waitcnt lgkmcnt(8)
    v_mfma_f32_16x16x32_bf16 v[8:11], v[112:115], v[160:163], v[8:11]
    ds_read_b128 v[128:131], v188 offset:8192
    ds_read_b128 v[132:135], v188 offset:10240
    ds_read_b128 v[136:139], v188 offset:12288
    ds_read_b128 v[140:143], v188 offset:14336
    ds_read_b64_tr_b16 v[156:157], v177 offset:24576
    ds_read_b64_tr_b16 v[158:159], v177 offset:25600
    v_mfma_f32_16x16x32_bf16 v[36:39], v[116:119], v[160:163], v[36:39]
    v_mfma_f32_16x16x32_bf16 v[64:67], v[120:123], v[160:163], v[64:67]
    v_mfma_f32_16x16x32_bf16 v[92:95], v[124:127], v[160:163], v[92:95]
    s_add_u32 m0, s70, 2048
    s_nop 0
    global_load_lds_dwordx4 v168, s[42:43] offset:0
    s_add_u32 m0, s70, 3072
    s_nop 0
    global_load_lds_dwordx4 v169, s[42:43] offset:0
    s_waitcnt lgkmcnt(12)
    v_mfma_f32_16x16x32_bf16 v[12:15], v[112:115], v[164:167], v[12:15]
    ds_read_b64_tr_b16 v[160:161], v178 offset:24576
    ds_read_b64_tr_b16 v[162:163], v178 offset:25600
    v_mfma_f32_16x16x32_bf16 v[40:43], v[116:119], v[164:167], v[40:43]
    v_mfma_f32_16x16x32_bf16 v[68:71], v[120:123], v[164:167], v[68:71]
    v_mfma_f32_16x16x32_bf16 v[96:99], v[124:127], v[164:167], v[96:99]
    s_add_u32 m0, s70, 4096
    s_nop 0
    global_load_lds_dwordx4 v168, s[44:45] offset:0
    s_add_u32 m0, s70, 5120
    s_nop 0
    global_load_lds_dwordx4 v169, s[44:45] offset:0
    s_waitcnt lgkmcnt(12)
    v_mfma_f32_16x16x32_bf16 v[16:19], v[112:115], v[144:147], v[16:19]
    ds_read_b64_tr_b16 v[164:165], v179 offset:24576
    ds_read_b64_tr_b16 v[166:167], v179 offset:25600
    v_mfma_f32_16x16x32_bf16 v[44:47], v[116:119], v[144:147], v[44:47]
    v_mfma_f32_16x16x32_bf16 v[72:75], v[120:123], v[144:147], v[72:75]
    v_mfma_f32_16x16x32_bf16 v[100:103], v[124:127], v[144:147], v[100:103]
    s_add_u32 m0, s70, 6144
    s_nop 0
    global_load_lds_dwordx4 v168, s[46:47] offset:0
    s_add_u32 m0, s70, 7168
    s_nop 0
    global_load_lds_dwordx4 v169, s[46:47] offset:0
    s_waitcnt lgkmcnt(12)
    v_mfma_f32_16x16x32_bf16 v[20:23], v[112:115], v[148:151], v[20:23]
    ds_read_b64_tr_b16 v[144:145], v180 offset:24576
    ds_read_b64_tr_b16 v[146:147], v180 offset:25600
    v_mfma_f32_16x16x32_bf16 v[48:51], v[116:119], v[148:151], v[48:51]
    v_mfma_f32_16x16x32_bf16 v[76:79], v[120:123], v[148:151], v[76:79]
    v_mfma_f32_16x16x32_bf16 v[104:107], v[124:127], v[148:151], v[104:107]
    s_waitcnt lgkmcnt(12)
    v_mfma_f32_16x16x32_bf16 v[24:27], v[112:115], v[152:155], v[24:27]
    ds_read_b64_tr_b16 v[148:149], v181 offset:24576
    ds_read_b64_tr_b16 v[150:151], v181 offset:25600
    v_mfma_f32_16x16x32_bf16 v[52:55], v[116:119], v[152:155], v[52:55]
    v_mfma_f32_16x16x32_bf16 v[80:83], v[120:123], v[152:155], v[80:83]
    v_mfma_f32_16x16x32_bf16 v[108:111], v[124:127], v[152:155], v[108:111]
    s_waitcnt lgkmcnt(8)
    v_mfma_f32_16x16x32_bf16 v[0:3], v[128:131], v[156:159], v[0:3]
    ds_read_b64_tr_b16 v[152:153], v182 offset:24576
    ds_read_b64_tr_b16 v[154:155], v182 offset:25600
    v_mfma_f32_16x16x32_bf16 v[28:31], v[132:135], v[156:159], v[28:31]
    v_mfma_f32_16x16x32_bf16 v[56:59], v[136:139], v[156:159], v[56:59]
    v_mfma_f32_16x16x32_bf16 v[84:87], v[140:143], v[156:159], v[84:87]
    s_waitcnt lgkmcnt(8)
    v_mfma_f32_16x16x32_bf16 v[4:7], v[128:131], v[160:163], v[4:7]
    ds_read_b64_tr_b16 v[156:157], v183 offset:24576
    ds_read_b64_tr_b16 v[158:159], v183 offset:25600
    v_mfma_f32_16x16x32_bf16 v[32:35], v[132:135], v[160:163], v[32:35]
    v_mfma_f32_16x16x32_bf16 v[60:63], v[136:139], v[160:163], v[60:63]
    v_mfma_f32_16x16x32_bf16 v[88:91], v[140:143], v[160:163], v[88:91]
    s_waitcnt lgkmcnt(8)
    v_mfma_f32_16x16x32_bf16 v[8:11], v[128:131], v[164:167], v[8:11]
    v_mfma_f32_16x16x32_bf16 v[36:39], v[132:135], v[164:167], v[36:39]
    v_mfma_f32_16x16x32_bf16 v[64:67], v[136:139], v[164:167], v[64:67]
    v_mfma_f32_16x16x32_bf16 v[92:95], v[140:143], v[164:167], v[92:95]
    s_waitcnt lgkmcnt(6)
    v_mfma_f32_16x16x32_bf16 v[12:15], v[128:131], v[144:147], v[12:15]
    v_mfma_f32_16x16x32_bf16 v[40:43], v[132:135], v[144:147], v[40:43]
    v_mfma_f32_16x16x32_bf16 v[68:71], v[136:139], v[144:147], v[68:71]
    v_mfma_f32_16x16x32_bf16 v[96:99], v[140:143], v[144:147], v[96:99]
    s_waitcnt lgkmcnt(4)
    v_mfma_f32_16x16x32_bf16 v[16:19], v[128:131], v[148:151], v[16:19]
    v_mfma_f32_16x16x32_bf16 v[44:47], v[132:135], v[148:151], v[44:47]
    v_mfma_f32_16x16x32_bf16 v[72:75], v[136:139], v[148:151], v[72:75]
    v_mfma_f32_16x16x32_bf16 v[100:103], v[140:143], v[148:151], v[100:103]
    s_waitcnt lgkmcnt(2)
    v_mfma_f32_16x16x32_bf16 v[20:23], v[128:131], v[152:155], v[20:23]
    v_mfma_f32_16x16x32_bf16 v[48:51], v[132:135], v[152:155], v[48:51]
    v_mfma_f32_16x16x32_bf16 v[76:79], v[136:139], v[152:155], v[76:79]
    v_mfma_f32_16x16x32_bf16 v[104:107], v[140:143], v[152:155], v[104:107]
    s_waitcnt lgkmcnt(0)
    v_mfma_f32_16x16x32_bf16 v[24:27], v[128:131], v[156:159], v[24:27]
    v_mfma_f32_16x16x32_bf16 v[52:55], v[132:135], v[156:159], v[52:55]
    v_mfma_f32_16x16x32_bf16 v[80:83], v[136:139], v[156:159], v[80:83]
    v_mfma_f32_16x16x32_bf16 v[108:111], v[140:143], v[156:159], v[108:111]
    s_waitcnt vmcnt(10)
    s_barrier
    ds_read_b128 v[112:115], v187 offset:16384
    ds_read_b128 v[116:119], v187 offset:18432
    ds_read_b128 v[120:123], v187 offset:20480
    ds_read_b128 v[124:127], v187 offset:22528
    ds_read_b64_tr_b16 v[160:161], v177 offset:32768
    ds_read_b64_tr_b16 v[162:163], v177 offset:33792
    ds_read_b64_tr_b16 v[164:165], v178 offset:32768
    ds_read_b64_tr_b16 v[166:167], v178 offset:33792
    ds_read_b64_tr_b16 v[144:145], v179 offset:32768
    ds_read_b64_tr_b16 v[146:147], v179 offset:33792
    ds_read_b64_tr_b16 v[148:149], v180 offset:32768
    ds_read_b64_tr_b16 v[150:151], v180 offset:33792
    ds_read_b64_tr_b16 v[152:153], v181 offset:32768
    ds_read_b64_tr_b16 v[154:155], v181 offset:33792
    s_waitcnt lgkmcnt(8)
    v_mfma_f32_16x16x32_bf16 v[0:3], v[112:115], v[160:163], v[0:3]
    ds_read_b64_tr_b16 v[156:157], v182 offset:32768
    ds_read_b64_tr_b16 v[158:159], v182 offset:33792
    v_mfma_f32_16x16x32_bf16 v[28:31], v[116:119], v[160:163], v[28:31]
    v_mfma_f32_16x16x32_bf16 v[56:59], v[120:123], v[160:163], v[56:59]
    v_mfma_f32_16x16x32_bf16 v[84:87], v[124:127], v[160:163], v[84:87]
    s_waitcnt lgkmcnt(8)
    v_mfma_f32_16x16x32_bf16 v[4:7], v[112:115], v[164:167], v[4:7]
    ds_read_b64_tr_b16 v[160:161], v183 offset:32768
    ds_read_b64_tr_b16 v[162:163], v183 offset:33792
    v_mfma_f32_16x16x32_bf16 v[32:35], v[116:119], v[164:167], v[32:35]
    v_mfma_f32_16x16x32_bf16 v[60:63], v[120:123], v[164:167], v[60:63]
    v_mfma_f32_16x16x32_bf16 v[88:91], v[124:127], v[164:167], v[88:91]
    s_waitcnt lgkmcnt(8)
    v_mfma_f32_16x16x32_bf16 v[8:11], v[112:115], v[144:147], v[8:11]
    ds_read_b128 v[128:131], v188 offset:16384
    ds_read_b128 v[132:135], v188 offset:18432
    ds_read_b128 v[136:139], v188 offset:20480
    ds_read_b128 v[140:143], v188 offset:22528
    ds_read_b64_tr_b16 v[164:165], v177 offset:40960
    ds_read_b64_tr_b16 v[166:167], v177 offset:41984
    v_mfma_f32_16x16x32_bf16 v[36:39], v[116:119], v[144:147], v[36:39]
    v_mfma_f32_16x16x32_bf16 v[64:67], v[120:123], v[144:147], v[64:67]
    v_mfma_f32_16x16x32_bf16 v[92:95], v[124:127], v[144:147], v[92:95]
    s_waitcnt lgkmcnt(12)
    v_mfma_f32_16x16x32_bf16 v[12:15], v[112:115], v[148:151], v[12:15]
    ds_read_b64_tr_b16 v[144:145], v178 offset:40960
    ds_read_b64_tr_b16 v[146:147], v178 offset:41984
    v_mfma_f32_16x16x32_bf16 v[40:43], v[116:119], v[148:151], v[40:43]
    v_mfma_f32_16x16x32_bf16 v[68:71], v[120:123], v[148:151], v[68:71]
    v_mfma_f32_16x16x32_bf16 v[96:99], v[124:127], v[148:151], v[96:99]
    s_waitcnt lgkmcnt(12)
    v_mfma_f32_16x16x32_bf16 v[16:19], v[112:115], v[152:155], v[16:19]
    ds_read_b64_tr_b16 v[148:149], v179 offset:40960
    ds_read_b64_tr_b16 v[150:151], v179 offset:41984
    v_mfma_f32_16x16x32_bf16 v[44:47], v[116:119], v[152:155], v[44:47]
    v_mfma_f32_16x16x32_bf16 v[72:75], v[120:123], v[152:155], v[72:75]
    v_mfma_f32_16x16x32_bf16 v[100:103], v[124:127], v[152:155], v[100:103]
    s_waitcnt lgkmcnt(12)
    v_mfma_f32_16x16x32_bf16 v[20:23], v[112:115], v[156:159], v[20:23]
    ds_read_b64_tr_b16 v[152:153], v180 offset:40960
    ds_read_b64_tr_b16 v[154:155], v180 offset:41984
    v_mfma_f32_16x16x32_bf16 v[48:51], v[116:119], v[156:159], v[48:51]
    v_mfma_f32_16x16x32_bf16 v[76:79], v[120:123], v[156:159], v[76:79]
    v_mfma_f32_16x16x32_bf16 v[104:107], v[124:127], v[156:159], v[104:107]
    s_waitcnt lgkmcnt(12)
    v_mfma_f32_16x16x32_bf16 v[24:27], v[112:115], v[160:163], v[24:27]
    ds_read_b64_tr_b16 v[156:157], v181 offset:40960
    ds_read_b64_tr_b16 v[158:159], v181 offset:41984
    v_mfma_f32_16x16x32_bf16 v[52:55], v[116:119], v[160:163], v[52:55]
    v_mfma_f32_16x16x32_bf16 v[80:83], v[120:123], v[160:163], v[80:83]
    v_mfma_f32_16x16x32_bf16 v[108:111], v[124:127], v[160:163], v[108:111]
    s_waitcnt lgkmcnt(8)
    v_mfma_f32_16x16x32_bf16 v[0:3], v[128:131], v[164:167], v[0:3]
    ds_read_b64_tr_b16 v[160:161], v182 offset:40960
    ds_read_b64_tr_b16 v[162:163], v182 offset:41984
    v_mfma_f32_16x16x32_bf16 v[28:31], v[132:135], v[164:167], v[28:31]
    v_mfma_f32_16x16x32_bf16 v[56:59], v[136:139], v[164:167], v[56:59]
    v_mfma_f32_16x16x32_bf16 v[84:87], v[140:143], v[164:167], v[84:87]
    s_waitcnt lgkmcnt(8)
    v_mfma_f32_16x16x32_bf16 v[4:7], v[128:131], v[144:147], v[4:7]
    ds_read_b64_tr_b16 v[164:165], v183 offset:40960
    ds_read_b64_tr_b16 v[166:167], v183 offset:41984
    v_mfma_f32_16x16x32_bf16 v[32:35], v[132:135], v[144:147], v[32:35]
    v_mfma_f32_16x16x32_bf16 v[60:63], v[136:139], v[144:147], v[60:63]
    v_mfma_f32_16x16x32_bf16 v[88:91], v[140:143], v[144:147], v[88:91]
    s_waitcnt lgkmcnt(8)
    v_mfma_f32_16x16x32_bf16 v[8:11], v[128:131], v[148:151], v[8:11]
    v_mfma_f32_16x16x32_bf16 v[36:39], v[132:135], v[148:151], v[36:39]
    v_mfma_f32_16x16x32_bf16 v[64:67], v[136:139], v[148:151], v[64:67]
    v_mfma_f32_16x16x32_bf16 v[92:95], v[140:143], v[148:151], v[92:95]
    s_waitcnt lgkmcnt(6)
    v_mfma_f32_16x16x32_bf16 v[12:15], v[128:131], v[152:155], v[12:15]
    v_mfma_f32_16x16x32_bf16 v[40:43], v[132:135], v[152:155], v[40:43]
    v_mfma_f32_16x16x32_bf16 v[68:71], v[136:139], v[152:155], v[68:71]
    v_mfma_f32_16x16x32_bf16 v[96:99], v[140:143], v[152:155], v[96:99]
    s_waitcnt lgkmcnt(4)
    v_mfma_f32_16x16x32_bf16 v[16:19], v[128:131], v[156:159], v[16:19]
    v_mfma_f32_16x16x32_bf16 v[44:47], v[132:135], v[156:159], v[44:47]
    v_mfma_f32_16x16x32_bf16 v[72:75], v[136:139], v[156:159], v[72:75]
    v_mfma_f32_16x16x32_bf16 v[100:103], v[140:143], v[156:159], v[100:103]
    s_waitcnt lgkmcnt(2)
    v_mfma_f32_16x16x32_bf16 v[20:23], v[128:131], v[160:163], v[20:23]
    v_mfma_f32_16x16x32_bf16 v[48:51], v[132:135], v[160:163], v[48:51]
    v_mfma_f32_16x16x32_bf16 v[76:79], v[136:139], v[160:163], v[76:79]
    v_mfma_f32_16x16x32_bf16 v[104:107], v[140:143], v[160:163], v[104:107]
    s_waitcnt lgkmcnt(0)
    v_mfma_f32_16x16x32_bf16 v[24:27], v[128:131], v[164:167], v[24:27]
    v_mfma_f32_16x16x32_bf16 v[52:55], v[132:135], v[164:167], v[52:55]
    v_mfma_f32_16x16x32_bf16 v[80:83], v[136:139], v[164:167], v[80:83]
    v_mfma_f32_16x16x32_bf16 v[108:111], v[140:143], v[164:167], v[108:111]
    s_waitcnt vmcnt(0)
    s_barrier
    v_mov_b32 v185, 143360
    ds_read_b32 v185, v185
    ds_read_b128 v[112:115], v187 offset:0
    ds_read_b128 v[116:119], v187 offset:2048
    ds_read_b128 v[120:123], v187 offset:4096
    ds_read_b128 v[124:127], v187 offset:6144
    ds_read_b64_tr_b16 v[144:145], v177 offset:49152
    ds_read_b64_tr_b16 v[146:147], v177 offset:50176
    ds_read_b64_tr_b16 v[148:149], v178 offset:49152
    ds_read_b64_tr_b16 v[150:151], v178 offset:50176
    ds_read_b64_tr_b16 v[152:153], v179 offset:49152
    ds_read_b64_tr_b16 v[154:155], v179 offset:50176
    ds_read_b64_tr_b16 v[156:157], v180 offset:49152
    ds_read_b64_tr_b16 v[158:159], v180 offset:50176
    ds_read_b64_tr_b16 v[160:161], v181 offset:49152
    ds_read_b64_tr_b16 v[162:163], v181 offset:50176
    s_waitcnt lgkmcnt(8)
    v_mfma_f32_16x16x32_bf16 v[0:3], v[112:115], v[144:147], v[0:3]
    ds_read_b64_tr_b16 v[164:165], v182 offset:49152
    ds_read_b64_tr_b16 v[166:167], v182 offset:50176
    v_mfma_f32_16x16x32_bf16 v[28:31], v[116:119], v[144:147], v[28:31]
    v_mfma_f32_16x16x32_bf16 v[56:59], v[120:123], v[144:147], v[56:59]
    v_mfma_f32_16x16x32_bf16 v[84:87], v[124:127], v[144:147], v[84:87]
    s_waitcnt lgkmcnt(8)
    v_mfma_f32_16x16x32_bf16 v[4:7], v[112:115], v[148:151], v[4:7]
    ds_read_b64_tr_b16 v[144:145], v183 offset:49152
    ds_read_b64_tr_b16 v[146:147], v183 offset:50176
    v_mfma_f32_16x16x32_bf16 v[32:35], v[116:119], v[148:151], v[32:35]
    v_mfma_f32_16x16x32_bf16 v[60:63], v[120:123], v[148:151], v[60:63]
    v_mfma_f32_16x16x32_bf16 v[88:91], v[124:127], v[148:151], v[88:91]
    s_waitcnt lgkmcnt(8)
    v_mfma_f32_16x16x32_bf16 v[8:11], v[112:115], v[152:155], v[8:11]
    ds_read_b128 v[128:131], v188 offset:0
    ds_read_b128 v[132:135], v188 offset:2048
    ds_read_b128 v[136:139], v188 offset:4096
    ds_read_b128 v[140:143], v188 offset:6144
    ds_read_b64_tr_b16 v[148:149], v177 offset:57344
    ds_read_b64_tr_b16 v[150:151], v177 offset:58368
    v_mfma_f32_16x16x32_bf16 v[36:39], v[116:119], v[152:155], v[36:39]
    v_mfma_f32_16x16x32_bf16 v[64:67], v[120:123], v[152:155], v[64:67]
    v_mfma_f32_16x16x32_bf16 v[92:95], v[124:127], v[152:155], v[92:95]
    s_waitcnt lgkmcnt(12)
    v_mfma_f32_16x16x32_bf16 v[12:15], v[112:115], v[156:159], v[12:15]
    ds_read_b64_tr_b16 v[152:153], v178 offset:57344
    ds_read_b64_tr_b16 v[154:155], v178 offset:58368
    v_mfma_f32_16x16x32_bf16 v[40:43], v[116:119], v[156:159], v[40:43]
    v_mfma_f32_16x16x32_bf16 v[68:71], v[120:123], v[156:159], v[68:71]
    v_mfma_f32_16x16x32_bf16 v[96:99], v[124:127], v[156:159], v[96:99]
    s_waitcnt lgkmcnt(12)
    v_mfma_f32_16x16x32_bf16 v[16:19], v[112:115], v[160:163], v[16:19]
    ds_read_b64_tr_b16 v[156:157], v179 offset:57344
    ds_read_b64_tr_b16 v[158:159], v179 offset:58368
    v_mfma_f32_16x16x32_bf16 v[44:47], v[116:119], v[160:163], v[44:47]
    v_mfma_f32_16x16x32_bf16 v[72:75], v[120:123], v[160:163], v[72:75]
    v_mfma_f32_16x16x32_bf16 v[100:103], v[124:127], v[160:163], v[100:103]
    s_waitcnt lgkmcnt(12)
    v_mfma_f32_16x16x32_bf16 v[20:23], v[112:115], v[164:167], v[20:23]
    ds_read_b64_tr_b16 v[160:161], v180 offset:57344
    ds_read_b64_tr_b16 v[162:163], v180 offset:58368
    v_mfma_f32_16x16x32_bf16 v[48:51], v[116:119], v[164:167], v[48:51]
    v_mfma_f32_16x16x32_bf16 v[76:79], v[120:123], v[164:167], v[76:79]
    v_mfma_f32_16x16x32_bf16 v[104:107], v[124:127], v[164:167], v[104:107]
    s_waitcnt lgkmcnt(12)
    v_mfma_f32_16x16x32_bf16 v[24:27], v[112:115], v[144:147], v[24:27]
    ds_read_b64_tr_b16 v[164:165], v181 offset:57344
    ds_read_b64_tr_b16 v[166:167], v181 offset:58368
    v_mfma_f32_16x16x32_bf16 v[52:55], v[116:119], v[144:147], v[52:55]
    v_mfma_f32_16x16x32_bf16 v[80:83], v[120:123], v[144:147], v[80:83]
    v_mfma_f32_16x16x32_bf16 v[108:111], v[124:127], v[144:147], v[108:111]
    s_waitcnt lgkmcnt(8)
    v_mfma_f32_16x16x32_bf16 v[0:3], v[128:131], v[148:151], v[0:3]
    ds_read_b64_tr_b16 v[144:145], v182 offset:57344
    ds_read_b64_tr_b16 v[146:147], v182 offset:58368
    v_mfma_f32_16x16x32_bf16 v[28:31], v[132:135], v[148:151], v[28:31]
    v_mfma_f32_16x16x32_bf16 v[56:59], v[136:139], v[148:151], v[56:59]
    v_mfma_f32_16x16x32_bf16 v[84:87], v[140:143], v[148:151], v[84:87]
    s_waitcnt lgkmcnt(8)
    v_mfma_f32_16x16x32_bf16 v[4:7], v[128:131], v[152:155], v[4:7]
    ds_read_b64_tr_b16 v[148:149], v183 offset:57344
    ds_read_b64_tr_b16 v[150:151], v183 offset:58368
    v_mfma_f32_16x16x32_bf16 v[32:35], v[132:135], v[152:155], v[32:35]
    v_mfma_f32_16x16x32_bf16 v[60:63], v[136:139], v[152:155], v[60:63]
    v_mfma_f32_16x16x32_bf16 v[88:91], v[140:143], v[152:155], v[88:91]
    s_waitcnt lgkmcnt(8)
    v_mfma_f32_16x16x32_bf16 v[8:11], v[128:131], v[156:159], v[8:11]
    v_mfma_f32_16x16x32_bf16 v[36:39], v[132:135], v[156:159], v[36:39]
    v_mfma_f32_16x16x32_bf16 v[64:67], v[136:139], v[156:159], v[64:67]
    v_mfma_f32_16x16x32_bf16 v[92:95], v[140:143], v[156:159], v[92:95]
    s_waitcnt lgkmcnt(6)
    v_mfma_f32_16x16x32_bf16 v[12:15], v[128:131], v[160:163], v[12:15]
    v_mfma_f32_16x16x32_bf16 v[40:43], v[132:135], v[160:163], v[40:43]
    v_mfma_f32_16x16x32_bf16 v[68:71], v[136:139], v[160:163], v[68:71]
    v_mfma_f32_16x16x32_bf16 v[96:99], v[140:143], v[160:163], v[96:99]
    s_waitcnt lgkmcnt(4)
    v_mfma_f32_16x16x32_bf16 v[16:19], v[128:131], v[164:167], v[16:19]
    v_mfma_f32_16x16x32_bf16 v[44:47], v[132:135], v[164:167], v[44:47]
    v_mfma_f32_16x16x32_bf16 v[72:75], v[136:139], v[164:167], v[72:75]
    v_mfma_f32_16x16x32_bf16 v[100:103], v[140:143], v[164:167], v[100:103]
    s_waitcnt lgkmcnt(2)
    v_mfma_f32_16x16x32_bf16 v[20:23], v[128:131], v[144:147], v[20:23]
    v_mfma_f32_16x16x32_bf16 v[48:51], v[132:135], v[144:147], v[48:51]
    v_mfma_f32_16x16x32_bf16 v[76:79], v[136:139], v[144:147], v[76:79]
    v_mfma_f32_16x16x32_bf16 v[104:107], v[140:143], v[144:147], v[104:107]
    s_waitcnt lgkmcnt(0)
    v_mfma_f32_16x16x32_bf16 v[24:27], v[128:131], v[148:151], v[24:27]
    v_mfma_f32_16x16x32_bf16 v[52:55], v[132:135], v[148:151], v[52:55]
    v_mfma_f32_16x16x32_bf16 v[80:83], v[136:139], v[148:151], v[80:83]
    v_mfma_f32_16x16x32_bf16 v[108:111], v[140:143], v[148:151], v[108:111]
    s_nop 7
    v_readfirstlane_b32 s32, v185
    v_cvt_pk_bf16_f32 v0, v0, v1
    v_cvt_pk_bf16_f32 v1, v2, v3
    v_cvt_pk_bf16_f32 v2, v28, v29
    v_cvt_pk_bf16_f32 v3, v30, v31
    global_store_dwordx4 v184, v[0:3], s[56:57] offset:0 sc1
    v_cvt_pk_bf16_f32 v56, v56, v57
    v_cvt_pk_bf16_f32 v57, v58, v59
    v_cvt_pk_bf16_f32 v58, v84, v85
    v_cvt_pk_bf16_f32 v59, v86, v87
    global_store_dwordx4 v184, v[56:59], s[56:57] offset:1024 sc1
    v_cvt_pk_bf16_f32 v4, v4, v5
    v_cvt_pk_bf16_f32 v5, v6, v7
    v_cvt_pk_bf16_f32 v6, v32, v33
    v_cvt_pk_bf16_f32 v7, v34, v35
    global_store_dwordx4 v184, v[4:7], s[58:59] offset:0 sc1
    v_cvt_pk_bf16_f32 v60, v60, v61
    v_cvt_pk_bf16_f32 v61, v62, v63
    v_cvt_pk_bf16_f32 v62, v88, v89
    v_cvt_pk_bf16_f32 v63, v90, v91
    global_store_dwordx4 v184, v[60:63], s[58:59] offset:1024 sc1
    v_cvt_pk_bf16_f32 v8, v8, v9
    v_cvt_pk_bf16_f32 v9, v10, v11
    v_cvt_pk_bf16_f32 v10, v36, v37
    v_cvt_pk_bf16_f32 v11, v38, v39
    global_store_dwordx4 v184, v[8:11], s[60:61] offset:0 sc1
    v_cvt_pk_bf16_f32 v64, v64, v65
    v_cvt_pk_bf16_f32 v65, v66, v67
    v_cvt_pk_bf16_f32 v66, v92, v93
    v_cvt_pk_bf16_f32 v67, v94, v95
    global_store_dwordx4 v184, v[64:67], s[60:61] offset:1024 sc1
    v_cvt_pk_bf16_f32 v12, v12, v13
    v_cvt_pk_bf16_f32 v13, v14, v15
    v_cvt_pk_bf16_f32 v14, v40, v41
    v_cvt_pk_bf16_f32 v15, v42, v43
    global_store_dwordx4 v184, v[12:15], s[62:63] offset:0 sc1
    v_cvt_pk_bf16_f32 v68, v68, v69
    v_cvt_pk_bf16_f32 v69, v70, v71
    v_cvt_pk_bf16_f32 v70, v96, v97
    v_cvt_pk_bf16_f32 v71, v98, v99
    global_store_dwordx4 v184, v[68:71], s[62:63] offset:1024 sc1
    v_cvt_pk_bf16_f32 v16, v16, v17
    v_cvt_pk_bf16_f32 v17, v18, v19
    v_cvt_pk_bf16_f32 v18, v44, v45
    v_cvt_pk_bf16_f32 v19, v46, v47
    global_store_dwordx4 v184, v[16:19], s[64:65] offset:0 sc1
    v_cvt_pk_bf16_f32 v72, v72, v73
    v_cvt_pk_bf16_f32 v73, v74, v75
    v_cvt_pk_bf16_f32 v74, v100, v101
    v_cvt_pk_bf16_f32 v75, v102, v103
    global_store_dwordx4 v184, v[72:75], s[64:65] offset:1024 sc1
    v_cvt_pk_bf16_f32 v20, v20, v21
    v_cvt_pk_bf16_f32 v21, v22, v23
    v_cvt_pk_bf16_f32 v22, v48, v49
    v_cvt_pk_bf16_f32 v23, v50, v51
    global_store_dwordx4 v184, v[20:23], s[66:67] offset:0 sc1
    v_cvt_pk_bf16_f32 v76, v76, v77
    v_cvt_pk_bf16_f32 v77, v78, v79
    v_cvt_pk_bf16_f32 v78, v104, v105
    v_cvt_pk_bf16_f32 v79, v106, v107
    global_store_dwordx4 v184, v[76:79], s[66:67] offset:1024 sc1
    v_cvt_pk_bf16_f32 v24, v24, v25
    v_cvt_pk_bf16_f32 v25, v26, v27
    v_cvt_pk_bf16_f32 v26, v52, v53
    v_cvt_pk_bf16_f32 v27, v54, v55
    global_store_dwordx4 v184, v[24:27], s[68:69] offset:0 sc1
    v_cvt_pk_bf16_f32 v80, v80, v81
    v_cvt_pk_bf16_f32 v81, v82, v83
    v_cvt_pk_bf16_f32 v82, v108, v109
    v_cvt_pk_bf16_f32 v83, v110, v111
    global_store_dwordx4 v184, v[80:83], s[68:69] offset:1024 sc1
    s_branch L_fused
P_B3:
    s_mul_i32 s82, s36, 229376
    s_mul_i32 s83, s37, 224
    s_add_u32 s82, s82, s83
    v_bfe_u32 v4, v186, 1, 3
    v_lshrrev_b32 v5, 4, v186
    v_xor_b32 v4, v4, v5
    v_mov_b32 v6, 0
    v_bfe_u32 v185, v186, 4, 2
    v_mul_u32_u24 v185, 896, v185
    v_add_u32 v6, v185, v6
    v_bfe_u32 v185, v186, 0, 1
    v_lshl_add_u32 v6, v185, 4, v6
    v_xor_b32 v5, 4, v4
    v_min_u32 v4, 6, v4
    v_min_u32 v5, 6, v5
    v_lshl_add_u32 v170, v4, 5, v6
    v_lshl_add_u32 v171, v5, 5, v6
    s_add_u32 s82, s82, 21504
    s_add_u32 s50, s14, s82
    s_addc_u32 s51, s15, 0
    v_mov_b32 v177, 0
    v_bfe_u32 v185, v186, 4, 2
    v_lshl_add_u32 v177, v185, 11, v177
    v_bfe_u32 v185, v186, 2, 2
    v_mul_u32_u24 v185, 288, v185
    v_add_u32 v177, v185, v177
    v_bfe_u32 v185, v186, 4, 1
    v_lshl_add_u32 v177, v185, 7, v177
    v_bfe_u32 v185, v186, 0, 2
    v_lshl_add_u32 v177, v185, 3, v177
    v_xor_b32 v178, 32, v177
    v_xor_b32 v179, 64, v177
    v_xor_b32 v180, 96, v177
    v_xor_b32 v181, 128, v177
    v_xor_b32 v182, 160, v177
    v_xor_b32 v183, 192, v177
    s_mul_i32 s80, s36, 28672
    s_mul_i32 s81, s38, 7168
    s_add_u32 s80, s80, s81
    s_lshl_b32 s81, s31, 11
    s_add_u32 s80, s80, s81
    s_add_u32 s80, s80, 6553600
    s_mul_i32 s85, s37, 7
    s_add_u32 s81, s85, 0
    s_lshr_b32 s83, s81, 1
    s_and_b32 s81, s81, 1
    s_lshl_b32 s83, s83, 5
    s_add_u32 s81, s81, s83
    s_mul_i32 s81, s81, 14336
    s_add_u32 s81, s81, s80
    s_add_u32 s56, s28, s81
    s_addc_u32 s57, s29, 0
    s_add_u32 s81, s85, 1
    s_lshr_b32 s83, s81, 1
    s_and_b32 s81, s81, 1
    s_lshl_b32 s83, s83, 5
    s_add_u32 s81, s81, s83
    s_mul_i32 s81, s81, 14336
    s_add_u32 s81, s81, s80
    s_add_u32 s58, s28, s81
    s_addc_u32 s59, s29, 0
    s_add_u32 s81, s85, 2
    s_lshr_b32 s83, s81, 1
    s_and_b32 s81, s81, 1
    s_lshl_b32 s83, s83, 5
    s_add_u32 s81, s81, s83
    s_mul_i32 s81, s81, 14336
    s_add_u32 s81, s81, s80
    s_add_u32 s60, s28, s81
    s_addc_u32 s61, s29, 0
    s_add_u32 s81, s85, 3
    s_lshr_b32 s83, s81, 1
    s_and_b32 s81, s81, 1
    s_lshl_b32 s83, s83, 5
    s_add_u32 s81, s81, s83
    s_mul_i32 s81, s81, 14336
    s_add_u32 s81, s81, s80
    s_add_u32 s62, s28, s81
    s_addc_u32 s63, s29, 0
    s_add_u32 s81, s85, 4
    s_lshr_b32 s83, s81, 1
    s_and_b32 s81, s81, 1
    s_lshl_b32 s83, s83, 5
    s_add_u32 s81, s81, s83
    s_mul_i32 s81, s81, 14336
    s_add_u32 s81, s81, s80
    s_add_u32 s64, s28, s81
    s_addc_u32 s65, s29, 0
    s_add_u32 s81, s85, 5
    s_lshr_b32 s83, s81, 1
    s_and_b32 s81, s81, 1
    s_lshl_b32 s83, s83, 5
    s_add_u32 s81, s81, s83
    s_mul_i32 s81, s81, 14336
    s_add_u32 s81, s81, s80
    s_add_u32 s66, s28, s81
    s_addc_u32 s67, s29, 0
    s_add_u32 s81, s85, 6
    s_lshr_b32 s83, s81, 1
    s_and_b32 s81, s81, 1
    s_lshl_b32 s83, s83, 5
    s_add_u32 s81, s81, s83
    s_mul_i32 s81, s81, 14336
    s_add_u32 s81, s81, s80
    s_add_u32 s68, s28, s81
    s_addc_u32 s69, s29, 0
    s_xor_b32 s89, s88, 0
    s_mul_i32 s89, s89, 57344
    s_add_u32 s48, s50, s89
    s_addc_u32 s49, s51, 0
    s_mov_b32 m0, 6144
    s_nop 0
    global_load_lds_dwordx4 v171, s[48:49] offset:0
    s_mov_b32 m0, 3584
    s_nop 0
    global_load_lds_dwordx4 v171, s[48:49] offset:3584
    s_add_u32 s48, s48, 7168
    s_addc_u32 s49, s49, 0
    s_mov_b32 m0, 8192
    s_nop 0
    global_load_lds_dwordx4 v170, s[48:49] offset:0
    s_mov_b32 m0, 5632
    s_nop 0
    global_load_lds_dwordx4 v170, s[48:49] offset:3584
    s_add_u32 s48, s48, 7168
    s_addc_u32 s49, s49, 0
    s_mov_b32 m0, 10240
    s_nop 0
    global_load_lds_dwordx4 v171, s[48:49] offset:0
    s_mov_b32 m0, 7680
    s_nop 0
    global_load_lds_dwordx4 v171, s[48:49] offset:3584
    s_add_u32 s48, s48, 7168
    s_addc_u32 s49, s49, 0
    s_mov_b32 m0, 12288
    s_nop 0
    global_load_lds_dwordx4 v170, s[48:49] offset:0
    s_mov_b32 m0, 9728
    s_nop 0
    global_load_lds_dwordx4 v170, s[48:49] offset:3584
    s_add_u32 s48, s48, 7168
    s_addc_u32 s49, s49, 0
    s_mov_b32 m0, 14336
    s_nop 0
    global_load_lds_dwordx4 v171, s[48:49] offset:0
    s_mov_b32 m0, 11776
    s_nop 0
    global_load_lds_dwordx4 v171, s[48:49] offset:3584
    s_add_u32 m0, s70, 0
    s_nop 0
    global_load_lds_dwordx4 v168, s[40:41] offset:0
    s_add_u32 m0, s70, 1024
    s_nop 0
    global_load_lds_dwordx4 v169, s[40:41] offset:0
    s_add_u32 m0, s70, 2048
    s_nop 0
    global_load_lds_dwordx4 v168, s[42:43] offset:0
    s_add_u32 m0, s70, 3072
    s_nop 0
    global_load_lds_dwordx4 v169, s[42:43] offset:0
    s_xor_b32 s89, s88, 1
    s_mul_i32 s89, s89, 57344
    s_add_u32 s48, s50, s89
    s_addc_u32 s49, s51, 0
    s_mov_b32 m0, 22528
    s_nop 0
    global_load_lds_dwordx4 v171, s[48:49] offset:0
    s_mov_b32 m0, 19968
    s_nop 0
    global_load_lds_dwordx4 v171, s[48:49] offset:3584
    s_add_u32 s48, s48, 7168
    s_addc_u32 s49, s49, 0
    s_mov_b32 m0, 24576
    s_nop 0
    global_load_lds_dwordx4 v170, s[48:49] offset:0
    s_mov_b32 m0, 22016
    s_nop 0
    global_load_lds_dwordx4 v170, s[48:49] offset:3584
    s_add_u32 s48, s48, 7168
    s_addc_u32 s49, s49, 0
    s_mov_b32 m0, 26624
    s_nop 0
    global_load_lds_dwordx4 v171, s[48:49] offset:0
    s_mov_b32 m0, 24064
    s_nop 0
    global_load_lds_dwordx4 v171, s[48:49] offset:3584
    s_add_u32 s48, s48, 7168
    s_addc_u32 s49, s49, 0
    s_mov_b32 m0, 28672
    s_nop 0
    global_load_lds_dwordx4 v170, s[48:49] offset:0
    s_mov_b32 m0, 26112
    s_nop 0
    global_load_lds_dwordx4 v170, s[48:49] offset:3584
    s_add_u32 s48, s48, 7168
    s_addc_u32 s49, s49, 0
    s_mov_b32 m0, 30720
    s_nop 0
    global_load_lds_dwordx4 v171, s[48:49] offset:0
    s_mov_b32 m0, 28160
    s_nop 0
    global_load_lds_dwordx4 v171, s[48:49] offset:3584
    v_xor_b32 v168, 128, v168
    v_xor_b32 v169, 128, v169
    s_add_u32 m0, s70, 8192
    s_nop 0
    global_load_lds_dwordx4 v168, s[40:41] offset:0
    s_add_u32 m0, s70, 9216
    s_nop 0
    global_load_lds_dwordx4 v169, s[40:41] offset:0
    s_add_u32 m0, s70, 10240
    s_nop 0
    global_load_lds_dwordx4 v168, s[42:43] offset:0
    s_add_u32 m0, s70, 11264
    s_nop 0
    global_load_lds_dwordx4 v169, s[42:43] offset:0
    v_add_u32 v187, s70, v176
    v_xor_b32 v188, 64, v187
    v_mov_b32 v0, 0
    v_mov_b32 v1, 0
    v_mov_b32 v2, 0
    v_mov_b32 v3, 0
    v_mov_b32 v4, 0
    v_mov_b32 v5, 0
    v_mov_b32 v6, 0
    v_mov_b32 v7, 0
    v_mov_b32 v8, 0
    v_mov_b32 v9, 0
    v_mov_b32 v10, 0
    v_mov_b32 v11, 0
    v_mov_b32 v12, 0
    v_mov_b32 v13, 0
    v_mov_b32 v14, 0
    v_mov_b32 v15, 0
    v_mov_b32 v16, 0
    v_mov_b32 v17, 0
    v_mov_b32 v18, 0
    v_mov_b32 v19, 0
    v_mov_b32 v20, 0
    v_mov_b32 v21, 0
    v_mov_b32 v22, 0
    v_mov_b32 v23, 0
    v_mov_b32 v24, 0
    v_mov_b32 v25, 0
    v_mov_b32 v26, 0
    v_mov_b32 v27, 0
    v_mov_b32 v28, 0
    v_mov_b32 v29, 0
    v_mov_b32 v30, 0
    v_mov_b32 v31, 0
    v_mov_b32 v32, 0
    v_mov_b32 v33, 0
    v_mov_b32 v34, 0
    v_mov_b32 v35, 0
    v_mov_b32 v36, 0
    v_mov_b32 v37, 0
    v_mov_b32 v38, 0
    v_mov_b32 v39, 0
    v_mov_b32 v40, 0
    v_mov_b32 v41, 0
    v_mov_b32 v42, 0
    v_mov_b32 v43, 0
    v_mov_b32 v44, 0
    v_mov_b32 v45, 0
    v_mov_b32 v46, 0
    v_mov_b32 v47, 0
    v_mov_b32 v48, 0
    v_mov_b32 v49, 0
    v_mov_b32 v50, 0
    v_mov_b32 v51, 0
    v_mov_b32 v52, 0
    v_mov_b32 v53, 0
    v_mov_b32 v54, 0
    v_mov_b32 v55, 0
    s_lshr_b32 s80, s2, 2
    s_mul_i32 s80, s80, 28672
    s_bfe_u32 s81, s2, 0x10001
    s_mul_i32 s81, s81, 3584
    s_add_u32 s80, s80, s81
    s_and_b32 s81, s2, 1
    s_mul_i32 s81, s81, 448
    s_add_u32 s80, s80, s81
    s_add_u32 s72, s4, s80
    s_addc_u32 s73, s5, 0
    s_add_u32 s74, s18, s80
    s_addc_u32 s75, s19, 0
    v_mov_b32 v189, 0
    v_bfe_u32 v185, v186, 2, 2
    v_mul_u32_u24 v185, 7168, v185
    v_add_u32 v189, v185, v189
    v_bfe_u32 v185, v186, 0, 2
    v_mul_u32_u24 v185, 896, v185
    v_add_u32 v189, v185, v189
    v_bfe_u32 v185, v186, 5, 1
    v_lshl_add_u32 v189, v185, 5, v189
    v_bfe_u32 v185, v186, 4, 1
    v_lshl_add_u32 v189, v185, 3, v189
    v_mov_b32 v190, 0
    v_bfe_u32 v185, v186, 2, 2
    v_mul_u32_u24 v185, 7168, v185
    v_add_u32 v190, v185, v190
    v_bfe_u32 v185, v186, 0, 2
    v_mul_u32_u24 v185, 896, v185
    v_add_u32 v190, v185, v190
    v_bfe_u32 v185, v186, 4, 2
    v_lshl_add_u32 v190, v185, 4, v190
    s_lshr_b32 s80, s2, 2
    s_mul_i32 s80, s80, 28672
    s_and_b32 s81, s2, 3
    s_mul_i32 s81, s81, 224
    s_add_u32 s80, s80, s81
    s_add_u32 s76, s4, s80
    s_addc_u32 s77, s5, 0
    v_lshrrev_b32 v91, 4, v186
    v_min_u32 v91, 2, v91
    v_mov_b32 v88, 0
    v_bfe_u32 v185, v186, 3, 1
    v_mul_u32_u24 v185, 7168, v185
    v_add_u32 v88, v185, v88
    v_bfe_u32 v185, v186, 2, 1
    v_mul_u32_u24 v185, 1792, v185
    v_add_u32 v88, v185, v88
    v_bfe_u32 v185, v186, 0, 1
    v_mul_u32_u24 v185, 896, v185
    v_add_u32 v88, v185, v88
    v_bfe_u32 v185, v186, 1, 1
    v_mul_u32_u24 v185, 3584, v185
    v_add_u32 v88, v185, v88
    v_bfe_u32 v185, v186, 4, 2
    v_lshl_add_u32 v88, v185, 5, v88
    v_mov_b32 v89, 128
    v_bfe_u32 v185, v186, 3, 1
    v_mul_u32_u24 v185, 7168, v185
    v_add_u32 v89, v185, v89
    v_bfe_u32 v185, v186, 2, 1
    v_mul_u32_u24 v185, 1792, v185
    v_add_u32 v89, v185, v89
    v_bfe_u32 v185, v186, 0, 1
    v_mul_u32_u24 v185, 896, v185
    v_add_u32 v89, v185, v89
    v_bfe_u32 v185, v186, 1, 1
    v_mul_u32_u24 v185, 3584, v185
    v_add_u32 v89, v185, v89
    v_lshl_add_u32 v89, v91, 5, v89
    v_mov_b32 v90, 1024
    v_bfe_u32 v185, v186, 0, 4
    v_lshl_add_u32 v90, v185, 4, v90
    v_lshl_add_u32 v90, v91, 8, v90
    s_getreg_b32 s86, hwreg(HW_REG_HW_ID, 8, 1)
    s_and_b32 s86, s86, 1
    s_lshl_b32 s80, s86, 16
    s_or_b32 s80, s80, 1
    v_mov_b32 v137, s80
    s_lshl_b32 s80, s30, 5
    v_mov_b32 v136, s80
    v_and_b32 v139, 7, v186
    v_lshlrev_b32 v139, 5, v139
    s_waitcnt vmcnt(28)
    s_mov_b64 exec, 1
    global_atomic_add v138, v136, v137, s[26:27] sc0
    s_mov_b64 exec, -1
    v_mov_b32 v142, 0
    v_bfe_u32 v143, v186, 4, 2
    v_lshl_add_u32 v142, v143, 5, v142
    v_bfe_u32 v143, v186, 1, 3
    v_mul_u32_u24 v143, 896, v143
    v_add_u32 v142, v143, v142
    v_bfe_u32 v143, v186, 0, 1
    v_lshl_add_u32 v142, v143, 4, v142
    global_load_dwordx2 v[192:193], v189, s[72:73] offset:0
    global_load_dwordx2 v[194:195], v189, s[72:73] offset:16
    global_load_dwordx4 v[220:223], v190, s[74:75] offset:0
    global_load_dwordx2 v[196:197], v189, s[72:73] offset:64
    global_load_dwordx2 v[198:199], v189, s[72:73] offset:80
    global_load_dwordx4 v[224:227], v190, s[74:75] offset:64
    global_load_dwordx2 v[200:201], v189, s[72:73] offset:128
    global_load_dwordx2 v[202:203], v189, s[72:73] offset:144
    global_load_dwordx4 v[228:231], v190, s[74:75] offset:128
    global_load_dwordx2 v[204:205], v189, s[72:73] offset:192
    global_load_dwordx2 v[206:207], v189, s[72:73] offset:208
    global_load_dwordx4 v[232:235], v190, s[74:75] offset:192
    global_load_dwordx2 v[208:209], v189, s[72:73] offset:256
    global_load_dwordx2 v[210:211], v189, s[72:73] offset:272
    global_load_dwordx4 v[236:239], v190, s[74:75] offset:256
    global_load_dwordx2 v[212:213], v189, s[72:73] offset:320
    global_load_dwordx2 v[214:215], v189, s[72:73] offset:336
    global_load_dwordx4 v[240:243], v190, s[74:75] offset:320
    global_load_dwordx2 v[216:217], v189, s[72:73] offset:384
    global_load_dwordx2 v[218:219], v189, s[72:73] offset:400
    global_load_dwordx4 v[244:247], v190, s[74:75] offset:384
    global_load_dwordx4 v[56:59], v88, s[76:77] offset:0
    global_load_dwordx4 v[60:63], v88, s[76:77] offset:16
    global_load_dwordx4 v[64:67], v89, s[76:77] offset:0
    global_load_dwordx4 v[68:71], v89, s[76:77] offset:16
    s_add_u32 s76, s76, 14336
    s_addc_u32 s77, s77, 0
    global_load_dwordx4 v[72:75], v88, s[76:77] offset:0
    global_load_dwordx4 v[76:79], v88, s[76:77] offset:16
    global_load_dwordx4 v[80:83], v89, s[76:77] offset:0
    global_load_dwordx4 v[84:87], v89, s[76:77] offset:16
    global_load_dwordx4 v[92:95], v142, s[6:7] offset:0
    global_load_dwordx4 v[96:99], v142, s[6:7] offset:128
    global_load_dwordx4 v[100:103], v142, s[6:7] offset:256
    global_load_dwordx4 v[104:107], v142, s[6:7] offset:384
    global_load_dwordx4 v[108:111], v142, s[6:7] offset:512
    global_load_dwordx4 v[120:123], v142, s[6:7] offset:640
    global_load_dwordx4 v[124:127], v142, s[6:7] offset:768
    s_waitcnt vmcnt(51)
    s_barrier
    ds_read_b128 v[112:115], v187 offset:0
    ds_read_b128 v[116:119], v187 offset:2048
    ds_read_b64_tr_b16 v[144:145], v177 offset:0
    ds_read_b64_tr_b16 v[146:147], v177 offset:1024
    ds_read_b64_tr_b16 v[148:149], v178 offset:0
    ds_read_b64_tr_b16 v[150:151], v178 offset:1024
    ds_read_b64_tr_b16 v[152:153], v179 offset:0
    ds_read_b64_tr_b16 v[154:155], v179 offset:1024
    ds_read_b64_tr_b16 v[156:157], v180 offset:0
    ds_read_b64_tr_b16 v[158:159], v180 offset:1024
    ds_read_b64_tr_b16 v[160:161], v181 offset:0
    ds_read_b64_tr_b16 v[162:163], v181 offset:1024
    s_waitcnt lgkmcnt(8)
    v_mfma_f32_16x16x32_bf16 v[0:3], v[112:115], v[144:147], v[0:3]
    ds_read_b64_tr_b16 v[164:165], v182 offset:0
    ds_read_b64_tr_b16 v[166:167], v182 offset:1024
    v_mfma_f32_16x16x32_bf16 v[28:31], v[116:119], v[144:147], v[28:31]
    s_xor_b32 s89, s88, 2
    s_mul_i32 s89, s89, 57344
    s_add_u32 s48, s50, s89
    s_addc_u32 s49, s51, 0
    s_mov_b32 m0, 38912
    s_nop 0
    global_load_lds_dwordx4 v171, s[48:49] offset:0
    s_mov_b32 m0, 36352
    s_nop 0
    global_load_lds_dwordx4 v171, s[48:49] offset:3584
    s_waitcnt lgkmcnt(8)
    v_mfma_f32_16x16x32_bf16 v[4:7], v[112:115], v[148:151], v[4:7]
    ds_read_b64_tr_b16 v[144:145], v183 offset:0
    ds_read_b64_tr_b16 v[146:147], v183 offset:1024
    v_mfma_f32_16x16x32_bf16 v[32:35], v[116:119], v[148:151], v[32:35]
    s_add_u32 s48, s48, 7168
    s_addc_u32 s49, s49, 0
    s_mov_b32 m0, 40960
    s_nop 0
    global_load_lds_dwordx4 v170, s[48:49] offset:0
    s_mov_b32 m0, 38400
    s_nop 0
    global_load_lds_dwordx4 v170, s[48:49] offset:3584
    s_waitcnt lgkmcnt(8)
    v_mfma_f32_16x16x32_bf16 v[8:11], v[112:115], v[152:155], v[8:11]
    ds_read_b128 v[128:131], v188 offset:0
    ds_read_b128 v[132:135], v188 offset:2048
    ds_read_b64_tr_b16 v[148:149], v177 offset:8192
    ds_read_b64_tr_b16 v[150:151], v177 offset:9216
    v_mfma_f32_16x16x32_bf16 v[36:39], v[116:119], v[152:155], v[36:39]
    s_add_u32 s48, s48, 7168
    s_addc_u32 s49, s49, 0
    s_mov_b32 m0, 43008
    s_nop 0
    global_load_lds_dwordx4 v171, s[48:49] offset:0
    s_mov_b32 m0, 40448
    s_nop 0
    global_load_lds_dwordx4 v171, s[48:49] offset:3584
    s_waitcnt lgkmcnt(10)
    v_mfma_f32_16x16x32_bf16 v[12:15], v[112:115], v[156:159], v[12:15]
    ds_read_b64_tr_b16 v[152:153], v178 offset:8192
    ds_read_b64_tr_b16 v[154:155], v178 offset:9216
    v_mfma_f32_16x16x32_bf16 v[40:43], v[116:119], v[156:159], v[40:43]
    s_add_u32 s48, s48, 7168
    s_addc_u32 s49, s49, 0
    s_mov_b32 m0, 45056
    s_nop 0
    global_load_lds_dwordx4 v170, s[48:49] offset:0
    s_mov_b32 m0, 42496
    s_nop 0
    global_load_lds_dwordx4 v170, s[48:49] offset:3584
    s_waitcnt lgkmcnt(10)
    v_mfma_f32_16x16x32_bf16 v[16:19], v[112:115], v[160:163], v[16:19]
    ds_read_b64_tr_b16 v[156:157], v179 offset:8192
    ds_read_b64_tr_b16 v[158:159], v179 offset:9216
    v_mfma_f32_16x16x32_bf16 v[44:47], v[116:119], v[160:163], v[44:47]
    s_add_u32 s48, s48, 7168
    s_addc_u32 s49, s49, 0
    s_mov_b32 m0, 47104
    s_nop 0
    global_load_lds_dwordx4 v171, s[48:49] offset:0
    s_mov_b32 m0, 44544
    s_nop 0
    global_load_lds_dwordx4 v171, s[48:49] offset:3584
    s_waitcnt lgkmcnt(10)
    v_mfma_f32_16x16x32_bf16 v[20:23], v[112:115], v[164:167], v[20:23]
    ds_read_b64_tr_b16 v[160:161], v180 offset:8192
    ds_read_b64_tr_b16 v[162:163], v180 offset:9216
    v_mfma_f32_16x16x32_bf16 v[48:51], v[116:119], v[164:167], v[48:51]
    v_xor_b32 v168, 384, v168
    v_xor_b32 v169, 384, v169
    s_add_u32 m0, s70, 16384
    s_nop 0
    global_load_lds_dwordx4 v168, s[40:41] offset:0
    s_add_u32 m0, s70, 17408
    s_nop 0
    global_load_lds_dwordx4 v169, s[40:41] offset:0
    s_waitcnt lgkmcnt(10)
    v_mfma_f32_16x16x32_bf16 v[24:27], v[112:115], v[144:147], v[24:27]
    ds_read_b64_tr_b16 v[164:165], v181 offset:8192
    ds_read_b64_tr_b16 v[166:167], v181 offset:9216
    v_mfma_f32_16x16x32_bf16 v[52:55], v[116:119], v[144:147], v[52:55]
    s_add_u32 m0, s70, 18432
    s_nop 0
    global_load_lds_dwordx4 v168, s[42:43] offset:0
    s_add_u32 m0, s70, 19456
    s_nop 0
    global_load_lds_dwordx4 v169, s[42:43] offset:0
    s_waitcnt lgkmcnt(8)
    v_mfma_f32_16x16x32_bf16 v[0:3], v[128:131], v[148:151], v[0:3]
    ds_read_b64_tr_b16 v[144:145], v182 offset:8192
    ds_read_b64_tr_b16 v[146:147], v182 offset:9216
    v_mfma_f32_16x16x32_bf16 v[28:31], v[132:135], v[148:151], v[28:31]
    s_waitcnt lgkmcnt(8)
    v_mfma_f32_16x16x32_bf16 v[4:7], v[128:131], v[152:155], v[4:7]
    ds_read_b64_tr_b16 v[148:149], v183 offset:8192
    ds_read_b64_tr_b16 v[150:151], v183 offset:9216
    v_mfma_f32_16x16x32_bf16 v[32:35], v[132:135], v[152:155], v[32:35]
    s_waitcnt lgkmcnt(8)
    v_mfma_f32_16x16x32_bf16 v[8:11], v[128:131], v[156:159], v[8:11]
    v_mfma_f32_16x16x32_bf16 v[36:39], v[132:135], v[156:159], v[36:39]
    s_waitcnt lgkmcnt(6)
    v_mfma_f32_16x16x32_bf16 v[12:15], v[128:131], v[160:163], v[12:15]
    v_mfma_f32_16x16x32_bf16 v[40:43], v[132:135], v[160:163], v[40:43]
    s_waitcnt lgkmcnt(4)
    v_mfma_f32_16x16x32_bf16 v[16:19], v[128:131], v[164:167], v[16:19]
    v_mfma_f32_16x16x32_bf16 v[44:47], v[132:135], v[164:167], v[44:47]
    s_waitcnt lgkmcnt(2)
    v_mfma_f32_16x16x32_bf16 v[20:23], v[128:131], v[144:147], v[20:23]
    v_mfma_f32_16x16x32_bf16 v[48:51], v[132:135], v[144:147], v[48:51]
    s_waitcnt lgkmcnt(0)
    v_mfma_f32_16x16x32_bf16 v[24:27], v[128:131], v[148:151], v[24:27]
    v_mfma_f32_16x16x32_bf16 v[52:55], v[132:135], v[148:151], v[52:55]
    s_waitcnt vmcnt(51)
    s_barrier
    ds_read_b128 v[112:115], v187 offset:8192
    ds_read_b128 v[116:119], v187 offset:10240
    ds_read_b64_tr_b16 v[152:153], v177 offset:16384
    ds_read_b64_tr_b16 v[154:155], v177 offset:17408
    ds_read_b64_tr_b16 v[156:157], v178 offset:16384
    ds_read_b64_tr_b16 v[158:159], v178 offset:17408
    ds_read_b64_tr_b16 v[160:161], v179 offset:16384
    ds_read_b64_tr_b16 v[162:163], v179 offset:17408
    ds_read_b64_tr_b16 v[164:165], v180 offset:16384
    ds_read_b64_tr_b16 v[166:167], v180 offset:17408
    ds_read_b64_tr_b16 v[144:145], v181 offset:16384
    ds_read_b64_tr_b16 v[146:147], v181 offset:17408
    s_waitcnt lgkmcnt(8)
    v_mfma_f32_16x16x32_bf16 v[0:3], v[112:115], v[152:155], v[0:3]
    ds_read_b64_tr_b16 v[148:149], v182 offset:16384
    ds_read_b64_tr_b16 v[150:151], v182 offset:17408
    v_mfma_f32_16x16x32_bf16 v[28:31], v[116:119], v[152:155], v[28:31]
    s_xor_b32 s89, s88, 3
    s_mul_i32 s89, s89, 57344
    s_add_u32 s48, s50, s89
    s_addc_u32 s49, s51, 0
    s_mov_b32 m0, 55296
    s_nop 0
    global_load_lds_dwordx4 v171, s[48:49] offset:0
    s_mov_b32 m0, 52736
    s_nop 0
    global_load_lds_dwordx4 v171, s[48:49] offset:3584
    s_waitcnt lgkmcnt(8)
    v_mfma_f32_16x16x32_bf16 v[4:7], v[112:115], v[156:159], v[4:7]
    ds_read_b64_tr_b16 v[152:153], v183 offset:16384
    ds_read_b64_tr_b16 v[154:155], v183 offset:17408
    v_mfma_f32_16x16x32_bf16 v[32:35], v[116:119], v[156:159], v[32:35]
    s_add_u32 s48, s48, 7168
    s_addc_u32 s49, s49, 0
    s_mov_b32 m0, 57344
    s_nop 0
    global_load_lds_dwordx4 v170, s[48:49] offset:0
    s_mov_b32 m0, 54784
    s_nop 0
    global_load_lds_dwordx4 v170, s[48:49] offset:3584
    s_waitcnt lgkmcnt(8)
    v_mfma_f32_16x16x32_bf16 v[8:11], v[112:115], v[160:163], v[8:11]
    ds_read_b128 v[128:131], v188 offset:8192
    ds_read_b128 v[132:135], v188 offset:10240
    ds_read_b64_tr_b16 v[156:157], v177 offset:24576
    ds_read_b64_tr_b16 v[158:159], v177 offset:25600
    v_mfma_f32_16x16x32_bf16 v[36:39], v[116:119], v[160:163], v[36:39]
    s_add_u32 s48, s48, 7168
    s_addc_u32 s49, s49, 0
    s_mov_b32 m0, 59392
    s_nop 0
    global_load_lds_dwordx4 v171, s[48:49] offset:0
    s_mov_b32 m0, 56832
    s_nop 0
    global_load_lds_dwordx4 v171, s[48:49] offset:3584
    s_waitcnt lgkmcnt(10)
    v_mfma_f32_16x16x32_bf16 v[12:15], v[112:115], v[164:167], v[12:15]
    ds_read_b64_tr_b16 v[160:161], v178 offset:24576
    ds_read_b64_tr_b16 v[162:163], v178 offset:25600
    v_mfma_f32_16x16x32_bf16 v[40:43], v[116:119], v[164:167], v[40:43]
    s_add_u32 s48, s48, 7168
    s_addc_u32 s49, s49, 0
    s_mov_b32 m0, 61440
    s_nop 0
    global_load_lds_dwordx4 v170, s[48:49] offset:0
    s_mov_b32 m0, 58880
    s_nop 0
    global_load_lds_dwordx4 v170, s[48:49] offset:3584
    s_waitcnt lgkmcnt(10)
    v_mfma_f32_16x16x32_bf16 v[16:19], v[112:115], v[144:147], v[16:19]
    ds_read_b64_tr_b16 v[164:165], v179 offset:24576
    ds_read_b64_tr_b16 v[166:167], v179 offset:25600
    v_mfma_f32_16x16x32_bf16 v[44:47], v[116:119], v[144:147], v[44:47]
    s_add_u32 s48, s48, 7168
    s_addc_u32 s49, s49, 0
    s_mov_b32 m0, 63488
    s_nop 0
    global_load_lds_dwordx4 v171, s[48:49] offset:0
    s_mov_b32 m0, 60928
    s_nop 0
    global_load_lds_dwordx4 v171, s[48:49] offset:3584
    s_waitcnt lgkmcnt(10)
    v_mfma_f32_16x16x32_bf16 v[20:23], v[112:115], v[148:151], v[20:23]
    ds_read_b64_tr_b16 v[144:145], v180 offset:24576
    ds_read_b64_tr_b16 v[146:147], v180 offset:25600
    v_mfma_f32_16x16x32_bf16 v[48:51], v[116:119], v[148:151], v[48:51]
    v_xor_b32 v168, 128, v168
    v_xor_b32 v169, 128, v169
    s_add_u32 m0, s70, 0
    s_nop 0
    global_load_lds_dwordx4 v168, s[40:41] offset:0
    s_add_u32 m0, s70, 1024
    s_nop 0
    global_load_lds_dwordx4 v169, s[40:41] offset:0
    s_waitcnt lgkmcnt(10)
    v_mfma_f32_16x16x32_bf16 v[24:27], v[112:115], v[152:155], v[24:27]
    ds_read_b64_tr_b16 v[148:149], v181 offset:24576
    ds_read_b64_tr_b16 v[150:151], v181 offset:25600
    v_mfma_f32_16x16x32_bf16 v[52:55], v[116:119], v[152:155], v[52:55]
    s_add_u32 m0, s70, 2048
    s_nop 0
    global_load_lds_dwordx4 v168, s[42:43] offset:0
    s_add_u32 m0, s70, 3072
    s_nop 0
    global_load_lds_dwordx4 v169, s[42:43] offset:0
    s_waitcnt lgkmcnt(8)
    v_mfma_f32_16x16x32_bf16 v[0:3], v[128:131], v[156:159], v[0:3]
    ds_read_b64_tr_b16 v[152:153], v182 offset:24576
    ds_read_b64_tr_b16 v[154:155], v182 offset:25600
    v_mfma_f32_16x16x32_bf16 v[28:31], v[132:135], v[156:159], v[28:31]
    s_waitcnt lgkmcnt(8)
    v_mfma_f32_16x16x32_bf16 v[4:7], v[128:131], v[160:163], v[4:7]
    ds_read_b64_tr_b16 v[156:157], v183 offset:24576
    ds_read_b64_tr_b16 v[158:159], v183 offset:25600
    v_mfma_f32_16x16x32_bf16 v[32:35], v[132:135], v[160:163], v[32:35]
    s_waitcnt lgkmcnt(8)
    v_mfma_f32_16x16x32_bf16 v[8:11], v[128:131], v[164:167], v[8:11]
    v_mfma_f32_16x16x32_bf16 v[36:39], v[132:135], v[164:167], v[36:39]
    s_waitcnt lgkmcnt(6)
    v_mfma_f32_16x16x32_bf16 v[12:15], v[128:131], v[144:147], v[12:15]
    v_mfma_f32_16x16x32_bf16 v[40:43], v[132:135], v[144:147], v[40:43]
    s_waitcnt lgkmcnt(4)
    v_mfma_f32_16x16x32_bf16 v[16:19], v[128:131], v[148:151], v[16:19]
    v_mfma_f32_16x16x32_bf16 v[44:47], v[132:135], v[148:151], v[44:47]
    s_waitcnt lgkmcnt(2)
    v_mfma_f32_16x16x32_bf16 v[20:23], v[128:131], v[152:155], v[20:23]
    v_mfma_f32_16x16x32_bf16 v[48:51], v[132:135], v[152:155], v[48:51]
    s_waitcnt lgkmcnt(0)
    v_mfma_f32_16x16x32_bf16 v[24:27], v[128:131], v[156:159], v[24:27]
    v_mfma_f32_16x16x32_bf16 v[52:55], v[132:135], v[156:159], v[52:55]
    s_waitcnt vmcnt(14)
    s_barrier
    global_load_dword v140, v139, s[26:27] sc1
    s_mul_i32 s80, s2, 7168
    s_add_u32 s80, s80, 15732736
    s_add_u32 s72, s28, s80
    s_addc_u32 s73, s29, 0
    s_add_u32 s74, s72, 2097152
    s_addc_u32 s75, s73, 0
    v_swap_b32 v193, v194
    global_store_dwordx4 v184, v[192:195], s[72:73] offset:-4096 sc1
    global_store_dwordx4 v184, v[220:223], s[74:75] offset:-4096 sc1
    v_swap_b32 v197, v198
    global_store_dwordx4 v184, v[196:199], s[72:73] offset:-3072 sc1
    global_store_dwordx4 v184, v[224:227], s[74:75] offset:-3072 sc1
    v_swap_b32 v201, v202
    global_store_dwordx4 v184, v[200:203], s[72:73] offset:-2048 sc1
    global_store_dwordx4 v184, v[228:231], s[74:75] offset:-2048 sc1
    v_swap_b32 v205, v206
    global_store_dwordx4 v184, v[204:207], s[72:73] offset:-1024 sc1
    global_store_dwordx4 v184, v[232:235], s[74:75] offset:-1024 sc1
    v_swap_b32 v209, v210
    global_store_dwordx4 v184, v[208:211], s[72:73] offset:0 sc1
    global_store_dwordx4 v184, v[236:239], s[74:75] offset:0 sc1
    v_swap_b32 v213, v214
    global_store_dwordx4 v184, v[212:215], s[72:73] offset:1024 sc1
    global_store_dwordx4 v184, v[240:243], s[74:75] offset:1024 sc1
    v_swap_b32 v217, v218
    global_store_dwordx4 v184, v[216:219], s[72:73] offset:2048 sc1
    global_store_dwordx4 v184, v[244:247], s[74:75] offset:2048 sc1
    s_add_u32 s76, s72, 47185920
    s_addc_u32 s77, s73, 0
    global_store_dwordx4 v184, v[56:59], s[76:77] offset:-4096 sc1
    global_store_dwordx4 v184, v[60:63], s[76:77] offset:-2304 sc1
    global_store_dwordx4 v90, v[64:67], s[76:77] offset:-4096 sc1
    global_store_dwordx4 v90, v[68:71], s[76:77] offset:-2304 sc1
    global_store_dwordx4 v184, v[72:75], s[76:77] offset:-512 sc1
    global_store_dwordx4 v184, v[76:79], s[76:77] offset:1280 sc1
    global_store_dwordx4 v90, v[80:83], s[76:77] offset:-512 sc1
    global_store_dwordx4 v90, v[84:87], s[76:77] offset:1280 sc1
    s_cmp_lg_u32 s2, 63
    s_cbranch_scc1 P_nom0_3
    s_add_u32 s72, s28, 13627392
    s_addc_u32 s73, s29, 0
    v_min_u32 v92, 0xfffffffe, v92
    v_min_u32 v94, 0xfffffffe, v94
    global_store_dwordx4 v184, v[92:95], s[72:73] offset:-4096 sc1
    v_min_u32 v96, 0xfffffffe, v96
    v_min_u32 v98, 0xfffffffe, v98
    global_store_dwordx4 v184, v[96:99], s[72:73] offset:-3072 sc1
    v_min_u32 v100, 0xfffffffe, v100
    v_min_u32 v102, 0xfffffffe, v102
    global_store_dwordx4 v184, v[100:103], s[72:73] offset:-2048 sc1
    v_min_u32 v104, 0xfffffffe, v104
    v_min_u32 v106, 0xfffffffe, v106
    global_store_dwordx4 v184, v[104:107], s[72:73] offset:-1024 sc1
    v_min_u32 v108, 0xfffffffe, v108
    v_min_u32 v110, 0xfffffffe, v110
    global_store_dwordx4 v184, v[108:111], s[72:73] offset:0 sc1
    v_min_u32 v120, 0xfffffffe, v120
    v_min_u32 v122, 0xfffffffe, v122
    global_store_dwordx4 v184, v[120:123], s[72:73] offset:1024 sc1
    v_min_u32 v124, 0xfffffffe, v124
    v_min_u32 v126, 0xfffffffe, v126
    global_store_dwordx4 v184, v[124:127], s[72:73] offset:2048 sc1
P_nom0_3:
    ds_read_b128 v[112:115], v187 offset:16384
    ds_read_b128 v[116:119], v187 offset:18432
    ds_read_b64_tr_b16 v[160:161], v177 offset:32768
    ds_read_b64_tr_b16 v[162:163], v177 offset:33792
    ds_read_b64_tr_b16 v[164:165], v178 offset:32768
    ds_read_b64_tr_b16 v[166:167], v178 offset:33792
    ds_read_b64_tr_b16 v[144:145], v179 offset:32768
    ds_read_b64_tr_b16 v[146:147], v179 offset:33792
    ds_read_b64_tr_b16 v[148:149], v180 offset:32768
    ds_read_b64_tr_b16 v[150:151], v180 offset:33792
    ds_read_b64_tr_b16 v[152:153], v181 offset:32768
    ds_read_b64_tr_b16 v[154:155], v181 offset:33792
    s_waitcnt lgkmcnt(8)
    v_mfma_f32_16x16x32_bf16 v[0:3], v[112:115], v[160:163], v[0:3]
    ds_read_b64_tr_b16 v[156:157], v182 offset:32768
    ds_read_b64_tr_b16 v[158:159], v182 offset:33792
    v_mfma_f32_16x16x32_bf16 v[28:31], v[116:119], v[160:163], v[28:31]
    s_waitcnt lgkmcnt(8)
    v_mfma_f32_16x16x32_bf16 v[4:7], v[112:115], v[164:167], v[4:7]
    ds_read_b64_tr_b16 v[160:161], v183 offset:32768
    ds_read_b64_tr_b16 v[162:163], v183 offset:33792
    v_mfma_f32_16x16x32_bf16 v[32:35], v[116:119], v[164:167], v[32:35]
    s_waitcnt lgkmcnt(8)
    v_mfma_f32_16x16x32_bf16 v[8:11], v[112:115], v[144:147], v[8:11]
    ds_read_b128 v[128:131], v188 offset:16384
    ds_read_b128 v[132:135], v188 offset:18432
    ds_read_b64_tr_b16 v[164:165], v177 offset:40960
    ds_read_b64_tr_b16 v[166:167], v177 offset:41984
    v_mfma_f32_16x16x32_bf16 v[36:39], v[116:119], v[144:147], v[36:39]
    s_waitcnt lgkmcnt(10)
    v_mfma_f32_16x16x32_bf16 v[12:15], v[112:115], v[148:151], v[12:15]
    ds_read_b64_tr_b16 v[144:145], v178 offset:40960
    ds_read_b64_tr_b16 v[146:147], v178 offset:41984
    v_mfma_f32_16x16x32_bf16 v[40:43], v[116:119], v[148:151], v[40:43]
    s_waitcnt lgkmcnt(10)
    v_mfma_f32_16x16x32_bf16 v[16:19], v[112:115], v[152:155], v[16:19]
    ds_read_b64_tr_b16 v[148:149], v179 offset:40960
    ds_read_b64_tr_b16 v[150:151], v179 offset:41984
    v_mfma_f32_16x16x32_bf16 v[44:47], v[116:119], v[152:155], v[44:47]
    s_waitcnt lgkmcnt(10)
    v_mfma_f32_16x16x32_bf16 v[20:23], v[112:115], v[156:159], v[20:23]
    ds_read_b64_tr_b16 v[152:153], v180 offset:40960
    ds_read_b64_tr_b16 v[154:155], v180 offset:41984
    v_mfma_f32_16x16x32_bf16 v[48:51], v[116:119], v[156:159], v[48:51]
    s_waitcnt lgkmcnt(10)
    v_mfma_f32_16x16x32_bf16 v[24:27], v[112:115], v[160:163], v[24:27]
    ds_read_b64_tr_b16 v[156:157], v181 offset:40960
    ds_read_b64_tr_b16 v[158:159], v181 offset:41984
    v_mfma_f32_16x16x32_bf16 v[52:55], v[116:119], v[160:163], v[52:55]
    s_waitcnt lgkmcnt(8)
    v_mfma_f32_16x16x32_bf16 v[0:3], v[128:131], v[164:167], v[0:3]
    ds_read_b64_tr_b16 v[160:161], v182 offset:40960
    ds_read_b64_tr_b16 v[162:163], v182 offset:41984
    v_mfma_f32_16x16x32_bf16 v[28:31], v[132:135], v[164:167], v[28:31]
    s_waitcnt lgkmcnt(8)
    v_mfma_f32_16x16x32_bf16 v[4:7], v[128:131], v[144:147], v[4:7]
    ds_read_b64_tr_b16 v[164:165], v183 offset:40960
    ds_read_b64_tr_b16 v[166:167], v183 offset:41984
    v_mfma_f32_16x16x32_bf16 v[32:35], v[132:135], v[144:147], v[32:35]
    s_waitcnt lgkmcnt(8)
    v_mfma_f32_16x16x32_bf16 v[8:11], v[128:131], v[148:151], v[8:11]
    v_mfma_f32_16x16x32_bf16 v[36:39], v[132:135], v[148:151], v[36:39]
    s_waitcnt lgkmcnt(6)
    v_mfma_f32_16x16x32_bf16 v[12:15], v[128:131], v[152:155], v[12:15]
    v_mfma_f32_16x16x32_bf16 v[40:43], v[132:135], v[152:155], v[40:43]
    s_waitcnt lgkmcnt(4)
    v_mfma_f32_16x16x32_bf16 v[16:19], v[128:131], v[156:159], v[16:19]
    v_mfma_f32_16x16x32_bf16 v[44:47], v[132:135], v[156:159], v[44:47]
    s_waitcnt lgkmcnt(2)
    v_mfma_f32_16x16x32_bf16 v[20:23], v[128:131], v[160:163], v[20:23]
    v_mfma_f32_16x16x32_bf16 v[48:51], v[132:135], v[160:163], v[48:51]
    s_waitcnt lgkmcnt(0)
    v_mfma_f32_16x16x32_bf16 v[24:27], v[128:131], v[164:167], v[24:27]
    v_mfma_f32_16x16x32_bf16 v[52:55], v[132:135], v[164:167], v[52:55]
    s_waitcnt vmcnt(23)
    s_waitcnt vmcnt(22)
    s_mov_b32 s80, 0
    s_lshl_b32 s81, s30, 5
L_tk_4chk:
    v_readfirstlane_b32 s82, v138
    s_lshr_b32 s83, s82, 16
    s_and_b32 s82, s82, 0xffff
    s_cmp_lt_u32 s82, 32
    s_cbranch_scc1 L_tk_4got
    s_add_u32 s80, s80, 1
    s_mov_b32 s81, 0xffff
    s_cmp_ge_u32 s80, 8
    s_cbranch_scc1 L_tk_4pub
    s_add_u32 s81, s30, s80
    s_and_b32 s81, s81, 7
    s_lshl_b32 s81, s81, 5
    v_mov_b32 v136, s81
    s_mov_b64 exec, 1
    global_atomic_add v138, v136, v137, s[26:27] sc0
    s_mov_b64 exec, -1
    s_waitcnt vmcnt(0)
    s_branch L_tk_4chk
L_tk_4got:
    s_sub_u32 s82, s83, s82
    s_add_u32 s82, s82, 31
    s_cmp_lg_u32 s86, 0
    s_cselect_b32 s82, s83, s82
    s_add_u32 s81, s81, s82
    s_cmp_lg_u32 s80, 0
    s_cselect_b32 s80, 0x100, 0
    s_or_b32 s81, s81, s80
L_tk_4pub:
    v_mov_b32 v136, 143360
    v_mov_b32 v138, s81
    ds_write_b32 v136, v138
L_tk_4tc:
    v_and_b32 v140, 0xffff, v140
    v_cmp_gt_u32 vcc, 32, v140
    s_cbranch_vccz L_tk_4ok
    global_load_dword v140, v139, s[26:27] sc1
    s_sub_u32 s35, s35, 1
    s_cbranch_scc1 L_tk_4ok
    s_waitcnt vmcnt(0)
    s_branch L_tk_4tc
L_tk_4ok:
    s_waitcnt lgkmcnt(0)
    s_barrier
    v_mov_b32 v185, 143360
    ds_read_b32 v185, v185
    ds_read_b128 v[112:115], v187 offset:0
    ds_read_b128 v[116:119], v187 offset:2048
    ds_read_b64_tr_b16 v[144:145], v177 offset:49152
    ds_read_b64_tr_b16 v[146:147], v177 offset:50176
    ds_read_b64_tr_b16 v[148:149], v178 offset:49152
    ds_read_b64_tr_b16 v[150:151], v178 offset:50176
    ds_read_b64_tr_b16 v[152:153], v179 offset:49152
    ds_read_b64_tr_b16 v[154:155], v179 offset:50176
    ds_read_b64_tr_b16 v[156:157], v180 offset:49152
    ds_read_b64_tr_b16 v[158:159], v180 offset:50176
    ds_read_b64_tr_b16 v[160:161], v181 offset:49152
    ds_read_b64_tr_b16 v[162:163], v181 offset:50176
    s_waitcnt lgkmcnt(8)
    v_mfma_f32_16x16x32_bf16 v[0:3], v[112:115], v[144:147], v[0:3]
    ds_read_b64_tr_b16 v[164:165], v182 offset:49152
    ds_read_b64_tr_b16 v[166:167], v182 offset:50176
    v_mfma_f32_16x16x32_bf16 v[28:31], v[116:119], v[144:147], v[28:31]
    s_waitcnt lgkmcnt(8)
    v_mfma_f32_16x16x32_bf16 v[4:7], v[112:115], v[148:151], v[4:7]
    ds_read_b64_tr_b16 v[144:145], v183 offset:49152
    ds_read_b64_tr_b16 v[146:147], v183 offset:50176
    v_mfma_f32_16x16x32_bf16 v[32:35], v[116:119], v[148:151], v[32:35]
    s_waitcnt lgkmcnt(8)
    v_mfma_f32_16x16x32_bf16 v[8:11], v[112:115], v[152:155], v[8:11]
    ds_read_b128 v[128:131], v188 offset:0
    ds_read_b128 v[132:135], v188 offset:2048
    ds_read_b64_tr_b16 v[148:149], v177 offset:57344
    ds_read_b64_tr_b16 v[150:151], v177 offset:58368
    v_mfma_f32_16x16x32_bf16 v[36:39], v[116:119], v[152:155], v[36:39]
    s_waitcnt lgkmcnt(10)
    v_mfma_f32_16x16x32_bf16 v[12:15], v[112:115], v[156:159], v[12:15]
    ds_read_b64_tr_b16 v[152:153], v178 offset:57344
    ds_read_b64_tr_b16 v[154:155], v178 offset:58368
    v_mfma_f32_16x16x32_bf16 v[40:43], v[116:119], v[156:159], v[40:43]
    s_waitcnt lgkmcnt(10)
    v_mfma_f32_16x16x32_bf16 v[16:19], v[112:115], v[160:163], v[16:19]
    ds_read_b64_tr_b16 v[156:157], v179 offset:57344
    ds_read_b64_tr_b16 v[158:159], v179 offset:58368
    v_mfma_f32_16x16x32_bf16 v[44:47], v[116:119], v[160:163], v[44:47]
    s_waitcnt lgkmcnt(10)
    v_mfma_f32_16x16x32_bf16 v[20:23], v[112:115], v[164:167], v[20:23]
    ds_read_b64_tr_b16 v[160:161], v180 offset:57344
    ds_read_b64_tr_b16 v[162:163], v180 offset:58368
    v_mfma_f32_16x16x32_bf16 v[48:51], v[116:119], v[164:167], v[48:51]
    s_waitcnt lgkmcnt(10)
    v_mfma_f32_16x16x32_bf16 v[24:27], v[112:115], v[144:147], v[24:27]
    ds_read_b64_tr_b16 v[164:165], v181 offset:57344
    ds_read_b64_tr_b16 v[166:167], v181 offset:58368
    v_mfma_f32_16x16x32_bf16 v[52:55], v[116:119], v[144:147], v[52:55]
    s_waitcnt lgkmcnt(8)
    v_mfma_f32_16x16x32_bf16 v[0:3], v[128:131], v[148:151], v[0:3]
    ds_read_b64_tr_b16 v[144:145], v182 offset:57344
    ds_read_b64_tr_b16 v[146:147], v182 offset:58368
    v_mfma_f32_16x16x32_bf16 v[28:31], v[132:135], v[148:151], v[28:31]
    s_waitcnt lgkmcnt(8)
    v_mfma_f32_16x16x32_bf16 v[4:7], v[128:131], v[152:155], v[4:7]
    ds_read_b64_tr_b16 v[148:149], v183 offset:57344
    ds_read_b64_tr_b16 v[150:151], v183 offset:58368
    v_mfma_f32_16x16x32_bf16 v[32:35], v[132:135], v[152:155], v[32:35]
    s_waitcnt lgkmcnt(8)
    v_mfma_f32_16x16x32_bf16 v[8:11], v[128:131], v[156:159], v[8:11]
    v_mfma_f32_16x16x32_bf16 v[36:39], v[132:135], v[156:159], v[36:39]
    s_waitcnt lgkmcnt(6)
    v_mfma_f32_16x16x32_bf16 v[12:15], v[128:131], v[160:163], v[12:15]
    v_mfma_f32_16x16x32_bf16 v[40:43], v[132:135], v[160:163], v[40:43]
    s_waitcnt lgkmcnt(4)
    v_mfma_f32_16x16x32_bf16 v[16:19], v[128:131], v[164:167], v[16:19]
    v_mfma_f32_16x16x32_bf16 v[44:47], v[132:135], v[164:167], v[44:47]
    s_waitcnt lgkmcnt(2)
    v_mfma_f32_16x16x32_bf16 v[20:23], v[128:131], v[144:147], v[20:23]
    v_mfma_f32_16x16x32_bf16 v[48:51], v[132:135], v[144:147], v[48:51]
    s_waitcnt lgkmcnt(0)
    v_mfma_f32_16x16x32_bf16 v[24:27], v[128:131], v[148:151], v[24:27]
    v_mfma_f32_16x16x32_bf16 v[52:55], v[132:135], v[148:151], v[52:55]
    s_nop 7
    v_readfirstlane_b32 s32, v185
    v_mov_b32 v136, 0
    s_waitcnt vmcnt(0)
    s_mov_b64 exec, 1
    global_store_dword v141, v136, s[28:29] sc1
    s_mov_b64 exec, -1
    v_cvt_pk_bf16_f32 v0, v0, v1
    v_cvt_pk_bf16_f32 v1, v2, v3
    v_cvt_pk_bf16_f32 v2, v28, v29
    v_cvt_pk_bf16_f32 v3, v30, v31
    global_store_dwordx4 v184, v[0:3], s[56:57] offset:0 sc1
    v_cvt_pk_bf16_f32 v4, v4, v5
    v_cvt_pk_bf16_f32 v5, v6, v7
    v_cvt_pk_bf16_f32 v6, v32, v33
    v_cvt_pk_bf16_f32 v7, v34, v35
    global_store_dwordx4 v184, v[4:7], s[58:59] offset:0 sc1
    v_cvt_pk_bf16_f32 v8, v8, v9
    v_cvt_pk_bf16_f32 v9, v10, v11
    v_cvt_pk_bf16_f32 v10, v36, v37
    v_cvt_pk_bf16_f32 v11, v38, v39
    global_store_dwordx4 v184, v[8:11], s[60:61] offset:0 sc1
    v_cvt_pk_bf16_f32 v12, v12, v13
    v_cvt_pk_bf16_f32 v13, v14, v15
    v_cvt_pk_bf16_f32 v14, v40, v41
    v_cvt_pk_bf16_f32 v15, v42, v43
    global_store_dwordx4 v184, v[12:15], s[62:63] offset:0 sc1
    v_cvt_pk_bf16_f32 v16, v16, v17
    v_cvt_pk_bf16_f32 v17, v18, v19
    v_cvt_pk_bf16_f32 v18, v44, v45
    v_cvt_pk_bf16_f32 v19, v46, v47
    global_store_dwordx4 v184, v[16:19], s[64:65] offset:0 sc1
    v_cvt_pk_bf16_f32 v20, v20, v21
    v_cvt_pk_bf16_f32 v21, v22, v23
    v_cvt_pk_bf16_f32 v22, v48, v49
    v_cvt_pk_bf16_f32 v23, v50, v51
    global_store_dwordx4 v184, v[20:23], s[66:67] offset:0 sc1
    v_cvt_pk_bf16_f32 v24, v24, v25
    v_cvt_pk_bf16_f32 v25, v26, v27
    v_cvt_pk_bf16_f32 v26, v52, v53
    v_cvt_pk_bf16_f32 v27, v54, v55
    global_store_dwordx4 v184, v[24:27], s[68:69] offset:0 sc1
    s_branch L_fused
P_end:
    s_endpgm
L_fused:
    v_mov_b32 v0, v186
    s_lshr_b32 s33, s32, 8
    s_and_b32 s32, s32, 0xff
    s_cmp_lt_u32 s32, 30
    s_cbranch_scc1 L_chain
    s_sub_u32 s36, s32, 32
    s_cmp_lt_u32 s36, 112
    s_cbranch_scc1 L_worker
    v_mov_b32 v248, s87
    v_mov_b32 v249, 0
    s_waitcnt vmcnt(0)

    s_mov_b64 exec, 1
    global_store_dword v248, v249, s[28:29] sc1
    s_mov_b64 exec, -1
    s_cmp_ge_u32 s32, 252
    s_cbranch_scc1 L_end
    s_cmp_lg_u32 s31, 3
    s_cbranch_scc1 L_role2
    v_lshlrev_b32 v2, 4, v0
    v_add_u32 v2, 15237120, v2
    v_mul_u32_u24 v3, 512, v0
    v_add_u32 v3, 15204352, v3
L_ad:
    global_load_dwordx4 v[4:7], v2, s[28:29] sc1
    global_load_dwordx4 v[8:11], v3, s[28:29] offset:0 sc1
    global_load_dwordx4 v[12:15], v3, s[28:29] offset:128 sc1
    global_load_dwordx4 v[16:19], v3, s[28:29] offset:256 sc1
    global_load_dwordx4 v[20:23], v3, s[28:29] offset:384 sc1
    s_sub_u32 s35, s35, 1
    s_cbranch_scc1 L_role2
    s_waitcnt vmcnt(0)
    v_or3_b32 v4, v4, v5, v6
    v_or3_b32 v4, v4, v7, v8
    v_or3_b32 v4, v4, v9, v10
    v_or3_b32 v4, v4, v11, v12
    v_or3_b32 v4, v4, v13, v14
    v_or3_b32 v4, v4, v15, v16
    v_or3_b32 v4, v4, v17, v18
    v_or3_b32 v4, v4, v19, v20
    v_or3_b32 v4, v4, v21, v22
    v_or_b32 v4, v4, v23
    v_cmp_ne_u32 vcc, 0, v4
    s_cbranch_vccz L_role2
    s_sleep 64
    s_branch L_ad
L_role2:
    s_barrier
    s_cmp_ge_u32 s32, 32
    s_cbranch_scc1 L_worker
L_chain:
    s_cmp_lg_u32 s31, 0
    s_cbranch_scc1 L_pre_sig
    s_mov_b64 exec, 1
    s_lshl_b32 s36, s33, 16
    s_add_u32 s36, s36, 1
    v_mov_b32 v1, 4
    v_mov_b32 v2, s36
    global_atomic_add v1, v2, s[26:27]
    s_mov_b64 exec, -1
L_pre_sig:
    s_cmp_ge_u32 s32, 30
    s_cbranch_scc1 L_helper
    s_cmp_ge_u32 s32, 16
    s_cbranch_scc1 L_vcu
L_tcu:
    v_mov_b32 v119, v0
    v_lshlrev_b32 v104, 4, v119
    v_lshlrev_b32 v108, 7, v119
    s_lshl_b32 s36, s32, 2
    s_add_u32 s36, s36, s31
    s_mul_i32 s37, s36, 100352
    s_add_u32 s37, s37, 0
    s_add_u32 s48, s28, s37
    s_addc_u32 s49, s29, 0
    s_mov_b32 s68, -1
    s_mov_b32 s69, 0x000f000f
    s_mov_b32 s50, -1
    s_mov_b32 s51, 0x00020000
    s_lshl_b32 s36, s31, 1
    s_add_u32 s36, s36, s32
    s_mul_i32 s37, s36, 37
    s_lshr_b32 s37, s37, 8
    s_mul_i32 s37, s37, 7
    s_sub_u32 s36, s36, s37
    s_lshl_b32 s56, s36, 10
    s_add_u32 s57, s56, 1024
    s_cmp_eq_u32 s57, 7168
    s_cselect_b32 s57, 0, s57
    s_add_u32 s58, s57, 1024
    s_cmp_eq_u32 s58, 7168
    s_cselect_b32 s58, 0, s58
    s_add_u32 s59, s58, 1024
    s_cmp_eq_u32 s59, 7168
    s_cselect_b32 s59, 0, s59
    s_add_u32 s60, s59, 1024
    s_cmp_eq_u32 s60, 7168
    s_cselect_b32 s60, 0, s60
    s_add_u32 s61, s60, 1024
    s_cmp_eq_u32 s61, 7168
    s_cselect_b32 s61, 0, s61
    s_add_u32 s62, s61, 1024
    s_cmp_eq_u32 s62, 7168
    s_cselect_b32 s62, 0, s62
    s_lshl_b32 s36, s32, 2
    s_add_u32 s36, s36, s31
    s_mul_i32 s36, s36, 256
    v_mov_b32 v117, s36
    v_add_u32 v117, 15204352, v117
    v_bfe_u32 v116, v119, 0, 1
    v_lshl_add_u32 v117, v116, 7, v117
    global_load_dwordx4 v[12:15], v117, s[28:29] sc1
    v_mov_b32 v4, s87
    v_mov_b32 v5, 0
    s_waitcnt vmcnt(0)

    s_mov_b64 exec, 1
    global_store_dword v4, v5, s[28:29] sc1
    s_mov_b64 exec, -1
    s_branch L_wd_5c
L_wd_5:
    s_sleep 12
    global_load_dwordx4 v[12:15], v117, s[28:29] sc1
    s_sub_u32 s35, s35, 1
    s_cbranch_scc1 L_bail
    s_waitcnt vmcnt(0)
L_wd_5c:
    v_or3_b32 v12, v12, v13, v14
    v_or_b32 v12, v12, v15
    v_cmp_ne_u32 vcc, 0, v12
    s_cbranch_vccnz L_wd_5
    s_lshl_b32 s36, s56, 1
    buffer_load_dwordx4 a[0:3], v104, s[48:51], s36 offen offset:0 sc1
    buffer_load_dwordx4 a[4:7], v104, s[48:51], s36 offen offset:1024 sc1
    s_lshl_b32 s36, s57, 1
    buffer_load_dwordx4 a[8:11], v104, s[48:51], s36 offen offset:0 sc1
    buffer_load_dwordx4 a[12:15], v104, s[48:51], s36 offen offset:1024 sc1
    s_lshl_b32 s36, s58, 1
    buffer_load_dwordx4 a[16:19], v104, s[48:51], s36 offen offset:0 sc1
    buffer_load_dwordx4 a[20:23], v104, s[48:51], s36 offen offset:1024 sc1
    s_lshl_b32 s36, s59, 1
    buffer_load_dwordx4 a[24:27], v104, s[48:51], s36 offen offset:0 sc1
    buffer_load_dwordx4 a[28:31], v104, s[48:51], s36 offen offset:1024 sc1
    s_lshl_b32 s36, s60, 1
    buffer_load_dwordx4 a[32:35], v104, s[48:51], s36 offen offset:0 sc1
    buffer_load_dwordx4 a[36:39], v104, s[48:51], s36 offen offset:1024 sc1
    s_lshl_b32 s36, s61, 1
    buffer_load_dwordx4 a[40:43], v104, s[48:51], s36 offen offset:0 sc1
    buffer_load_dwordx4 a[44:47], v104, s[48:51], s36 offen offset:1024 sc1
    s_lshl_b32 s36, s62, 1
    buffer_load_dwordx4 a[48:51], v104, s[48:51], s36 offen offset:0 sc1
    buffer_load_dwordx4 a[52:55], v104, s[48:51], s36 offen offset:1024 sc1
    s_add_u32 s48, s48, 14336
    s_addc_u32 s49, s49, 0
    s_lshl_b32 s36, s56, 1
    buffer_load_dwordx4 a[56:59], v104, s[48:51], s36 offen offset:0 sc1
    buffer_load_dwordx4 a[60:63], v104, s[48:51], s36 offen offset:1024 sc1
    s_lshl_b32 s36, s57, 1
    buffer_load_dwordx4 a[64:67], v104, s[48:51], s36 offen offset:0 sc1
    buffer_load_dwordx4 a[68:71], v104, s[48:51], s36 offen offset:1024 sc1
    s_lshl_b32 s36, s58, 1
    buffer_load_dwordx4 a[72:75], v104, s[48:51], s36 offen offset:0 sc1
    buffer_load_dwordx4 a[76:79], v104, s[48:51], s36 offen offset:1024 sc1
    s_lshl_b32 s36, s59, 1
    buffer_load_dwordx4 a[80:83], v104, s[48:51], s36 offen offset:0 sc1
    buffer_load_dwordx4 a[84:87], v104, s[48:51], s36 offen offset:1024 sc1
    s_lshl_b32 s36, s60, 1
    buffer_load_dwordx4 a[88:91], v104, s[48:51], s36 offen offset:0 sc1
    buffer_load_dwordx4 a[92:95], v104, s[48:51], s36 offen offset:1024 sc1
    s_lshl_b32 s36, s61, 1
    buffer_load_dwordx4 a[96:99], v104, s[48:51], s36 offen offset:0 sc1
    buffer_load_dwordx4 a[100:103], v104, s[48:51], s36 offen offset:1024 sc1
    s_lshl_b32 s36, s62, 1
    buffer_load_dwordx4 a[104:107], v104, s[48:51], s36 offen offset:0 sc1
    buffer_load_dwordx4 a[108:111], v104, s[48:51], s36 offen offset:1024 sc1
    s_add_u32 s48, s48, 14336
    s_addc_u32 s49, s49, 0
    s_lshl_b32 s36, s56, 1
    buffer_load_dwordx4 a[112:115], v104, s[48:51], s36 offen offset:0 sc1
    buffer_load_dwordx4 a[116:119], v104, s[48:51], s36 offen offset:1024 sc1
    s_lshl_b32 s36, s57, 1
    buffer_load_dwordx4 a[120:123], v104, s[48:51], s36 offen offset:0 sc1
    buffer_load_dwordx4 a[124:127], v104, s[48:51], s36 offen offset:1024 sc1
    s_lshl_b32 s36, s58, 1
    buffer_load_dwordx4 a[128:131], v104, s[48:51], s36 offen offset:0 sc1
    buffer_load_dwordx4 a[132:135], v104, s[48:51], s36 offen offset:1024 sc1
    s_lshl_b32 s36, s59, 1
    buffer_load_dwordx4 a[136:139], v104, s[48:51], s36 offen offset:0 sc1
    buffer_load_dwordx4 a[140:143], v104, s[48:51], s36 offen offset:1024 sc1
    s_lshl_b32 s36, s60, 1
    buffer_load_dwordx4 a[144:147], v104, s[48:51], s36 offen offset:0 sc1
    buffer_load_dwordx4 a[148:151], v104, s[48:51], s36 offen offset:1024 sc1
    s_lshl_b32 s36, s61, 1
    buffer_load_dwordx4 a[152:155], v104, s[48:51], s36 offen offset:0 sc1
    buffer_load_dwordx4 a[156:159], v104, s[48:51], s36 offen offset:1024 sc1
    s_lshl_b32 s36, s62, 1
    buffer_load_dwordx4 a[160:163], v104, s[48:51], s36 offen offset:0 sc1
    buffer_load_dwordx4 a[164:167], v104, s[48:51], s36 offen offset:1024 sc1
    s_add_u32 s48, s48, 14336
    s_addc_u32 s49, s49, 0
    s_lshl_b32 s36, s56, 1
    buffer_load_dwordx4 a[168:171], v104, s[48:51], s36 offen offset:0 sc1
    buffer_load_dwordx4 a[172:175], v104, s[48:51], s36 offen offset:1024 sc1
    s_lshl_b32 s36, s57, 1
    buffer_load_dwordx4 a[176:179], v104, s[48:51], s36 offen offset:0 sc1
    buffer_load_dwordx4 a[180:183], v104, s[48:51], s36 offen offset:1024 sc1
    s_lshl_b32 s36, s58, 1
    buffer_load_dwordx4 a[184:187], v104, s[48:51], s36 offen offset:0 sc1
    buffer_load_dwordx4 a[188:191], v104, s[48:51], s36 offen offset:1024 sc1
    s_lshl_b32 s36, s59, 1
    buffer_load_dwordx4 a[192:195], v104, s[48:51], s36 offen offset:0 sc1
    buffer_load_dwordx4 a[196:199], v104, s[48:51], s36 offen offset:1024 sc1
    s_waitcnt vmcnt(48)
    s_lshl_b32 s36, s60, 1
    buffer_load_dwordx4 a[200:203], v104, s[48:51], s36 offen offset:0 sc1
    buffer_load_dwordx4 a[204:207], v104, s[48:51], s36 offen offset:1024 sc1
    s_waitcnt vmcnt(48)
    s_lshl_b32 s36, s61, 1
    buffer_load_dwordx4 a[208:211], v104, s[48:51], s36 offen offset:0 sc1
    buffer_load_dwordx4 a[212:215], v104, s[48:51], s36 offen offset:1024 sc1
    s_waitcnt vmcnt(48)
    s_lshl_b32 s36, s62, 1
    buffer_load_dwordx4 a[216:219], v104, s[48:51], s36 offen offset:0 sc1
    buffer_load_dwordx4 a[220:223], v104, s[48:51], s36 offen offset:1024 sc1
    s_waitcnt vmcnt(48)
    s_add_u32 s48, s48, 14336
    s_addc_u32 s49, s49, 0
    s_lshl_b32 s36, s56, 1
    buffer_load_dwordx4 a[224:227], v104, s[48:51], s36 offen offset:0 sc1
    buffer_load_dwordx4 a[228:231], v104, s[48:51], s36 offen offset:1024 sc1
    s_waitcnt vmcnt(48)
    s_lshl_b32 s36, s57, 1
    buffer_load_dwordx4 a[232:235], v104, s[48:51], s36 offen offset:0 sc1
    buffer_load_dwordx4 a[236:239], v104, s[48:51], s36 offen offset:1024 sc1
    s_waitcnt vmcnt(48)
    s_lshl_b32 s36, s58, 1
    buffer_load_dwordx4 a[240:243], v104, s[48:51], s36 offen offset:0 sc1
    buffer_load_dwordx4 a[244:247], v104, s[48:51], s36 offen offset:1024 sc1
    s_waitcnt vmcnt(48)
    s_lshl_b32 s36, s59, 1
    buffer_load_dwordx4 a[248:251], v104, s[48:51], s36 offen offset:0 sc1
    buffer_load_dwordx4 a[252:255], v104, s[48:51], s36 offen offset:1024 sc1
    s_waitcnt vmcnt(48)
    s_lshl_b32 s36, s60, 1
    buffer_load_dwordx4 v[120:123], v104, s[48:51], s36 offen offset:0 sc1
    buffer_load_dwordx4 v[124:127], v104, s[48:51], s36 offen offset:1024 sc1
    s_waitcnt vmcnt(48)
    s_lshl_b32 s36, s61, 1
    buffer_load_dwordx4 v[128:131], v104, s[48:51], s36 offen offset:0 sc1
    buffer_load_dwordx4 v[132:135], v104, s[48:51], s36 offen offset:1024 sc1
    s_waitcnt vmcnt(48)
    s_lshl_b32 s36, s62, 1
    buffer_load_dwordx4 v[136:139], v104, s[48:51], s36 offen offset:0 sc1
    buffer_load_dwordx4 v[140:143], v104, s[48:51], s36 offen offset:1024 sc1
    s_waitcnt vmcnt(48)
    s_add_u32 s48, s48, 14336
    s_addc_u32 s49, s49, 0
    s_lshl_b32 s36, s56, 1
    buffer_load_dwordx4 v[144:147], v104, s[48:51], s36 offen offset:0 sc1
    buffer_load_dwordx4 v[148:151], v104, s[48:51], s36 offen offset:1024 sc1
    s_waitcnt vmcnt(48)
    s_lshl_b32 s36, s57, 1
    buffer_load_dwordx4 v[152:155], v104, s[48:51], s36 offen offset:0 sc1
    buffer_load_dwordx4 v[156:159], v104, s[48:51], s36 offen offset:1024 sc1
    s_waitcnt vmcnt(48)
    s_lshl_b32 s36, s58, 1
    buffer_load_dwordx4 v[160:163], v104, s[48:51], s36 offen offset:0 sc1
    buffer_load_dwordx4 v[164:167], v104, s[48:51], s36 offen offset:1024 sc1
    s_waitcnt vmcnt(48)
    s_lshl_b32 s36, s59, 1
    buffer_load_dwordx4 v[168:171], v104, s[48:51], s36 offen offset:0 sc1
    buffer_load_dwordx4 v[172:175], v104, s[48:51], s36 offen offset:1024 sc1
    s_waitcnt vmcnt(48)
    s_lshl_b32 s36, s60, 1
    buffer_load_dwordx4 v[176:179], v104, s[48:51], s36 offen offset:0 sc1
    buffer_load_dwordx4 v[180:183], v104, s[48:51], s36 offen offset:1024 sc1
    s_waitcnt vmcnt(48)
    s_lshl_b32 s36, s61, 1
    buffer_load_dwordx4 v[184:187], v104, s[48:51], s36 offen offset:0 sc1
    buffer_load_dwordx4 v[188:191], v104, s[48:51], s36 offen offset:1024 sc1
    s_waitcnt vmcnt(48)
    s_lshl_b32 s36, s62, 1
    buffer_load_dwordx4 v[192:195], v104, s[48:51], s36 offen offset:0 sc1
    buffer_load_dwordx4 v[196:199], v104, s[48:51], s36 offen offset:1024 sc1
    s_waitcnt vmcnt(48)
    s_add_u32 s48, s48, 14336
    s_addc_u32 s49, s49, 0
    s_lshl_b32 s36, s56, 1
    buffer_load_dwordx4 v[200:203], v104, s[48:51], s36 offen offset:0 sc1
    buffer_load_dwordx4 v[204:207], v104, s[48:51], s36 offen offset:1024 sc1
    s_waitcnt vmcnt(48)
    s_lshl_b32 s36, s57, 1
    buffer_load_dwordx4 v[208:211], v104, s[48:51], s36 offen offset:0 sc1
    buffer_load_dwordx4 v[212:215], v104, s[48:51], s36 offen offset:1024 sc1
    s_waitcnt vmcnt(48)
    s_lshl_b32 s36, s58, 1
    buffer_load_dwordx4 v[216:219], v104, s[48:51], s36 offen offset:0 sc1
    buffer_load_dwordx4 v[220:223], v104, s[48:51], s36 offen offset:1024 sc1
    s_waitcnt vmcnt(48)
    s_lshl_b32 s36, s59, 1
    buffer_load_dwordx4 v[224:227], v104, s[48:51], s36 offen offset:0 sc1
    buffer_load_dwordx4 v[228:231], v104, s[48:51], s36 offen offset:1024 sc1
    s_waitcnt vmcnt(48)
    s_lshl_b32 s36, s60, 1
    buffer_load_dwordx4 v[232:235], v104, s[48:51], s36 offen offset:0 sc1
    buffer_load_dwordx4 v[236:239], v104, s[48:51], s36 offen offset:1024 sc1
    s_waitcnt vmcnt(48)
    s_lshl_b32 s36, s61, 1
    buffer_load_dwordx4 v[240:243], v104, s[48:51], s36 offen offset:0 sc1
    buffer_load_dwordx4 v[244:247], v104, s[48:51], s36 offen offset:1024 sc1
    s_waitcnt vmcnt(48)
    s_lshl_b32 s36, s62, 1
    buffer_load_dwordx4 v[248:251], v104, s[48:51], s36 offen offset:0 sc1
    buffer_load_dwordx4 v[252:255], v104, s[48:51], s36 offen offset:1024 sc1
    s_waitcnt vmcnt(48)
    s_add_u32 s48, s48, 14336
    s_addc_u32 s49, s49, 0
    s_barrier
    v_and_b32 v116, 1, v119
    v_cmp_eq_u32 vcc, 1, v116
    v_mov_b32 v105, 0x44444444
    v_mov_b32 v116, 0xeeeeeeee
    v_cndmask_b32 v105, v105, v116, vcc
    s_mul_i32 s36, s31, 1792
    s_mul_i32 s37, s31, 224
    v_lshrrev_b32 v117, 4, v119
    v_min_u32 v117, 2, v117
    v_mov_b32 v106, s36
    v_bfe_u32 v116, v119, 4, 2
    v_lshl_add_u32 v106, v116, 8, v106
    v_bfe_u32 v116, v119, 0, 3
    v_lshl_add_u32 v106, v116, 5, v106
    v_mov_b32 v107, s36
    v_add_u32 v107, 1024, v107
    v_bfe_u32 v116, v119, 0, 3
    v_lshl_add_u32 v107, v116, 5, v107
    v_lshl_add_u32 v107, v117, 8, v107
    v_mov_b32 v109, 1024
    v_bfe_u32 v116, v119, 0, 4
    v_lshl_add_u32 v109, v116, 4, v109
    v_lshl_add_u32 v109, v117, 8, v109
    s_lshl_b32 s36, s31, 11
    v_mov_b32 v110, s36
    v_add_u32 v110, 256, v110
    v_bfe_u32 v116, v119, 1, 1
    v_lshl_add_u32 v110, v116, 9, v110
    v_bfe_u32 v116, v119, 3, 1
    v_lshl_add_u32 v110, v116, 8, v110
    v_bfe_u32 v116, v119, 4, 2
    v_lshl_add_u32 v110, v116, 6, v110
    v_bfe_u32 v116, v119, 0, 1
    v_lshl_add_u32 v110, v116, 4, v110
    v_bfe_u32 v116, v119, 2, 1
    v_lshl_add_u32 v110, v116, 3, v110
    v_mov_b32 v111, s36
    v_add_u32 v111, 1280, v111
    v_bfe_u32 v116, v119, 2, 1
    v_lshl_add_u32 v111, v116, 9, v111
    v_bfe_u32 v116, v119, 4, 2
    v_lshl_add_u32 v111, v116, 6, v111
    v_bfe_u32 v116, v119, 0, 1
    v_lshl_add_u32 v111, v116, 4, v111
    v_bfe_u32 v116, v119, 3, 1
    v_lshl_add_u32 v111, v116, 3, v111
    v_bfe_u32 v116, v119, 1, 1
    v_lshl_add_u32 v111, v116, 2, v111
    v_mov_b32 v112, s36
    v_add_u32 v112, 1536, v112
    v_bfe_u32 v116, v119, 3, 1
    v_lshl_add_u32 v112, v116, 9, v112
    v_bfe_u32 v116, v119, 4, 2
    v_lshl_add_u32 v112, v116, 6, v112
    v_bfe_u32 v116, v119, 1, 1
    v_lshl_add_u32 v112, v116, 4, v112
    v_bfe_u32 v116, v119, 2, 1
    v_lshl_add_u32 v112, v116, 2, v112
    v_bfe_u32 v116, v119, 0, 1
    v_lshl_add_u32 v112, v116, 1, v112
    v_mov_b32 v113, s36
    v_add_u32 v113, 256, v113
    v_bfe_u32 v116, v119, 0, 6
    v_lshl_add_u32 v113, v116, 4, v113
    s_mul_i32 s36, s31, 1792
    v_mov_b32 v114, s36
    v_add_u32 v114, 8448, v114
    v_bfe_u32 v116, v119, 4, 2
    v_mul_u32_u24 v116, 448, v116
    v_add_u32 v114, v116, v114
    v_bfe_u32 v116, v119, 0, 4
    v_lshl_add_u32 v114, v116, 2, v114
    v_mov_b32 v0, 0
    v_mov_b32 v1, 0
    v_mov_b32 v2, 0
    v_mov_b32 v3, 0
    ds_write_b128 v113, v[0:3] offset:1024
    v_mov_b32 v0, 0xf149f2ca
    v_mov_b32 v117, s36
    v_add_u32 v117, 8640, v117
    v_bfe_u32 v116, v119, 3, 3
    v_mul_u32_u24 v116, 224, v116
    v_add_u32 v117, v116, v117
    v_bfe_u32 v116, v119, 0, 3
    v_lshl_add_u32 v117, v116, 2, v117
    ds_write_b32 v117, v0
    s_mul_i32 s36, s31, 448
    v_mov_b32 v115, s36
    v_add_u32 v115, 8448, v115
    v_bfe_u32 v116, v119, 4, 1
    v_mul_u32_u24 v116, 224, v116
    v_add_u32 v115, v116, v115
    v_mov_b32 v0, 0
    v_bfe_u32 v116, v119, 5, 1
    v_lshl_add_u32 v0, v116, 4, v0
    v_bfe_u32 v116, v119, 0, 4
    v_lshl_add_u32 v0, v116, 0, v0
    v_cmp_gt_u32 vcc, 20, v0
    v_lshlrev_b32 v116, 3, v0
    v_mov_b32 v117, 192
    v_cndmask_b32 v116, v117, v116, vcc
    v_add_u32 v115, v115, v116
    s_and_b32 s37, s32, 3
    s_lshl_b32 s36, s31, 6
    s_lshl_b32 s38, s37, 9
    s_add_u32 s36, s36, s38
    v_mov_b32 v118, s36
    v_bfe_u32 v116, v119, 3, 1
    v_lshl_add_u32 v118, v116, 8, v118
    v_bfe_u32 v116, v119, 1, 1
    v_lshl_add_u32 v118, v116, 4, v118
    v_bfe_u32 v116, v119, 2, 1
    v_lshl_add_u32 v118, v116, 3, v118
    v_bfe_u32 v116, v119, 0, 1
    v_lshl_add_u32 v118, v116, 2, v118
    v_bfe_u32 v116, v119, 4, 1
    v_lshl_add_u32 v118, v116, 5, v118
    s_lshl_b32 s36, s31, 7
    s_and_b32 s38, s37, 1
    s_lshl_b32 s38, s38, 6
    s_add_u32 s36, s36, s38
    s_lshr_b32 s38, s37, 1
    s_lshl_b32 s38, s38, 2
    s_add_u32 s36, s36, s38
    v_mov_b32 v117, s36
    v_add_u32 v117, 2048, v117
    v_bfe_u32 v116, v119, 0, 2
    v_lshl_add_u32 v117, v116, 4, v117
    v_bfe_u32 v116, v119, 4, 1
    v_lshl_add_u32 v117, v116, 3, v117
    v_cmp_lt_u32 vcc, 15, v0
    s_nop 1
    v_cndmask_b32 v118, v118, v117, vcc
    s_lshr_b32 s37, s32, 2
    s_add_u32 s40, s28, 13623296
    s_addc_u32 s41, s29, 0
    s_mov_b32 s42, -1
    s_mov_b32 s43, 0x00020000
    s_mul_i32 s36, s37, 2560
    s_add_u32 s36, s36, 14147584
    s_add_u32 s52, s28, s36
    s_addc_u32 s53, s29, 0
    s_mul_i32 s36, s31, 7168
    s_add_u32 s36, s36, 62918656
    s_add_u32 s44, s28, s36
    s_addc_u32 s45, s29, 0
    s_mul_i32 s36, s32, 1
    s_add_u32 s36, s36, 14819328
    s_add_u32 s72, s28, s36
    s_addc_u32 s73, s29, 0
    s_cmp_eq_u32 s31, 3
    s_cselect_b32 s74, 4080, 0
    s_mov_b32 s75, 0x00020000
    s_add_u32 s70, s28, 14815232
    s_addc_u32 s71, s29, 0
    s_mov_b64 exec, s[68:69]
    v_mov_b32 v2, -1
    v_mov_b32 v3, -1
    s_mov_b32 s46, 8
    ds_write_b64 v115, v[2:3] offset:0
    ds_write_b64 v115, v[2:3] offset:1792
    ds_write_b64 v115, v[2:3] offset:3584
    ds_write_b64 v115, v[2:3] offset:5376
    s_mov_b64 exec, -1
    v_mov_b32 v0, v119
    v_mov_b32 v119, 0
    s_mov_b32 s34, 0
    v_mov_b32 v116, 4
    v_lshlrev_b32 v4, 4, v0
    v_add_u32 v4, 15237120, v4
L_cw_6:
    s_sub_u32 s35, s35, 1
    s_cbranch_scc1 L_bail
    global_load_dwordx4 v[6:9], v4, s[28:29] sc1
    global_load_dword v117, v116, s[26:27] sc1
    s_waitcnt vmcnt(0)
    v_or3_b32 v6, v6, v7, v8
    v_or_b32 v6, v6, v9
    v_cmp_ne_u32 vcc, 0, v6
    s_cbranch_vccnz L_cw_6
    v_readfirstlane_b32 s36, v117
    s_and_b32 s37, s36, 0xffff
    s_cmp_lg_u32 s37, 32
    s_cbranch_scc1 L_cw_6
    s_lshr_b32 s33, s36, 16
    s_waitcnt vmcnt(0)
    s_cmp_lg_u32 s33, 0
    s_cbranch_scc1 L_t_loop_s
    s_cmp_eq_u32 s31, 1
    s_cbranch_scc1 L_t_loop_f1
    s_cmp_eq_u32 s31, 2
    s_cbranch_scc1 L_t_loop_f2
    s_cmp_eq_u32 s31, 3
    s_cbranch_scc1 L_t_loop_f3
.p2align 6
L_t_loop_f0:
    s_add_u32 s70, s70, 4096
    s_addc_u32 s71, s71, 0
    v_mov_b32 v0, 0
    v_mov_b32 v1, 0
    v_mov_b32 v2, 0
    v_mov_b32 v3, 0
    v_mov_b32 v4, 0
    v_mov_b32 v5, 0
    v_mov_b32 v6, 0
    v_mov_b32 v7, 0
    v_mov_b32 v8, 0
    v_mov_b32 v9, 0
    v_mov_b32 v10, 0
    v_mov_b32 v11, 0
    v_mov_b32 v12, 0
    v_mov_b32 v13, 0
    v_mov_b32 v14, 0
    v_mov_b32 v15, 0
    v_mov_b32 v16, 0
    v_mov_b32 v17, 0
    v_mov_b32 v18, 0
    v_mov_b32 v19, 0
    v_mov_b32 v20, 0
    v_mov_b32 v21, 0
    v_mov_b32 v22, 0
    v_mov_b32 v23, 0
    v_mov_b32 v24, 0
    v_mov_b32 v25, 0
    v_mov_b32 v26, 0
    v_mov_b32 v27, 0
    v_add_u32 v96, s56, v104
    v_add_u32 v97, s57, v104
    v_add_u32 v44, s60, v104
    v_add_u32 v48, s61, v104
    v_add_u32 v52, s62, v104
    s_nop 15
    s_nop 15
    s_nop 15
    s_nop 15
    s_nop 15
    s_waitcnt lgkmcnt(0)
    s_mov_b32 s4, -1
    s_mov_b32 s8, -1
    s_mov_b32 s12, -1
    s_mov_b32 s16, -1
    s_mov_b32 s20, -1
    s_mov_b32 s48, -1
    s_mov_b32 s64, -1
    s_mov_b32 s76, -1
    buffer_load_dwordx4 v[28:31], v104, s[40:43], s56 offen sc1
    s_nop 14
    buffer_load_dwordx4 v[32:35], v104, s[40:43], s57 offen sc1
    s_nop 14
    buffer_load_dwordx4 v[36:39], v104, s[40:43], s58 offen sc1
    s_nop 14
    buffer_load_dwordx4 v[40:43], v104, s[40:43], s59 offen sc1
L_t_shot_f0:
    s_waitcnt vmcnt(3)
    v_smfmac_f32_16x16x64_bf16 v[0:3], v[28:31], a[0:7], v105
    ds_write_b128 v96, v[28:31] offset:16384
    v_smfmac_f32_16x16x64_bf16 v[4:7], v[28:31], a[56:63], v105
    v_max3_u32 v116, v28, v29, v30
    v_smfmac_f32_16x16x64_bf16 v[8:11], v[28:31], a[112:119], v105
    global_load_dwordx4 v[56:59], v104, s[44:45] offset:-4096
    v_smfmac_f32_16x16x64_bf16 v[12:15], v[28:31], a[168:175], v105
    v_smfmac_f32_16x16x64_bf16 v[16:19], v[28:31], a[224:231], v105
    s_waitcnt vmcnt(3)
    v_max3_u32 v116, v116, v31, v32
    v_smfmac_f32_16x16x64_bf16 v[20:23], v[28:31], v[144:151], v105
    ds_write_b128 v97, v[32:35] offset:16384
    v_smfmac_f32_16x16x64_bf16 v[24:27], v[28:31], v[200:207], v105
    global_load_dwordx4 v[60:63], v104, s[44:45] offset:-2304
    v_max3_u32 v116, v116, v33, v34
    v_smfmac_f32_16x16x64_bf16 v[0:3], v[32:35], a[8:15], v105
    v_max_u32 v116, v116, v35
    v_smfmac_f32_16x16x64_bf16 v[4:7], v[32:35], a[64:71], v105
    v_cmp_eq_u32 vcc, -1, v116
    v_smfmac_f32_16x16x64_bf16 v[8:11], v[32:35], a[120:127], v105
    s_cbranch_vccnz L_t_retry_f0
    v_mov_b32 v28, 0
    v_smfmac_f32_16x16x64_bf16 v[12:15], v[32:35], a[176:183], v105
    s_waitcnt vmcnt(3) lgkmcnt(0)
    v_max3_u32 v116, v36, v37, v38
    v_smfmac_f32_16x16x64_bf16 v[16:19], v[32:35], a[232:239], v105
    global_load_dwordx4 v[72:75], v104, s[44:45] offset:-512
    v_max_u32 v116, v116, v39
    v_smfmac_f32_16x16x64_bf16 v[20:23], v[32:35], v[152:159], v105
    v_cmp_eq_u32 vcc, -1, v116
    v_smfmac_f32_16x16x64_bf16 v[24:27], v[32:35], v[208:215], v105
    s_barrier
    s_cbranch_vccnz L_t_fix2_f0
L_t_fix2r_f0:
    v_mov_b32 v29, 0
    v_smfmac_f32_16x16x64_bf16 v[0:3], v[36:39], a[16:23], v105
    ds_read_b128 v[44:47], v44 offset:16384
    v_mov_b32 v30, 0
    v_smfmac_f32_16x16x64_bf16 v[4:7], v[36:39], a[72:79], v105
    ds_read_b128 v[48:51], v48 offset:16384
    global_load_dwordx4 v[76:79], v104, s[44:45] offset:1280
    v_mov_b32 v31, 0
    v_smfmac_f32_16x16x64_bf16 v[8:11], v[36:39], a[128:135], v105
    ds_read_b128 v[52:55], v52 offset:16384
    v_mov_b32 v32, 0
    v_smfmac_f32_16x16x64_bf16 v[12:15], v[36:39], a[184:191], v105
    s_waitcnt vmcnt(4)
    v_max3_u32 v116, v40, v41, v42
    v_smfmac_f32_16x16x64_bf16 v[16:19], v[36:39], a[240:247], v105
    v_max_u32 v116, v116, v43
    v_smfmac_f32_16x16x64_bf16 v[20:23], v[36:39], v[160:167], v105
    global_load_dwordx4 v[64:67], v109, s[44:45] offset:-4096
    v_cmp_eq_u32 vcc, -1, v116
    v_smfmac_f32_16x16x64_bf16 v[24:27], v[36:39], v[216:223], v105
    s_cbranch_vccnz L_t_fix3_f0
L_t_fix3r_f0:
    v_mov_b32 v33, 0
    v_smfmac_f32_16x16x64_bf16 v[0:3], v[40:43], a[24:31], v105
    v_mov_b32 v34, 0
    v_smfmac_f32_16x16x64_bf16 v[4:7], v[40:43], a[80:87], v105
    v_mov_b32 v35, 0
    v_smfmac_f32_16x16x64_bf16 v[8:11], v[40:43], a[136:143], v105
    global_load_dwordx4 v[68:71], v109, s[44:45] offset:-2304
    v_mov_b32 v36, 0
    v_smfmac_f32_16x16x64_bf16 v[12:15], v[40:43], a[192:199], v105
    s_waitcnt lgkmcnt(0)
    v_mov_b32 v37, 0
    v_smfmac_f32_16x16x64_bf16 v[0:3], v[44:47], a[32:39], v105
    v_mov_b32 v38, 0
    v_smfmac_f32_16x16x64_bf16 v[0:3], v[48:51], a[40:47], v105
    ds_read_b128 v[88:91], v106 offset:16384
    v_mov_b32 v39, 0
    v_smfmac_f32_16x16x64_bf16 v[0:3], v[52:55], a[48:55], v105
    global_load_dwordx4 v[80:83], v109, s[44:45] offset:-512
    v_smfmac_f32_16x16x64_bf16 v[4:7], v[44:47], a[88:95], v105
    ds_read_b128 v[92:95], v106 offset:16400
    v_smfmac_f32_16x16x64_bf16 v[4:7], v[48:51], a[96:103], v105
    ds_read_b128 v[96:99], v107 offset:16384
    v_add_f32 v0, v0, v1
    v_smfmac_f32_16x16x64_bf16 v[4:7], v[52:55], a[104:111], v105
    ds_read_b128 v[100:103], v107 offset:16400
    v_add_f32 v2, v2, v3
    v_smfmac_f32_16x16x64_bf16 v[8:11], v[44:47], a[144:151], v105
    global_load_dwordx4 v[84:87], v109, s[44:45] offset:1280
    v_smfmac_f32_16x16x64_bf16 v[8:11], v[48:51], a[152:159], v105
    v_add_f32 v4, v4, v5
    v_smfmac_f32_16x16x64_bf16 v[8:11], v[52:55], a[160:167], v105
    v_add_f32 v6, v6, v7
    v_smfmac_f32_16x16x64_bf16 v[12:15], v[44:47], a[200:207], v105
    v_cvt_pk_bf16_f32 v0, v0, v4
    v_smfmac_f32_16x16x64_bf16 v[12:15], v[48:51], a[208:215], v105
    v_add_f32 v8, v8, v9
    v_smfmac_f32_16x16x64_bf16 v[12:15], v[52:55], a[216:223], v105
    v_add_f32 v10, v10, v11
    v_smfmac_f32_16x16x64_bf16 v[16:19], v[40:43], a[248:255], v105
    v_cvt_pk_bf16_f32 v2, v2, v6
    v_smfmac_f32_16x16x64_bf16 v[16:19], v[44:47], v[120:127], v105
    v_add_f32 v12, v12, v13
    v_smfmac_f32_16x16x64_bf16 v[16:19], v[48:51], v[128:135], v105
    v_add_f32 v14, v14, v15
    v_smfmac_f32_16x16x64_bf16 v[16:19], v[52:55], v[136:143], v105
    v_cvt_pk_bf16_f32 v1, v8, v12
    v_smfmac_f32_16x16x64_bf16 v[20:23], v[40:43], v[168:175], v105
    ds_write_b64 v110, v[0:1]
    v_cvt_pk_bf16_f32 v3, v10, v14
    v_smfmac_f32_16x16x64_bf16 v[20:23], v[44:47], v[176:183], v105
    ds_write_b64 v110, v[2:3] offset:32
    v_add_f32 v16, v16, v17
    v_smfmac_f32_16x16x64_bf16 v[20:23], v[48:51], v[184:191], v105
    ds_read_b128 v[4:7], v113
    v_add_f32 v18, v18, v19
    v_smfmac_f32_16x16x64_bf16 v[20:23], v[52:55], v[192:199], v105
    v_smfmac_f32_16x16x64_bf16 v[24:27], v[40:43], v[224:231], v105
    v_smfmac_f32_16x16x64_bf16 v[24:27], v[44:47], v[232:239], v105
    v_add_f32 v20, v20, v21
    v_smfmac_f32_16x16x64_bf16 v[24:27], v[48:51], v[240:247], v105
    s_waitcnt vmcnt(4)
    v_add_f32 v22, v22, v23
    v_smfmac_f32_16x16x64_bf16 v[24:27], v[52:55], v[248:255], v105
    v_cvt_pk_bf16_f32 v16, v16, v20
    v_cvt_pk_bf16_f32 v17, v18, v22
    ds_write2_b32 v111, v16, v17 offset1:8
    s_nop 3
    v_add_f32 v24, v24, v25
    v_add_f32 v26, v26, v27
    v_cvt_pk_bf16_f32 v24, v24, v26
    ds_write_b16 v112, v24
    ds_write_b16_d16_hi v112, v24 offset:32
    ds_read_b128 v[8:11], v113 offset:1024
    s_waitcnt lgkmcnt(4)
    v_smfmac_f32_16x16x64_bf16 v[28:31], v[4:7], v[56:63], v105
    v_smfmac_f32_16x16x64_bf16 v[32:35], v[4:7], v[72:79], v105
    v_smfmac_f32_16x16x64_bf16 v[36:39], v[4:7], v[88:95], v105
    s_waitcnt vmcnt(0) lgkmcnt(0)
    v_smfmac_f32_16x16x64_bf16 v[28:31], v[8:11], v[64:71], v105
    v_smfmac_f32_16x16x64_bf16 v[32:35], v[8:11], v[80:87], v105
    v_smfmac_f32_16x16x64_bf16 v[36:39], v[8:11], v[96:103], v105
    v_add_f32 v28, v28, v29
    v_add_f32 v30, v30, v31
    ds_write2_b32 v114, v28, v30 offset0:0 offset1:56
    v_add_f32 v32, v32, v33
    v_add_f32 v34, v34, v35
    ds_write2_b32 v114, v32, v34 offset0:16 offset1:72
    s_nop 0
    v_add_f32 v36, v36, v37
    v_add_f32 v38, v38, v39
    ds_write2_b32 v114, v36, v38 offset0:32 offset1:88
    s_barrier
    ds_read_b64 v[0:1], v115 offset:0
    ds_read_b64 v[2:3], v115 offset:1792
    ds_read_b64 v[4:5], v115 offset:3584
    ds_read_b64 v[6:7], v115 offset:5376
L_t_red_f0:
    s_waitcnt lgkmcnt(2)
    v_pk_add_f32 v[0:1], v[0:1], v[2:3]
    s_waitcnt lgkmcnt(0)
    v_pk_add_f32 v[4:5], v[4:5], v[6:7]
    v_pk_add_f32 v[0:1], v[0:1], v[4:5]
    v_max_f32 v4, v0, v1
    v_cmp_u_f32 vcc, v0, v1
    s_nop 0
    v_max_f32_dpp v5, v4, v4 row_ror:1 row_mask:0xf bank_mask:0xf
    v_max_f32_dpp v5, v4, v5 row_ror:2 row_mask:0xf bank_mask:0xf
    v_max_f32_dpp v5, v4, v5 row_ror:3 row_mask:0xf bank_mask:0xf
    s_cbranch_vccnz L_t_nan_f0
L_t_nanr_f0:
    s_nop 0
    v_max_f32_dpp v4, v5, v5 row_ror:4 row_mask:0xf bank_mask:0xf
    v_max_f32_dpp v4, v5, v4 row_ror:8 row_mask:0xf bank_mask:0xf
    v_max_f32_dpp v6, v5, v4 row_ror:12 row_mask:0xf bank_mask:0xf
    v_max_f32_dpp v4, v5, v4 row_ror:12 row_mask:0xf bank_mask:0xf
    s_nop 1
    v_permlane32_swap_b32 v4, v6
    v_max_f32 v4, v4, v6
    v_pk_add_f32 v[0:1], v[0:1], v[4:5] op_sel_hi:[1,0] neg_lo:[0,1] neg_hi:[0,1]
    v_exp_f32 v0, v0
    v_exp_f32 v1, v1
    s_nop 0
    v_add_f32 v4, v0, v1
    s_nop 1
    v_add_f32_dpp v5, v4, v4 row_ror:1 row_mask:0xf bank_mask:0xf
    v_add_f32_dpp v5, v4, v5 row_ror:2 row_mask:0xf bank_mask:0xf
    v_add_f32_dpp v5, v4, v5 row_ror:3 row_mask:0xf bank_mask:0xf
    s_nop 1
    v_add_f32_dpp v4, v5, v5 row_ror:4 row_mask:0xf bank_mask:0xf
    v_add_f32_dpp v4, v5, v4 row_ror:8 row_mask:0xf bank_mask:0xf
    v_add_f32_dpp v6, v5, v4 row_ror:12 row_mask:0xf bank_mask:0xf
    v_add_f32_dpp v4, v5, v4 row_ror:12 row_mask:0xf bank_mask:0xf
    s_nop 1
    v_permlane32_swap_b32 v4, v6
    v_add_f32 v4, v4, v6
    v_rcp_f32 v4, v4
    s_mov_b64 exec, s[68:69]
    v_mul_f32_e64 v0, v0, v4 clamp
    v_mul_f32_e64 v1, v1, v4 clamp
    v_cvt_pk_bf16_f32 v0, v0, v1
    global_store_dword v118, v0, s[52:53]
    v_mov_b32 v2, -1
    v_mov_b32 v3, -1
    s_mov_b32 s46, 8
    ds_write_b64 v115, v[2:3] offset:0
    ds_write_b64 v115, v[2:3] offset:1792
    ds_write_b64 v115, v[2:3] offset:3584
    ds_write_b64 v115, v[2:3] offset:5376
    s_mov_b64 exec, -1
    s_add_u32 s44, s44, 28672
    s_addc_u32 s45, s45, 0
    s_add_u32 s40, s40, 8192
    s_addc_u32 s41, s41, 0
    s_add_u32 s52, s52, 10240
    s_addc_u32 s53, s53, 0
    s_add_u32 s72, s72, 4096
    s_addc_u32 s73, s73, 0
    s_cmp_eq_u32 s34, 62
    s_cbranch_scc1 L_t_end
    s_nop 7
    s_load_dwordx4 s[4:7], s[70:71], 0
    s_nop 3
    s_load_dwordx4 s[8:11], s[70:71], 128
    s_nop 3
    s_load_dwordx4 s[12:15], s[70:71], 256
    s_nop 3
    s_load_dwordx4 s[16:19], s[70:71], 384
    s_nop 3
    s_load_dwordx4 s[20:23], s[70:71], 512
    s_nop 3
    s_load_dwordx4 s[48:51], s[70:71], 640
    s_nop 3
    s_load_dwordx4 s[64:67], s[70:71], 768
    s_or_b64 s[36:37], s[4:5], s[6:7]
    s_cbranch_scc0 L_t_sync_f0
    s_nop 1
    s_load_dwordx4 s[76:79], s[70:71], 896
    s_or_b64 s[36:37], s[8:9], s[10:11]
    s_cbranch_scc0 L_t_sync_f0
    s_nop 1
    s_load_dwordx4 s[4:7], s[70:71], 1024
    s_or_b64 s[36:37], s[12:13], s[14:15]
    s_cbranch_scc0 L_t_sync_f0
    s_nop 1
    s_load_dwordx4 s[8:11], s[70:71], 1152
    s_or_b64 s[36:37], s[16:17], s[18:19]
    s_cbranch_scc0 L_t_sync_f0
    s_nop 1
    s_load_dwordx4 s[12:15], s[70:71], 1280
    s_or_b64 s[36:37], s[20:21], s[22:23]
    s_cbranch_scc0 L_t_sync_f0
    s_nop 1
    s_load_dwordx4 s[16:19], s[70:71], 1408
    s_or_b64 s[36:37], s[48:49], s[50:51]
    s_cbranch_scc0 L_t_sync_f0
    s_nop 1
    s_load_dwordx4 s[20:23], s[70:71], 1536
    s_or_b64 s[36:37], s[64:65], s[66:67]
    s_cbranch_scc0 L_t_sync_f0
    s_nop 1
    s_load_dwordx4 s[48:51], s[70:71], 1664
    s_or_b64 s[36:37], s[76:77], s[78:79]
    s_cbranch_scc0 L_t_sync_f0
    s_nop 1
    s_load_dwordx4 s[64:67], s[70:71], 1792
    s_or_b64 s[36:37], s[4:5], s[6:7]
    s_cbranch_scc0 L_t_sync_f0
    s_nop 1
    s_load_dwordx4 s[76:79], s[70:71], 1920
    s_or_b64 s[36:37], s[8:9], s[10:11]
    s_cbranch_scc0 L_t_sync_f0
    s_nop 1
    s_load_dwordx4 s[4:7], s[70:71], 2048
    s_or_b64 s[36:37], s[12:13], s[14:15]
    s_cbranch_scc0 L_t_sync_f0
    s_nop 1
    s_load_dwordx4 s[8:11], s[70:71], 2176
    s_or_b64 s[36:37], s[16:17], s[18:19]
    s_cbranch_scc0 L_t_sync_f0
    s_nop 1
    s_load_dwordx4 s[12:15], s[70:71], 2304
    s_or_b64 s[36:37], s[20:21], s[22:23]
    s_cbranch_scc0 L_t_sync_f0
    s_nop 1
    s_load_dwordx4 s[16:19], s[70:71], 2432
    s_or_b64 s[36:37], s[48:49], s[50:51]
    s_cbranch_scc0 L_t_sync_f0
    s_nop 1
    s_load_dwordx4 s[20:23], s[70:71], 2560
    s_or_b64 s[36:37], s[64:65], s[66:67]
    s_cbranch_scc0 L_t_sync_f0
    s_nop 1
    s_load_dwordx4 s[48:51], s[70:71], 2688
    s_or_b64 s[36:37], s[76:77], s[78:79]
    s_cbranch_scc0 L_t_sync_f0
    s_nop 1
    s_load_dwordx4 s[64:67], s[70:71], 2816
    s_or_b64 s[36:37], s[4:5], s[6:7]
    s_cbranch_scc0 L_t_sync_f0
    s_nop 1
    s_load_dwordx4 s[76:79], s[70:71], 2944
    s_or_b64 s[36:37], s[8:9], s[10:11]
    s_cbranch_scc0 L_t_sync_f0
    s_nop 1
    s_load_dwordx4 s[4:7], s[70:71], 3072
    s_or_b64 s[36:37], s[12:13], s[14:15]
    s_cbranch_scc0 L_t_sync_f0
    s_nop 1
    s_load_dwordx4 s[8:11], s[70:71], 3200
    s_or_b64 s[36:37], s[16:17], s[18:19]
    s_cbranch_scc0 L_t_sync_f0
    s_nop 1
    s_load_dwordx4 s[12:15], s[70:71], 3328
    s_or_b64 s[36:37], s[20:21], s[22:23]
    s_cbranch_scc0 L_t_sync_f0
    s_nop 1
    s_load_dwordx4 s[16:19], s[70:71], 3456
    s_or_b64 s[36:37], s[48:49], s[50:51]
    s_cbranch_scc0 L_t_sync_f0
    s_nop 1
    s_load_dwordx4 s[20:23], s[70:71], 3584
    s_or_b64 s[36:37], s[64:65], s[66:67]
    s_cbranch_scc0 L_t_sync_f0
    s_nop 1
    s_load_dwordx4 s[48:51], s[70:71], 3712
    s_or_b64 s[36:37], s[76:77], s[78:79]
    s_cbranch_scc0 L_t_sync_f0
    s_nop 1
    s_load_dwordx4 s[64:67], s[70:71], 3840
    s_or_b64 s[36:37], s[4:5], s[6:7]
    s_cbranch_scc0 L_t_sync_f0
    s_nop 1
    s_load_dwordx4 s[76:79], s[70:71], 3968
    s_or_b64 s[36:37], s[8:9], s[10:11]
    s_cbranch_scc0 L_t_sync_f0
    s_nop 1
    s_nop 0
    s_or_b64 s[36:37], s[12:13], s[14:15]
    s_cbranch_scc0 L_t_sync_f0
    s_nop 1
    s_nop 0
    s_or_b64 s[36:37], s[16:17], s[18:19]
    s_cbranch_scc0 L_t_sync_f0
    s_nop 1
    s_nop 0
    s_or_b64 s[36:37], s[20:21], s[22:23]
    s_cbranch_scc0 L_t_sync_f0
    s_nop 1
    s_nop 0
    s_or_b64 s[36:37], s[48:49], s[50:51]
    s_cbranch_scc0 L_t_sync_f0
    s_nop 1
    s_nop 0
    s_or_b64 s[36:37], s[64:65], s[66:67]
    s_cbranch_scc0 L_t_sync_f0
    s_nop 1
    s_nop 0
    s_or_b64 s[36:37], s[76:77], s[78:79]
    s_cbranch_scc0 L_t_sync_f0
    s_nop 1
L_t_sync_f0:
    s_barrier
    s_add_u32 s34, s34, 1
    s_branch L_t_loop_f0
.p2align 6
L_t_loop_f1:
    s_add_u32 s70, s70, 4096
    s_addc_u32 s71, s71, 0
    v_mov_b32 v0, 0
    v_mov_b32 v1, 0
    v_mov_b32 v2, 0
    v_mov_b32 v3, 0
    v_mov_b32 v4, 0
    v_mov_b32 v5, 0
    v_mov_b32 v6, 0
    v_mov_b32 v7, 0
    v_mov_b32 v8, 0
    v_mov_b32 v9, 0
    v_mov_b32 v10, 0
    v_mov_b32 v11, 0
    v_mov_b32 v12, 0
    v_mov_b32 v13, 0
    v_mov_b32 v14, 0
    v_mov_b32 v15, 0
    v_mov_b32 v16, 0
    v_mov_b32 v17, 0
    v_mov_b32 v18, 0
    v_mov_b32 v19, 0
    v_mov_b32 v20, 0
    v_mov_b32 v21, 0
    v_mov_b32 v22, 0
    v_mov_b32 v23, 0
    v_mov_b32 v24, 0
    v_mov_b32 v25, 0
    v_mov_b32 v26, 0
    v_mov_b32 v27, 0
    v_add_u32 v96, s56, v104
    v_add_u32 v97, s57, v104
    v_add_u32 v44, s60, v104
    v_add_u32 v48, s61, v104
    v_add_u32 v52, s62, v104
    s_nop 3
    s_nop 15
    s_nop 15
    s_nop 15
    s_nop 15
    s_nop 15
    s_nop 8
    buffer_load_dwordx4 v[28:31], v104, s[40:43], s56 offen sc1
    s_nop 14
    buffer_load_dwordx4 v[32:35], v104, s[40:43], s57 offen sc1
    s_nop 14
    buffer_load_dwordx4 v[36:39], v104, s[40:43], s58 offen sc1
    s_nop 14
    buffer_load_dwordx4 v[40:43], v104, s[40:43], s59 offen sc1
L_t_shot_f1:
    s_waitcnt vmcnt(3)
    v_smfmac_f32_16x16x64_bf16 v[0:3], v[28:31], a[0:7], v105
    ds_write_b128 v96, v[28:31] offset:16384
    v_smfmac_f32_16x16x64_bf16 v[4:7], v[28:31], a[56:63], v105
    v_max3_u32 v116, v28, v29, v30
    v_smfmac_f32_16x16x64_bf16 v[8:11], v[28:31], a[112:119], v105
    global_load_dwordx4 v[56:59], v104, s[44:45] offset:-4096
    v_smfmac_f32_16x16x64_bf16 v[12:15], v[28:31], a[168:175], v105
    v_smfmac_f32_16x16x64_bf16 v[16:19], v[28:31], a[224:231], v105
    s_waitcnt vmcnt(3)
    v_max3_u32 v116, v116, v31, v32
    v_smfmac_f32_16x16x64_bf16 v[20:23], v[28:31], v[144:151], v105
    ds_write_b128 v97, v[32:35] offset:16384
    v_smfmac_f32_16x16x64_bf16 v[24:27], v[28:31], v[200:207], v105
    global_load_dwordx4 v[60:63], v104, s[44:45] offset:-2304
    v_max3_u32 v116, v116, v33, v34
    v_smfmac_f32_16x16x64_bf16 v[0:3], v[32:35], a[8:15], v105
    v_max_u32 v116, v116, v35
    v_smfmac_f32_16x16x64_bf16 v[4:7], v[32:35], a[64:71], v105
    v_cmp_eq_u32 vcc, -1, v116
    v_smfmac_f32_16x16x64_bf16 v[8:11], v[32:35], a[120:127], v105
    s_cbranch_vccnz L_t_retry_f1
    v_mov_b32 v28, 0
    v_smfmac_f32_16x16x64_bf16 v[12:15], v[32:35], a[176:183], v105
    s_waitcnt vmcnt(3) lgkmcnt(0)
    v_max3_u32 v116, v36, v37, v38
    v_smfmac_f32_16x16x64_bf16 v[16:19], v[32:35], a[232:239], v105
    global_load_dwordx4 v[72:75], v104, s[44:45] offset:-512
    v_max_u32 v116, v116, v39
    v_smfmac_f32_16x16x64_bf16 v[20:23], v[32:35], v[152:159], v105
    s_barrier
    v_cmp_eq_u32 vcc, -1, v116
    v_smfmac_f32_16x16x64_bf16 v[24:27], v[32:35], v[208:215], v105
    s_cbranch_vccnz L_t_fix2_f1
L_t_fix2r_f1:
    v_mov_b32 v29, 0
    v_smfmac_f32_16x16x64_bf16 v[0:3], v[36:39], a[16:23], v105
    ds_read_b128 v[44:47], v44 offset:16384
    v_mov_b32 v30, 0
    v_smfmac_f32_16x16x64_bf16 v[4:7], v[36:39], a[72:79], v105
    ds_read_b128 v[48:51], v48 offset:16384
    global_load_dwordx4 v[76:79], v104, s[44:45] offset:1280
    v_mov_b32 v31, 0
    v_smfmac_f32_16x16x64_bf16 v[8:11], v[36:39], a[128:135], v105
    ds_read_b128 v[52:55], v52 offset:16384
    v_mov_b32 v32, 0
    v_smfmac_f32_16x16x64_bf16 v[12:15], v[36:39], a[184:191], v105
    s_waitcnt vmcnt(4)
    v_max3_u32 v116, v40, v41, v42
    v_smfmac_f32_16x16x64_bf16 v[16:19], v[36:39], a[240:247], v105
    v_max_u32 v116, v116, v43
    v_smfmac_f32_16x16x64_bf16 v[20:23], v[36:39], v[160:167], v105
    global_load_dwordx4 v[64:67], v109, s[44:45] offset:-4096
    v_cmp_eq_u32 vcc, -1, v116
    v_smfmac_f32_16x16x64_bf16 v[24:27], v[36:39], v[216:223], v105
    s_cbranch_vccnz L_t_fix3_f1
L_t_fix3r_f1:
    v_mov_b32 v33, 0
    v_smfmac_f32_16x16x64_bf16 v[0:3], v[40:43], a[24:31], v105
    v_mov_b32 v34, 0
    v_smfmac_f32_16x16x64_bf16 v[4:7], v[40:43], a[80:87], v105
    v_mov_b32 v35, 0
    v_smfmac_f32_16x16x64_bf16 v[8:11], v[40:43], a[136:143], v105
    global_load_dwordx4 v[68:71], v109, s[44:45] offset:-2304
    v_mov_b32 v36, 0
    v_smfmac_f32_16x16x64_bf16 v[12:15], v[40:43], a[192:199], v105
    s_waitcnt lgkmcnt(0)
    v_mov_b32 v37, 0
    v_smfmac_f32_16x16x64_bf16 v[0:3], v[44:47], a[32:39], v105
    v_mov_b32 v38, 0
    v_smfmac_f32_16x16x64_bf16 v[0:3], v[48:51], a[40:47], v105
    ds_read_b128 v[88:91], v106 offset:16384
    v_mov_b32 v39, 0
    v_smfmac_f32_16x16x64_bf16 v[0:3], v[52:55], a[48:55], v105
    global_load_dwordx4 v[80:83], v109, s[44:45] offset:-512
    v_smfmac_f32_16x16x64_bf16 v[4:7], v[44:47], a[88:95], v105
    ds_read_b128 v[92:95], v106 offset:16400
    v_smfmac_f32_16x16x64_bf16 v[4:7], v[48:51], a[96:103], v105
    ds_read_b128 v[96:99], v107 offset:16384
    v_add_f32 v0, v0, v1
    v_smfmac_f32_16x16x64_bf16 v[4:7], v[52:55], a[104:111], v105
    ds_read_b128 v[100:103], v107 offset:16400
    v_add_f32 v2, v2, v3
    v_smfmac_f32_16x16x64_bf16 v[8:11], v[44:47], a[144:151], v105
    global_load_dwordx4 v[84:87], v109, s[44:45] offset:1280
    v_smfmac_f32_16x16x64_bf16 v[8:11], v[48:51], a[152:159], v105
    v_add_f32 v4, v4, v5
    v_smfmac_f32_16x16x64_bf16 v[8:11], v[52:55], a[160:167], v105
    v_add_f32 v6, v6, v7
    v_smfmac_f32_16x16x64_bf16 v[12:15], v[44:47], a[200:207], v105
    v_cvt_pk_bf16_f32 v0, v0, v4
    v_smfmac_f32_16x16x64_bf16 v[12:15], v[48:51], a[208:215], v105
    v_add_f32 v8, v8, v9
    v_smfmac_f32_16x16x64_bf16 v[12:15], v[52:55], a[216:223], v105
    v_add_f32 v10, v10, v11
    v_smfmac_f32_16x16x64_bf16 v[16:19], v[40:43], a[248:255], v105
    v_cvt_pk_bf16_f32 v2, v2, v6
    v_smfmac_f32_16x16x64_bf16 v[16:19], v[44:47], v[120:127], v105
    v_add_f32 v12, v12, v13
    v_smfmac_f32_16x16x64_bf16 v[16:19], v[48:51], v[128:135], v105
    v_add_f32 v14, v14, v15
    v_smfmac_f32_16x16x64_bf16 v[16:19], v[52:55], v[136:143], v105
    v_cvt_pk_bf16_f32 v1, v8, v12
    v_smfmac_f32_16x16x64_bf16 v[20:23], v[40:43], v[168:175], v105
    ds_write_b64 v110, v[0:1]
    v_cvt_pk_bf16_f32 v3, v10, v14
    v_smfmac_f32_16x16x64_bf16 v[20:23], v[44:47], v[176:183], v105
    ds_write_b64 v110, v[2:3] offset:32
    v_add_f32 v16, v16, v17
    v_smfmac_f32_16x16x64_bf16 v[20:23], v[48:51], v[184:191], v105
    ds_read_b128 v[4:7], v113
    v_add_f32 v18, v18, v19
    v_smfmac_f32_16x16x64_bf16 v[20:23], v[52:55], v[192:199], v105
    v_smfmac_f32_16x16x64_bf16 v[24:27], v[40:43], v[224:231], v105
    v_smfmac_f32_16x16x64_bf16 v[24:27], v[44:47], v[232:239], v105
    v_add_f32 v20, v20, v21
    v_smfmac_f32_16x16x64_bf16 v[24:27], v[48:51], v[240:247], v105
    s_waitcnt vmcnt(4)
    v_add_f32 v22, v22, v23
    v_smfmac_f32_16x16x64_bf16 v[24:27], v[52:55], v[248:255], v105
    v_cvt_pk_bf16_f32 v16, v16, v20
    v_cvt_pk_bf16_f32 v17, v18, v22
    ds_write2_b32 v111, v16, v17 offset1:8
    s_nop 3
    v_add_f32 v24, v24, v25
    v_add_f32 v26, v26, v27
    v_cvt_pk_bf16_f32 v24, v24, v26
    ds_write_b16 v112, v24
    ds_write_b16_d16_hi v112, v24 offset:32
    ds_read_b128 v[8:11], v113 offset:1024
    s_waitcnt lgkmcnt(4)
    v_smfmac_f32_16x16x64_bf16 v[28:31], v[4:7], v[56:63], v105
    v_smfmac_f32_16x16x64_bf16 v[32:35], v[4:7], v[72:79], v105
    v_smfmac_f32_16x16x64_bf16 v[36:39], v[4:7], v[88:95], v105
    s_waitcnt vmcnt(0) lgkmcnt(0)
    v_smfmac_f32_16x16x64_bf16 v[28:31], v[8:11], v[64:71], v105
    v_smfmac_f32_16x16x64_bf16 v[32:35], v[8:11], v[80:87], v105
    v_smfmac_f32_16x16x64_bf16 v[36:39], v[8:11], v[96:103], v105
    v_add_f32 v28, v28, v29
    v_add_f32 v30, v30, v31
    ds_write2_b32 v114, v28, v30 offset0:0 offset1:56
    v_add_f32 v32, v32, v33
    v_add_f32 v34, v34, v35
    ds_write2_b32 v114, v32, v34 offset0:16 offset1:72
    s_nop 0
    v_add_f32 v36, v36, v37
    v_add_f32 v38, v38, v39
    ds_write2_b32 v114, v36, v38 offset0:32 offset1:88
    s_barrier
    ds_read_b64 v[0:1], v115 offset:0
    ds_read_b64 v[2:3], v115 offset:1792
    ds_read_b64 v[4:5], v115 offset:3584
    ds_read_b64 v[6:7], v115 offset:5376
L_t_red_f1:
    s_waitcnt lgkmcnt(2)
    v_pk_add_f32 v[0:1], v[0:1], v[2:3]
    s_waitcnt lgkmcnt(0)
    v_pk_add_f32 v[4:5], v[4:5], v[6:7]
    v_pk_add_f32 v[0:1], v[0:1], v[4:5]
    v_max_f32 v4, v0, v1
    v_cmp_u_f32 vcc, v0, v1
    s_nop 0
    v_max_f32_dpp v5, v4, v4 row_ror:1 row_mask:0xf bank_mask:0xf
    v_max_f32_dpp v5, v4, v5 row_ror:2 row_mask:0xf bank_mask:0xf
    v_max_f32_dpp v5, v4, v5 row_ror:3 row_mask:0xf bank_mask:0xf
    s_cbranch_vccnz L_t_nan_f1
L_t_nanr_f1:
    s_nop 0
    v_max_f32_dpp v4, v5, v5 row_ror:4 row_mask:0xf bank_mask:0xf
    v_max_f32_dpp v4, v5, v4 row_ror:8 row_mask:0xf bank_mask:0xf
    v_max_f32_dpp v6, v5, v4 row_ror:12 row_mask:0xf bank_mask:0xf
    v_max_f32_dpp v4, v5, v4 row_ror:12 row_mask:0xf bank_mask:0xf
    s_nop 1
    v_permlane32_swap_b32 v4, v6
    v_max_f32 v4, v4, v6
    v_pk_add_f32 v[0:1], v[0:1], v[4:5] op_sel_hi:[1,0] neg_lo:[0,1] neg_hi:[0,1]
    v_exp_f32 v0, v0
    v_exp_f32 v1, v1
    s_nop 0
    v_add_f32 v4, v0, v1
    s_nop 1
    v_add_f32_dpp v5, v4, v4 row_ror:1 row_mask:0xf bank_mask:0xf
    v_add_f32_dpp v5, v4, v5 row_ror:2 row_mask:0xf bank_mask:0xf
    v_add_f32_dpp v5, v4, v5 row_ror:3 row_mask:0xf bank_mask:0xf
    s_nop 1
    v_add_f32_dpp v4, v5, v5 row_ror:4 row_mask:0xf bank_mask:0xf
    v_add_f32_dpp v4, v5, v4 row_ror:8 row_mask:0xf bank_mask:0xf
    v_add_f32_dpp v6, v5, v4 row_ror:12 row_mask:0xf bank_mask:0xf
    v_add_f32_dpp v4, v5, v4 row_ror:12 row_mask:0xf bank_mask:0xf
    s_nop 1
    v_permlane32_swap_b32 v4, v6
    v_add_f32 v4, v4, v6
    v_rcp_f32 v4, v4
    s_mov_b64 exec, s[68:69]
    v_mul_f32_e64 v0, v0, v4 clamp
    v_mul_f32_e64 v1, v1, v4 clamp
    v_cvt_pk_bf16_f32 v0, v0, v1
    global_store_dword v118, v0, s[52:53]
    v_mov_b32 v2, -1
    v_mov_b32 v3, -1
    s_mov_b32 s46, 8
    ds_write_b64 v115, v[2:3] offset:0
    ds_write_b64 v115, v[2:3] offset:1792
    ds_write_b64 v115, v[2:3] offset:3584
    ds_write_b64 v115, v[2:3] offset:5376
    s_mov_b64 exec, -1
    s_add_u32 s44, s44, 28672
    s_addc_u32 s45, s45, 0
    s_add_u32 s40, s40, 8192
    s_addc_u32 s41, s41, 0
    s_add_u32 s52, s52, 10240
    s_addc_u32 s53, s53, 0
    s_add_u32 s72, s72, 4096
    s_addc_u32 s73, s73, 0
    s_cmp_eq_u32 s34, 62
    s_cbranch_scc1 L_t_end
L_t_sync_f1:
    s_barrier
    s_add_u32 s34, s34, 1
    s_branch L_t_loop_f1
.p2align 6
L_t_loop_f2:
    s_add_u32 s70, s70, 4096
    s_addc_u32 s71, s71, 0
    v_mov_b32 v0, 0
    v_mov_b32 v1, 0
    v_mov_b32 v2, 0
    v_mov_b32 v3, 0
    v_mov_b32 v4, 0
    v_mov_b32 v5, 0
    v_mov_b32 v6, 0
    v_mov_b32 v7, 0
    v_mov_b32 v8, 0
    v_mov_b32 v9, 0
    v_mov_b32 v10, 0
    v_mov_b32 v11, 0
    v_mov_b32 v12, 0
    v_mov_b32 v13, 0
    v_mov_b32 v14, 0
    v_mov_b32 v15, 0
    v_mov_b32 v16, 0
    v_mov_b32 v17, 0
    v_mov_b32 v18, 0
    v_mov_b32 v19, 0
    v_mov_b32 v20, 0
    v_mov_b32 v21, 0
    v_mov_b32 v22, 0
    v_mov_b32 v23, 0
    v_mov_b32 v24, 0
    v_mov_b32 v25, 0
    v_mov_b32 v26, 0
    v_mov_b32 v27, 0
    v_add_u32 v96, s56, v104
    v_add_u32 v97, s57, v104
    v_add_u32 v44, s60, v104
    v_add_u32 v48, s61, v104
    v_add_u32 v52, s62, v104
    s_nop 7
    s_nop 15
    s_nop 15
    s_nop 15
    s_nop 15
    s_nop 15
    s_nop 8
    buffer_load_dwordx4 v[28:31], v104, s[40:43], s56 offen sc1
    s_nop 14
    buffer_load_dwordx4 v[32:35], v104, s[40:43], s57 offen sc1
    s_nop 14
    buffer_load_dwordx4 v[36:39], v104, s[40:43], s58 offen sc1
    s_nop 14
    buffer_load_dwordx4 v[40:43], v104, s[40:43], s59 offen sc1
L_t_shot_f2:
    s_waitcnt vmcnt(3)
    v_smfmac_f32_16x16x64_bf16 v[0:3], v[28:31], a[0:7], v105
    ds_write_b128 v96, v[28:31] offset:16384
    v_smfmac_f32_16x16x64_bf16 v[4:7], v[28:31], a[56:63], v105
    v_max3_u32 v116, v28, v29, v30
    v_smfmac_f32_16x16x64_bf16 v[8:11], v[28:31], a[112:119], v105
    global_load_dwordx4 v[56:59], v104, s[44:45] offset:-4096
    v_smfmac_f32_16x16x64_bf16 v[12:15], v[28:31], a[168:175], v105
    v_smfmac_f32_16x16x64_bf16 v[16:19], v[28:31], a[224:231], v105
    s_waitcnt vmcnt(3)
    v_max3_u32 v116, v116, v31, v32
    v_smfmac_f32_16x16x64_bf16 v[20:23], v[28:31], v[144:151], v105
    ds_write_b128 v97, v[32:35] offset:16384
    v_smfmac_f32_16x16x64_bf16 v[24:27], v[28:31], v[200:207], v105
    global_load_dwordx4 v[60:63], v104, s[44:45] offset:-2304
    v_max3_u32 v116, v116, v33, v34
    v_smfmac_f32_16x16x64_bf16 v[0:3], v[32:35], a[8:15], v105
    v_max_u32 v116, v116, v35
    v_smfmac_f32_16x16x64_bf16 v[4:7], v[32:35], a[64:71], v105
    v_cmp_eq_u32 vcc, -1, v116
    v_smfmac_f32_16x16x64_bf16 v[8:11], v[32:35], a[120:127], v105
    s_cbranch_vccnz L_t_retry_f2
    v_mov_b32 v28, 0
    v_smfmac_f32_16x16x64_bf16 v[12:15], v[32:35], a[176:183], v105
    s_waitcnt vmcnt(3) lgkmcnt(0)
    v_max3_u32 v116, v36, v37, v38
    v_smfmac_f32_16x16x64_bf16 v[16:19], v[32:35], a[232:239], v105
    s_barrier
    global_load_dwordx4 v[72:75], v104, s[44:45] offset:-512
    v_max_u32 v116, v116, v39
    v_smfmac_f32_16x16x64_bf16 v[20:23], v[32:35], v[152:159], v105
    v_cmp_eq_u32 vcc, -1, v116
    v_smfmac_f32_16x16x64_bf16 v[24:27], v[32:35], v[208:215], v105
    s_cbranch_vccnz L_t_fix2_f2
L_t_fix2r_f2:
    v_mov_b32 v29, 0
    v_smfmac_f32_16x16x64_bf16 v[0:3], v[36:39], a[16:23], v105
    ds_read_b128 v[44:47], v44 offset:16384
    v_mov_b32 v30, 0
    v_smfmac_f32_16x16x64_bf16 v[4:7], v[36:39], a[72:79], v105
    ds_read_b128 v[48:51], v48 offset:16384
    global_load_dwordx4 v[76:79], v104, s[44:45] offset:1280
    v_mov_b32 v31, 0
    v_smfmac_f32_16x16x64_bf16 v[8:11], v[36:39], a[128:135], v105
    ds_read_b128 v[52:55], v52 offset:16384
    v_mov_b32 v32, 0
    v_smfmac_f32_16x16x64_bf16 v[12:15], v[36:39], a[184:191], v105
    s_waitcnt vmcnt(4)
    v_max3_u32 v116, v40, v41, v42
    v_smfmac_f32_16x16x64_bf16 v[16:19], v[36:39], a[240:247], v105
    v_max_u32 v116, v116, v43
    v_smfmac_f32_16x16x64_bf16 v[20:23], v[36:39], v[160:167], v105
    global_load_dwordx4 v[64:67], v109, s[44:45] offset:-4096
    v_cmp_eq_u32 vcc, -1, v116
    v_smfmac_f32_16x16x64_bf16 v[24:27], v[36:39], v[216:223], v105
    s_cbranch_vccnz L_t_fix3_f2
L_t_fix3r_f2:
    v_mov_b32 v33, 0
    v_smfmac_f32_16x16x64_bf16 v[0:3], v[40:43], a[24:31], v105
    v_mov_b32 v34, 0
    v_smfmac_f32_16x16x64_bf16 v[4:7], v[40:43], a[80:87], v105
    v_mov_b32 v35, 0
    v_smfmac_f32_16x16x64_bf16 v[8:11], v[40:43], a[136:143], v105
    global_load_dwordx4 v[68:71], v109, s[44:45] offset:-2304
    v_mov_b32 v36, 0
    v_smfmac_f32_16x16x64_bf16 v[12:15], v[40:43], a[192:199], v105
    s_waitcnt lgkmcnt(0)
    v_mov_b32 v37, 0
    v_smfmac_f32_16x16x64_bf16 v[0:3], v[44:47], a[32:39], v105
    v_mov_b32 v38, 0
    v_smfmac_f32_16x16x64_bf16 v[0:3], v[48:51], a[40:47], v105
    ds_read_b128 v[88:91], v106 offset:16384
    v_mov_b32 v39, 0
    v_smfmac_f32_16x16x64_bf16 v[0:3], v[52:55], a[48:55], v105
    global_load_dwordx4 v[80:83], v109, s[44:45] offset:-512
    v_smfmac_f32_16x16x64_bf16 v[4:7], v[44:47], a[88:95], v105
    ds_read_b128 v[92:95], v106 offset:16400
    v_smfmac_f32_16x16x64_bf16 v[4:7], v[48:51], a[96:103], v105
    ds_read_b128 v[96:99], v107 offset:16384
    v_add_f32 v0, v0, v1
    v_smfmac_f32_16x16x64_bf16 v[4:7], v[52:55], a[104:111], v105
    ds_read_b128 v[100:103], v107 offset:16400
    v_add_f32 v2, v2, v3
    v_smfmac_f32_16x16x64_bf16 v[8:11], v[44:47], a[144:151], v105
    global_load_dwordx4 v[84:87], v109, s[44:45] offset:1280
    v_smfmac_f32_16x16x64_bf16 v[8:11], v[48:51], a[152:159], v105
    v_add_f32 v4, v4, v5
    v_smfmac_f32_16x16x64_bf16 v[8:11], v[52:55], a[160:167], v105
    v_add_f32 v6, v6, v7
    v_smfmac_f32_16x16x64_bf16 v[12:15], v[44:47], a[200:207], v105
    v_cvt_pk_bf16_f32 v0, v0, v4
    v_smfmac_f32_16x16x64_bf16 v[12:15], v[48:51], a[208:215], v105
    v_add_f32 v8, v8, v9
    v_smfmac_f32_16x16x64_bf16 v[12:15], v[52:55], a[216:223], v105
    v_add_f32 v10, v10, v11
    v_smfmac_f32_16x16x64_bf16 v[16:19], v[40:43], a[248:255], v105
    v_cvt_pk_bf16_f32 v2, v2, v6
    v_smfmac_f32_16x16x64_bf16 v[16:19], v[44:47], v[120:127], v105
    v_add_f32 v12, v12, v13
    v_smfmac_f32_16x16x64_bf16 v[16:19], v[48:51], v[128:135], v105
    v_add_f32 v14, v14, v15
    v_smfmac_f32_16x16x64_bf16 v[16:19], v[52:55], v[136:143], v105
    v_cvt_pk_bf16_f32 v1, v8, v12
    v_smfmac_f32_16x16x64_bf16 v[20:23], v[40:43], v[168:175], v105
    ds_write_b64 v110, v[0:1]
    v_cvt_pk_bf16_f32 v3, v10, v14
    v_smfmac_f32_16x16x64_bf16 v[20:23], v[44:47], v[176:183], v105
    ds_write_b64 v110, v[2:3] offset:32
    v_add_f32 v16, v16, v17
    v_smfmac_f32_16x16x64_bf16 v[20:23], v[48:51], v[184:191], v105
    ds_read_b128 v[4:7], v113
    v_add_f32 v18, v18, v19
    v_smfmac_f32_16x16x64_bf16 v[20:23], v[52:55], v[192:199], v105
    v_smfmac_f32_16x16x64_bf16 v[24:27], v[40:43], v[224:231], v105
    v_smfmac_f32_16x16x64_bf16 v[24:27], v[44:47], v[232:239], v105
    v_add_f32 v20, v20, v21
    v_smfmac_f32_16x16x64_bf16 v[24:27], v[48:51], v[240:247], v105
    s_waitcnt vmcnt(4)
    v_add_f32 v22, v22, v23
    v_smfmac_f32_16x16x64_bf16 v[24:27], v[52:55], v[248:255], v105
    v_cvt_pk_bf16_f32 v16, v16, v20
    v_cvt_pk_bf16_f32 v17, v18, v22
    ds_write2_b32 v111, v16, v17 offset1:8
    s_nop 3
    v_add_f32 v24, v24, v25
    v_add_f32 v26, v26, v27
    v_cvt_pk_bf16_f32 v24, v24, v26
    ds_write_b16 v112, v24
    ds_write_b16_d16_hi v112, v24 offset:32
    ds_read_b128 v[8:11], v113 offset:1024
    s_waitcnt lgkmcnt(4)
    v_smfmac_f32_16x16x64_bf16 v[28:31], v[4:7], v[56:63], v105
    v_smfmac_f32_16x16x64_bf16 v[32:35], v[4:7], v[72:79], v105
    v_smfmac_f32_16x16x64_bf16 v[36:39], v[4:7], v[88:95], v105
    s_waitcnt vmcnt(0) lgkmcnt(0)
    v_smfmac_f32_16x16x64_bf16 v[28:31], v[8:11], v[64:71], v105
    v_smfmac_f32_16x16x64_bf16 v[32:35], v[8:11], v[80:87], v105
    v_smfmac_f32_16x16x64_bf16 v[36:39], v[8:11], v[96:103], v105
    v_add_f32 v28, v28, v29
    v_add_f32 v30, v30, v31
    ds_write2_b32 v114, v28, v30 offset0:0 offset1:56
    v_add_f32 v32, v32, v33
    v_add_f32 v34, v34, v35
    ds_write2_b32 v114, v32, v34 offset0:16 offset1:72
    s_nop 0
    v_add_f32 v36, v36, v37
    v_add_f32 v38, v38, v39
    ds_write2_b32 v114, v36, v38 offset0:32 offset1:88
    s_barrier
    ds_read_b64 v[0:1], v115 offset:0
    ds_read_b64 v[2:3], v115 offset:1792
    ds_read_b64 v[4:5], v115 offset:3584
    ds_read_b64 v[6:7], v115 offset:5376
L_t_red_f2:
    s_waitcnt lgkmcnt(2)
    v_pk_add_f32 v[0:1], v[0:1], v[2:3]
    s_waitcnt lgkmcnt(0)
    v_pk_add_f32 v[4:5], v[4:5], v[6:7]
    v_pk_add_f32 v[0:1], v[0:1], v[4:5]
    v_max_f32 v4, v0, v1
    v_cmp_u_f32 vcc, v0, v1
    s_nop 0
    v_max_f32_dpp v5, v4, v4 row_ror:1 row_mask:0xf bank_mask:0xf
    v_max_f32_dpp v5, v4, v5 row_ror:2 row_mask:0xf bank_mask:0xf
    v_max_f32_dpp v5, v4, v5 row_ror:3 row_mask:0xf bank_mask:0xf
    s_cbranch_vccnz L_t_nan_f2
L_t_nanr_f2:
    s_nop 0
    v_max_f32_dpp v4, v5, v5 row_ror:4 row_mask:0xf bank_mask:0xf
    v_max_f32_dpp v4, v5, v4 row_ror:8 row_mask:0xf bank_mask:0xf
    v_max_f32_dpp v6, v5, v4 row_ror:12 row_mask:0xf bank_mask:0xf
    v_max_f32_dpp v4, v5, v4 row_ror:12 row_mask:0xf bank_mask:0xf
    s_nop 1
    v_permlane32_swap_b32 v4, v6
    v_max_f32 v4, v4, v6
    v_pk_add_f32 v[0:1], v[0:1], v[4:5] op_sel_hi:[1,0] neg_lo:[0,1] neg_hi:[0,1]
    v_exp_f32 v0, v0
    v_exp_f32 v1, v1
    s_nop 0
    v_add_f32 v4, v0, v1
    s_nop 1
    v_add_f32_dpp v5, v4, v4 row_ror:1 row_mask:0xf bank_mask:0xf
    v_add_f32_dpp v5, v4, v5 row_ror:2 row_mask:0xf bank_mask:0xf
    v_add_f32_dpp v5, v4, v5 row_ror:3 row_mask:0xf bank_mask:0xf
    s_nop 1
    v_add_f32_dpp v4, v5, v5 row_ror:4 row_mask:0xf bank_mask:0xf
    v_add_f32_dpp v4, v5, v4 row_ror:8 row_mask:0xf bank_mask:0xf
    v_add_f32_dpp v6, v5, v4 row_ror:12 row_mask:0xf bank_mask:0xf
    v_add_f32_dpp v4, v5, v4 row_ror:12 row_mask:0xf bank_mask:0xf
    s_nop 1
    v_permlane32_swap_b32 v4, v6
    v_add_f32 v4, v4, v6
    v_rcp_f32 v4, v4
    s_mov_b64 exec, s[68:69]
    v_mul_f32_e64 v0, v0, v4 clamp
    v_mul_f32_e64 v1, v1, v4 clamp
    v_cvt_pk_bf16_f32 v0, v0, v1
    global_store_dword v118, v0, s[52:53]
    v_mov_b32 v2, -1
    v_mov_b32 v3, -1
    s_mov_b32 s46, 8
    ds_write_b64 v115, v[2:3] offset:0
    ds_write_b64 v115, v[2:3] offset:1792
    ds_write_b64 v115, v[2:3] offset:3584
    ds_write_b64 v115, v[2:3] offset:5376
    s_mov_b64 exec, -1
    s_add_u32 s44, s44, 28672
    s_addc_u32 s45, s45, 0
    s_add_u32 s40, s40, 8192
    s_addc_u32 s41, s41, 0
    s_add_u32 s52, s52, 10240
    s_addc_u32 s53, s53, 0
    s_add_u32 s72, s72, 4096
    s_addc_u32 s73, s73, 0
    s_cmp_eq_u32 s34, 62
    s_cbranch_scc1 L_t_end
L_t_sync_f2:
    s_barrier
    s_add_u32 s34, s34, 1
    s_branch L_t_loop_f2
.p2align 6
L_t_loop_f3:
    s_add_u32 s70, s70, 4096
    s_addc_u32 s71, s71, 0
    v_mov_b32 v0, 0
    v_mov_b32 v1, 0
    v_mov_b32 v2, 0
    v_mov_b32 v3, 0
    v_mov_b32 v4, 0
    v_mov_b32 v5, 0
    v_mov_b32 v6, 0
    v_mov_b32 v7, 0
    v_mov_b32 v8, 0
    v_mov_b32 v9, 0
    v_mov_b32 v10, 0
    v_mov_b32 v11, 0
    v_mov_b32 v12, 0
    v_mov_b32 v13, 0
    v_mov_b32 v14, 0
    v_mov_b32 v15, 0
    v_mov_b32 v16, 0
    v_mov_b32 v17, 0
    v_mov_b32 v18, 0
    v_mov_b32 v19, 0
    v_mov_b32 v20, 0
    v_mov_b32 v21, 0
    v_mov_b32 v22, 0
    v_mov_b32 v23, 0
    v_mov_b32 v24, 0
    v_mov_b32 v25, 0
    v_mov_b32 v26, 0
    v_mov_b32 v27, 0
    v_add_u32 v96, s56, v104
    v_add_u32 v97, s57, v104
    v_add_u32 v44, s60, v104
    v_add_u32 v48, s61, v104
    v_add_u32 v52, s62, v104
    s_nop 11
    s_nop 15
    s_nop 15
    s_nop 15
    s_nop 15
    s_nop 15
    s_nop 8
    buffer_load_dwordx4 v[28:31], v104, s[40:43], s56 offen sc1
    s_nop 14
    buffer_load_dwordx4 v[32:35], v104, s[40:43], s57 offen sc1
    s_nop 14
    buffer_load_dwordx4 v[36:39], v104, s[40:43], s58 offen sc1
    s_nop 14
    buffer_load_dwordx4 v[40:43], v104, s[40:43], s59 offen sc1
L_t_shot_f3:
    s_waitcnt vmcnt(3)
    v_smfmac_f32_16x16x64_bf16 v[0:3], v[28:31], a[0:7], v105
    ds_write_b128 v96, v[28:31] offset:16384
    v_smfmac_f32_16x16x64_bf16 v[4:7], v[28:31], a[56:63], v105
    v_max3_u32 v116, v28, v29, v30
    v_smfmac_f32_16x16x64_bf16 v[8:11], v[28:31], a[112:119], v105
    global_load_dwordx4 v[56:59], v104, s[44:45] offset:-4096
    v_smfmac_f32_16x16x64_bf16 v[12:15], v[28:31], a[168:175], v105
    v_smfmac_f32_16x16x64_bf16 v[16:19], v[28:31], a[224:231], v105
    s_waitcnt vmcnt(3)
    v_max3_u32 v116, v116, v31, v32
    v_smfmac_f32_16x16x64_bf16 v[20:23], v[28:31], v[144:151], v105
    ds_write_b128 v97, v[32:35] offset:16384
    v_smfmac_f32_16x16x64_bf16 v[24:27], v[28:31], v[200:207], v105
    global_load_dwordx4 v[60:63], v104, s[44:45] offset:-2304
    v_max3_u32 v116, v116, v33, v34
    v_smfmac_f32_16x16x64_bf16 v[0:3], v[32:35], a[8:15], v105
    v_max_u32 v116, v116, v35
    v_smfmac_f32_16x16x64_bf16 v[4:7], v[32:35], a[64:71], v105
    v_cmp_eq_u32 vcc, -1, v116
    v_smfmac_f32_16x16x64_bf16 v[8:11], v[32:35], a[120:127], v105
    s_cbranch_vccnz L_t_retry_f3
    v_mov_b32 v28, 0
    v_smfmac_f32_16x16x64_bf16 v[12:15], v[32:35], a[176:183], v105
    s_waitcnt vmcnt(3) lgkmcnt(0)
    s_barrier
    v_max3_u32 v116, v36, v37, v38
    v_smfmac_f32_16x16x64_bf16 v[16:19], v[32:35], a[232:239], v105
    global_load_dwordx4 v[72:75], v104, s[44:45] offset:-512
    v_max_u32 v116, v116, v39
    v_smfmac_f32_16x16x64_bf16 v[20:23], v[32:35], v[152:159], v105
    v_cmp_eq_u32 vcc, -1, v116
    v_smfmac_f32_16x16x64_bf16 v[24:27], v[32:35], v[208:215], v105
    s_cbranch_vccnz L_t_fix2_f3
L_t_fix2r_f3:
    v_mov_b32 v29, 0
    v_smfmac_f32_16x16x64_bf16 v[0:3], v[36:39], a[16:23], v105
    ds_read_b128 v[44:47], v44 offset:16384
    v_mov_b32 v30, 0
    v_smfmac_f32_16x16x64_bf16 v[4:7], v[36:39], a[72:79], v105
    ds_read_b128 v[48:51], v48 offset:16384
    global_load_dwordx4 v[76:79], v104, s[44:45] offset:1280
    v_mov_b32 v31, 0
    v_smfmac_f32_16x16x64_bf16 v[8:11], v[36:39], a[128:135], v105
    ds_read_b128 v[52:55], v52 offset:16384
    v_mov_b32 v32, 0
    v_smfmac_f32_16x16x64_bf16 v[12:15], v[36:39], a[184:191], v105
    s_waitcnt vmcnt(4)
    v_max3_u32 v116, v40, v41, v42
    v_smfmac_f32_16x16x64_bf16 v[16:19], v[36:39], a[240:247], v105
    v_max_u32 v116, v116, v43
    v_smfmac_f32_16x16x64_bf16 v[20:23], v[36:39], v[160:167], v105
    global_load_dwordx4 v[64:67], v109, s[44:45] offset:-4096
    v_cmp_eq_u32 vcc, -1, v116
    v_smfmac_f32_16x16x64_bf16 v[24:27], v[36:39], v[216:223], v105
    s_cbranch_vccnz L_t_fix3_f3
L_t_fix3r_f3:
    v_mov_b32 v33, 0
    v_smfmac_f32_16x16x64_bf16 v[0:3], v[40:43], a[24:31], v105
    v_mov_b32 v34, 0
    v_smfmac_f32_16x16x64_bf16 v[4:7], v[40:43], a[80:87], v105
    v_mov_b32 v35, 0
    v_smfmac_f32_16x16x64_bf16 v[8:11], v[40:43], a[136:143], v105
    global_load_dwordx4 v[68:71], v109, s[44:45] offset:-2304
    v_mov_b32 v36, 0
    v_smfmac_f32_16x16x64_bf16 v[12:15], v[40:43], a[192:199], v105
    s_waitcnt lgkmcnt(0)
    v_mov_b32 v37, 0
    v_smfmac_f32_16x16x64_bf16 v[0:3], v[44:47], a[32:39], v105
    v_mov_b32 v38, 0
    v_smfmac_f32_16x16x64_bf16 v[0:3], v[48:51], a[40:47], v105
    ds_read_b128 v[88:91], v106 offset:16384
    v_mov_b32 v39, 0
    v_smfmac_f32_16x16x64_bf16 v[0:3], v[52:55], a[48:55], v105
    global_load_dwordx4 v[80:83], v109, s[44:45] offset:-512
    v_smfmac_f32_16x16x64_bf16 v[4:7], v[44:47], a[88:95], v105
    ds_read_b128 v[92:95], v106 offset:16400
    v_smfmac_f32_16x16x64_bf16 v[4:7], v[48:51], a[96:103], v105
    ds_read_b128 v[96:99], v107 offset:16384
    v_add_f32 v0, v0, v1
    v_smfmac_f32_16x16x64_bf16 v[4:7], v[52:55], a[104:111], v105
    ds_read_b128 v[100:103], v107 offset:16400
    v_add_f32 v2, v2, v3
    v_smfmac_f32_16x16x64_bf16 v[8:11], v[44:47], a[144:151], v105
    global_load_dwordx4 v[84:87], v109, s[44:45] offset:1280
    v_smfmac_f32_16x16x64_bf16 v[8:11], v[48:51], a[152:159], v105
    v_add_f32 v4, v4, v5
    v_smfmac_f32_16x16x64_bf16 v[8:11], v[52:55], a[160:167], v105
    v_add_f32 v6, v6, v7
    v_smfmac_f32_16x16x64_bf16 v[12:15], v[44:47], a[200:207], v105
    v_cvt_pk_bf16_f32 v0, v0, v4
    v_smfmac_f32_16x16x64_bf16 v[12:15], v[48:51], a[208:215], v105
    v_add_f32 v8, v8, v9
    v_smfmac_f32_16x16x64_bf16 v[12:15], v[52:55], a[216:223], v105
    v_add_f32 v10, v10, v11
    v_smfmac_f32_16x16x64_bf16 v[16:19], v[40:43], a[248:255], v105
    v_cvt_pk_bf16_f32 v2, v2, v6
    v_smfmac_f32_16x16x64_bf16 v[16:19], v[44:47], v[120:127], v105
    v_add_f32 v12, v12, v13
    v_smfmac_f32_16x16x64_bf16 v[16:19], v[48:51], v[128:135], v105
    v_add_f32 v14, v14, v15
    v_smfmac_f32_16x16x64_bf16 v[16:19], v[52:55], v[136:143], v105
    v_cvt_pk_bf16_f32 v1, v8, v12
    v_smfmac_f32_16x16x64_bf16 v[20:23], v[40:43], v[168:175], v105
    ds_write_b64 v110, v[0:1]
    v_cvt_pk_bf16_f32 v3, v10, v14
    v_smfmac_f32_16x16x64_bf16 v[20:23], v[44:47], v[176:183], v105
    ds_write_b64 v110, v[2:3] offset:32
    v_add_f32 v16, v16, v17
    v_smfmac_f32_16x16x64_bf16 v[20:23], v[48:51], v[184:191], v105
    ds_read_b128 v[4:7], v113
    v_add_f32 v18, v18, v19
    v_smfmac_f32_16x16x64_bf16 v[20:23], v[52:55], v[192:199], v105
    v_smfmac_f32_16x16x64_bf16 v[24:27], v[40:43], v[224:231], v105
    v_smfmac_f32_16x16x64_bf16 v[24:27], v[44:47], v[232:239], v105
    v_add_f32 v20, v20, v21
    v_smfmac_f32_16x16x64_bf16 v[24:27], v[48:51], v[240:247], v105
    s_waitcnt vmcnt(4)
    v_add_f32 v22, v22, v23
    v_smfmac_f32_16x16x64_bf16 v[24:27], v[52:55], v[248:255], v105
    v_cvt_pk_bf16_f32 v16, v16, v20
    v_cvt_pk_bf16_f32 v17, v18, v22
    ds_write2_b32 v111, v16, v17 offset1:8
    s_nop 3
    v_add_f32 v24, v24, v25
    v_add_f32 v26, v26, v27
    v_cvt_pk_bf16_f32 v24, v24, v26
    ds_write_b16 v112, v24
    ds_write_b16_d16_hi v112, v24 offset:32
    ds_read_b128 v[8:11], v113 offset:1024
    s_waitcnt lgkmcnt(4)
    v_smfmac_f32_16x16x64_bf16 v[28:31], v[4:7], v[56:63], v105
    v_smfmac_f32_16x16x64_bf16 v[32:35], v[4:7], v[72:79], v105
    v_smfmac_f32_16x16x64_bf16 v[36:39], v[4:7], v[88:95], v105
    s_waitcnt vmcnt(0) lgkmcnt(0)
    v_smfmac_f32_16x16x64_bf16 v[28:31], v[8:11], v[64:71], v105
    v_smfmac_f32_16x16x64_bf16 v[32:35], v[8:11], v[80:87], v105
    v_smfmac_f32_16x16x64_bf16 v[36:39], v[8:11], v[96:103], v105
    v_add_f32 v28, v28, v29
    v_add_f32 v30, v30, v31
    ds_write2_b32 v114, v28, v30 offset0:0 offset1:56
    v_add_f32 v32, v32, v33
    v_add_f32 v34, v34, v35
    ds_write2_b32 v114, v32, v34 offset0:16 offset1:72
    s_nop 0
    v_add_f32 v36, v36, v37
    v_add_f32 v38, v38, v39
    ds_write2_b32 v114, v36, v38 offset0:32 offset1:88
    s_barrier
    ds_read_b64 v[0:1], v115 offset:0
    ds_read_b64 v[2:3], v115 offset:1792
    ds_read_b64 v[4:5], v115 offset:3584
    ds_read_b64 v[6:7], v115 offset:5376
    buffer_store_byte v119, v108, s[72:75], 0 offen offset:64
L_t_red_f3:
    s_waitcnt lgkmcnt(2)
    v_pk_add_f32 v[0:1], v[0:1], v[2:3]
    s_waitcnt lgkmcnt(0)
    v_pk_add_f32 v[4:5], v[4:5], v[6:7]
    v_pk_add_f32 v[0:1], v[0:1], v[4:5]
    v_max_f32 v4, v0, v1
    v_cmp_u_f32 vcc, v0, v1
    s_nop 0
    v_max_f32_dpp v5, v4, v4 row_ror:1 row_mask:0xf bank_mask:0xf
    v_max_f32_dpp v5, v4, v5 row_ror:2 row_mask:0xf bank_mask:0xf
    v_max_f32_dpp v5, v4, v5 row_ror:3 row_mask:0xf bank_mask:0xf
    s_cbranch_vccnz L_t_nan_f3
L_t_nanr_f3:
    s_nop 0
    v_max_f32_dpp v4, v5, v5 row_ror:4 row_mask:0xf bank_mask:0xf
    v_max_f32_dpp v4, v5, v4 row_ror:8 row_mask:0xf bank_mask:0xf
    v_max_f32_dpp v6, v5, v4 row_ror:12 row_mask:0xf bank_mask:0xf
    v_max_f32_dpp v4, v5, v4 row_ror:12 row_mask:0xf bank_mask:0xf
    s_nop 1
    v_permlane32_swap_b32 v4, v6
    v_max_f32 v4, v4, v6
    v_pk_add_f32 v[0:1], v[0:1], v[4:5] op_sel_hi:[1,0] neg_lo:[0,1] neg_hi:[0,1]
    v_exp_f32 v0, v0
    v_exp_f32 v1, v1
    s_nop 0
    v_add_f32 v4, v0, v1
    s_nop 1
    v_add_f32_dpp v5, v4, v4 row_ror:1 row_mask:0xf bank_mask:0xf
    v_add_f32_dpp v5, v4, v5 row_ror:2 row_mask:0xf bank_mask:0xf
    v_add_f32_dpp v5, v4, v5 row_ror:3 row_mask:0xf bank_mask:0xf
    s_nop 1
    v_add_f32_dpp v4, v5, v5 row_ror:4 row_mask:0xf bank_mask:0xf
    v_add_f32_dpp v4, v5, v4 row_ror:8 row_mask:0xf bank_mask:0xf
    v_add_f32_dpp v6, v5, v4 row_ror:12 row_mask:0xf bank_mask:0xf
    v_add_f32_dpp v4, v5, v4 row_ror:12 row_mask:0xf bank_mask:0xf
    s_nop 1
    v_permlane32_swap_b32 v4, v6
    v_add_f32 v4, v4, v6
    v_rcp_f32 v4, v4
    s_mov_b64 exec, s[68:69]
    v_mul_f32_e64 v0, v0, v4 clamp
    v_mul_f32_e64 v1, v1, v4 clamp
    v_cvt_pk_bf16_f32 v0, v0, v1
    global_store_dword v118, v0, s[52:53]
    v_mov_b32 v2, -1
    v_mov_b32 v3, -1
    s_mov_b32 s46, 8
    ds_write_b64 v115, v[2:3] offset:0
    ds_write_b64 v115, v[2:3] offset:1792
    ds_write_b64 v115, v[2:3] offset:3584
    ds_write_b64 v115, v[2:3] offset:5376
    s_nop 0
    buffer_store_byte v119, v108, s[72:75], 0 offen
    s_mov_b64 exec, -1
    s_add_u32 s44, s44, 28672
    s_addc_u32 s45, s45, 0
    s_add_u32 s40, s40, 8192
    s_addc_u32 s41, s41, 0
    s_add_u32 s52, s52, 10240
    s_addc_u32 s53, s53, 0
    s_add_u32 s72, s72, 4096
    s_addc_u32 s73, s73, 0
    s_cmp_eq_u32 s34, 62
    s_cbranch_scc1 L_t_end
L_t_sync_f3:
    s_barrier
    s_add_u32 s34, s34, 1
    s_branch L_t_loop_f3
.p2align 6
L_t_loop_s:
    s_add_u32 s70, s70, 4096
    s_addc_u32 s71, s71, 0
    v_mov_b32 v0, 0
    v_mov_b32 v1, 0
    v_mov_b32 v2, 0
    v_mov_b32 v3, 0
    v_mov_b32 v4, 0
    v_mov_b32 v5, 0
    v_mov_b32 v6, 0
    v_mov_b32 v7, 0
    v_mov_b32 v8, 0
    v_mov_b32 v9, 0
    v_mov_b32 v10, 0
    v_mov_b32 v11, 0
    v_mov_b32 v12, 0
    v_mov_b32 v13, 0
    v_mov_b32 v14, 0
    v_mov_b32 v15, 0
    v_mov_b32 v16, 0
    v_mov_b32 v17, 0
    v_mov_b32 v18, 0
    v_mov_b32 v19, 0
    v_mov_b32 v20, 0
    v_mov_b32 v21, 0
    v_mov_b32 v22, 0
    v_mov_b32 v23, 0
    v_mov_b32 v24, 0
    v_mov_b32 v25, 0
    v_mov_b32 v26, 0
    v_mov_b32 v27, 0
    v_add_u32 v96, s56, v104
    v_add_u32 v97, s57, v104
    v_add_u32 v44, s60, v104
    v_add_u32 v48, s61, v104
    v_add_u32 v52, s62, v104
    s_nop 11
    s_nop 15
    s_nop 15
    s_nop 15
    s_nop 15
    s_nop 15
    s_waitcnt lgkmcnt(0)
    s_mov_b32 s4, -1
    s_mov_b32 s8, -1
    s_mov_b32 s12, -1
    s_mov_b32 s16, -1
    s_mov_b32 s20, -1
    s_mov_b32 s48, -1
    s_mov_b32 s64, -1
    s_mov_b32 s76, -1
    buffer_load_dwordx4 v[28:31], v104, s[40:43], s56 offen sc1
    s_nop 14
    buffer_load_dwordx4 v[32:35], v104, s[40:43], s57 offen sc1
    s_nop 14
    buffer_load_dwordx4 v[36:39], v104, s[40:43], s58 offen sc1
    s_nop 14
    buffer_load_dwordx4 v[40:43], v104, s[40:43], s59 offen sc1
L_t_shot_s:
    s_waitcnt vmcnt(3)
    v_smfmac_f32_16x16x64_bf16 v[0:3], v[28:31], a[0:7], v105
    ds_write_b128 v96, v[28:31] offset:16384
    v_smfmac_f32_16x16x64_bf16 v[4:7], v[28:31], a[56:63], v105
    v_max3_u32 v116, v28, v29, v30
    v_smfmac_f32_16x16x64_bf16 v[8:11], v[28:31], a[112:119], v105
    global_load_dwordx4 v[56:59], v104, s[44:45] offset:-4096
    v_smfmac_f32_16x16x64_bf16 v[12:15], v[28:31], a[168:175], v105
    v_smfmac_f32_16x16x64_bf16 v[16:19], v[28:31], a[224:231], v105
    s_waitcnt vmcnt(3)
    v_max3_u32 v116, v116, v31, v32
    v_smfmac_f32_16x16x64_bf16 v[20:23], v[28:31], v[144:151], v105
    ds_write_b128 v97, v[32:35] offset:16384
    v_smfmac_f32_16x16x64_bf16 v[24:27], v[28:31], v[200:207], v105
    global_load_dwordx4 v[60:63], v104, s[44:45] offset:-2304
    v_max3_u32 v116, v116, v33, v34
    v_smfmac_f32_16x16x64_bf16 v[0:3], v[32:35], a[8:15], v105
    v_max_u32 v116, v116, v35
    v_smfmac_f32_16x16x64_bf16 v[4:7], v[32:35], a[64:71], v105
    v_cmp_eq_u32 vcc, -1, v116
    v_smfmac_f32_16x16x64_bf16 v[8:11], v[32:35], a[120:127], v105
    s_cbranch_vccnz L_t_retry_s
    v_mov_b32 v28, 0
    v_smfmac_f32_16x16x64_bf16 v[12:15], v[32:35], a[176:183], v105
    s_waitcnt vmcnt(3) lgkmcnt(0)
    s_barrier
    v_max3_u32 v116, v36, v37, v38
    v_smfmac_f32_16x16x64_bf16 v[16:19], v[32:35], a[232:239], v105
    global_load_dwordx4 v[72:75], v104, s[44:45] offset:-512
    v_max_u32 v116, v116, v39
    v_smfmac_f32_16x16x64_bf16 v[20:23], v[32:35], v[152:159], v105
    v_cmp_eq_u32 vcc, -1, v116
    v_smfmac_f32_16x16x64_bf16 v[24:27], v[32:35], v[208:215], v105
    s_cbranch_vccnz L_t_fix2_s
L_t_fix2r_s:
    v_mov_b32 v29, 0
    v_smfmac_f32_16x16x64_bf16 v[0:3], v[36:39], a[16:23], v105
    ds_read_b128 v[44:47], v44 offset:16384
    v_mov_b32 v30, 0
    v_smfmac_f32_16x16x64_bf16 v[4:7], v[36:39], a[72:79], v105
    ds_read_b128 v[48:51], v48 offset:16384
    global_load_dwordx4 v[76:79], v104, s[44:45] offset:1280
    v_mov_b32 v31, 0
    v_smfmac_f32_16x16x64_bf16 v[8:11], v[36:39], a[128:135], v105
    ds_read_b128 v[52:55], v52 offset:16384
    v_mov_b32 v32, 0
    v_smfmac_f32_16x16x64_bf16 v[12:15], v[36:39], a[184:191], v105
    s_waitcnt vmcnt(4)
    v_max3_u32 v116, v40, v41, v42
    v_smfmac_f32_16x16x64_bf16 v[16:19], v[36:39], a[240:247], v105
    v_max_u32 v116, v116, v43
    v_smfmac_f32_16x16x64_bf16 v[20:23], v[36:39], v[160:167], v105
    global_load_dwordx4 v[64:67], v109, s[44:45] offset:-4096
    v_cmp_eq_u32 vcc, -1, v116
    v_smfmac_f32_16x16x64_bf16 v[24:27], v[36:39], v[216:223], v105
    s_cbranch_vccnz L_t_fix3_s
L_t_fix3r_s:
    v_mov_b32 v33, 0
    v_smfmac_f32_16x16x64_bf16 v[0:3], v[40:43], a[24:31], v105
    v_mov_b32 v34, 0
    v_smfmac_f32_16x16x64_bf16 v[4:7], v[40:43], a[80:87], v105
    v_mov_b32 v35, 0
    v_smfmac_f32_16x16x64_bf16 v[8:11], v[40:43], a[136:143], v105
    global_load_dwordx4 v[68:71], v109, s[44:45] offset:-2304
    v_mov_b32 v36, 0
    v_smfmac_f32_16x16x64_bf16 v[12:15], v[40:43], a[192:199], v105
    s_waitcnt lgkmcnt(0)
    v_mov_b32 v37, 0
    v_smfmac_f32_16x16x64_bf16 v[0:3], v[44:47], a[32:39], v105
    v_mov_b32 v38, 0
    v_smfmac_f32_16x16x64_bf16 v[0:3], v[48:51], a[40:47], v105
    ds_read_b128 v[88:91], v106 offset:16384
    v_mov_b32 v39, 0
    v_smfmac_f32_16x16x64_bf16 v[0:3], v[52:55], a[48:55], v105
    global_load_dwordx4 v[80:83], v109, s[44:45] offset:-512
    v_smfmac_f32_16x16x64_bf16 v[4:7], v[44:47], a[88:95], v105
    ds_read_b128 v[92:95], v106 offset:16400
    v_smfmac_f32_16x16x64_bf16 v[4:7], v[48:51], a[96:103], v105
    ds_read_b128 v[96:99], v107 offset:16384
    v_add_f32 v0, v0, v1
    v_smfmac_f32_16x16x64_bf16 v[4:7], v[52:55], a[104:111], v105
    ds_read_b128 v[100:103], v107 offset:16400
    v_add_f32 v2, v2, v3
    v_smfmac_f32_16x16x64_bf16 v[8:11], v[44:47], a[144:151], v105
    global_load_dwordx4 v[84:87], v109, s[44:45] offset:1280
    v_smfmac_f32_16x16x64_bf16 v[8:11], v[48:51], a[152:159], v105
    v_add_f32 v4, v4, v5
    v_smfmac_f32_16x16x64_bf16 v[8:11], v[52:55], a[160:167], v105
    v_add_f32 v6, v6, v7
    v_smfmac_f32_16x16x64_bf16 v[12:15], v[44:47], a[200:207], v105
    v_cvt_pk_bf16_f32 v0, v0, v4
    v_smfmac_f32_16x16x64_bf16 v[12:15], v[48:51], a[208:215], v105
    v_add_f32 v8, v8, v9
    v_smfmac_f32_16x16x64_bf16 v[12:15], v[52:55], a[216:223], v105
    v_add_f32 v10, v10, v11
    v_smfmac_f32_16x16x64_bf16 v[16:19], v[40:43], a[248:255], v105
    v_cvt_pk_bf16_f32 v2, v2, v6
    v_smfmac_f32_16x16x64_bf16 v[16:19], v[44:47], v[120:127], v105
    v_add_f32 v12, v12, v13
    v_smfmac_f32_16x16x64_bf16 v[16:19], v[48:51], v[128:135], v105
    v_add_f32 v14, v14, v15
    v_smfmac_f32_16x16x64_bf16 v[16:19], v[52:55], v[136:143], v105
    v_cvt_pk_bf16_f32 v1, v8, v12
    v_smfmac_f32_16x16x64_bf16 v[20:23], v[40:43], v[168:175], v105
    ds_write_b64 v110, v[0:1]
    v_cvt_pk_bf16_f32 v3, v10, v14
    v_smfmac_f32_16x16x64_bf16 v[20:23], v[44:47], v[176:183], v105
    ds_write_b64 v110, v[2:3] offset:32
    v_add_f32 v16, v16, v17
    v_smfmac_f32_16x16x64_bf16 v[20:23], v[48:51], v[184:191], v105
    ds_read_b128 v[4:7], v113
    v_add_f32 v18, v18, v19
    v_smfmac_f32_16x16x64_bf16 v[20:23], v[52:55], v[192:199], v105
    v_smfmac_f32_16x16x64_bf16 v[24:27], v[40:43], v[224:231], v105
    v_smfmac_f32_16x16x64_bf16 v[24:27], v[44:47], v[232:239], v105
    v_add_f32 v20, v20, v21
    v_smfmac_f32_16x16x64_bf16 v[24:27], v[48:51], v[240:247], v105
    s_waitcnt vmcnt(4)
    v_add_f32 v22, v22, v23
    v_smfmac_f32_16x16x64_bf16 v[24:27], v[52:55], v[248:255], v105
    v_cvt_pk_bf16_f32 v16, v16, v20
    v_cvt_pk_bf16_f32 v17, v18, v22
    ds_write2_b32 v111, v16, v17 offset1:8
    s_nop 3
    v_add_f32 v24, v24, v25
    v_add_f32 v26, v26, v27
    v_cvt_pk_bf16_f32 v24, v24, v26
    ds_write_b16 v112, v24
    ds_write_b16_d16_hi v112, v24 offset:32
    ds_read_b128 v[8:11], v113 offset:1024
    s_waitcnt lgkmcnt(4)
    v_smfmac_f32_16x16x64_bf16 v[28:31], v[4:7], v[56:63], v105
    v_smfmac_f32_16x16x64_bf16 v[32:35], v[4:7], v[72:79], v105
    v_smfmac_f32_16x16x64_bf16 v[36:39], v[4:7], v[88:95], v105
    s_waitcnt vmcnt(0) lgkmcnt(0)
    v_smfmac_f32_16x16x64_bf16 v[28:31], v[8:11], v[64:71], v105
    v_smfmac_f32_16x16x64_bf16 v[32:35], v[8:11], v[80:87], v105
    v_smfmac_f32_16x16x64_bf16 v[36:39], v[8:11], v[96:103], v105
    v_add_f32 v28, v28, v29
    v_add_f32 v30, v30, v31
    ds_write2_b32 v114, v28, v30 offset0:0 offset1:56
    v_add_f32 v32, v32, v33
    v_add_f32 v34, v34, v35
    ds_write2_b32 v114, v32, v34 offset0:16 offset1:72
    s_nop 0
    v_add_f32 v36, v36, v37
    v_add_f32 v38, v38, v39
    ds_write2_b32 v114, v36, v38 offset0:32 offset1:88
    s_barrier
    ds_read_b64 v[0:1], v115 offset:0
    ds_read_b64 v[2:3], v115 offset:1792
    ds_read_b64 v[4:5], v115 offset:3584
    ds_read_b64 v[6:7], v115 offset:5376
    buffer_store_byte v119, v108, s[72:75], 0 offen offset:64 sc1
L_t_red_s:
    s_waitcnt lgkmcnt(2)
    v_pk_add_f32 v[0:1], v[0:1], v[2:3]
    s_waitcnt lgkmcnt(0)
    v_pk_add_f32 v[4:5], v[4:5], v[6:7]
    v_pk_add_f32 v[0:1], v[0:1], v[4:5]
    v_max_f32 v4, v0, v1
    v_cmp_u_f32 vcc, v0, v1
    s_nop 0
    v_max_f32_dpp v5, v4, v4 row_ror:1 row_mask:0xf bank_mask:0xf
    v_max_f32_dpp v5, v4, v5 row_ror:2 row_mask:0xf bank_mask:0xf
    v_max_f32_dpp v5, v4, v5 row_ror:3 row_mask:0xf bank_mask:0xf
    s_cbranch_vccnz L_t_nan_s
L_t_nanr_s:
    s_nop 0
    v_max_f32_dpp v4, v5, v5 row_ror:4 row_mask:0xf bank_mask:0xf
    v_max_f32_dpp v4, v5, v4 row_ror:8 row_mask:0xf bank_mask:0xf
    v_max_f32_dpp v6, v5, v4 row_ror:12 row_mask:0xf bank_mask:0xf
    v_max_f32_dpp v4, v5, v4 row_ror:12 row_mask:0xf bank_mask:0xf
    s_nop 1
    v_permlane32_swap_b32 v4, v6
    v_max_f32 v4, v4, v6
    v_pk_add_f32 v[0:1], v[0:1], v[4:5] op_sel_hi:[1,0] neg_lo:[0,1] neg_hi:[0,1]
    v_exp_f32 v0, v0
    v_exp_f32 v1, v1
    s_nop 0
    v_add_f32 v4, v0, v1
    s_nop 1
    v_add_f32_dpp v5, v4, v4 row_ror:1 row_mask:0xf bank_mask:0xf
    v_add_f32_dpp v5, v4, v5 row_ror:2 row_mask:0xf bank_mask:0xf
    v_add_f32_dpp v5, v4, v5 row_ror:3 row_mask:0xf bank_mask:0xf
    s_nop 1
    v_add_f32_dpp v4, v5, v5 row_ror:4 row_mask:0xf bank_mask:0xf
    v_add_f32_dpp v4, v5, v4 row_ror:8 row_mask:0xf bank_mask:0xf
    v_add_f32_dpp v6, v5, v4 row_ror:12 row_mask:0xf bank_mask:0xf
    v_add_f32_dpp v4, v5, v4 row_ror:12 row_mask:0xf bank_mask:0xf
    s_nop 1
    v_permlane32_swap_b32 v4, v6
    v_add_f32 v4, v4, v6
    v_rcp_f32 v4, v4
    s_mov_b64 exec, s[68:69]
    v_mul_f32_e64 v0, v0, v4 clamp
    v_mul_f32_e64 v1, v1, v4 clamp
    v_cvt_pk_bf16_f32 v0, v0, v1
    global_store_dword v118, v0, s[52:53] sc1
    v_mov_b32 v2, -1
    v_mov_b32 v3, -1
    s_mov_b32 s46, 8
    ds_write_b64 v115, v[2:3] offset:0
    ds_write_b64 v115, v[2:3] offset:1792
    ds_write_b64 v115, v[2:3] offset:3584
    ds_write_b64 v115, v[2:3] offset:5376
    s_nop 0
    buffer_store_byte v119, v108, s[72:75], 0 offen sc1
    s_mov_b64 exec, -1
    s_add_u32 s44, s44, 28672
    s_addc_u32 s45, s45, 0
    s_add_u32 s40, s40, 8192
    s_addc_u32 s41, s41, 0
    s_add_u32 s52, s52, 10240
    s_addc_u32 s53, s53, 0
    s_add_u32 s72, s72, 4096
    s_addc_u32 s73, s73, 0
    s_cmp_eq_u32 s34, 62
    s_cbranch_scc1 L_t_end
    s_cmp_lg_u32 s31, 0
    s_cbranch_scc1 L_t_sync_s
    s_nop 7
    s_load_dwordx4 s[4:7], s[70:71], 0
    s_nop 3
    s_load_dwordx4 s[8:11], s[70:71], 128
    s_nop 3
    s_load_dwordx4 s[12:15], s[70:71], 256
    s_nop 3
    s_load_dwordx4 s[16:19], s[70:71], 384
    s_nop 3
    s_load_dwordx4 s[20:23], s[70:71], 512
    s_nop 3
    s_load_dwordx4 s[48:51], s[70:71], 640
    s_nop 3
    s_load_dwordx4 s[64:67], s[70:71], 768
    s_or_b64 s[36:37], s[4:5], s[6:7]
    s_cbranch_scc0 L_t_sync_s
    s_nop 1
    s_load_dwordx4 s[76:79], s[70:71], 896
    s_or_b64 s[36:37], s[8:9], s[10:11]
    s_cbranch_scc0 L_t_sync_s
    s_nop 1
    s_load_dwordx4 s[4:7], s[70:71], 1024
    s_or_b64 s[36:37], s[12:13], s[14:15]
    s_cbranch_scc0 L_t_sync_s
    s_nop 1
    s_load_dwordx4 s[8:11], s[70:71], 1152
    s_or_b64 s[36:37], s[16:17], s[18:19]
    s_cbranch_scc0 L_t_sync_s
    s_nop 1
    s_load_dwordx4 s[12:15], s[70:71], 1280
    s_or_b64 s[36:37], s[20:21], s[22:23]
    s_cbranch_scc0 L_t_sync_s
    s_nop 1
    s_load_dwordx4 s[16:19], s[70:71], 1408
    s_or_b64 s[36:37], s[48:49], s[50:51]
    s_cbranch_scc0 L_t_sync_s
    s_nop 1
    s_load_dwordx4 s[20:23], s[70:71], 1536
    s_or_b64 s[36:37], s[64:65], s[66:67]
    s_cbranch_scc0 L_t_sync_s
    s_nop 1
    s_load_dwordx4 s[48:51], s[70:71], 1664
    s_or_b64 s[36:37], s[76:77], s[78:79]
    s_cbranch_scc0 L_t_sync_s
    s_nop 1
    s_load_dwordx4 s[64:67], s[70:71], 1792
    s_or_b64 s[36:37], s[4:5], s[6:7]
    s_cbranch_scc0 L_t_sync_s
    s_nop 1
    s_load_dwordx4 s[76:79], s[70:71], 1920
    s_or_b64 s[36:37], s[8:9], s[10:11]
    s_cbranch_scc0 L_t_sync_s
    s_nop 1
    s_load_dwordx4 s[4:7], s[70:71], 2048
    s_or_b64 s[36:37], s[12:13], s[14:15]
    s_cbranch_scc0 L_t_sync_s
    s_nop 1
    s_load_dwordx4 s[8:11], s[70:71], 2176
    s_or_b64 s[36:37], s[16:17], s[18:19]
    s_cbranch_scc0 L_t_sync_s
    s_nop 1
    s_load_dwordx4 s[12:15], s[70:71], 2304
    s_or_b64 s[36:37], s[20:21], s[22:23]
    s_cbranch_scc0 L_t_sync_s
    s_nop 1
    s_load_dwordx4 s[16:19], s[70:71], 2432
    s_or_b64 s[36:37], s[48:49], s[50:51]
    s_cbranch_scc0 L_t_sync_s
    s_nop 1
    s_load_dwordx4 s[20:23], s[70:71], 2560
    s_or_b64 s[36:37], s[64:65], s[66:67]
    s_cbranch_scc0 L_t_sync_s
    s_nop 1
    s_load_dwordx4 s[48:51], s[70:71], 2688
    s_or_b64 s[36:37], s[76:77], s[78:79]
    s_cbranch_scc0 L_t_sync_s
    s_nop 1
    s_load_dwordx4 s[64:67], s[70:71], 2816
    s_or_b64 s[36:37], s[4:5], s[6:7]
    s_cbranch_scc0 L_t_sync_s
    s_nop 1
    s_load_dwordx4 s[76:79], s[70:71], 2944
    s_or_b64 s[36:37], s[8:9], s[10:11]
    s_cbranch_scc0 L_t_sync_s
    s_nop 1
    s_load_dwordx4 s[4:7], s[70:71], 3072
    s_or_b64 s[36:37], s[12:13], s[14:15]
    s_cbranch_scc0 L_t_sync_s
    s_nop 1
    s_load_dwordx4 s[8:11], s[70:71], 3200
    s_or_b64 s[36:37], s[16:17], s[18:19]
    s_cbranch_scc0 L_t_sync_s
    s_nop 1
    s_load_dwordx4 s[12:15], s[70:71], 3328
    s_or_b64 s[36:37], s[20:21], s[22:23]
    s_cbranch_scc0 L_t_sync_s
    s_nop 1
    s_load_dwordx4 s[16:19], s[70:71], 3456
    s_or_b64 s[36:37], s[48:49], s[50:51]
    s_cbranch_scc0 L_t_sync_s
    s_nop 1
    s_load_dwordx4 s[20:23], s[70:71], 3584
    s_or_b64 s[36:37], s[64:65], s[66:67]
    s_cbranch_scc0 L_t_sync_s
    s_nop 1
    s_load_dwordx4 s[48:51], s[70:71], 3712
    s_or_b64 s[36:37], s[76:77], s[78:79]
    s_cbranch_scc0 L_t_sync_s
    s_nop 1
    s_load_dwordx4 s[64:67], s[70:71], 3840
    s_or_b64 s[36:37], s[4:5], s[6:7]
    s_cbranch_scc0 L_t_sync_s
    s_nop 1
    s_load_dwordx4 s[76:79], s[70:71], 3968
    s_or_b64 s[36:37], s[8:9], s[10:11]
    s_cbranch_scc0 L_t_sync_s
    s_nop 1
    s_nop 0
    s_or_b64 s[36:37], s[12:13], s[14:15]
    s_cbranch_scc0 L_t_sync_s
    s_nop 1
    s_nop 0
    s_or_b64 s[36:37], s[16:17], s[18:19]
    s_cbranch_scc0 L_t_sync_s
    s_nop 1
    s_nop 0
    s_or_b64 s[36:37], s[20:21], s[22:23]
    s_cbranch_scc0 L_t_sync_s
    s_nop 1
    s_nop 0
    s_or_b64 s[36:37], s[48:49], s[50:51]
    s_cbranch_scc0 L_t_sync_s
    s_nop 1
    s_nop 0
    s_or_b64 s[36:37], s[64:65], s[66:67]
    s_cbranch_scc0 L_t_sync_s
    s_nop 1
    s_nop 0
    s_or_b64 s[36:37], s[76:77], s[78:79]
    s_cbranch_scc0 L_t_sync_s
    s_nop 1
L_t_sync_s:
    s_barrier
    s_add_u32 s34, s34, 1
    s_branch L_t_loop_s
L_t_end:
    s_waitcnt vmcnt(0)
    s_endpgm
L_vcu:
    v_mov_b32 v119, v0
    v_lshlrev_b32 v108, 4, v119
    s_sub_u32 s54, s32, 16
    s_lshl_b32 s36, s54, 2
    s_add_u32 s36, s36, s31
    s_mul_i32 s37, s36, 114688
    s_add_u32 s37, s37, 6553600
    s_add_u32 s48, s28, s37
    s_addc_u32 s49, s29, 0
    s_mul_i32 s37, s36, 8192
    s_add_u32 s37, s37, 33558528
    s_add_u32 s44, s28, s37
    s_addc_u32 s45, s29, 0
    s_lshl_b32 s39, s36, 7
    s_mov_b32 s50, -1
    s_mov_b32 s51, 0x00020000
    s_lshl_b32 s36, s31, 1
    s_add_u32 s36, s36, s32
    s_mul_i32 s37, s36, 37
    s_lshr_b32 s37, s37, 8
    s_mul_i32 s37, s37, 7
    s_sub_u32 s36, s36, s37
    s_lshl_b32 s56, s36, 10
    s_add_u32 s57, s56, 1024
    s_cmp_eq_u32 s57, 7168
    s_cselect_b32 s57, 0, s57
    s_add_u32 s58, s57, 1024
    s_cmp_eq_u32 s58, 7168
    s_cselect_b32 s58, 0, s58
    s_add_u32 s59, s58, 1024
    s_cmp_eq_u32 s59, 7168
    s_cselect_b32 s59, 0, s59
    s_add_u32 s60, s59, 1024
    s_cmp_eq_u32 s60, 7168
    s_cselect_b32 s60, 0, s60
    s_add_u32 s61, s60, 1024
    s_cmp_eq_u32 s61, 7168
    s_cselect_b32 s61, 0, s61
    s_add_u32 s62, s61, 1024
    s_cmp_eq_u32 s62, 7168
    s_cselect_b32 s62, 0, s62
    s_lshl_b32 s36, s54, 1
    v_bfe_u32 v117, v119, 1, 1
    v_add_u32 v117, s36, v117
    v_mul_u32_u24 v117, 37, v117
    v_lshrrev_b32 v112, 8, v117
    s_mul_i32 s36, s31, 4096
    v_mov_b32 v118, s36
    v_add_u32 v118, 15220736, v118
    v_bfe_u32 v117, v119, 0, 1
    v_lshl_add_u32 v118, v117, 7, v118
    v_bfe_u32 v117, v119, 2, 2
    v_lshl_add_u32 v118, v117, 10, v118
    v_lshl_add_u32 v118, v112, 8, v118
    global_load_dwordx4 v[12:15], v118, s[28:29] sc1
    v_mov_b32 v4, s87
    v_mov_b32 v5, 0
    s_waitcnt vmcnt(0)

    s_mov_b64 exec, 1
    global_store_dword v4, v5, s[28:29] sc1
    s_mov_b64 exec, -1
    s_branch L_wd_7c
L_wd_7:
    s_sleep 12
    global_load_dwordx4 v[12:15], v118, s[28:29] sc1
    s_sub_u32 s35, s35, 1
    s_cbranch_scc1 L_bail
    s_waitcnt vmcnt(0)
L_wd_7c:
    v_or3_b32 v12, v12, v13, v14
    v_or_b32 v12, v12, v15
    v_cmp_ne_u32 vcc, 0, v12
    s_cbranch_vccnz L_wd_7
    s_lshl_b32 s36, s56, 1
    buffer_load_dwordx4 a[0:3], v108, s[48:51], s36 offen offset:0 sc1
    buffer_load_dwordx4 a[4:7], v108, s[48:51], s36 offen offset:1024 sc1
    s_lshl_b32 s36, s57, 1
    buffer_load_dwordx4 a[8:11], v108, s[48:51], s36 offen offset:0 sc1
    buffer_load_dwordx4 a[12:15], v108, s[48:51], s36 offen offset:1024 sc1
    s_lshl_b32 s36, s58, 1
    buffer_load_dwordx4 a[16:19], v108, s[48:51], s36 offen offset:0 sc1
    buffer_load_dwordx4 a[20:23], v108, s[48:51], s36 offen offset:1024 sc1
    s_lshl_b32 s36, s59, 1
    buffer_load_dwordx4 a[24:27], v108, s[48:51], s36 offen offset:0 sc1
    buffer_load_dwordx4 a[28:31], v108, s[48:51], s36 offen offset:1024 sc1
    s_lshl_b32 s36, s60, 1
    buffer_load_dwordx4 a[32:35], v108, s[48:51], s36 offen offset:0 sc1
    buffer_load_dwordx4 a[36:39], v108, s[48:51], s36 offen offset:1024 sc1
    s_lshl_b32 s36, s61, 1
    buffer_load_dwordx4 a[40:43], v108, s[48:51], s36 offen offset:0 sc1
    buffer_load_dwordx4 a[44:47], v108, s[48:51], s36 offen offset:1024 sc1
    s_lshl_b32 s36, s62, 1
    buffer_load_dwordx4 a[48:51], v108, s[48:51], s36 offen offset:0 sc1
    buffer_load_dwordx4 a[52:55], v108, s[48:51], s36 offen offset:1024 sc1
    s_add_u32 s48, s48, 14336
    s_addc_u32 s49, s49, 0
    s_lshl_b32 s36, s56, 1
    buffer_load_dwordx4 a[56:59], v108, s[48:51], s36 offen offset:0 sc1
    buffer_load_dwordx4 a[60:63], v108, s[48:51], s36 offen offset:1024 sc1
    s_lshl_b32 s36, s57, 1
    buffer_load_dwordx4 a[64:67], v108, s[48:51], s36 offen offset:0 sc1
    buffer_load_dwordx4 a[68:71], v108, s[48:51], s36 offen offset:1024 sc1
    s_lshl_b32 s36, s58, 1
    buffer_load_dwordx4 a[72:75], v108, s[48:51], s36 offen offset:0 sc1
    buffer_load_dwordx4 a[76:79], v108, s[48:51], s36 offen offset:1024 sc1
    s_lshl_b32 s36, s59, 1
    buffer_load_dwordx4 a[80:83], v108, s[48:51], s36 offen offset:0 sc1
    buffer_load_dwordx4 a[84:87], v108, s[48:51], s36 offen offset:1024 sc1
    s_lshl_b32 s36, s60, 1
    buffer_load_dwordx4 a[88:91], v108, s[48:51], s36 offen offset:0 sc1
    buffer_load_dwordx4 a[92:95], v108, s[48:51], s36 offen offset:1024 sc1
    s_lshl_b32 s36, s61, 1
    buffer_load_dwordx4 a[96:99], v108, s[48:51], s36 offen offset:0 sc1
    buffer_load_dwordx4 a[100:103], v108, s[48:51], s36 offen offset:1024 sc1
    s_lshl_b32 s36, s62, 1
    buffer_load_dwordx4 a[104:107], v108, s[48:51], s36 offen offset:0 sc1
    buffer_load_dwordx4 a[108:111], v108, s[48:51], s36 offen offset:1024 sc1
    s_add_u32 s48, s48, 14336
    s_addc_u32 s49, s49, 0
    s_lshl_b32 s36, s56, 1
    buffer_load_dwordx4 a[112:115], v108, s[48:51], s36 offen offset:0 sc1
    buffer_load_dwordx4 a[116:119], v108, s[48:51], s36 offen offset:1024 sc1
    s_lshl_b32 s36, s57, 1
    buffer_load_dwordx4 a[120:123], v108, s[48:51], s36 offen offset:0 sc1
    buffer_load_dwordx4 a[124:127], v108, s[48:51], s36 offen offset:1024 sc1
    s_lshl_b32 s36, s58, 1
    buffer_load_dwordx4 a[128:131], v108, s[48:51], s36 offen offset:0 sc1
    buffer_load_dwordx4 a[132:135], v108, s[48:51], s36 offen offset:1024 sc1
    s_lshl_b32 s36, s59, 1
    buffer_load_dwordx4 a[136:139], v108, s[48:51], s36 offen offset:0 sc1
    buffer_load_dwordx4 a[140:143], v108, s[48:51], s36 offen offset:1024 sc1
    s_lshl_b32 s36, s60, 1
    buffer_load_dwordx4 a[144:147], v108, s[48:51], s36 offen offset:0 sc1
    buffer_load_dwordx4 a[148:151], v108, s[48:51], s36 offen offset:1024 sc1
    s_lshl_b32 s36, s61, 1
    buffer_load_dwordx4 a[152:155], v108, s[48:51], s36 offen offset:0 sc1
    buffer_load_dwordx4 a[156:159], v108, s[48:51], s36 offen offset:1024 sc1
    s_lshl_b32 s36, s62, 1
    buffer_load_dwordx4 a[160:163], v108, s[48:51], s36 offen offset:0 sc1
    buffer_load_dwordx4 a[164:167], v108, s[48:51], s36 offen offset:1024 sc1
    s_add_u32 s48, s48, 14336
    s_addc_u32 s49, s49, 0
    s_lshl_b32 s36, s56, 1
    buffer_load_dwordx4 a[168:171], v108, s[48:51], s36 offen offset:0 sc1
    buffer_load_dwordx4 a[172:175], v108, s[48:51], s36 offen offset:1024 sc1
    s_lshl_b32 s36, s57, 1
    buffer_load_dwordx4 a[176:179], v108, s[48:51], s36 offen offset:0 sc1
    buffer_load_dwordx4 a[180:183], v108, s[48:51], s36 offen offset:1024 sc1
    s_lshl_b32 s36, s58, 1
    buffer_load_dwordx4 a[184:187], v108, s[48:51], s36 offen offset:0 sc1
    buffer_load_dwordx4 a[188:191], v108, s[48:51], s36 offen offset:1024 sc1
    s_lshl_b32 s36, s59, 1
    buffer_load_dwordx4 a[192:195], v108, s[48:51], s36 offen offset:0 sc1
    buffer_load_dwordx4 a[196:199], v108, s[48:51], s36 offen offset:1024 sc1
    s_waitcnt vmcnt(48)
    s_lshl_b32 s36, s60, 1
    buffer_load_dwordx4 a[200:203], v108, s[48:51], s36 offen offset:0 sc1
    buffer_load_dwordx4 a[204:207], v108, s[48:51], s36 offen offset:1024 sc1
    s_waitcnt vmcnt(48)
    s_lshl_b32 s36, s61, 1
    buffer_load_dwordx4 a[208:211], v108, s[48:51], s36 offen offset:0 sc1
    buffer_load_dwordx4 a[212:215], v108, s[48:51], s36 offen offset:1024 sc1
    s_waitcnt vmcnt(48)
    s_lshl_b32 s36, s62, 1
    buffer_load_dwordx4 a[216:219], v108, s[48:51], s36 offen offset:0 sc1
    buffer_load_dwordx4 a[220:223], v108, s[48:51], s36 offen offset:1024 sc1
    s_waitcnt vmcnt(48)
    s_add_u32 s48, s48, 14336
    s_addc_u32 s49, s49, 0
    s_lshl_b32 s36, s56, 1
    buffer_load_dwordx4 a[224:227], v108, s[48:51], s36 offen offset:0 sc1
    buffer_load_dwordx4 a[228:231], v108, s[48:51], s36 offen offset:1024 sc1
    s_waitcnt vmcnt(48)
    s_lshl_b32 s36, s57, 1
    buffer_load_dwordx4 a[232:235], v108, s[48:51], s36 offen offset:0 sc1
    buffer_load_dwordx4 a[236:239], v108, s[48:51], s36 offen offset:1024 sc1
    s_waitcnt vmcnt(48)
    s_lshl_b32 s36, s58, 1
    buffer_load_dwordx4 a[240:243], v108, s[48:51], s36 offen offset:0 sc1
    buffer_load_dwordx4 a[244:247], v108, s[48:51], s36 offen offset:1024 sc1
    s_waitcnt vmcnt(48)
    s_lshl_b32 s36, s59, 1
    buffer_load_dwordx4 a[248:251], v108, s[48:51], s36 offen offset:0 sc1
    buffer_load_dwordx4 a[252:255], v108, s[48:51], s36 offen offset:1024 sc1
    s_waitcnt vmcnt(48)
    s_lshl_b32 s36, s60, 1
    buffer_load_dwordx4 v[120:123], v108, s[48:51], s36 offen offset:0 sc1
    buffer_load_dwordx4 v[124:127], v108, s[48:51], s36 offen offset:1024 sc1
    s_waitcnt vmcnt(48)
    s_lshl_b32 s36, s61, 1
    buffer_load_dwordx4 v[128:131], v108, s[48:51], s36 offen offset:0 sc1
    buffer_load_dwordx4 v[132:135], v108, s[48:51], s36 offen offset:1024 sc1
    s_waitcnt vmcnt(48)
    s_lshl_b32 s36, s62, 1
    buffer_load_dwordx4 v[136:139], v108, s[48:51], s36 offen offset:0 sc1
    buffer_load_dwordx4 v[140:143], v108, s[48:51], s36 offen offset:1024 sc1
    s_waitcnt vmcnt(48)
    s_add_u32 s48, s48, 14336
    s_addc_u32 s49, s49, 0
    s_lshl_b32 s36, s56, 1
    buffer_load_dwordx4 v[144:147], v108, s[48:51], s36 offen offset:0 sc1
    buffer_load_dwordx4 v[148:151], v108, s[48:51], s36 offen offset:1024 sc1
    s_waitcnt vmcnt(48)
    s_lshl_b32 s36, s57, 1
    buffer_load_dwordx4 v[152:155], v108, s[48:51], s36 offen offset:0 sc1
    buffer_load_dwordx4 v[156:159], v108, s[48:51], s36 offen offset:1024 sc1
    s_waitcnt vmcnt(48)
    s_lshl_b32 s36, s58, 1
    buffer_load_dwordx4 v[160:163], v108, s[48:51], s36 offen offset:0 sc1
    buffer_load_dwordx4 v[164:167], v108, s[48:51], s36 offen offset:1024 sc1
    s_waitcnt vmcnt(48)
    s_lshl_b32 s36, s59, 1
    buffer_load_dwordx4 v[168:171], v108, s[48:51], s36 offen offset:0 sc1
    buffer_load_dwordx4 v[172:175], v108, s[48:51], s36 offen offset:1024 sc1
    s_waitcnt vmcnt(48)
    s_lshl_b32 s36, s60, 1
    buffer_load_dwordx4 v[176:179], v108, s[48:51], s36 offen offset:0 sc1
    buffer_load_dwordx4 v[180:183], v108, s[48:51], s36 offen offset:1024 sc1
    s_waitcnt vmcnt(48)
    s_lshl_b32 s36, s61, 1
    buffer_load_dwordx4 v[184:187], v108, s[48:51], s36 offen offset:0 sc1
    buffer_load_dwordx4 v[188:191], v108, s[48:51], s36 offen offset:1024 sc1
    s_waitcnt vmcnt(48)
    s_lshl_b32 s36, s62, 1
    buffer_load_dwordx4 v[192:195], v108, s[48:51], s36 offen offset:0 sc1
    buffer_load_dwordx4 v[196:199], v108, s[48:51], s36 offen offset:1024 sc1
    s_waitcnt vmcnt(48)
    s_add_u32 s48, s48, 14336
    s_addc_u32 s49, s49, 0
    s_lshl_b32 s36, s56, 1
    buffer_load_dwordx4 v[200:203], v108, s[48:51], s36 offen offset:0 sc1
    buffer_load_dwordx4 v[204:207], v108, s[48:51], s36 offen offset:1024 sc1
    s_waitcnt vmcnt(48)
    s_lshl_b32 s36, s57, 1
    buffer_load_dwordx4 v[208:211], v108, s[48:51], s36 offen offset:0 sc1
    buffer_load_dwordx4 v[212:215], v108, s[48:51], s36 offen offset:1024 sc1
    s_waitcnt vmcnt(48)
    s_lshl_b32 s36, s58, 1
    buffer_load_dwordx4 v[216:219], v108, s[48:51], s36 offen offset:0 sc1
    buffer_load_dwordx4 v[220:223], v108, s[48:51], s36 offen offset:1024 sc1
    s_waitcnt vmcnt(48)
    s_lshl_b32 s36, s59, 1
    buffer_load_dwordx4 v[224:227], v108, s[48:51], s36 offen offset:0 sc1
    buffer_load_dwordx4 v[228:231], v108, s[48:51], s36 offen offset:1024 sc1
    s_waitcnt vmcnt(48)
    s_lshl_b32 s36, s60, 1
    buffer_load_dwordx4 v[232:235], v108, s[48:51], s36 offen offset:0 sc1
    buffer_load_dwordx4 v[236:239], v108, s[48:51], s36 offen offset:1024 sc1
    s_waitcnt vmcnt(48)
    s_lshl_b32 s36, s61, 1
    buffer_load_dwordx4 v[240:243], v108, s[48:51], s36 offen offset:0 sc1
    buffer_load_dwordx4 v[244:247], v108, s[48:51], s36 offen offset:1024 sc1
    s_waitcnt vmcnt(48)
    s_lshl_b32 s36, s62, 1
    buffer_load_dwordx4 v[248:251], v108, s[48:51], s36 offen offset:0 sc1
    buffer_load_dwordx4 v[252:255], v108, s[48:51], s36 offen offset:1024 sc1
    s_waitcnt vmcnt(48)
    s_add_u32 s48, s48, 14336
    s_addc_u32 s49, s49, 0
    s_lshl_b32 s36, s56, 1
    buffer_load_dwordx4 v[0:3], v108, s[48:51], s36 offen offset:0 sc1
    buffer_load_dwordx4 v[4:7], v108, s[48:51], s36 offen offset:1024 sc1
    s_waitcnt vmcnt(48)
    s_lshl_b32 s36, s57, 1
    buffer_load_dwordx4 v[8:11], v108, s[48:51], s36 offen offset:0 sc1
    buffer_load_dwordx4 v[12:15], v108, s[48:51], s36 offen offset:1024 sc1
    s_waitcnt vmcnt(48)
    s_lshl_b32 s36, s58, 1
    buffer_load_dwordx4 v[16:19], v108, s[48:51], s36 offen offset:0 sc1
    buffer_load_dwordx4 v[20:23], v108, s[48:51], s36 offen offset:1024 sc1
    s_waitcnt vmcnt(48)
    s_lshl_b32 s36, s59, 1
    buffer_load_dwordx4 v[24:27], v108, s[48:51], s36 offen offset:0 sc1
    buffer_load_dwordx4 v[28:31], v108, s[48:51], s36 offen offset:1024 sc1
    s_waitcnt vmcnt(48)
    s_lshl_b32 s36, s60, 1
    buffer_load_dwordx4 v[32:35], v108, s[48:51], s36 offen offset:0 sc1
    buffer_load_dwordx4 v[36:39], v108, s[48:51], s36 offen offset:1024 sc1
    s_waitcnt vmcnt(48)
    s_lshl_b32 s36, s61, 1
    buffer_load_dwordx4 v[40:43], v108, s[48:51], s36 offen offset:0 sc1
    buffer_load_dwordx4 v[44:47], v108, s[48:51], s36 offen offset:1024 sc1
    s_waitcnt vmcnt(48)
    s_lshl_b32 s36, s62, 1
    buffer_load_dwordx4 v[48:51], v108, s[48:51], s36 offen offset:0 sc1
    buffer_load_dwordx4 v[52:55], v108, s[48:51], s36 offen offset:1024 sc1
    s_waitcnt vmcnt(48)
    s_add_u32 s48, s48, 14336
    s_addc_u32 s49, s49, 0
    s_barrier
    s_mul_i32 s36, s31, 14336
    v_mov_b32 v115, s36
    v_add_u32 v115, 16384, v115
    v_bfe_u32 v117, v119, 0, 6
    v_lshl_add_u32 v115, v117, 4, v115
    s_waitcnt vmcnt(0)
    ds_write_b128 v115, v[0:3] offset:0
    ds_write_b128 v115, v[4:7] offset:1024
    ds_write_b128 v115, v[8:11] offset:2048
    ds_write_b128 v115, v[12:15] offset:3072
    ds_write_b128 v115, v[16:19] offset:4096
    ds_write_b128 v115, v[20:23] offset:5120
    ds_write_b128 v115, v[24:27] offset:6144
    ds_write_b128 v115, v[28:31] offset:7168
    ds_write_b128 v115, v[32:35] offset:8192
    ds_write_b128 v115, v[36:39] offset:9216
    ds_write_b128 v115, v[40:43] offset:10240
    ds_write_b128 v115, v[44:47] offset:11264
    ds_write_b128 v115, v[48:51] offset:12288
    ds_write_b128 v115, v[52:55] offset:13312
    v_and_b32 v117, 1, v119
    v_cmp_eq_u32 vcc, 1, v117
    v_mov_b32 v109, 0x44444444
    v_mov_b32 v117, 0xeeeeeeee
    v_cndmask_b32 v109, v109, v117, vcc
    v_mov_b32 v111, 0
    v_bfe_u32 v117, v119, 2, 2
    v_lshl_add_u32 v111, v117, 7, v111
    v_bfe_u32 v117, v119, 0, 1
    v_lshl_add_u32 v111, v117, 6, v111
    v_bfe_u32 v117, v119, 4, 2
    v_lshl_add_u32 v111, v117, 4, v111
    v_bfe_u32 v117, v119, 1, 1
    v_lshl_add_u32 v111, v117, 3, v111
    s_mul_i32 s36, s31, 1280
    v_mov_b32 v112, s36
    v_add_u32 v112, 256, v112
    v_bfe_u32 v117, v119, 4, 2
    v_mul_u32_u24 v117, 320, v117
    v_add_u32 v112, v117, v112
    v_bfe_u32 v117, v119, 0, 4
    v_lshl_add_u32 v112, v117, 2, v112
    s_and_b32 s36, s31, 1
    s_mul_i32 s36, s36, 640
    s_lshr_b32 s37, s31, 1
    s_lshl_b32 s37, s37, 6
    s_add_u32 s36, s36, s37
    v_mov_b32 v113, s36
    v_add_u32 v113, 256, v113
    v_bfe_u32 v117, v119, 3, 2
    v_mul_u32_u24 v117, 160, v117
    v_add_u32 v113, v117, v113
    v_bfe_u32 v117, v119, 0, 3
    v_lshl_add_u32 v113, v117, 3, v113
    v_mov_b32 v114, s39
    v_add_u32 v114, 8192, v114
    v_bfe_u32 v117, v119, 0, 5
    v_lshl_add_u32 v114, v117, 2, v114
    s_add_u32 s40, s28, 13623296
    s_addc_u32 s41, s29, 0
    s_mov_b32 s42, -1
    s_mov_b32 s43, 0x00020000
    s_mul_i32 s36, s31, 2560
    s_add_u32 s36, s36, 14147584
    s_add_u32 s52, s28, s36
    s_addc_u32 s53, s29, 0
    s_add_u32 s70, s28, 14819328
    s_addc_u32 s71, s29, 0
    v_mov_b32 v116, 14802944
    s_mov_b32 s34, 0
    s_waitcnt lgkmcnt(0)
    v_mov_b32 v2, -1
    v_mov_b32 v3, -1
    s_mov_b32 s46, 8
    ds_write_b64 v113, v[2:3] offset:0
    ds_write_b64 v113, v[2:3] offset:1280
    ds_write_b64 v113, v[2:3] offset:2560
    ds_write_b64 v113, v[2:3] offset:3840
    v_mov_b32 v0, v119
    v_mov_b32 v117, 4
    v_lshlrev_b32 v4, 4, v0
    v_add_u32 v4, 15237120, v4
L_cw_8:
    s_sub_u32 s35, s35, 1
    s_cbranch_scc1 L_bail
    global_load_dwordx4 v[6:9], v4, s[28:29] sc1
    global_load_dword v118, v117, s[26:27] sc1
    s_waitcnt vmcnt(0)
    v_or3_b32 v6, v6, v7, v8
    v_or_b32 v6, v6, v9
    v_cmp_ne_u32 vcc, 0, v6
    s_cbranch_vccnz L_cw_8
    v_readfirstlane_b32 s36, v118
    s_and_b32 s37, s36, 0xffff
    s_cmp_lg_u32 s37, 32
    s_cbranch_scc1 L_cw_8
    s_lshr_b32 s33, s36, 16
    global_load_dword v118, v116, s[28:29] sc1
    s_waitcnt vmcnt(0)
    s_cmp_lg_u32 s33, 0
    s_cbranch_scc1 L_v_loop_s
.p2align 6
L_v_loop_f:
    v_cmp_eq_u32 vcc, -1, v118
    s_cbranch_vccnz L_v_rdy_f
    s_nop 15
    s_nop 6
    buffer_load_dwordx4 v[32:35], v108, s[40:43], s56 offen sc1
    buffer_load_dwordx4 v[36:39], v108, s[40:43], s57 offen sc1
    v_add_u32 v116, 4, v116
    v_mov_b32 v0, 0
    v_mov_b32 v1, 0
    v_mov_b32 v2, 0
    v_mov_b32 v3, 0
    v_mov_b32 v4, 0
    v_mov_b32 v5, 0
    v_mov_b32 v6, 0
    v_mov_b32 v7, 0
    v_mov_b32 v8, 0
    v_mov_b32 v9, 0
    v_mov_b32 v10, 0
    v_mov_b32 v11, 0
    v_mov_b32 v12, 0
    v_mov_b32 v13, 0
    v_mov_b32 v14, 0
    v_mov_b32 v15, 0
    v_mov_b32 v16, 0
    v_mov_b32 v17, 0
    v_mov_b32 v18, 0
    v_mov_b32 v19, 0
    v_mov_b32 v20, 0
    v_mov_b32 v21, 0
    v_mov_b32 v22, 0
    v_mov_b32 v23, 0
    v_mov_b32 v24, 0
    v_mov_b32 v25, 0
    v_mov_b32 v26, 0
    v_mov_b32 v27, 0
    v_mov_b32 v28, 0
    v_mov_b32 v29, 0
    v_mov_b32 v30, 0
    v_mov_b32 v31, 0
    v_add_u32 v100, s56, v108
    v_add_u32 v101, s57, v108
    v_add_u32 v40, s58, v108
    v_add_u32 v44, s59, v108
    v_add_u32 v48, s60, v108
    v_add_u32 v52, s61, v108
    v_add_u32 v56, s62, v108
    s_waitcnt lgkmcnt(0)
    s_mov_b32 s4, -1
    s_mov_b32 s8, -1
    s_mov_b32 s12, -1
    s_mov_b32 s16, -1
    s_mov_b32 s20, -1
    s_mov_b32 s48, -1
    s_mov_b32 s64, -1
    s_mov_b32 s76, -1
    ds_read_b128 v[92:95], v115 offset:0
    ds_read_b128 v[96:99], v115 offset:1024
L_v_mw_f:
    s_waitcnt vmcnt(0)
    v_max3_u32 v117, v32, v33, v34
    v_max3_u32 v117, v117, v35, v36
    v_max3_u32 v117, v117, v37, v38
    v_max_u32 v117, v117, v39
    v_cmp_eq_u32 vcc, -1, v117
    s_cbranch_vccnz L_v_mretry_f
    global_load_dwordx4 v[60:63], v108, s[44:45] offset:-4096 sc1
    ds_write_b128 v100, v[32:35] offset:6144
    ds_write_b128 v101, v[36:39] offset:6144
    s_waitcnt lgkmcnt(2)
    v_smfmac_f32_16x16x64_bf16 v[28:31], v[32:35], v[92:99], v109
    ds_read_b128 v[92:95], v115 offset:2048
    v_smfmac_f32_16x16x64_bf16 v[0:3], v[32:35], a[0:7], v109
    ds_read_b128 v[96:99], v115 offset:3072
    v_smfmac_f32_16x16x64_bf16 v[4:7], v[32:35], a[56:63], v109
    v_smfmac_f32_16x16x64_bf16 v[8:11], v[32:35], a[112:119], v109
    global_load_dwordx4 v[68:71], v108, s[44:45] offset:-3072 sc1
    v_smfmac_f32_16x16x64_bf16 v[12:15], v[32:35], a[168:175], v109
    v_smfmac_f32_16x16x64_bf16 v[16:19], v[32:35], a[224:231], v109
    s_waitcnt lgkmcnt(0)
    s_barrier
    v_smfmac_f32_16x16x64_bf16 v[20:23], v[32:35], v[144:151], v109
    ds_read_b128 v[40:43], v40 offset:6144
    v_smfmac_f32_16x16x64_bf16 v[24:27], v[32:35], v[200:207], v109
    ds_read_b128 v[44:47], v44 offset:6144
    global_load_dwordx4 v[64:67], v108, s[44:45] offset:-2048 sc1
    v_smfmac_f32_16x16x64_bf16 v[28:31], v[36:39], v[92:99], v109
    ds_read_b128 v[92:95], v115 offset:4096
    v_smfmac_f32_16x16x64_bf16 v[0:3], v[36:39], a[8:15], v109
    ds_read_b128 v[96:99], v115 offset:5120
    v_smfmac_f32_16x16x64_bf16 v[4:7], v[36:39], a[64:71], v109
    ds_read_b128 v[48:51], v48 offset:6144
    v_smfmac_f32_16x16x64_bf16 v[8:11], v[36:39], a[120:127], v109
    ds_read_b128 v[52:55], v52 offset:6144
    global_load_dwordx4 v[72:75], v108, s[44:45] offset:-1024 sc1
    v_smfmac_f32_16x16x64_bf16 v[12:15], v[36:39], a[176:183], v109
    ds_read_b128 v[56:59], v56 offset:6144
    v_smfmac_f32_16x16x64_bf16 v[16:19], v[36:39], a[232:239], v109
    v_smfmac_f32_16x16x64_bf16 v[20:23], v[36:39], v[152:159], v109
    v_smfmac_f32_16x16x64_bf16 v[24:27], v[36:39], v[208:215], v109
    s_waitcnt lgkmcnt(0)
    global_load_dwordx4 v[76:79], v108, s[44:45] offset:0 sc1
    v_smfmac_f32_16x16x64_bf16 v[28:31], v[40:43], v[92:99], v109
    ds_read_b128 v[92:95], v115 offset:6144
    v_smfmac_f32_16x16x64_bf16 v[0:3], v[40:43], a[16:23], v109
    ds_read_b128 v[96:99], v115 offset:7168
    v_smfmac_f32_16x16x64_bf16 v[0:3], v[44:47], a[24:31], v109
    v_smfmac_f32_16x16x64_bf16 v[0:3], v[48:51], a[32:39], v109
    global_load_dwordx4 v[84:87], v108, s[44:45] offset:1024 sc1
    v_smfmac_f32_16x16x64_bf16 v[0:3], v[52:55], a[40:47], v109
    v_smfmac_f32_16x16x64_bf16 v[0:3], v[56:59], a[48:55], v109
    s_waitcnt lgkmcnt(0)
    v_smfmac_f32_16x16x64_bf16 v[28:31], v[44:47], v[92:99], v109
    ds_read_b128 v[92:95], v115 offset:8192
    v_smfmac_f32_16x16x64_bf16 v[4:7], v[40:43], a[72:79], v109
    ds_read_b128 v[96:99], v115 offset:9216
    global_load_dwordx4 v[80:83], v108, s[44:45] offset:2048 sc1
    v_smfmac_f32_16x16x64_bf16 v[4:7], v[44:47], a[80:87], v109
    v_add_f32 v0, v0, v1
    v_smfmac_f32_16x16x64_bf16 v[4:7], v[48:51], a[88:95], v109
    v_add_f32 v2, v2, v3
    v_smfmac_f32_16x16x64_bf16 v[4:7], v[52:55], a[96:103], v109
    v_cvt_pk_bf16_f32 v100, v0, v2
    v_smfmac_f32_16x16x64_bf16 v[4:7], v[56:59], a[104:111], v109
    s_waitcnt lgkmcnt(0)
    global_load_dwordx4 v[88:91], v108, s[44:45] offset:3072 sc1
    v_mov_b32 v0, 0
    v_smfmac_f32_16x16x64_bf16 v[28:31], v[48:51], v[92:99], v109
    ds_read_b128 v[92:95], v115 offset:10240
    v_mov_b32 v1, 0
    v_smfmac_f32_16x16x64_bf16 v[8:11], v[40:43], a[128:135], v109
    ds_read_b128 v[96:99], v115 offset:11264
    v_mov_b32 v2, 0
    v_smfmac_f32_16x16x64_bf16 v[8:11], v[44:47], a[136:143], v109
    v_mov_b32 v3, 0
    v_smfmac_f32_16x16x64_bf16 v[8:11], v[48:51], a[144:151], v109
    global_load_dword v118, v116, s[28:29] sc1
    v_add_f32 v4, v4, v5
    v_smfmac_f32_16x16x64_bf16 v[8:11], v[52:55], a[152:159], v109
    v_add_f32 v6, v6, v7
    v_smfmac_f32_16x16x64_bf16 v[8:11], v[56:59], a[160:167], v109
    s_waitcnt lgkmcnt(0)
    v_cvt_pk_bf16_f32 v104, v4, v6
    v_smfmac_f32_16x16x64_bf16 v[28:31], v[52:55], v[92:99], v109
    ds_read_b128 v[92:95], v115 offset:12288
    v_mov_b32 v4, 0
    v_smfmac_f32_16x16x64_bf16 v[12:15], v[40:43], a[184:191], v109
    ds_read_b128 v[96:99], v115 offset:13312
    v_mov_b32 v5, 0
    v_smfmac_f32_16x16x64_bf16 v[12:15], v[44:47], a[192:199], v109
    v_mov_b32 v6, 0
    v_smfmac_f32_16x16x64_bf16 v[12:15], v[48:51], a[200:207], v109
    v_mov_b32 v7, 0
    v_smfmac_f32_16x16x64_bf16 v[12:15], v[52:55], a[208:215], v109
    v_add_f32 v8, v8, v9
    v_smfmac_f32_16x16x64_bf16 v[12:15], v[56:59], a[216:223], v109
    s_waitcnt lgkmcnt(0)
    v_add_f32 v10, v10, v11
    v_smfmac_f32_16x16x64_bf16 v[28:31], v[56:59], v[92:99], v109
    v_cvt_pk_bf16_f32 v101, v8, v10
    v_smfmac_f32_16x16x64_bf16 v[16:19], v[40:43], a[240:247], v109
    v_smfmac_f32_16x16x64_bf16 v[16:19], v[44:47], a[248:255], v109
    v_add_f32 v12, v12, v13
    v_smfmac_f32_16x16x64_bf16 v[16:19], v[48:51], v[120:127], v109
    v_add_f32 v14, v14, v15
    v_smfmac_f32_16x16x64_bf16 v[16:19], v[52:55], v[128:135], v109
    v_cvt_pk_bf16_f32 v105, v12, v14
    v_smfmac_f32_16x16x64_bf16 v[16:19], v[56:59], v[136:143], v109
    v_add_f32 v28, v28, v29
    v_smfmac_f32_16x16x64_bf16 v[20:23], v[40:43], v[160:167], v109
    v_add_f32 v30, v30, v31
    v_smfmac_f32_16x16x64_bf16 v[20:23], v[44:47], v[168:175], v109
    v_cvt_pk_bf16_f32 v107, v28, v30
    v_smfmac_f32_16x16x64_bf16 v[20:23], v[48:51], v[176:183], v109
    v_add_f32 v16, v16, v17
    v_smfmac_f32_16x16x64_bf16 v[20:23], v[52:55], v[184:191], v109
    v_add_f32 v18, v18, v19
    v_smfmac_f32_16x16x64_bf16 v[20:23], v[56:59], v[192:199], v109
    v_cvt_pk_bf16_f32 v102, v16, v18
    v_smfmac_f32_16x16x64_bf16 v[24:27], v[40:43], v[216:223], v109
    v_smfmac_f32_16x16x64_bf16 v[24:27], v[44:47], v[224:231], v109
    v_smfmac_f32_16x16x64_bf16 v[24:27], v[48:51], v[232:239], v109
    v_add_f32 v20, v20, v21
    v_smfmac_f32_16x16x64_bf16 v[24:27], v[52:55], v[240:247], v109
    v_add_f32 v22, v22, v23
    v_smfmac_f32_16x16x64_bf16 v[24:27], v[56:59], v[248:255], v109
    v_cvt_pk_bf16_f32 v106, v20, v22
    s_nop 7
    v_add_f32 v24, v24, v25
    v_add_f32 v26, v26, v27
    v_cvt_pk_bf16_f32 v103, v24, v26
    s_cmp_lg_u32 s31, 0
    s_cbranch_scc1 L_v_sync_f
    s_load_dwordx4 s[4:7], s[70:71], 64
    s_nop 3
    s_load_dwordx4 s[8:11], s[70:71], 192
    s_nop 3
    s_load_dwordx4 s[12:15], s[70:71], 320
    s_nop 3
    s_load_dwordx4 s[16:19], s[70:71], 448
    s_nop 3
    s_load_dwordx4 s[20:23], s[70:71], 576
    s_nop 3
    s_load_dwordx4 s[48:51], s[70:71], 704
    s_nop 3
    s_load_dwordx4 s[64:67], s[70:71], 832
    s_or_b64 s[36:37], s[4:5], s[6:7]
    s_cbranch_scc0 L_v_sync_f
    s_nop 1
    s_load_dwordx4 s[76:79], s[70:71], 960
    s_or_b64 s[36:37], s[8:9], s[10:11]
    s_cbranch_scc0 L_v_sync_f
    s_nop 1
    s_load_dwordx4 s[4:7], s[70:71], 1088
    s_or_b64 s[36:37], s[12:13], s[14:15]
    s_cbranch_scc0 L_v_sync_f
    s_nop 1
    s_load_dwordx4 s[8:11], s[70:71], 1216
    s_or_b64 s[36:37], s[16:17], s[18:19]
    s_cbranch_scc0 L_v_sync_f
    s_nop 1
    s_load_dwordx4 s[12:15], s[70:71], 1344
    s_or_b64 s[36:37], s[20:21], s[22:23]
    s_cbranch_scc0 L_v_sync_f
    s_nop 1
    s_load_dwordx4 s[16:19], s[70:71], 1472
    s_or_b64 s[36:37], s[48:49], s[50:51]
    s_cbranch_scc0 L_v_sync_f
    s_nop 1
    s_load_dwordx4 s[20:23], s[70:71], 1600
    s_or_b64 s[36:37], s[64:65], s[66:67]
    s_cbranch_scc0 L_v_sync_f
    s_nop 1
    s_load_dwordx4 s[48:51], s[70:71], 1728
    s_or_b64 s[36:37], s[76:77], s[78:79]
    s_cbranch_scc0 L_v_sync_f
    s_nop 1
    s_load_dwordx4 s[64:67], s[70:71], 1856
    s_or_b64 s[36:37], s[4:5], s[6:7]
    s_cbranch_scc0 L_v_sync_f
    s_nop 1
    s_load_dwordx4 s[76:79], s[70:71], 1984
    s_or_b64 s[36:37], s[8:9], s[10:11]
    s_cbranch_scc0 L_v_sync_f
    s_nop 1
    s_load_dwordx4 s[4:7], s[70:71], 2112
    s_or_b64 s[36:37], s[12:13], s[14:15]
    s_cbranch_scc0 L_v_sync_f
    s_nop 1
    s_load_dwordx4 s[8:11], s[70:71], 2240
    s_or_b64 s[36:37], s[16:17], s[18:19]
    s_cbranch_scc0 L_v_sync_f
    s_nop 1
    s_load_dwordx4 s[12:15], s[70:71], 2368
    s_or_b64 s[36:37], s[20:21], s[22:23]
    s_cbranch_scc0 L_v_sync_f
    s_nop 1
    s_load_dwordx4 s[16:19], s[70:71], 2496
    s_or_b64 s[36:37], s[48:49], s[50:51]
    s_cbranch_scc0 L_v_sync_f
    s_nop 1
    s_load_dwordx4 s[20:23], s[70:71], 2624
    s_or_b64 s[36:37], s[64:65], s[66:67]
    s_cbranch_scc0 L_v_sync_f
    s_nop 1
    s_load_dwordx4 s[48:51], s[70:71], 2752
    s_or_b64 s[36:37], s[76:77], s[78:79]
    s_cbranch_scc0 L_v_sync_f
    s_nop 1
    s_load_dwordx4 s[64:67], s[70:71], 2880
    s_or_b64 s[36:37], s[4:5], s[6:7]
    s_cbranch_scc0 L_v_sync_f
    s_nop 1
    s_load_dwordx4 s[76:79], s[70:71], 3008
    s_or_b64 s[36:37], s[8:9], s[10:11]
    s_cbranch_scc0 L_v_sync_f
    s_nop 1
    s_load_dwordx4 s[4:7], s[70:71], 3136
    s_or_b64 s[36:37], s[12:13], s[14:15]
    s_cbranch_scc0 L_v_sync_f
    s_nop 1
    s_load_dwordx4 s[8:11], s[70:71], 3264
    s_or_b64 s[36:37], s[16:17], s[18:19]
    s_cbranch_scc0 L_v_sync_f
    s_nop 1
    s_load_dwordx4 s[12:15], s[70:71], 3392
    s_or_b64 s[36:37], s[20:21], s[22:23]
    s_cbranch_scc0 L_v_sync_f
    s_nop 1
    s_load_dwordx4 s[16:19], s[70:71], 3520
    s_or_b64 s[36:37], s[48:49], s[50:51]
    s_cbranch_scc0 L_v_sync_f
    s_nop 1
    s_load_dwordx4 s[20:23], s[70:71], 3648
    s_or_b64 s[36:37], s[64:65], s[66:67]
    s_cbranch_scc0 L_v_sync_f
    s_nop 1
    s_load_dwordx4 s[48:51], s[70:71], 3776
    s_or_b64 s[36:37], s[76:77], s[78:79]
    s_cbranch_scc0 L_v_sync_f
    s_nop 1
    s_load_dwordx4 s[64:67], s[70:71], 3904
    s_or_b64 s[36:37], s[4:5], s[6:7]
    s_cbranch_scc0 L_v_sync_f
    s_nop 1
    s_load_dwordx4 s[76:79], s[70:71], 4032
    s_or_b64 s[36:37], s[8:9], s[10:11]
    s_cbranch_scc0 L_v_sync_f
    s_nop 1
    s_nop 0
    s_or_b64 s[36:37], s[12:13], s[14:15]
    s_cbranch_scc0 L_v_sync_f
    s_nop 1
    s_nop 0
    s_or_b64 s[36:37], s[16:17], s[18:19]
    s_cbranch_scc0 L_v_sync_f
    s_nop 1
    s_nop 0
    s_or_b64 s[36:37], s[20:21], s[22:23]
    s_cbranch_scc0 L_v_sync_f
    s_nop 1
    s_nop 0
    s_or_b64 s[36:37], s[48:49], s[50:51]
    s_cbranch_scc0 L_v_sync_f
    s_nop 1
    s_nop 0
    s_or_b64 s[36:37], s[64:65], s[66:67]
    s_cbranch_scc0 L_v_sync_f
    s_nop 1
    s_nop 0
    s_or_b64 s[36:37], s[76:77], s[78:79]
    s_cbranch_scc0 L_v_sync_f
    s_nop 1
L_v_sync_f:
    s_barrier
    s_nop 15
    s_nop 15
    s_nop 12
    global_load_dwordx4 v[32:35], v108, s[52:53] sc1
    s_nop 11
    global_load_dwordx4 v[36:39], v108, s[52:53] offset:1024 sc1
    s_nop 11
    global_load_dwordx2 v[40:41], v111, s[52:53] offset:2048 sc1
L_v_pwait_f:
    s_waitcnt vmcnt(2)
    v_smfmac_f32_16x16x64_bf16 v[0:3], v[32:35], v[60:67], v109
    v_max3_u32 v117, v32, v33, v34
    v_smfmac_f32_16x16x64_bf16 v[4:7], v[32:35], v[68:75], v109
    s_waitcnt vmcnt(1)
    v_smfmac_f32_16x16x64_bf16 v[0:3], v[36:39], v[76:83], v109
    v_max3_u32 v117, v117, v35, v36
    v_smfmac_f32_16x16x64_bf16 v[4:7], v[36:39], v[84:91], v109
    v_max3_u32 v117, v117, v37, v38
    s_waitcnt vmcnt(0)
    v_smfmac_f32_16x16x32_bf16 v[0:3], v[40:41], v[100:103], v109
    v_max3_u32 v117, v117, v39, v40
    v_smfmac_f32_16x16x32_bf16 v[4:7], v[40:41], v[104:107], v109
    v_max_u32 v117, v117, v41
    v_cmp_eq_u32 vcc, -1, v117
    s_cbranch_vccnz L_v_pretry_f
    s_nop 2
    v_add_f32 v0, v0, v1
    v_add_f32 v2, v2, v3
    ds_write2_b32 v112, v0, v2 offset0:0 offset1:40
    v_add_f32 v4, v4, v5
    v_add_f32 v6, v6, v7
    ds_write2_b32 v112, v4, v6 offset0:16 offset1:56
    s_mov_b64 exec, 0xffffffff
    s_barrier
    ds_read_b64 v[8:9], v113 offset:0
    ds_read_b64 v[10:11], v113 offset:1280
    ds_read_b64 v[12:13], v113 offset:2560
    ds_read_b64 v[14:15], v113 offset:3840
L_v_red_f:
    s_waitcnt lgkmcnt(2)
    v_pk_add_f32 v[8:9], v[8:9], v[10:11]
    s_waitcnt lgkmcnt(0)
    v_pk_add_f32 v[12:13], v[12:13], v[14:15]
    v_pk_add_f32 v[8:9], v[8:9], v[12:13]
    v_cmp_u_f32 vcc, v8, v9
    v_cvt_pk_bf16_f32 v8, v8, v9
    s_cbranch_vccnz L_v_nan_f
L_v_nanr_f:
    global_store_dword v114, v8, s[40:41]
    v_mov_b32 v10, -1
    v_mov_b32 v11, -1
    s_mov_b32 s46, 8
    ds_write_b64 v113, v[10:11] offset:0
    ds_write_b64 v113, v[10:11] offset:1280
    ds_write_b64 v113, v[10:11] offset:2560
    ds_write_b64 v113, v[10:11] offset:3840
    s_mov_b64 exec, -1
    s_add_u32 s40, s40, 8192
    s_addc_u32 s41, s41, 0
    s_add_u32 s52, s52, 10240
    s_addc_u32 s53, s53, 0
    s_add_u32 s44, s44, 458752
    s_addc_u32 s45, s45, 0
    s_add_u32 s70, s70, 4096
    s_addc_u32 s71, s71, 0
    s_add_u32 s34, s34, 1
    s_cmp_lt_u32 s34, 63
    s_cbranch_scc1 L_v_loop_f
    s_branch L_v_end
.p2align 6
L_v_loop_s:
    v_cmp_eq_u32 vcc, -1, v118
    s_cbranch_vccnz L_v_rdy_s
    s_nop 15
    s_nop 6
    buffer_load_dwordx4 v[32:35], v108, s[40:43], s56 offen sc1
    buffer_load_dwordx4 v[36:39], v108, s[40:43], s57 offen sc1
    v_add_u32 v116, 4, v116
    v_mov_b32 v0, 0
    v_mov_b32 v1, 0
    v_mov_b32 v2, 0
    v_mov_b32 v3, 0
    v_mov_b32 v4, 0
    v_mov_b32 v5, 0
    v_mov_b32 v6, 0
    v_mov_b32 v7, 0
    v_mov_b32 v8, 0
    v_mov_b32 v9, 0
    v_mov_b32 v10, 0
    v_mov_b32 v11, 0
    v_mov_b32 v12, 0
    v_mov_b32 v13, 0
    v_mov_b32 v14, 0
    v_mov_b32 v15, 0
    v_mov_b32 v16, 0
    v_mov_b32 v17, 0
    v_mov_b32 v18, 0
    v_mov_b32 v19, 0
    v_mov_b32 v20, 0
    v_mov_b32 v21, 0
    v_mov_b32 v22, 0
    v_mov_b32 v23, 0
    v_mov_b32 v24, 0
    v_mov_b32 v25, 0
    v_mov_b32 v26, 0
    v_mov_b32 v27, 0
    v_mov_b32 v28, 0
    v_mov_b32 v29, 0
    v_mov_b32 v30, 0
    v_mov_b32 v31, 0
    v_add_u32 v100, s56, v108
    v_add_u32 v101, s57, v108
    v_add_u32 v40, s58, v108
    v_add_u32 v44, s59, v108
    v_add_u32 v48, s60, v108
    v_add_u32 v52, s61, v108
    v_add_u32 v56, s62, v108
    s_waitcnt lgkmcnt(0)
    s_mov_b32 s4, -1
    s_mov_b32 s8, -1
    s_mov_b32 s12, -1
    s_mov_b32 s16, -1
    s_mov_b32 s20, -1
    s_mov_b32 s48, -1
    s_mov_b32 s64, -1
    s_mov_b32 s76, -1
    ds_read_b128 v[92:95], v115 offset:0
    ds_read_b128 v[96:99], v115 offset:1024
L_v_mw_s:
    s_waitcnt vmcnt(0)
    v_max3_u32 v117, v32, v33, v34
    v_max3_u32 v117, v117, v35, v36
    v_max3_u32 v117, v117, v37, v38
    v_max_u32 v117, v117, v39
    v_cmp_eq_u32 vcc, -1, v117
    s_cbranch_vccnz L_v_mretry_s
    global_load_dwordx4 v[60:63], v108, s[44:45] offset:-4096 sc1
    ds_write_b128 v100, v[32:35] offset:6144
    ds_write_b128 v101, v[36:39] offset:6144
    s_waitcnt lgkmcnt(2)
    v_smfmac_f32_16x16x64_bf16 v[28:31], v[32:35], v[92:99], v109
    ds_read_b128 v[92:95], v115 offset:2048
    v_smfmac_f32_16x16x64_bf16 v[0:3], v[32:35], a[0:7], v109
    ds_read_b128 v[96:99], v115 offset:3072
    v_smfmac_f32_16x16x64_bf16 v[4:7], v[32:35], a[56:63], v109
    v_smfmac_f32_16x16x64_bf16 v[8:11], v[32:35], a[112:119], v109
    global_load_dwordx4 v[68:71], v108, s[44:45] offset:-3072 sc1
    v_smfmac_f32_16x16x64_bf16 v[12:15], v[32:35], a[168:175], v109
    v_smfmac_f32_16x16x64_bf16 v[16:19], v[32:35], a[224:231], v109
    s_waitcnt lgkmcnt(0)
    s_barrier
    v_smfmac_f32_16x16x64_bf16 v[20:23], v[32:35], v[144:151], v109
    ds_read_b128 v[40:43], v40 offset:6144
    v_smfmac_f32_16x16x64_bf16 v[24:27], v[32:35], v[200:207], v109
    ds_read_b128 v[44:47], v44 offset:6144
    global_load_dwordx4 v[64:67], v108, s[44:45] offset:-2048 sc1
    v_smfmac_f32_16x16x64_bf16 v[28:31], v[36:39], v[92:99], v109
    ds_read_b128 v[92:95], v115 offset:4096
    v_smfmac_f32_16x16x64_bf16 v[0:3], v[36:39], a[8:15], v109
    ds_read_b128 v[96:99], v115 offset:5120
    v_smfmac_f32_16x16x64_bf16 v[4:7], v[36:39], a[64:71], v109
    ds_read_b128 v[48:51], v48 offset:6144
    v_smfmac_f32_16x16x64_bf16 v[8:11], v[36:39], a[120:127], v109
    ds_read_b128 v[52:55], v52 offset:6144
    global_load_dwordx4 v[72:75], v108, s[44:45] offset:-1024 sc1
    v_smfmac_f32_16x16x64_bf16 v[12:15], v[36:39], a[176:183], v109
    ds_read_b128 v[56:59], v56 offset:6144
    v_smfmac_f32_16x16x64_bf16 v[16:19], v[36:39], a[232:239], v109
    v_smfmac_f32_16x16x64_bf16 v[20:23], v[36:39], v[152:159], v109
    v_smfmac_f32_16x16x64_bf16 v[24:27], v[36:39], v[208:215], v109
    s_waitcnt lgkmcnt(0)
    global_load_dwordx4 v[76:79], v108, s[44:45] offset:0 sc1
    v_smfmac_f32_16x16x64_bf16 v[28:31], v[40:43], v[92:99], v109
    ds_read_b128 v[92:95], v115 offset:6144
    v_smfmac_f32_16x16x64_bf16 v[0:3], v[40:43], a[16:23], v109
    ds_read_b128 v[96:99], v115 offset:7168
    v_smfmac_f32_16x16x64_bf16 v[0:3], v[44:47], a[24:31], v109
    v_smfmac_f32_16x16x64_bf16 v[0:3], v[48:51], a[32:39], v109
    global_load_dwordx4 v[84:87], v108, s[44:45] offset:1024 sc1
    v_smfmac_f32_16x16x64_bf16 v[0:3], v[52:55], a[40:47], v109
    v_smfmac_f32_16x16x64_bf16 v[0:3], v[56:59], a[48:55], v109
    s_waitcnt lgkmcnt(0)
    v_smfmac_f32_16x16x64_bf16 v[28:31], v[44:47], v[92:99], v109
    ds_read_b128 v[92:95], v115 offset:8192
    v_smfmac_f32_16x16x64_bf16 v[4:7], v[40:43], a[72:79], v109
    ds_read_b128 v[96:99], v115 offset:9216
    global_load_dwordx4 v[80:83], v108, s[44:45] offset:2048 sc1
    v_smfmac_f32_16x16x64_bf16 v[4:7], v[44:47], a[80:87], v109
    v_add_f32 v0, v0, v1
    v_smfmac_f32_16x16x64_bf16 v[4:7], v[48:51], a[88:95], v109
    v_add_f32 v2, v2, v3
    v_smfmac_f32_16x16x64_bf16 v[4:7], v[52:55], a[96:103], v109
    v_cvt_pk_bf16_f32 v100, v0, v2
    v_smfmac_f32_16x16x64_bf16 v[4:7], v[56:59], a[104:111], v109
    s_waitcnt lgkmcnt(0)
    global_load_dwordx4 v[88:91], v108, s[44:45] offset:3072 sc1
    v_mov_b32 v0, 0
    v_smfmac_f32_16x16x64_bf16 v[28:31], v[48:51], v[92:99], v109
    ds_read_b128 v[92:95], v115 offset:10240
    v_mov_b32 v1, 0
    v_smfmac_f32_16x16x64_bf16 v[8:11], v[40:43], a[128:135], v109
    ds_read_b128 v[96:99], v115 offset:11264
    v_mov_b32 v2, 0
    v_smfmac_f32_16x16x64_bf16 v[8:11], v[44:47], a[136:143], v109
    v_mov_b32 v3, 0
    v_smfmac_f32_16x16x64_bf16 v[8:11], v[48:51], a[144:151], v109
    global_load_dword v118, v116, s[28:29] sc1
    v_add_f32 v4, v4, v5
    v_smfmac_f32_16x16x64_bf16 v[8:11], v[52:55], a[152:159], v109
    v_add_f32 v6, v6, v7
    v_smfmac_f32_16x16x64_bf16 v[8:11], v[56:59], a[160:167], v109
    s_waitcnt lgkmcnt(0)
    v_cvt_pk_bf16_f32 v104, v4, v6
    v_smfmac_f32_16x16x64_bf16 v[28:31], v[52:55], v[92:99], v109
    ds_read_b128 v[92:95], v115 offset:12288
    v_mov_b32 v4, 0
    v_smfmac_f32_16x16x64_bf16 v[12:15], v[40:43], a[184:191], v109
    ds_read_b128 v[96:99], v115 offset:13312
    v_mov_b32 v5, 0
    v_smfmac_f32_16x16x64_bf16 v[12:15], v[44:47], a[192:199], v109
    v_mov_b32 v6, 0
    v_smfmac_f32_16x16x64_bf16 v[12:15], v[48:51], a[200:207], v109
    v_mov_b32 v7, 0
    v_smfmac_f32_16x16x64_bf16 v[12:15], v[52:55], a[208:215], v109
    v_add_f32 v8, v8, v9
    v_smfmac_f32_16x16x64_bf16 v[12:15], v[56:59], a[216:223], v109
    s_waitcnt lgkmcnt(0)
    v_add_f32 v10, v10, v11
    v_smfmac_f32_16x16x64_bf16 v[28:31], v[56:59], v[92:99], v109
    v_cvt_pk_bf16_f32 v101, v8, v10
    v_smfmac_f32_16x16x64_bf16 v[16:19], v[40:43], a[240:247], v109
    v_smfmac_f32_16x16x64_bf16 v[16:19], v[44:47], a[248:255], v109
    v_add_f32 v12, v12, v13
    v_smfmac_f32_16x16x64_bf16 v[16:19], v[48:51], v[120:127], v109
    v_add_f32 v14, v14, v15
    v_smfmac_f32_16x16x64_bf16 v[16:19], v[52:55], v[128:135], v109
    v_cvt_pk_bf16_f32 v105, v12, v14
    v_smfmac_f32_16x16x64_bf16 v[16:19], v[56:59], v[136:143], v109
    v_add_f32 v28, v28, v29
    v_smfmac_f32_16x16x64_bf16 v[20:23], v[40:43], v[160:167], v109
    v_add_f32 v30, v30, v31
    v_smfmac_f32_16x16x64_bf16 v[20:23], v[44:47], v[168:175], v109
    v_cvt_pk_bf16_f32 v107, v28, v30
    v_smfmac_f32_16x16x64_bf16 v[20:23], v[48:51], v[176:183], v109
    v_add_f32 v16, v16, v17
    v_smfmac_f32_16x16x64_bf16 v[20:23], v[52:55], v[184:191], v109
    v_add_f32 v18, v18, v19
    v_smfmac_f32_16x16x64_bf16 v[20:23], v[56:59], v[192:199], v109
    v_cvt_pk_bf16_f32 v102, v16, v18
    v_smfmac_f32_16x16x64_bf16 v[24:27], v[40:43], v[216:223], v109
    v_smfmac_f32_16x16x64_bf16 v[24:27], v[44:47], v[224:231], v109
    v_smfmac_f32_16x16x64_bf16 v[24:27], v[48:51], v[232:239], v109
    v_add_f32 v20, v20, v21
    v_smfmac_f32_16x16x64_bf16 v[24:27], v[52:55], v[240:247], v109
    v_add_f32 v22, v22, v23
    v_smfmac_f32_16x16x64_bf16 v[24:27], v[56:59], v[248:255], v109
    v_cvt_pk_bf16_f32 v106, v20, v22
    s_nop 7
    v_add_f32 v24, v24, v25
    v_add_f32 v26, v26, v27
    v_cvt_pk_bf16_f32 v103, v24, v26
    s_cmp_lg_u32 s31, 0
    s_cbranch_scc1 L_v_sync_s
    s_load_dwordx4 s[4:7], s[70:71], 64
    s_nop 3
    s_load_dwordx4 s[8:11], s[70:71], 192
    s_nop 3
    s_load_dwordx4 s[12:15], s[70:71], 320
    s_nop 3
    s_load_dwordx4 s[16:19], s[70:71], 448
    s_nop 3
    s_load_dwordx4 s[20:23], s[70:71], 576
    s_nop 3
    s_load_dwordx4 s[48:51], s[70:71], 704
    s_nop 3
    s_load_dwordx4 s[64:67], s[70:71], 832
    s_or_b64 s[36:37], s[4:5], s[6:7]
    s_cbranch_scc0 L_v_sync_s
    s_nop 1
    s_load_dwordx4 s[76:79], s[70:71], 960
    s_or_b64 s[36:37], s[8:9], s[10:11]
    s_cbranch_scc0 L_v_sync_s
    s_nop 1
    s_load_dwordx4 s[4:7], s[70:71], 1088
    s_or_b64 s[36:37], s[12:13], s[14:15]
    s_cbranch_scc0 L_v_sync_s
    s_nop 1
    s_load_dwordx4 s[8:11], s[70:71], 1216
    s_or_b64 s[36:37], s[16:17], s[18:19]
    s_cbranch_scc0 L_v_sync_s
    s_nop 1
    s_load_dwordx4 s[12:15], s[70:71], 1344
    s_or_b64 s[36:37], s[20:21], s[22:23]
    s_cbranch_scc0 L_v_sync_s
    s_nop 1
    s_load_dwordx4 s[16:19], s[70:71], 1472
    s_or_b64 s[36:37], s[48:49], s[50:51]
    s_cbranch_scc0 L_v_sync_s
    s_nop 1
    s_load_dwordx4 s[20:23], s[70:71], 1600
    s_or_b64 s[36:37], s[64:65], s[66:67]
    s_cbranch_scc0 L_v_sync_s
    s_nop 1
    s_load_dwordx4 s[48:51], s[70:71], 1728
    s_or_b64 s[36:37], s[76:77], s[78:79]
    s_cbranch_scc0 L_v_sync_s
    s_nop 1
    s_load_dwordx4 s[64:67], s[70:71], 1856
    s_or_b64 s[36:37], s[4:5], s[6:7]
    s_cbranch_scc0 L_v_sync_s
    s_nop 1
    s_load_dwordx4 s[76:79], s[70:71], 1984
    s_or_b64 s[36:37], s[8:9], s[10:11]
    s_cbranch_scc0 L_v_sync_s
    s_nop 1
    s_load_dwordx4 s[4:7], s[70:71], 2112
    s_or_b64 s[36:37], s[12:13], s[14:15]
    s_cbranch_scc0 L_v_sync_s
    s_nop 1
    s_load_dwordx4 s[8:11], s[70:71], 2240
    s_or_b64 s[36:37], s[16:17], s[18:19]
    s_cbranch_scc0 L_v_sync_s
    s_nop 1
    s_load_dwordx4 s[12:15], s[70:71], 2368
    s_or_b64 s[36:37], s[20:21], s[22:23]
    s_cbranch_scc0 L_v_sync_s
    s_nop 1
    s_load_dwordx4 s[16:19], s[70:71], 2496
    s_or_b64 s[36:37], s[48:49], s[50:51]
    s_cbranch_scc0 L_v_sync_s
    s_nop 1
    s_load_dwordx4 s[20:23], s[70:71], 2624
    s_or_b64 s[36:37], s[64:65], s[66:67]
    s_cbranch_scc0 L_v_sync_s
    s_nop 1
    s_load_dwordx4 s[48:51], s[70:71], 2752
    s_or_b64 s[36:37], s[76:77], s[78:79]
    s_cbranch_scc0 L_v_sync_s
    s_nop 1
    s_load_dwordx4 s[64:67], s[70:71], 2880
    s_or_b64 s[36:37], s[4:5], s[6:7]
    s_cbranch_scc0 L_v_sync_s
    s_nop 1
    s_load_dwordx4 s[76:79], s[70:71], 3008
    s_or_b64 s[36:37], s[8:9], s[10:11]
    s_cbranch_scc0 L_v_sync_s
    s_nop 1
    s_load_dwordx4 s[4:7], s[70:71], 3136
    s_or_b64 s[36:37], s[12:13], s[14:15]
    s_cbranch_scc0 L_v_sync_s
    s_nop 1
    s_load_dwordx4 s[8:11], s[70:71], 3264
    s_or_b64 s[36:37], s[16:17], s[18:19]
    s_cbranch_scc0 L_v_sync_s
    s_nop 1
    s_load_dwordx4 s[12:15], s[70:71], 3392
    s_or_b64 s[36:37], s[20:21], s[22:23]
    s_cbranch_scc0 L_v_sync_s
    s_nop 1
    s_load_dwordx4 s[16:19], s[70:71], 3520
    s_or_b64 s[36:37], s[48:49], s[50:51]
    s_cbranch_scc0 L_v_sync_s
    s_nop 1
    s_load_dwordx4 s[20:23], s[70:71], 3648
    s_or_b64 s[36:37], s[64:65], s[66:67]
    s_cbranch_scc0 L_v_sync_s
    s_nop 1
    s_load_dwordx4 s[48:51], s[70:71], 3776
    s_or_b64 s[36:37], s[76:77], s[78:79]
    s_cbranch_scc0 L_v_sync_s
    s_nop 1
    s_load_dwordx4 s[64:67], s[70:71], 3904
    s_or_b64 s[36:37], s[4:5], s[6:7]
    s_cbranch_scc0 L_v_sync_s
    s_nop 1
    s_load_dwordx4 s[76:79], s[70:71], 4032
    s_or_b64 s[36:37], s[8:9], s[10:11]
    s_cbranch_scc0 L_v_sync_s
    s_nop 1
    s_nop 0
    s_or_b64 s[36:37], s[12:13], s[14:15]
    s_cbranch_scc0 L_v_sync_s
    s_nop 1
    s_nop 0
    s_or_b64 s[36:37], s[16:17], s[18:19]
    s_cbranch_scc0 L_v_sync_s
    s_nop 1
    s_nop 0
    s_or_b64 s[36:37], s[20:21], s[22:23]
    s_cbranch_scc0 L_v_sync_s
    s_nop 1
    s_nop 0
    s_or_b64 s[36:37], s[48:49], s[50:51]
    s_cbranch_scc0 L_v_sync_s
    s_nop 1
    s_nop 0
    s_or_b64 s[36:37], s[64:65], s[66:67]
    s_cbranch_scc0 L_v_sync_s
    s_nop 1
    s_nop 0
    s_or_b64 s[36:37], s[76:77], s[78:79]
    s_cbranch_scc0 L_v_sync_s
    s_nop 1
L_v_sync_s:
    s_barrier
    s_nop 15
    s_nop 15
    s_nop 12
    global_load_dwordx4 v[32:35], v108, s[52:53] sc1
    s_nop 11
    global_load_dwordx4 v[36:39], v108, s[52:53] offset:1024 sc1
    s_nop 11
    global_load_dwordx2 v[40:41], v111, s[52:53] offset:2048 sc1
L_v_pwait_s:
    s_waitcnt vmcnt(2)
    v_smfmac_f32_16x16x64_bf16 v[0:3], v[32:35], v[60:67], v109
    v_max3_u32 v117, v32, v33, v34
    v_smfmac_f32_16x16x64_bf16 v[4:7], v[32:35], v[68:75], v109
    s_waitcnt vmcnt(1)
    v_smfmac_f32_16x16x64_bf16 v[0:3], v[36:39], v[76:83], v109
    v_max3_u32 v117, v117, v35, v36
    v_smfmac_f32_16x16x64_bf16 v[4:7], v[36:39], v[84:91], v109
    v_max3_u32 v117, v117, v37, v38
    s_waitcnt vmcnt(0)
    v_smfmac_f32_16x16x32_bf16 v[0:3], v[40:41], v[100:103], v109
    v_max3_u32 v117, v117, v39, v40
    v_smfmac_f32_16x16x32_bf16 v[4:7], v[40:41], v[104:107], v109
    v_max_u32 v117, v117, v41
    v_cmp_eq_u32 vcc, -1, v117
    s_cbranch_vccnz L_v_pretry_s
    s_nop 2
    v_add_f32 v0, v0, v1
    v_add_f32 v2, v2, v3
    ds_write2_b32 v112, v0, v2 offset0:0 offset1:40
    v_add_f32 v4, v4, v5
    v_add_f32 v6, v6, v7
    ds_write2_b32 v112, v4, v6 offset0:16 offset1:56
    s_mov_b64 exec, 0xffffffff
    s_barrier
    ds_read_b64 v[8:9], v113 offset:0
    ds_read_b64 v[10:11], v113 offset:1280
    ds_read_b64 v[12:13], v113 offset:2560
    ds_read_b64 v[14:15], v113 offset:3840
L_v_red_s:
    s_waitcnt lgkmcnt(2)
    v_pk_add_f32 v[8:9], v[8:9], v[10:11]
    s_waitcnt lgkmcnt(0)
    v_pk_add_f32 v[12:13], v[12:13], v[14:15]
    v_pk_add_f32 v[8:9], v[8:9], v[12:13]
    v_cmp_u_f32 vcc, v8, v9
    v_cvt_pk_bf16_f32 v8, v8, v9
    s_cbranch_vccnz L_v_nan_s
L_v_nanr_s:
    global_store_dword v114, v8, s[40:41] sc1
    v_mov_b32 v10, -1
    v_mov_b32 v11, -1
    s_mov_b32 s46, 8
    ds_write_b64 v113, v[10:11] offset:0
    ds_write_b64 v113, v[10:11] offset:1280
    ds_write_b64 v113, v[10:11] offset:2560
    ds_write_b64 v113, v[10:11] offset:3840
    s_mov_b64 exec, -1
    s_add_u32 s40, s40, 8192
    s_addc_u32 s41, s41, 0
    s_add_u32 s52, s52, 10240
    s_addc_u32 s53, s53, 0
    s_add_u32 s44, s44, 458752
    s_addc_u32 s45, s45, 0
    s_add_u32 s70, s70, 4096
    s_addc_u32 s71, s71, 0
    s_add_u32 s34, s34, 1
    s_cmp_lt_u32 s34, 63
    s_cbranch_scc1 L_v_loop_s
    s_branch L_v_end
L_v_end:
    s_add_u32 s40, s28, 13099008
    s_addc_u32 s41, s29, 0
    s_mov_b64 exec, 0xffffffff
    global_store_dword v114, v8, s[40:41] sc1
    s_mov_b64 exec, -1
    s_endpgm
.p2align 6
L_helper:
    v_mov_b32 v4, 4
L_cw_9:
    s_sub_u32 s35, s35, 1
    s_cbranch_scc1 L_bail
    global_load_dword v5, v4, s[26:27] sc1
    s_waitcnt vmcnt(0)
    v_readfirstlane_b32 s36, v5
    s_and_b32 s37, s36, 0xffff
    s_cmp_lg_u32 s37, 32
    s_cbranch_scc1 L_cw_9
    s_lshr_b32 s33, s36, 16
    v_lshlrev_b32 v1, 4, v0
    s_cmp_lg_u32 s32, 30
    s_cbranch_scc1 L_h_tch
    s_cmp_eq_u32 s31, 1
    s_cbranch_scc1 L_h_rdy
    s_cmp_lg_u32 s31, 0
    s_cbranch_scc1 L_h_tch
    s_add_u32 s40, s28, 13635584
    s_addc_u32 s41, s29, 0
    s_add_u32 s42, s28, 13619200
    s_addc_u32 s43, s29, 0
    s_mov_b32 s34, 1
L_h_cp:
    global_load_dwordx4 v[4:7], v1, s[40:41] offset:-4096 sc1
    global_load_dwordx4 v[8:11], v1, s[40:41] offset:-3072 sc1
    global_load_dwordx4 v[12:15], v1, s[40:41] offset:-2048 sc1
    global_load_dwordx4 v[16:19], v1, s[40:41] offset:-1024 sc1
    global_load_dwordx4 v[20:23], v1, s[40:41] offset:0 sc1
    global_load_dwordx4 v[24:27], v1, s[40:41] offset:1024 sc1
    global_load_dwordx4 v[28:31], v1, s[40:41] offset:2048 sc1
    s_sub_u32 s35, s35, 1
    s_cbranch_scc1 L_bail
    s_waitcnt vmcnt(0)
    v_max3_u32 v2, v4, v5, v6
    v_max3_u32 v2, v2, v7, v8
    v_max3_u32 v2, v2, v9, v10
    v_max3_u32 v2, v2, v11, v12
    v_max3_u32 v2, v2, v13, v14
    v_max3_u32 v2, v2, v15, v16
    v_max3_u32 v2, v2, v17, v18
    v_max3_u32 v2, v2, v19, v20
    v_max3_u32 v2, v2, v21, v22
    v_max3_u32 v2, v2, v23, v24
    v_max3_u32 v2, v2, v25, v26
    v_max3_u32 v2, v2, v27, v28
    v_max3_u32 v2, v2, v29, v30
    v_max_u32 v2, v2, v31
    v_cmp_eq_u32 vcc, -1, v2
    s_cbranch_vccnz L_h_cp
    global_store_dwordx4 v1, v[4:7], s[42:43] offset:-4096 sc1
    global_store_dwordx4 v1, v[8:11], s[42:43] offset:-3072 sc1
    global_store_dwordx4 v1, v[12:15], s[42:43] offset:-2048 sc1
    global_store_dwordx4 v1, v[16:19], s[42:43] offset:-1024 sc1
    global_store_dwordx4 v1, v[20:23], s[42:43] offset:0 sc1
    global_store_dwordx4 v1, v[24:27], s[42:43] offset:1024 sc1
    global_store_dwordx4 v1, v[28:31], s[42:43] offset:2048 sc1
    s_add_u32 s40, s40, 8192
    s_addc_u32 s41, s41, 0
    s_sub_u32 s42, s42, 8192
    s_subb_u32 s43, s43, 0
    s_add_u32 s34, s34, 1
    s_sleep 16
    s_cmp_lt_u32 s34, 63
    s_cbranch_scc1 L_h_cp
    s_endpgm
L_h_rdy:
    s_add_u32 s40, s28, 14802944
    s_addc_u32 s41, s29, 0
    v_lshlrev_b32 v1, 2, v0
    v_add_u32 v2, 256, v1
    v_min_u32 v2, 444, v2
    v_mov_b32 v8, 0
    v_mov_b32 v9, 1
    s_mov_b32 s34, 0
L_h_r0:
    s_and_b32 s36, s34, 3
    s_mul_i32 s36, s36, 448
    s_lshr_b32 s37, s34, 2
    v_add_u32 v3, s36, v1
    v_add_u32 v4, s36, v2
L_h_r1:
    global_load_dword v5, v3, s[40:41] offset:1024 sc1
    global_load_dword v6, v4, s[40:41] offset:1024 sc1
    s_sub_u32 s35, s35, 1
    s_cbranch_scc1 L_bail
    s_waitcnt vmcnt(0)
    v_min_i32 v5, v5, v6
    v_cmp_ge_i32 vcc, s37, v5
    s_cbranch_vccnz L_h_r1
    s_mov_b64 exec, 1
    s_cmp_lg_u32 s33, 0
    s_cbranch_scc1 L_st_10
    global_store_dword v8, v9, s[40:41]
L_st_11:
    s_mov_b64 exec, -1
    v_add_u32 v8, 4, v8
    s_add_u32 s34, s34, 1
    s_cmp_lt_u32 s34, 64
    s_cbranch_scc1 L_h_r0
    s_endpgm
.p2align 6
s_nop 0
s_nop 0
s_nop 0
s_nop 0
L_h_tch:
    s_mov_b32 s34, 0
    v_mov_b32 v6, 14802944
    v_mov_b32 v7, 14802944
    s_cmp_ge_u32 s31, 2
    s_cbranch_scc1 L_h_vx
    s_lshl_b32 s36, s31, 6
    v_add_u32 v2, s36, v0
    v_add_u32 v2, 0, v2
    v_min_u32 v2, 391, v2
    v_lshlrev_b32 v3, 7, v2
    v_add_u32 v16, 14773248, v3
    v_mov_b32 v32, 4096
    v_add_u32 v5, 13592576, v3
    v_mov_b32 v4, 8192
    v_cmp_gt_u32 vcc, 360, v2
    s_nop 1
    v_cndmask_b32 v16, v16, v5, vcc
    v_cndmask_b32 v32, v32, v4, vcc
    v_add_u32 v5, 14118912, v3
    v_mov_b32 v4, 10240
    v_cmp_gt_u32 vcc, 304, v2
    s_nop 1
    v_cndmask_b32 v16, v16, v5, vcc
    v_cndmask_b32 v32, v32, v4, vcc
    v_add_u32 v5, 62914560, v3
    v_mov_b32 v4, 28672
    v_cmp_gt_u32 vcc, 224, v2
    s_nop 1
    v_cndmask_b32 v16, v16, v5, vcc
    v_cndmask_b32 v32, v32, v4, vcc
    v_add_u32 v2, s36, v0
    v_add_u32 v2, 128, v2
    v_min_u32 v2, 391, v2
    v_lshlrev_b32 v3, 7, v2
    v_add_u32 v17, 14773248, v3
    v_mov_b32 v33, 4096
    v_add_u32 v5, 13592576, v3
    v_mov_b32 v4, 8192
    v_cmp_gt_u32 vcc, 360, v2
    s_nop 1
    v_cndmask_b32 v17, v17, v5, vcc
    v_cndmask_b32 v33, v33, v4, vcc
    v_add_u32 v5, 14118912, v3
    v_mov_b32 v4, 10240
    v_cmp_gt_u32 vcc, 304, v2
    s_nop 1
    v_cndmask_b32 v17, v17, v5, vcc
    v_cndmask_b32 v33, v33, v4, vcc
    v_add_u32 v5, 62914560, v3
    v_mov_b32 v4, 28672
    v_cmp_gt_u32 vcc, 224, v2
    s_nop 1
    v_cndmask_b32 v17, v17, v5, vcc
    v_cndmask_b32 v33, v33, v4, vcc
    v_add_u32 v2, s36, v0
    v_add_u32 v2, 256, v2
    v_min_u32 v2, 391, v2
    v_lshlrev_b32 v3, 7, v2
    v_add_u32 v18, 14773248, v3
    v_mov_b32 v34, 4096
    v_add_u32 v5, 13592576, v3
    v_mov_b32 v4, 8192
    v_cmp_gt_u32 vcc, 360, v2
    s_nop 1
    v_cndmask_b32 v18, v18, v5, vcc
    v_cndmask_b32 v34, v34, v4, vcc
    v_add_u32 v5, 14118912, v3
    v_mov_b32 v4, 10240
    v_cmp_gt_u32 vcc, 304, v2
    s_nop 1
    v_cndmask_b32 v18, v18, v5, vcc
    v_cndmask_b32 v34, v34, v4, vcc
    v_add_u32 v5, 62914560, v3
    v_mov_b32 v4, 28672
    v_cmp_gt_u32 vcc, 224, v2
    s_nop 1
    v_cndmask_b32 v18, v18, v5, vcc
    v_cndmask_b32 v34, v34, v4, vcc
    v_add_u32 v2, s36, v0
    v_add_u32 v2, 384, v2
    v_min_u32 v2, 391, v2
    v_lshlrev_b32 v3, 7, v2
    v_add_u32 v19, 14773248, v3
    v_mov_b32 v35, 4096
    v_add_u32 v5, 13592576, v3
    v_mov_b32 v4, 8192
    v_cmp_gt_u32 vcc, 360, v2
    s_nop 1
    v_cndmask_b32 v19, v19, v5, vcc
    v_cndmask_b32 v35, v35, v4, vcc
    v_add_u32 v5, 14118912, v3
    v_mov_b32 v4, 10240
    v_cmp_gt_u32 vcc, 304, v2
    s_nop 1
    v_cndmask_b32 v19, v19, v5, vcc
    v_cndmask_b32 v35, v35, v4, vcc
    v_add_u32 v5, 62914560, v3
    v_mov_b32 v4, 28672
    v_cmp_gt_u32 vcc, 224, v2
    s_nop 1
    v_cndmask_b32 v19, v19, v5, vcc
    v_cndmask_b32 v35, v35, v4, vcc
L_h_t0:
    s_cmp_le_u32 s34, 3
    s_cselect_b32 s38, 0, -1
    global_load_dword v8, v6, s[28:29] sc1
    s_sub_u32 s35, s35, 1
    s_cbranch_scc1 L_bail
    s_waitcnt vmcnt(0)
    v_readfirstlane_b32 s36, v8
    s_and_b32 s36, s36, s38
    s_cmp_eq_u32 s36, -1
    s_cbranch_scc1 L_h_t0
    global_load_dword v10, v16, s[28:29] sc1
    global_load_dword v10, v17, s[28:29] sc1
    global_load_dword v10, v18, s[28:29] sc1
    global_load_dword v10, v19, s[28:29] sc1
    v_add_u32 v16, v16, v32
    v_add_u32 v17, v17, v33
    v_add_u32 v18, v18, v34
    v_add_u32 v19, v19, v35
    v_add_u32 v6, 4096, v6
    v_add_u32 v7, 4, v7
    s_add_u32 s34, s34, 1
    s_cmp_lt_u32 s34, 63
    s_cbranch_scc1 L_h_t0
    s_waitcnt vmcnt(0)
    s_endpgm
L_h_vx:
    s_endpgm
.p2align 6
L_t_retry_f0:
    buffer_load_dwordx4 v[28:31], v104, s[40:43], s56 offen sc1
    buffer_load_dwordx4 v[32:35], v104, s[40:43], s57 offen sc1
    buffer_load_dwordx4 v[36:39], v104, s[40:43], s58 offen sc1
    buffer_load_dwordx4 v[40:43], v104, s[40:43], s59 offen sc1
    s_nop 7
    v_mov_b32 v0, 0
    v_mov_b32 v1, 0
    v_mov_b32 v2, 0
    v_mov_b32 v3, 0
    v_mov_b32 v4, 0
    v_mov_b32 v5, 0
    v_mov_b32 v6, 0
    v_mov_b32 v7, 0
    v_mov_b32 v8, 0
    v_mov_b32 v9, 0
    v_mov_b32 v10, 0
    v_mov_b32 v11, 0
    v_mov_b32 v12, 0
    v_mov_b32 v13, 0
    v_mov_b32 v14, 0
    v_mov_b32 v15, 0
    v_mov_b32 v16, 0
    v_mov_b32 v17, 0
    v_mov_b32 v18, 0
    v_mov_b32 v19, 0
    v_mov_b32 v20, 0
    v_mov_b32 v21, 0
    v_mov_b32 v22, 0
    v_mov_b32 v23, 0
    v_mov_b32 v24, 0
    v_mov_b32 v25, 0
    v_mov_b32 v26, 0
    v_mov_b32 v27, 0
    s_sub_u32 s35, s35, 1
    s_cbranch_scc1 L_bail
    s_branch L_t_shot_f0
.p2align 6
L_t_fix2_f0:
    v_add_u32 v116, s58, v104
    ds_read_b128 v[36:39], v116 offset:16384
    s_waitcnt lgkmcnt(0)
    s_branch L_t_fix2r_f0
.p2align 6
L_t_fix3_f0:
    v_add_u32 v116, s59, v104
    ds_read_b128 v[40:43], v116 offset:16384
    s_waitcnt lgkmcnt(0)
    s_branch L_t_fix3r_f0
.p2align 6
L_t_nan_f0:
    s_sub_u32 s46, s46, 1
    s_cbranch_scc1 L_t_nanr_f0
    s_nop 15
    ds_read_b64 v[0:1], v115 offset:0
    ds_read_b64 v[2:3], v115 offset:1792
    ds_read_b64 v[4:5], v115 offset:3584
    ds_read_b64 v[6:7], v115 offset:5376
    s_branch L_t_red_f0
.p2align 6
L_t_retry_f1:
    buffer_load_dwordx4 v[28:31], v104, s[40:43], s56 offen sc1
    buffer_load_dwordx4 v[32:35], v104, s[40:43], s57 offen sc1
    buffer_load_dwordx4 v[36:39], v104, s[40:43], s58 offen sc1
    buffer_load_dwordx4 v[40:43], v104, s[40:43], s59 offen sc1
    s_nop 7
    v_mov_b32 v0, 0
    v_mov_b32 v1, 0
    v_mov_b32 v2, 0
    v_mov_b32 v3, 0
    v_mov_b32 v4, 0
    v_mov_b32 v5, 0
    v_mov_b32 v6, 0
    v_mov_b32 v7, 0
    v_mov_b32 v8, 0
    v_mov_b32 v9, 0
    v_mov_b32 v10, 0
    v_mov_b32 v11, 0
    v_mov_b32 v12, 0
    v_mov_b32 v13, 0
    v_mov_b32 v14, 0
    v_mov_b32 v15, 0
    v_mov_b32 v16, 0
    v_mov_b32 v17, 0
    v_mov_b32 v18, 0
    v_mov_b32 v19, 0
    v_mov_b32 v20, 0
    v_mov_b32 v21, 0
    v_mov_b32 v22, 0
    v_mov_b32 v23, 0
    v_mov_b32 v24, 0
    v_mov_b32 v25, 0
    v_mov_b32 v26, 0
    v_mov_b32 v27, 0
    s_sub_u32 s35, s35, 1
    s_cbranch_scc1 L_bail
    s_branch L_t_shot_f1
.p2align 6
L_t_fix2_f1:
    v_add_u32 v116, s58, v104
    ds_read_b128 v[36:39], v116 offset:16384
    s_waitcnt lgkmcnt(0)
    s_branch L_t_fix2r_f1
.p2align 6
L_t_fix3_f1:
    v_add_u32 v116, s59, v104
    ds_read_b128 v[40:43], v116 offset:16384
    s_waitcnt lgkmcnt(0)
    s_branch L_t_fix3r_f1
.p2align 6
L_t_nan_f1:
    s_sub_u32 s46, s46, 1
    s_cbranch_scc1 L_t_nanr_f1
    s_nop 15
    ds_read_b64 v[0:1], v115 offset:0
    ds_read_b64 v[2:3], v115 offset:1792
    ds_read_b64 v[4:5], v115 offset:3584
    ds_read_b64 v[6:7], v115 offset:5376
    s_branch L_t_red_f1
.p2align 6
L_t_retry_f2:
    buffer_load_dwordx4 v[28:31], v104, s[40:43], s56 offen sc1
    buffer_load_dwordx4 v[32:35], v104, s[40:43], s57 offen sc1
    buffer_load_dwordx4 v[36:39], v104, s[40:43], s58 offen sc1
    buffer_load_dwordx4 v[40:43], v104, s[40:43], s59 offen sc1
    s_nop 7
    v_mov_b32 v0, 0
    v_mov_b32 v1, 0
    v_mov_b32 v2, 0
    v_mov_b32 v3, 0
    v_mov_b32 v4, 0
    v_mov_b32 v5, 0
    v_mov_b32 v6, 0
    v_mov_b32 v7, 0
    v_mov_b32 v8, 0
    v_mov_b32 v9, 0
    v_mov_b32 v10, 0
    v_mov_b32 v11, 0
    v_mov_b32 v12, 0
    v_mov_b32 v13, 0
    v_mov_b32 v14, 0
    v_mov_b32 v15, 0
    v_mov_b32 v16, 0
    v_mov_b32 v17, 0
    v_mov_b32 v18, 0
    v_mov_b32 v19, 0
    v_mov_b32 v20, 0
    v_mov_b32 v21, 0
    v_mov_b32 v22, 0
    v_mov_b32 v23, 0
    v_mov_b32 v24, 0
    v_mov_b32 v25, 0
    v_mov_b32 v26, 0
    v_mov_b32 v27, 0
    s_sub_u32 s35, s35, 1
    s_cbranch_scc1 L_bail
    s_branch L_t_shot_f2
.p2align 6
L_t_fix2_f2:
    v_add_u32 v116, s58, v104
    ds_read_b128 v[36:39], v116 offset:16384
    s_waitcnt lgkmcnt(0)
    s_branch L_t_fix2r_f2
.p2align 6
L_t_fix3_f2:
    v_add_u32 v116, s59, v104
    ds_read_b128 v[40:43], v116 offset:16384
    s_waitcnt lgkmcnt(0)
    s_branch L_t_fix3r_f2
.p2align 6
L_t_nan_f2:
    s_sub_u32 s46, s46, 1
    s_cbranch_scc1 L_t_nanr_f2
    s_nop 15
    ds_read_b64 v[0:1], v115 offset:0
    ds_read_b64 v[2:3], v115 offset:1792
    ds_read_b64 v[4:5], v115 offset:3584
    ds_read_b64 v[6:7], v115 offset:5376
    s_branch L_t_red_f2
.p2align 6
L_t_retry_f3:
    buffer_load_dwordx4 v[28:31], v104, s[40:43], s56 offen sc1
    buffer_load_dwordx4 v[32:35], v104, s[40:43], s57 offen sc1
    buffer_load_dwordx4 v[36:39], v104, s[40:43], s58 offen sc1
    buffer_load_dwordx4 v[40:43], v104, s[40:43], s59 offen sc1
    s_nop 7
    v_mov_b32 v0, 0
    v_mov_b32 v1, 0
    v_mov_b32 v2, 0
    v_mov_b32 v3, 0
    v_mov_b32 v4, 0
    v_mov_b32 v5, 0
    v_mov_b32 v6, 0
    v_mov_b32 v7, 0
    v_mov_b32 v8, 0
    v_mov_b32 v9, 0
    v_mov_b32 v10, 0
    v_mov_b32 v11, 0
    v_mov_b32 v12, 0
    v_mov_b32 v13, 0
    v_mov_b32 v14, 0
    v_mov_b32 v15, 0
    v_mov_b32 v16, 0
    v_mov_b32 v17, 0
    v_mov_b32 v18, 0
    v_mov_b32 v19, 0
    v_mov_b32 v20, 0
    v_mov_b32 v21, 0
    v_mov_b32 v22, 0
    v_mov_b32 v23, 0
    v_mov_b32 v24, 0
    v_mov_b32 v25, 0
    v_mov_b32 v26, 0
    v_mov_b32 v27, 0
    s_sub_u32 s35, s35, 1
    s_cbranch_scc1 L_bail
    s_branch L_t_shot_f3
.p2align 6
L_t_fix2_f3:
    v_add_u32 v116, s58, v104
    ds_read_b128 v[36:39], v116 offset:16384
    s_waitcnt lgkmcnt(0)
    s_branch L_t_fix2r_f3
.p2align 6
L_t_fix3_f3:
    v_add_u32 v116, s59, v104
    ds_read_b128 v[40:43], v116 offset:16384
    s_waitcnt lgkmcnt(0)
    s_branch L_t_fix3r_f3
.p2align 6
L_t_nan_f3:
    s_sub_u32 s46, s46, 1
    s_cbranch_scc1 L_t_nanr_f3
    s_nop 15
    ds_read_b64 v[0:1], v115 offset:0
    ds_read_b64 v[2:3], v115 offset:1792
    ds_read_b64 v[4:5], v115 offset:3584
    ds_read_b64 v[6:7], v115 offset:5376
    s_branch L_t_red_f3
.p2align 6
L_t_retry_s:
    buffer_load_dwordx4 v[28:31], v104, s[40:43], s56 offen sc1
    buffer_load_dwordx4 v[32:35], v104, s[40:43], s57 offen sc1
    buffer_load_dwordx4 v[36:39], v104, s[40:43], s58 offen sc1
    buffer_load_dwordx4 v[40:43], v104, s[40:43], s59 offen sc1
    s_nop 7
    v_mov_b32 v0, 0
    v_mov_b32 v1, 0
    v_mov_b32 v2, 0
    v_mov_b32 v3, 0
    v_mov_b32 v4, 0
    v_mov_b32 v5, 0
    v_mov_b32 v6, 0
    v_mov_b32 v7, 0
    v_mov_b32 v8, 0
    v_mov_b32 v9, 0
    v_mov_b32 v10, 0
    v_mov_b32 v11, 0
    v_mov_b32 v12, 0
    v_mov_b32 v13, 0
    v_mov_b32 v14, 0
    v_mov_b32 v15, 0
    v_mov_b32 v16, 0
    v_mov_b32 v17, 0
    v_mov_b32 v18, 0
    v_mov_b32 v19, 0
    v_mov_b32 v20, 0
    v_mov_b32 v21, 0
    v_mov_b32 v22, 0
    v_mov_b32 v23, 0
    v_mov_b32 v24, 0
    v_mov_b32 v25, 0
    v_mov_b32 v26, 0
    v_mov_b32 v27, 0
    s_sub_u32 s35, s35, 1
    s_cbranch_scc1 L_bail
    s_branch L_t_shot_s
.p2align 6
L_t_fix2_s:
    v_add_u32 v116, s58, v104
    ds_read_b128 v[36:39], v116 offset:16384
    s_waitcnt lgkmcnt(0)
    s_branch L_t_fix2r_s
.p2align 6
L_t_fix3_s:
    v_add_u32 v116, s59, v104
    ds_read_b128 v[40:43], v116 offset:16384
    s_waitcnt lgkmcnt(0)
    s_branch L_t_fix3r_s
.p2align 6
L_t_nan_s:
    s_sub_u32 s46, s46, 1
    s_cbranch_scc1 L_t_nanr_s
    s_nop 15
    ds_read_b64 v[0:1], v115 offset:0
    ds_read_b64 v[2:3], v115 offset:1792
    ds_read_b64 v[4:5], v115 offset:3584
    ds_read_b64 v[6:7], v115 offset:5376
    s_branch L_t_red_s
.p2align 6
L_v_rdy_f:
    global_load_dword v118, v116, s[28:29] sc1
    s_sub_u32 s35, s35, 1
    s_cbranch_scc1 L_bail
    s_waitcnt vmcnt(0)
    s_branch L_v_loop_f
.p2align 6
L_v_mretry_f:
    buffer_load_dwordx4 v[32:35], v108, s[40:43], s56 offen sc1
    buffer_load_dwordx4 v[36:39], v108, s[40:43], s57 offen sc1
    s_sub_u32 s35, s35, 1
    s_cbranch_scc1 L_bail
    s_branch L_v_mw_f
.p2align 6
L_v_pretry_f:
    global_load_dwordx4 v[32:35], v108, s[52:53] sc1
    global_load_dwordx4 v[36:39], v108, s[52:53] offset:1024 sc1
    global_load_dwordx2 v[40:41], v111, s[52:53] offset:2048 sc1
    s_nop 4
    v_mov_b32 v0, 0
    v_mov_b32 v1, 0
    v_mov_b32 v2, 0
    v_mov_b32 v3, 0
    v_mov_b32 v4, 0
    v_mov_b32 v5, 0
    v_mov_b32 v6, 0
    v_mov_b32 v7, 0
    s_sub_u32 s35, s35, 1
    s_cbranch_scc1 L_bail
    s_branch L_v_pwait_f
.p2align 6
L_v_nan_f:
    v_min_u32 v8, 0xfffffffe, v8
    s_sub_u32 s46, s46, 1
    s_cbranch_scc1 L_v_nanr_f
    s_nop 15
    ds_read_b64 v[8:9], v113 offset:0
    ds_read_b64 v[10:11], v113 offset:1280
    ds_read_b64 v[12:13], v113 offset:2560
    ds_read_b64 v[14:15], v113 offset:3840
    s_branch L_v_red_f
.p2align 6
L_v_rdy_s:
    global_load_dword v118, v116, s[28:29] sc1
    s_sub_u32 s35, s35, 1
    s_cbranch_scc1 L_bail
    s_waitcnt vmcnt(0)
    s_branch L_v_loop_s
.p2align 6
L_v_mretry_s:
    buffer_load_dwordx4 v[32:35], v108, s[40:43], s56 offen sc1
    buffer_load_dwordx4 v[36:39], v108, s[40:43], s57 offen sc1
    s_sub_u32 s35, s35, 1
    s_cbranch_scc1 L_bail
    s_branch L_v_mw_s
.p2align 6
L_v_pretry_s:
    global_load_dwordx4 v[32:35], v108, s[52:53] sc1
    global_load_dwordx4 v[36:39], v108, s[52:53] offset:1024 sc1
    global_load_dwordx2 v[40:41], v111, s[52:53] offset:2048 sc1
    s_nop 4
    v_mov_b32 v0, 0
    v_mov_b32 v1, 0
    v_mov_b32 v2, 0
    v_mov_b32 v3, 0
    v_mov_b32 v4, 0
    v_mov_b32 v5, 0
    v_mov_b32 v6, 0
    v_mov_b32 v7, 0
    s_sub_u32 s35, s35, 1
    s_cbranch_scc1 L_bail
    s_branch L_v_pwait_s
.p2align 6
L_v_nan_s:
    v_min_u32 v8, 0xfffffffe, v8
    s_sub_u32 s46, s46, 1
    s_cbranch_scc1 L_v_nanr_s
    s_nop 15
    ds_read_b64 v[8:9], v113 offset:0
    ds_read_b64 v[10:11], v113 offset:1280
    ds_read_b64 v[12:13], v113 offset:2560
    ds_read_b64 v[14:15], v113 offset:3840
    s_branch L_v_red_s
.p2align 6
L_st_10:
    global_store_dword v8, v9, s[40:41] sc1
    s_branch L_st_11
L_bail:
    s_mov_b64 exec, 1
    v_mov_b32 v0, 8
    v_mov_b32 v1, 1
    global_atomic_add v0, v1, s[26:27]
L_end:
    s_endpgm
L_worker:
    s_sub_u32 s40, s32, 32
    s_cmp_ge_u32 s40, 220
    s_cbranch_scc1 L_end
    s_cmp_ge_u32 s40, 144
    s_cbranch_scc1 L_po
    v_mov_b32 v245, v0
    v_lshlrev_b32 v240, 4, v0
    v_mov_b32 v249, 0
    v_add_u32 v241, 8192, v240
    v_add_u32 v242, 16384, v240
    v_add_u32 v243, 24576, v240
    v_add_u32 v244, 32768, v240
    s_cmp_ge_u32 s40, 112
    s_cbranch_scc1 L_partb
    s_and_b32 s48, s40, 15
    s_lshr_b32 s49, s40, 4
    s_lshl_b32 s36, s49, 6
    s_lshl_b32 s37, s48, 1
    s_add_u32 s36, s36, s37
    s_lshl_b32 s38, s49, 2
    v_bfe_u32 v246, v245, 1, 1
    v_mul_u32_u24 v246, 3, v246
    v_add_u32 v246, s38, v246
    v_mul_u32_u24 v246, 37, v246
    v_lshrrev_b32 v248, 8, v246
    s_mul_i32 s38, s48, 1024
    s_mov_b32 s54, s36
    v_mov_b32 v247, s38
    v_add_u32 v247, 15220736, v247
    v_bfe_u32 v246, v245, 0, 1
    v_lshl_add_u32 v247, v246, 7, v247
    v_lshl_add_u32 v247, v248, 8, v247
    v_mov_b32 v4, s87
    v_mov_b32 v5, 0
    s_waitcnt vmcnt(0)

    s_mov_b64 exec, 1
    global_store_dword v4, v5, s[28:29] sc1
    s_mov_b64 exec, -1
    s_cmp_lg_u32 s31, 0
    s_cbranch_scc1 L_wd_12e
L_wd_12:
    s_sleep 16
    global_load_dwordx4 v[12:15], v247, s[28:29] sc1
    s_sub_u32 s35, s35, 1
    s_cbranch_scc1 L_bail
    s_waitcnt vmcnt(0)
L_wd_12c:
    v_or3_b32 v12, v12, v13, v14
    v_or_b32 v12, v12, v15
    v_cmp_ne_u32 vcc, 0, v12
    s_cbranch_vccnz L_wd_12
    v_lshlrev_b32 v4, 4, v0
    v_add_u32 v4, 15237120, v4
L_wd_12i:
    global_load_dwordx4 v[6:9], v4, s[28:29] sc1
    s_sub_u32 s35, s35, 1
    s_cbranch_scc1 L_bail
    s_waitcnt vmcnt(0)
    v_or3_b32 v6, v6, v7, v8
    v_or_b32 v6, v6, v9
    v_cmp_ne_u32 vcc, 0, v6
    s_cbranch_vccnz L_wd_12i
L_wd_12e:
    s_barrier
    s_mov_b32 s36, s54
    s_mul_i32 s37, s36, 14336
    s_add_u32 s37, s37, 6557696
    s_add_u32 s50, s28, s37
    s_addc_u32 s51, s29, 0
    s_add_u32 s52, s50, 458752
    s_addc_u32 s53, s51, 0
    global_load_dwordx4 a[0:3], v240, s[50:51] offset:-4096
    global_load_dwordx4 a[4:7], v240, s[50:51] offset:-3072
    global_load_dwordx4 a[8:11], v240, s[50:51] offset:-2048
    global_load_dwordx4 a[12:15], v240, s[50:51] offset:-1024
    global_load_dwordx4 a[16:19], v240, s[50:51] offset:0
    global_load_dwordx4 a[20:23], v240, s[50:51] offset:1024
    global_load_dwordx4 a[24:27], v240, s[50:51] offset:2048
    global_load_dwordx4 a[28:31], v240, s[50:51] offset:3072
    global_load_dwordx4 a[32:35], v241, s[50:51] offset:-4096
    global_load_dwordx4 a[36:39], v241, s[50:51] offset:-3072
    global_load_dwordx4 a[40:43], v241, s[50:51] offset:-2048
    global_load_dwordx4 a[44:47], v241, s[50:51] offset:-1024
    global_load_dwordx4 a[48:51], v241, s[50:51] offset:0
    global_load_dwordx4 a[52:55], v241, s[50:51] offset:1024
    global_load_dwordx4 a[56:59], v241, s[50:51] offset:2048
    global_load_dwordx4 a[60:63], v241, s[50:51] offset:3072
    global_load_dwordx4 a[64:67], v242, s[50:51] offset:-4096
    global_load_dwordx4 a[68:71], v242, s[50:51] offset:-3072
    global_load_dwordx4 a[72:75], v242, s[50:51] offset:-2048
    global_load_dwordx4 a[76:79], v242, s[50:51] offset:-1024
    global_load_dwordx4 a[80:83], v242, s[50:51] offset:0
    global_load_dwordx4 a[84:87], v242, s[50:51] offset:1024
    global_load_dwordx4 a[88:91], v242, s[50:51] offset:2048
    global_load_dwordx4 a[92:95], v242, s[50:51] offset:3072
    global_load_dwordx4 a[96:99], v243, s[50:51] offset:-4096
    global_load_dwordx4 a[100:103], v243, s[50:51] offset:-3072
    global_load_dwordx4 a[104:107], v243, s[50:51] offset:-2048
    global_load_dwordx4 a[108:111], v243, s[50:51] offset:-1024
    global_load_dwordx4 a[112:115], v240, s[52:53] offset:-4096
    global_load_dwordx4 a[116:119], v240, s[52:53] offset:-3072
    global_load_dwordx4 a[120:123], v240, s[52:53] offset:-2048
    global_load_dwordx4 a[124:127], v240, s[52:53] offset:-1024
    global_load_dwordx4 a[128:131], v240, s[52:53] offset:0
    global_load_dwordx4 a[132:135], v240, s[52:53] offset:1024
    global_load_dwordx4 a[136:139], v240, s[52:53] offset:2048
    global_load_dwordx4 a[140:143], v240, s[52:53] offset:3072
    global_load_dwordx4 a[144:147], v241, s[52:53] offset:-4096
    global_load_dwordx4 a[148:151], v241, s[52:53] offset:-3072
    global_load_dwordx4 a[152:155], v241, s[52:53] offset:-2048
    global_load_dwordx4 a[156:159], v241, s[52:53] offset:-1024
    global_load_dwordx4 a[160:163], v241, s[52:53] offset:0
    global_load_dwordx4 a[164:167], v241, s[52:53] offset:1024
    global_load_dwordx4 a[168:171], v241, s[52:53] offset:2048
    global_load_dwordx4 a[172:175], v241, s[52:53] offset:3072
    global_load_dwordx4 a[176:179], v242, s[52:53] offset:-4096
    global_load_dwordx4 a[180:183], v242, s[52:53] offset:-3072
    global_load_dwordx4 a[184:187], v242, s[52:53] offset:-2048
    global_load_dwordx4 a[188:191], v242, s[52:53] offset:-1024
    global_load_dwordx4 a[192:195], v242, s[52:53] offset:0
    global_load_dwordx4 a[196:199], v242, s[52:53] offset:1024
    global_load_dwordx4 a[200:203], v242, s[52:53] offset:2048
    global_load_dwordx4 a[204:207], v242, s[52:53] offset:3072
    global_load_dwordx4 a[208:211], v243, s[52:53] offset:-4096
    global_load_dwordx4 a[212:215], v243, s[52:53] offset:-3072
    global_load_dwordx4 a[216:219], v243, s[52:53] offset:-2048
    global_load_dwordx4 a[220:223], v243, s[52:53] offset:-1024
    s_mul_i32 s37, s31, 28672
    s_add_u32 s37, s37, 15732736
    s_add_u32 s42, s28, s37
    s_addc_u32 s43, s29, 0
    s_lshl_b32 s38, s36, 10
    s_mul_i32 s37, s31, 458752
    s_add_u32 s38, s38, s37
    s_mul_i32 s37, s38, 1
    s_add_u32 s37, s37, 33554432
    s_add_u32 s46, s28, s37
    s_addc_u32 s47, s29, 0
    s_mul_i32 s38, s31, 112
    s_add_u32 s38, s38, s40
    s_mul_i32 s37, s38, 4
    s_add_u32 s37, s37, 14803968
    s_add_u32 s44, s28, s37
    s_addc_u32 s45, s29, 0
    s_waitcnt vmcnt(24)
    global_load_dwordx4 v[0:3], v240, s[42:43] offset:-4096
    global_load_dwordx4 v[56:59], v241, s[42:43] offset:2048
    global_load_dwordx4 v[4:7], v240, s[42:43] offset:-3072
    global_load_dwordx4 v[60:63], v241, s[42:43] offset:3072
    global_load_dwordx4 v[8:11], v240, s[42:43] offset:-2048
    global_load_dwordx4 v[64:67], v242, s[42:43] offset:-4096
    global_load_dwordx4 v[12:15], v240, s[42:43] offset:-1024
    global_load_dwordx4 v[68:71], v242, s[42:43] offset:-3072
    global_load_dwordx4 v[16:19], v240, s[42:43] offset:0
    global_load_dwordx4 v[72:75], v242, s[42:43] offset:-2048
    global_load_dwordx4 v[20:23], v240, s[42:43] offset:1024
    global_load_dwordx4 v[76:79], v242, s[42:43] offset:-1024
    global_load_dwordx4 v[24:27], v240, s[42:43] offset:2048
    global_load_dwordx4 v[80:83], v242, s[42:43] offset:0
    global_load_dwordx4 v[28:31], v240, s[42:43] offset:3072
    global_load_dword v250, v240, s[42:43]
    global_load_dwordx4 v[84:87], v242, s[42:43] offset:1024
    global_load_dwordx4 v[32:35], v241, s[42:43] offset:-4096
    global_load_dwordx4 v[88:91], v242, s[42:43] offset:2048
    global_load_dwordx4 v[36:39], v241, s[42:43] offset:-3072
    global_load_dwordx4 v[92:95], v242, s[42:43] offset:3072
    global_load_dwordx4 v[40:43], v241, s[42:43] offset:-2048
    global_load_dwordx4 v[96:99], v243, s[42:43] offset:-4096
    global_load_dwordx4 v[44:47], v241, s[42:43] offset:-1024
    global_load_dwordx4 v[100:103], v243, s[42:43] offset:-3072
    global_load_dwordx4 v[48:51], v241, s[42:43] offset:0
    global_load_dwordx4 v[104:107], v243, s[42:43] offset:-2048
    global_load_dwordx4 v[52:55], v241, s[42:43] offset:1024
    global_load_dwordx4 v[108:111], v243, s[42:43] offset:-1024
    global_load_dword v250, v240, s[42:43]
    global_load_dword v250, v240, s[42:43]
    global_load_dword v250, v240, s[42:43]
    global_load_dword v250, v240, s[42:43]
    s_add_u32 s42, s42, 114688
    s_addc_u32 s43, s43, 0
    s_mov_b32 s41, 0
L_vx:
    s_waitcnt vmcnt(32)
    v_mfma_f32_16x16x32_bf16 v[128:131], v[0:3], a[0:3], 0
    v_mfma_f32_16x16x32_bf16 v[132:135], v[0:3], a[56:59], 0
    v_mfma_f32_16x16x32_bf16 v[136:139], v[0:3], a[112:115], 0
    v_mfma_f32_16x16x32_bf16 v[140:143], v[0:3], a[168:171], 0
    global_load_dwordx4 v[0:3], v240, s[42:43] offset:-4096
    s_waitcnt vmcnt(32)
    v_mfma_f32_16x16x32_bf16 v[144:147], v[56:59], a[0:3], 0
    v_mfma_f32_16x16x32_bf16 v[148:151], v[56:59], a[56:59], 0
    v_mfma_f32_16x16x32_bf16 v[152:155], v[56:59], a[112:115], 0
    v_mfma_f32_16x16x32_bf16 v[156:159], v[56:59], a[168:171], 0
    global_load_dwordx4 v[56:59], v241, s[42:43] offset:2048
    s_waitcnt vmcnt(32)
    v_mfma_f32_16x16x32_bf16 v[128:131], v[4:7], a[4:7], v[128:131]
    v_mfma_f32_16x16x32_bf16 v[132:135], v[4:7], a[60:63], v[132:135]
    v_mfma_f32_16x16x32_bf16 v[136:139], v[4:7], a[116:119], v[136:139]
    v_mfma_f32_16x16x32_bf16 v[140:143], v[4:7], a[172:175], v[140:143]
    global_load_dwordx4 v[4:7], v240, s[42:43] offset:-3072
    s_waitcnt vmcnt(32)
    v_mfma_f32_16x16x32_bf16 v[144:147], v[60:63], a[4:7], v[144:147]
    v_mfma_f32_16x16x32_bf16 v[148:151], v[60:63], a[60:63], v[148:151]
    v_mfma_f32_16x16x32_bf16 v[152:155], v[60:63], a[116:119], v[152:155]
    v_mfma_f32_16x16x32_bf16 v[156:159], v[60:63], a[172:175], v[156:159]
    global_load_dwordx4 v[60:63], v241, s[42:43] offset:3072
    s_waitcnt vmcnt(32)
    v_mfma_f32_16x16x32_bf16 v[128:131], v[8:11], a[8:11], v[128:131]
    v_mfma_f32_16x16x32_bf16 v[132:135], v[8:11], a[64:67], v[132:135]
    v_mfma_f32_16x16x32_bf16 v[136:139], v[8:11], a[120:123], v[136:139]
    v_mfma_f32_16x16x32_bf16 v[140:143], v[8:11], a[176:179], v[140:143]
    global_load_dwordx4 v[8:11], v240, s[42:43] offset:-2048
    s_waitcnt vmcnt(32)
    v_mfma_f32_16x16x32_bf16 v[144:147], v[64:67], a[8:11], v[144:147]
    v_mfma_f32_16x16x32_bf16 v[148:151], v[64:67], a[64:67], v[148:151]
    v_mfma_f32_16x16x32_bf16 v[152:155], v[64:67], a[120:123], v[152:155]
    v_mfma_f32_16x16x32_bf16 v[156:159], v[64:67], a[176:179], v[156:159]
    global_load_dwordx4 v[64:67], v242, s[42:43] offset:-4096
    s_waitcnt vmcnt(32)
    v_mfma_f32_16x16x32_bf16 v[128:131], v[12:15], a[12:15], v[128:131]
    v_mfma_f32_16x16x32_bf16 v[132:135], v[12:15], a[68:71], v[132:135]
    v_mfma_f32_16x16x32_bf16 v[136:139], v[12:15], a[124:127], v[136:139]
    v_mfma_f32_16x16x32_bf16 v[140:143], v[12:15], a[180:183], v[140:143]
    global_load_dwordx4 v[12:15], v240, s[42:43] offset:-1024
    s_waitcnt vmcnt(32)
    v_mfma_f32_16x16x32_bf16 v[144:147], v[68:71], a[12:15], v[144:147]
    v_mfma_f32_16x16x32_bf16 v[148:151], v[68:71], a[68:71], v[148:151]
    v_mfma_f32_16x16x32_bf16 v[152:155], v[68:71], a[124:127], v[152:155]
    v_mfma_f32_16x16x32_bf16 v[156:159], v[68:71], a[180:183], v[156:159]
    global_load_dwordx4 v[68:71], v242, s[42:43] offset:-3072
    s_waitcnt vmcnt(32)
    v_mfma_f32_16x16x32_bf16 v[128:131], v[16:19], a[16:19], v[128:131]
    v_mfma_f32_16x16x32_bf16 v[132:135], v[16:19], a[72:75], v[132:135]
    v_mfma_f32_16x16x32_bf16 v[136:139], v[16:19], a[128:131], v[136:139]
    v_mfma_f32_16x16x32_bf16 v[140:143], v[16:19], a[184:187], v[140:143]
    global_load_dwordx4 v[16:19], v240, s[42:43] offset:0
    s_waitcnt vmcnt(32)
    v_mfma_f32_16x16x32_bf16 v[144:147], v[72:75], a[16:19], v[144:147]
    v_mfma_f32_16x16x32_bf16 v[148:151], v[72:75], a[72:75], v[148:151]
    v_mfma_f32_16x16x32_bf16 v[152:155], v[72:75], a[128:131], v[152:155]
    v_mfma_f32_16x16x32_bf16 v[156:159], v[72:75], a[184:187], v[156:159]
    global_load_dwordx4 v[72:75], v242, s[42:43] offset:-2048
    s_waitcnt vmcnt(32)
    v_mfma_f32_16x16x32_bf16 v[128:131], v[20:23], a[20:23], v[128:131]
    v_mfma_f32_16x16x32_bf16 v[132:135], v[20:23], a[76:79], v[132:135]
    v_mfma_f32_16x16x32_bf16 v[136:139], v[20:23], a[132:135], v[136:139]
    v_mfma_f32_16x16x32_bf16 v[140:143], v[20:23], a[188:191], v[140:143]
    global_load_dwordx4 v[20:23], v240, s[42:43] offset:1024
    s_waitcnt vmcnt(32)
    v_mfma_f32_16x16x32_bf16 v[144:147], v[76:79], a[20:23], v[144:147]
    v_mfma_f32_16x16x32_bf16 v[148:151], v[76:79], a[76:79], v[148:151]
    v_mfma_f32_16x16x32_bf16 v[152:155], v[76:79], a[132:135], v[152:155]
    v_mfma_f32_16x16x32_bf16 v[156:159], v[76:79], a[188:191], v[156:159]
    global_load_dwordx4 v[76:79], v242, s[42:43] offset:-1024
    s_waitcnt vmcnt(32)
    v_mfma_f32_16x16x32_bf16 v[128:131], v[24:27], a[24:27], v[128:131]
    v_mfma_f32_16x16x32_bf16 v[132:135], v[24:27], a[80:83], v[132:135]
    v_mfma_f32_16x16x32_bf16 v[136:139], v[24:27], a[136:139], v[136:139]
    v_mfma_f32_16x16x32_bf16 v[140:143], v[24:27], a[192:195], v[140:143]
    global_load_dwordx4 v[24:27], v240, s[42:43] offset:2048
    s_waitcnt vmcnt(32)
    v_mfma_f32_16x16x32_bf16 v[144:147], v[80:83], a[24:27], v[144:147]
    v_mfma_f32_16x16x32_bf16 v[148:151], v[80:83], a[80:83], v[148:151]
    v_mfma_f32_16x16x32_bf16 v[152:155], v[80:83], a[136:139], v[152:155]
    v_mfma_f32_16x16x32_bf16 v[156:159], v[80:83], a[192:195], v[156:159]
    global_load_dwordx4 v[80:83], v242, s[42:43] offset:0
    s_waitcnt vmcnt(32)
    v_mfma_f32_16x16x32_bf16 v[128:131], v[28:31], a[28:31], v[128:131]
    v_mfma_f32_16x16x32_bf16 v[132:135], v[28:31], a[84:87], v[132:135]
    v_mfma_f32_16x16x32_bf16 v[136:139], v[28:31], a[140:143], v[136:139]
    v_mfma_f32_16x16x32_bf16 v[140:143], v[28:31], a[196:199], v[140:143]
    global_load_dwordx4 v[28:31], v240, s[42:43] offset:3072
    s_waitcnt vmcnt(15)
    v_mov_b32 v246, s41
    s_mov_b64 exec, 1
    global_store_dword v249, v246, s[44:45] sc1
    s_mov_b64 exec, -1
    v_mfma_f32_16x16x32_bf16 v[144:147], v[84:87], a[28:31], v[144:147]
    v_mfma_f32_16x16x32_bf16 v[148:151], v[84:87], a[84:87], v[148:151]
    v_mfma_f32_16x16x32_bf16 v[152:155], v[84:87], a[140:143], v[152:155]
    v_mfma_f32_16x16x32_bf16 v[156:159], v[84:87], a[196:199], v[156:159]
    global_load_dwordx4 v[84:87], v242, s[42:43] offset:1024
    v_mfma_f32_16x16x32_bf16 v[128:131], v[32:35], a[32:35], v[128:131]
    v_mfma_f32_16x16x32_bf16 v[132:135], v[32:35], a[88:91], v[132:135]
    v_mfma_f32_16x16x32_bf16 v[136:139], v[32:35], a[144:147], v[136:139]
    v_mfma_f32_16x16x32_bf16 v[140:143], v[32:35], a[200:203], v[140:143]
    global_load_dwordx4 v[32:35], v241, s[42:43] offset:-4096
    v_mfma_f32_16x16x32_bf16 v[144:147], v[88:91], a[32:35], v[144:147]
    v_mfma_f32_16x16x32_bf16 v[148:151], v[88:91], a[88:91], v[148:151]
    v_mfma_f32_16x16x32_bf16 v[152:155], v[88:91], a[144:147], v[152:155]
    v_mfma_f32_16x16x32_bf16 v[156:159], v[88:91], a[200:203], v[156:159]
    global_load_dwordx4 v[88:91], v242, s[42:43] offset:2048
    v_mfma_f32_16x16x32_bf16 v[128:131], v[36:39], a[36:39], v[128:131]
    v_mfma_f32_16x16x32_bf16 v[132:135], v[36:39], a[92:95], v[132:135]
    v_mfma_f32_16x16x32_bf16 v[136:139], v[36:39], a[148:151], v[136:139]
    v_mfma_f32_16x16x32_bf16 v[140:143], v[36:39], a[204:207], v[140:143]
    global_load_dwordx4 v[36:39], v241, s[42:43] offset:-3072
    v_mfma_f32_16x16x32_bf16 v[144:147], v[92:95], a[36:39], v[144:147]
    v_mfma_f32_16x16x32_bf16 v[148:151], v[92:95], a[92:95], v[148:151]
    v_mfma_f32_16x16x32_bf16 v[152:155], v[92:95], a[148:151], v[152:155]
    v_mfma_f32_16x16x32_bf16 v[156:159], v[92:95], a[204:207], v[156:159]
    global_load_dwordx4 v[92:95], v242, s[42:43] offset:3072
    v_mfma_f32_16x16x32_bf16 v[128:131], v[40:43], a[40:43], v[128:131]
    v_mfma_f32_16x16x32_bf16 v[132:135], v[40:43], a[96:99], v[132:135]
    v_mfma_f32_16x16x32_bf16 v[136:139], v[40:43], a[152:155], v[136:139]
    v_mfma_f32_16x16x32_bf16 v[140:143], v[40:43], a[208:211], v[140:143]
    global_load_dwordx4 v[40:43], v241, s[42:43] offset:-2048
    v_mfma_f32_16x16x32_bf16 v[144:147], v[96:99], a[40:43], v[144:147]
    v_mfma_f32_16x16x32_bf16 v[148:151], v[96:99], a[96:99], v[148:151]
    v_mfma_f32_16x16x32_bf16 v[152:155], v[96:99], a[152:155], v[152:155]
    v_mfma_f32_16x16x32_bf16 v[156:159], v[96:99], a[208:211], v[156:159]
    global_load_dwordx4 v[96:99], v243, s[42:43] offset:-4096
    v_mfma_f32_16x16x32_bf16 v[128:131], v[44:47], a[44:47], v[128:131]
    v_mfma_f32_16x16x32_bf16 v[132:135], v[44:47], a[100:103], v[132:135]
    v_mfma_f32_16x16x32_bf16 v[136:139], v[44:47], a[156:159], v[136:139]
    v_mfma_f32_16x16x32_bf16 v[140:143], v[44:47], a[212:215], v[140:143]
    global_load_dwordx4 v[44:47], v241, s[42:43] offset:-1024
    v_mfma_f32_16x16x32_bf16 v[144:147], v[100:103], a[44:47], v[144:147]
    v_mfma_f32_16x16x32_bf16 v[148:151], v[100:103], a[100:103], v[148:151]
    v_mfma_f32_16x16x32_bf16 v[152:155], v[100:103], a[156:159], v[152:155]
    v_mfma_f32_16x16x32_bf16 v[156:159], v[100:103], a[212:215], v[156:159]
    global_load_dwordx4 v[100:103], v243, s[42:43] offset:-3072
    v_mfma_f32_16x16x32_bf16 v[128:131], v[48:51], a[48:51], v[128:131]
    v_mfma_f32_16x16x32_bf16 v[132:135], v[48:51], a[104:107], v[132:135]
    v_mfma_f32_16x16x32_bf16 v[136:139], v[48:51], a[160:163], v[136:139]
    v_mfma_f32_16x16x32_bf16 v[140:143], v[48:51], a[216:219], v[140:143]
    global_load_dwordx4 v[48:51], v241, s[42:43] offset:0
    v_mfma_f32_16x16x32_bf16 v[144:147], v[104:107], a[48:51], v[144:147]
    v_mfma_f32_16x16x32_bf16 v[148:151], v[104:107], a[104:107], v[148:151]
    v_mfma_f32_16x16x32_bf16 v[152:155], v[104:107], a[160:163], v[152:155]
    v_mfma_f32_16x16x32_bf16 v[156:159], v[104:107], a[216:219], v[156:159]
    global_load_dwordx4 v[104:107], v243, s[42:43] offset:-2048
    v_mfma_f32_16x16x32_bf16 v[128:131], v[52:55], a[52:55], v[128:131]
    v_mfma_f32_16x16x32_bf16 v[132:135], v[52:55], a[108:111], v[132:135]
    v_mfma_f32_16x16x32_bf16 v[136:139], v[52:55], a[164:167], v[136:139]
    v_mfma_f32_16x16x32_bf16 v[140:143], v[52:55], a[220:223], v[140:143]
    global_load_dwordx4 v[52:55], v241, s[42:43] offset:1024
    v_mfma_f32_16x16x32_bf16 v[144:147], v[108:111], a[52:55], v[144:147]
    v_mfma_f32_16x16x32_bf16 v[148:151], v[108:111], a[108:111], v[148:151]
    v_mfma_f32_16x16x32_bf16 v[152:155], v[108:111], a[164:167], v[152:155]
    v_mfma_f32_16x16x32_bf16 v[156:159], v[108:111], a[220:223], v[156:159]
    global_load_dwordx4 v[108:111], v243, s[42:43] offset:-1024
    s_nop 7
    v_cvt_pk_bf16_f32 v128, v128, v129
    v_cvt_pk_bf16_f32 v129, v130, v131
    v_cvt_pk_bf16_f32 v130, v144, v145
    v_cvt_pk_bf16_f32 v131, v146, v147
    global_store_dwordx4 v240, v[128:131], s[46:47] offset:0 sc1
    v_cvt_pk_bf16_f32 v132, v132, v133
    v_cvt_pk_bf16_f32 v133, v134, v135
    v_cvt_pk_bf16_f32 v134, v148, v149
    v_cvt_pk_bf16_f32 v135, v150, v151
    global_store_dwordx4 v240, v[132:135], s[46:47] offset:1024 sc1
    v_cvt_pk_bf16_f32 v136, v136, v137
    v_cvt_pk_bf16_f32 v137, v138, v139
    v_cvt_pk_bf16_f32 v138, v152, v153
    v_cvt_pk_bf16_f32 v139, v154, v155
    global_store_dwordx4 v244, v[136:139], s[46:47] offset:0 sc1
    v_cvt_pk_bf16_f32 v140, v140, v141
    v_cvt_pk_bf16_f32 v141, v142, v143
    v_cvt_pk_bf16_f32 v142, v156, v157
    v_cvt_pk_bf16_f32 v143, v158, v159
    global_store_dwordx4 v244, v[140:143], s[46:47] offset:1024 sc1
    s_add_u32 s46, s46, 1835008
    s_addc_u32 s47, s47, 0
    s_add_u32 s41, s41, 1
    s_cmp_lt_u32 s41, 15
    s_cselect_b32 s36, 114688, 0
    s_add_u32 s42, s42, s36
    s_addc_u32 s43, s43, 0
    s_cmp_lt_u32 s41, 16
    s_cbranch_scc1 L_vx
    s_waitcnt vmcnt(0)
    v_mov_b32 v246, 16
    s_mov_b64 exec, 1
    global_store_dword v249, v246, s[44:45] sc1
    s_mov_b64 exec, -1
    s_lshr_b32 s37, s31, 1
    s_lshl_b32 s37, s37, 5
    s_and_b32 s38, s31, 1
    s_add_u32 s37, s37, s38
    s_mul_i32 s37, s37, 14336
    s_add_u32 s50, s50, s37
    s_addc_u32 s51, s51, 0
    global_load_dwordx4 v[0:3], v240, s[50:51] offset:-4096
    global_load_dwordx4 v[4:7], v240, s[50:51] offset:-3072
    global_load_dwordx4 v[8:11], v240, s[50:51] offset:-2048
    global_load_dwordx4 v[12:15], v240, s[50:51] offset:-1024
    global_load_dwordx4 v[16:19], v240, s[50:51] offset:0
    global_load_dwordx4 v[20:23], v240, s[50:51] offset:1024
    global_load_dwordx4 v[24:27], v240, s[50:51] offset:2048
    global_load_dwordx4 v[28:31], v240, s[50:51] offset:3072
    global_load_dwordx4 v[32:35], v241, s[50:51] offset:-4096
    global_load_dwordx4 v[36:39], v241, s[50:51] offset:-3072
    global_load_dwordx4 v[40:43], v241, s[50:51] offset:-2048
    global_load_dwordx4 v[44:47], v241, s[50:51] offset:-1024
    global_load_dwordx4 v[48:51], v241, s[50:51] offset:0
    global_load_dwordx4 v[52:55], v241, s[50:51] offset:1024
    v_and_b32 v246, 1, v245
    v_cmp_eq_u32 vcc, 1, v246
    v_mov_b32 v88, 0x44444444
    v_mov_b32 v246, 0xeeeeeeee
    v_cndmask_b32 v88, v88, v246, vcc
    s_lshl_b32 s36, s49, 1
    s_lshr_b32 s37, s31, 1
    s_add_u32 s36, s36, s37
    s_lshl_b32 s36, s36, 13
    s_lshr_b32 s37, s48, 2
    s_lshl_b32 s37, s37, 11
    s_add_u32 s36, s36, s37
    s_and_b32 s37, s31, 1
    s_lshl_b32 s37, s37, 10
    s_add_u32 s36, s36, s37
    s_and_b32 s37, s48, 3
    s_lshl_b32 s37, s37, 2
    s_add_u32 s36, s36, s37
    s_mul_i32 s37, s36, 1
    s_add_u32 s37, s37, 26214400
    s_add_u32 s46, s28, s37
    s_addc_u32 s47, s29, 0
    s_lshl_b32 s36, s49, 2
    s_add_u32 s36, s36, s31
    s_lshl_b32 s36, s36, 4
    s_add_u32 s36, s36, s48
    s_mul_i32 s37, s36, 4
    s_add_u32 s37, s37, 14807040
    s_add_u32 s44, s28, s37
    s_addc_u32 s45, s29, 0
    s_add_u32 s42, s28, 13627392
    s_addc_u32 s43, s29, 0
    s_mov_b32 s41, 0
    v_mov_b32 v247, -1
    s_add_u32 s50, s46, 7110656
    s_addc_u32 s51, s47, 0
    global_store_dword v240, v247, s[50:51] sc1
    s_add_u32 s50, s46, 7225344
    s_addc_u32 s51, s47, 0
    global_store_dword v240, v247, s[50:51] sc1
L_vm:
    global_load_dwordx4 v[56:59], v240, s[42:43] offset:-4096 sc1
    global_load_dwordx4 v[60:63], v240, s[42:43] offset:-3072 sc1
    global_load_dwordx4 v[64:67], v240, s[42:43] offset:-2048 sc1
    global_load_dwordx4 v[68:71], v240, s[42:43] offset:-1024 sc1
    global_load_dwordx4 v[72:75], v240, s[42:43] offset:0 sc1
    global_load_dwordx4 v[76:79], v240, s[42:43] offset:1024 sc1
    global_load_dwordx4 v[80:83], v240, s[42:43] offset:2048 sc1
    s_waitcnt vmcnt(7)
    v_mov_b32 v246, s41
    s_mov_b64 exec, 1
    global_store_dword v249, v246, s[44:45] sc1
    s_mov_b64 exec, -1
    v_mov_b32 v84, 0
    v_mov_b32 v85, 0
    v_mov_b32 v86, 0
    v_mov_b32 v87, 0
    s_waitcnt vmcnt(1)
L_vm_chk:
    v_max3_u32 v246, v56, v57, v58
    v_max3_u32 v246, v246, v59, v60
    v_max3_u32 v246, v246, v61, v62
    v_max3_u32 v246, v246, v63, v64
    v_max3_u32 v246, v246, v65, v66
    v_max3_u32 v246, v246, v67, v68
    v_max3_u32 v246, v246, v69, v70
    v_max3_u32 v246, v246, v71, v72
    v_max3_u32 v246, v246, v73, v74
    v_max3_u32 v246, v246, v75, v76
    v_max3_u32 v246, v246, v77, v78
    v_max3_u32 v246, v246, v79, v80
    v_max3_u32 v246, v246, v81, v82
    v_max_u32 v246, v246, v83
    v_cmp_eq_u32 vcc, -1, v246
    s_cbranch_vccz L_vm_go
    s_sleep 2
    global_load_dwordx4 v[56:59], v240, s[42:43] offset:-4096 sc1
    global_load_dwordx4 v[60:63], v240, s[42:43] offset:-3072 sc1
    global_load_dwordx4 v[64:67], v240, s[42:43] offset:-2048 sc1
    global_load_dwordx4 v[68:71], v240, s[42:43] offset:-1024 sc1
    global_load_dwordx4 v[72:75], v240, s[42:43] offset:0 sc1
    global_load_dwordx4 v[76:79], v240, s[42:43] offset:1024 sc1
    global_load_dwordx4 v[80:83], v240, s[42:43] offset:2048 sc1
    s_sub_u32 s35, s35, 1
    s_cbranch_scc1 L_bail
    s_waitcnt vmcnt(0)
    s_branch L_vm_chk
L_vm_go:
    v_smfmac_f32_16x16x64_bf16 v[84:87], v[56:59], v[0:7], v88
    v_smfmac_f32_16x16x64_bf16 v[84:87], v[60:63], v[8:15], v88
    v_smfmac_f32_16x16x64_bf16 v[84:87], v[64:67], v[16:23], v88
    v_smfmac_f32_16x16x64_bf16 v[84:87], v[68:71], v[24:31], v88
    v_smfmac_f32_16x16x64_bf16 v[84:87], v[72:75], v[32:39], v88
    v_smfmac_f32_16x16x64_bf16 v[84:87], v[76:79], v[40:47], v88
    v_smfmac_f32_16x16x64_bf16 v[84:87], v[80:83], v[48:55], v88
    s_sub_u32 s42, s42, 8192
    s_subb_u32 s43, s43, 0
    s_add_u32 s41, s41, 1
    s_nop 5
    v_add_f32 v84, v84, v85
    v_add_f32 v86, v86, v87
    v_cvt_pk_bf16_f32 v247, v84, v86
    v_min_u32 v247, 0xfffffffe, v247
    global_store_dword v240, v247, s[46:47] sc1
    s_add_u32 s46, s46, 114688
    s_addc_u32 s47, s47, 0
    s_cmp_lt_u32 s41, 64
    s_cbranch_scc1 L_vm
    s_waitcnt vmcnt(0)
    v_mov_b32 v246, 64
    s_mov_b64 exec, 1
    global_store_dword v249, v246, s[44:45] sc1
    s_mov_b64 exec, -1
    s_endpgm
L_partb:
    s_sub_u32 s48, s40, 112
    s_lshr_b32 s39, s48, 1
    s_mul_i32 s39, s39, 56
    s_add_u32 s39, s39, 896
    s_lshl_b32 s36, s31, 2
    s_mul_i32 s37, s36, 2688
    v_mov_b32 v247, s39
    v_bfe_u32 v246, v245, 3, 1
    v_mul_u32_u24 v246, 896, v246
    v_add_u32 v247, v246, v247
    v_bfe_u32 v246, v245, 2, 1
    v_lshl_add_u32 v247, v246, 5, v247
    v_bfe_u32 v246, v245, 0, 2
    v_lshl_add_u32 v247, v246, 3, v247
    v_min_u32 v247, 2680, v247
    v_mov_b32 v248, s37
    v_bfe_u32 v246, v245, 4, 2
    v_mul_u32_u24 v246, 2688, v246
    v_add_u32 v248, v246, v248
    v_add_u32 v247, v247, v248
    s_mul_i32 s37, s36, 144
    v_mov_b32 v248, s37
    v_bfe_u32 v246, v245, 4, 2
    v_mul_u32_u24 v246, 144, v246
    v_add_u32 v248, v246, v248
    v_bfe_u32 v246, v245, 0, 4
    v_lshl_add_u32 v248, v246, 3, v248
    s_add_u32 s50, s20, 0
    s_addc_u32 s51, s21, 0
    global_load_dwordx2 v[0:1], v247, s[50:51]
    s_add_u32 s50, s50, 43008
    s_addc_u32 s51, s51, 0
    global_load_dwordx2 v[2:3], v247, s[50:51]
    s_add_u32 s50, s50, 43008
    s_addc_u32 s51, s51, 0
    global_load_dwordx2 v[4:5], v247, s[50:51]
    s_add_u32 s50, s50, 43008
    s_addc_u32 s51, s51, 0
    global_load_dwordx2 v[6:7], v247, s[50:51]
    s_add_u32 s50, s50, 43008
    s_addc_u32 s51, s51, 0
    global_load_dwordx2 v[8:9], v247, s[50:51]
    s_add_u32 s50, s50, 43008
    s_addc_u32 s51, s51, 0
    global_load_dwordx2 v[10:11], v247, s[50:51]
    s_add_u32 s50, s50, 43008
    s_addc_u32 s51, s51, 0
    global_load_dwordx2 v[12:13], v247, s[50:51]
    s_add_u32 s50, s50, 43008
    s_addc_u32 s51, s51, 0
    global_load_dwordx2 v[14:15], v247, s[50:51]
    s_add_u32 s50, s50, 43008
    s_addc_u32 s51, s51, 0
    global_load_dwordx2 v[16:17], v247, s[50:51]
    s_add_u32 s50, s50, 43008
    s_addc_u32 s51, s51, 0
    global_load_dwordx2 v[18:19], v247, s[50:51]
    s_add_u32 s50, s50, 43008
    s_addc_u32 s51, s51, 0
    global_load_dwordx2 v[20:21], v247, s[50:51]
    s_add_u32 s50, s50, 43008
    s_addc_u32 s51, s51, 0
    global_load_dwordx2 v[22:23], v247, s[50:51]
    s_add_u32 s50, s50, 43008
    s_addc_u32 s51, s51, 0
    global_load_dwordx2 v[24:25], v247, s[50:51]
    s_add_u32 s50, s50, 43008
    s_addc_u32 s51, s51, 0
    global_load_dwordx2 v[26:27], v247, s[50:51]
    s_add_u32 s50, s50, 43008
    s_addc_u32 s51, s51, 0
    global_load_dwordx2 v[28:29], v247, s[50:51]
    s_add_u32 s50, s50, 43008
    s_addc_u32 s51, s51, 0
    global_load_dwordx2 v[30:31], v247, s[50:51]
    s_add_u32 s50, s50, 43008
    s_addc_u32 s51, s51, 0
    global_load_dwordx2 v[32:33], v247, s[50:51]
    s_add_u32 s50, s50, 43008
    s_addc_u32 s51, s51, 0
    global_load_dwordx2 v[34:35], v247, s[50:51]
    s_add_u32 s50, s50, 43008
    s_addc_u32 s51, s51, 0
    global_load_dwordx2 v[36:37], v247, s[50:51]
    s_add_u32 s50, s50, 43008
    s_addc_u32 s51, s51, 0
    global_load_dwordx2 v[38:39], v247, s[50:51]
    s_add_u32 s50, s50, 43008
    s_addc_u32 s51, s51, 0
    global_load_dwordx2 v[40:41], v247, s[50:51]
    s_add_u32 s50, s50, 43008
    s_addc_u32 s51, s51, 0
    global_load_dwordx2 v[42:43], v247, s[50:51]
    s_add_u32 s50, s50, 43008
    s_addc_u32 s51, s51, 0
    global_load_dwordx2 v[44:45], v247, s[50:51]
    s_add_u32 s50, s50, 43008
    s_addc_u32 s51, s51, 0
    global_load_dwordx2 v[46:47], v247, s[50:51]
    s_add_u32 s50, s50, 43008
    s_addc_u32 s51, s51, 0
    global_load_dwordx2 v[48:49], v247, s[50:51]
    s_add_u32 s50, s50, 43008
    s_addc_u32 s51, s51, 0
    global_load_dwordx2 v[50:51], v247, s[50:51]
    s_add_u32 s50, s50, 43008
    s_addc_u32 s51, s51, 0
    global_load_dwordx2 v[52:53], v247, s[50:51]
    s_add_u32 s50, s50, 43008
    s_addc_u32 s51, s51, 0
    global_load_dwordx2 v[54:55], v247, s[50:51]
    s_barrier
    s_waitcnt vmcnt(27)
    ds_write_b64 v248, v[0:1] offset:0
    s_waitcnt vmcnt(26)
    ds_write_b64 v248, v[2:3] offset:2304
    s_waitcnt vmcnt(25)
    ds_write_b64 v248, v[4:5] offset:4608
    s_waitcnt vmcnt(24)
    ds_write_b64 v248, v[6:7] offset:6912
    s_waitcnt vmcnt(23)
    ds_write_b64 v248, v[8:9] offset:9216
    s_waitcnt vmcnt(22)
    ds_write_b64 v248, v[10:11] offset:11520
    s_waitcnt vmcnt(21)
    ds_write_b64 v248, v[12:13] offset:13824
    s_waitcnt vmcnt(20)
    ds_write_b64 v248, v[14:15] offset:16128
    s_waitcnt vmcnt(19)
    ds_write_b64 v248, v[16:17] offset:18432
    s_waitcnt vmcnt(18)
    ds_write_b64 v248, v[18:19] offset:20736
    s_waitcnt vmcnt(17)
    ds_write_b64 v248, v[20:21] offset:23040
    s_waitcnt vmcnt(16)
    ds_write_b64 v248, v[22:23] offset:25344
    s_waitcnt vmcnt(15)
    ds_write_b64 v248, v[24:25] offset:27648
    s_waitcnt vmcnt(14)
    ds_write_b64 v248, v[26:27] offset:29952
    s_waitcnt vmcnt(13)
    ds_write_b64 v248, v[28:29] offset:32256
    s_waitcnt vmcnt(12)
    ds_write_b64 v248, v[30:31] offset:34560
    s_waitcnt vmcnt(11)
    ds_write_b64 v248, v[32:33] offset:36864
    s_waitcnt vmcnt(10)
    ds_write_b64 v248, v[34:35] offset:39168
    s_waitcnt vmcnt(9)
    ds_write_b64 v248, v[36:37] offset:41472
    s_waitcnt vmcnt(8)
    ds_write_b64 v248, v[38:39] offset:43776
    s_waitcnt vmcnt(7)
    ds_write_b64 v248, v[40:41] offset:46080
    s_waitcnt vmcnt(6)
    ds_write_b64 v248, v[42:43] offset:48384
    s_waitcnt vmcnt(5)
    ds_write_b64 v248, v[44:45] offset:50688
    s_waitcnt vmcnt(4)
    ds_write_b64 v248, v[46:47] offset:52992
    s_waitcnt vmcnt(3)
    ds_write_b64 v248, v[48:49] offset:55296
    s_waitcnt vmcnt(2)
    ds_write_b64 v248, v[50:51] offset:57600
    s_waitcnt vmcnt(1)
    ds_write_b64 v248, v[52:53] offset:59904
    s_waitcnt vmcnt(0)
    ds_write_b64 v248, v[54:55] offset:62208
    ds_write_b64 v248, v[54:55] offset:64512
    v_mov_b32 v247, 0
    v_bfe_u32 v246, v245, 4, 2
    v_mul_u32_u24 v246, 1152, v246
    v_add_u32 v247, v246, v247
    v_bfe_u32 v246, v245, 2, 2
    v_mul_u32_u24 v246, 144, v246
    v_add_u32 v247, v246, v247
    v_bfe_u32 v246, v245, 0, 2
    v_lshl_add_u32 v247, v246, 3, v247
    s_waitcnt lgkmcnt(0)
    s_barrier
    ds_read_b64_tr_b16 a[0:1], v247 offset:0
    ds_read_b64_tr_b16 a[2:3], v247 offset:576
    ds_read_b64_tr_b16 a[4:5], v247 offset:4608
    ds_read_b64_tr_b16 a[6:7], v247 offset:5184
    ds_read_b64_tr_b16 a[8:9], v247 offset:9216
    ds_read_b64_tr_b16 a[10:11], v247 offset:9792
    ds_read_b64_tr_b16 a[12:13], v247 offset:13824
    ds_read_b64_tr_b16 a[14:15], v247 offset:14400
    s_waitcnt lgkmcnt(8)
    ds_read_b64_tr_b16 a[16:17], v247 offset:18432
    ds_read_b64_tr_b16 a[18:19], v247 offset:19008
    ds_read_b64_tr_b16 a[20:21], v247 offset:23040
    ds_read_b64_tr_b16 a[22:23], v247 offset:23616
    ds_read_b64_tr_b16 a[24:25], v247 offset:27648
    ds_read_b64_tr_b16 a[26:27], v247 offset:28224
    ds_read_b64_tr_b16 a[28:29], v247 offset:32256
    ds_read_b64_tr_b16 a[30:31], v247 offset:32832
    s_waitcnt lgkmcnt(8)
    ds_read_b64_tr_b16 a[32:33], v247 offset:36864
    ds_read_b64_tr_b16 a[34:35], v247 offset:37440
    ds_read_b64_tr_b16 a[36:37], v247 offset:41472
    ds_read_b64_tr_b16 a[38:39], v247 offset:42048
    ds_read_b64_tr_b16 a[40:41], v247 offset:46080
    ds_read_b64_tr_b16 a[42:43], v247 offset:46656
    ds_read_b64_tr_b16 a[44:45], v247 offset:50688
    ds_read_b64_tr_b16 a[46:47], v247 offset:51264
    s_waitcnt lgkmcnt(8)
    ds_read_b64_tr_b16 a[48:49], v247 offset:55296
    ds_read_b64_tr_b16 a[50:51], v247 offset:55872
    ds_read_b64_tr_b16 a[52:53], v247 offset:59904
    ds_read_b64_tr_b16 a[54:55], v247 offset:60480
    ds_read_b64_tr_b16 a[56:57], v247 offset:32
    ds_read_b64_tr_b16 a[58:59], v247 offset:608
    ds_read_b64_tr_b16 a[60:61], v247 offset:4640
    ds_read_b64_tr_b16 a[62:63], v247 offset:5216
    s_waitcnt lgkmcnt(8)
    ds_read_b64_tr_b16 a[64:65], v247 offset:9248
    ds_read_b64_tr_b16 a[66:67], v247 offset:9824
    ds_read_b64_tr_b16 a[68:69], v247 offset:13856
    ds_read_b64_tr_b16 a[70:71], v247 offset:14432
    ds_read_b64_tr_b16 a[72:73], v247 offset:18464
    ds_read_b64_tr_b16 a[74:75], v247 offset:19040
    ds_read_b64_tr_b16 a[76:77], v247 offset:23072
    ds_read_b64_tr_b16 a[78:79], v247 offset:23648
    s_waitcnt lgkmcnt(8)
    ds_read_b64_tr_b16 a[80:81], v247 offset:27680
    ds_read_b64_tr_b16 a[82:83], v247 offset:28256
    ds_read_b64_tr_b16 a[84:85], v247 offset:32288
    ds_read_b64_tr_b16 a[86:87], v247 offset:32864
    ds_read_b64_tr_b16 a[88:89], v247 offset:36896
    ds_read_b64_tr_b16 a[90:91], v247 offset:37472
    ds_read_b64_tr_b16 a[92:93], v247 offset:41504
    ds_read_b64_tr_b16 a[94:95], v247 offset:42080
    s_waitcnt lgkmcnt(8)
    ds_read_b64_tr_b16 a[96:97], v247 offset:46112
    ds_read_b64_tr_b16 a[98:99], v247 offset:46688
    ds_read_b64_tr_b16 a[100:101], v247 offset:50720
    ds_read_b64_tr_b16 a[102:103], v247 offset:51296
    ds_read_b64_tr_b16 a[104:105], v247 offset:55328
    ds_read_b64_tr_b16 a[106:107], v247 offset:55904
    ds_read_b64_tr_b16 a[108:109], v247 offset:59936
    ds_read_b64_tr_b16 a[110:111], v247 offset:60512
    s_waitcnt lgkmcnt(8)
    ds_read_b64_tr_b16 a[112:113], v247 offset:64
    ds_read_b64_tr_b16 a[114:115], v247 offset:640
    ds_read_b64_tr_b16 a[116:117], v247 offset:4672
    ds_read_b64_tr_b16 a[118:119], v247 offset:5248
    ds_read_b64_tr_b16 a[120:121], v247 offset:9280
    ds_read_b64_tr_b16 a[122:123], v247 offset:9856
    ds_read_b64_tr_b16 a[124:125], v247 offset:13888
    ds_read_b64_tr_b16 a[126:127], v247 offset:14464
    s_waitcnt lgkmcnt(8)
    ds_read_b64_tr_b16 a[128:129], v247 offset:18496
    ds_read_b64_tr_b16 a[130:131], v247 offset:19072
    ds_read_b64_tr_b16 a[132:133], v247 offset:23104
    ds_read_b64_tr_b16 a[134:135], v247 offset:23680
    ds_read_b64_tr_b16 a[136:137], v247 offset:27712
    ds_read_b64_tr_b16 a[138:139], v247 offset:28288
    ds_read_b64_tr_b16 a[140:141], v247 offset:32320
    ds_read_b64_tr_b16 a[142:143], v247 offset:32896
    s_waitcnt lgkmcnt(8)
    ds_read_b64_tr_b16 a[144:145], v247 offset:36928
    ds_read_b64_tr_b16 a[146:147], v247 offset:37504
    ds_read_b64_tr_b16 a[148:149], v247 offset:41536
    ds_read_b64_tr_b16 a[150:151], v247 offset:42112
    ds_read_b64_tr_b16 a[152:153], v247 offset:46144
    ds_read_b64_tr_b16 a[154:155], v247 offset:46720
    ds_read_b64_tr_b16 a[156:157], v247 offset:50752
    ds_read_b64_tr_b16 a[158:159], v247 offset:51328
    s_waitcnt lgkmcnt(8)
    ds_read_b64_tr_b16 a[160:161], v247 offset:55360
    ds_read_b64_tr_b16 a[162:163], v247 offset:55936
    ds_read_b64_tr_b16 a[164:165], v247 offset:59968
    ds_read_b64_tr_b16 a[166:167], v247 offset:60544
    ds_read_b64_tr_b16 a[168:169], v247 offset:96
    ds_read_b64_tr_b16 a[170:171], v247 offset:672
    ds_read_b64_tr_b16 a[172:173], v247 offset:4704
    ds_read_b64_tr_b16 a[174:175], v247 offset:5280
    s_waitcnt lgkmcnt(8)
    ds_read_b64_tr_b16 a[176:177], v247 offset:9312
    ds_read_b64_tr_b16 a[178:179], v247 offset:9888
    ds_read_b64_tr_b16 a[180:181], v247 offset:13920
    ds_read_b64_tr_b16 a[182:183], v247 offset:14496
    ds_read_b64_tr_b16 a[184:185], v247 offset:18528
    ds_read_b64_tr_b16 a[186:187], v247 offset:19104
    ds_read_b64_tr_b16 a[188:189], v247 offset:23136
    ds_read_b64_tr_b16 a[190:191], v247 offset:23712
    s_waitcnt lgkmcnt(8)
    ds_read_b64_tr_b16 a[192:193], v247 offset:27744
    ds_read_b64_tr_b16 a[194:195], v247 offset:28320
    ds_read_b64_tr_b16 a[196:197], v247 offset:32352
    ds_read_b64_tr_b16 a[198:199], v247 offset:32928
    ds_read_b64_tr_b16 a[200:201], v247 offset:36960
    ds_read_b64_tr_b16 a[202:203], v247 offset:37536
    ds_read_b64_tr_b16 a[204:205], v247 offset:41568
    ds_read_b64_tr_b16 a[206:207], v247 offset:42144
    s_waitcnt lgkmcnt(8)
    ds_read_b64_tr_b16 a[208:209], v247 offset:46176
    ds_read_b64_tr_b16 a[210:211], v247 offset:46752
    ds_read_b64_tr_b16 a[212:213], v247 offset:50784
    ds_read_b64_tr_b16 a[214:215], v247 offset:51360
    ds_read_b64_tr_b16 a[216:217], v247 offset:55392
    ds_read_b64_tr_b16 a[218:219], v247 offset:55968
    ds_read_b64_tr_b16 a[220:221], v247 offset:60000
    ds_read_b64_tr_b16 a[222:223], v247 offset:60576
    s_waitcnt lgkmcnt(8)
    s_waitcnt lgkmcnt(0)
    s_and_b32 s36, s48, 1
    s_lshl_b32 s36, s36, 5
    s_add_u32 s36, s36, s31
    s_mul_i32 s37, s36, 28672
    s_add_u32 s37, s37, 17829888
    s_add_u32 s42, s28, s37
    s_addc_u32 s43, s29, 0
    v_mov_b32 v160, 0
    v_mov_b32 v161, 0
    v_mov_b32 v162, 0
    v_mov_b32 v163, 0
    v_mov_b32 v164, 0
    v_mov_b32 v165, 0
    v_mov_b32 v166, 0
    v_mov_b32 v167, 0
    v_mov_b32 v168, 0
    v_mov_b32 v169, 0
    v_mov_b32 v170, 0
    v_mov_b32 v171, 0
    v_mov_b32 v172, 0
    v_mov_b32 v173, 0
    v_mov_b32 v174, 0
    v_mov_b32 v175, 0
    v_mov_b32 v176, 0
    v_mov_b32 v177, 0
    v_mov_b32 v178, 0
    v_mov_b32 v179, 0
    v_mov_b32 v180, 0
    v_mov_b32 v181, 0
    v_mov_b32 v182, 0
    v_mov_b32 v183, 0
    v_mov_b32 v184, 0x3f803f80
    v_mov_b32 v185, 0x3f803f80
    v_mov_b32 v186, 0x3f803f80
    v_mov_b32 v187, 0x3f803f80
    global_load_dwordx4 v[0:3], v240, s[42:43] offset:-4096
    global_load_dwordx4 v[56:59], v241, s[42:43] offset:2048
    global_load_dwordx4 v[4:7], v240, s[42:43] offset:-3072
    global_load_dwordx4 v[60:63], v241, s[42:43] offset:3072
    global_load_dwordx4 v[8:11], v240, s[42:43] offset:-2048
    global_load_dwordx4 v[64:67], v242, s[42:43] offset:-4096
    global_load_dwordx4 v[12:15], v240, s[42:43] offset:-1024
    global_load_dwordx4 v[68:71], v242, s[42:43] offset:-3072
    global_load_dwordx4 v[16:19], v240, s[42:43] offset:0
    global_load_dwordx4 v[72:75], v242, s[42:43] offset:-2048
    global_load_dwordx4 v[20:23], v240, s[42:43] offset:1024
    global_load_dwordx4 v[76:79], v242, s[42:43] offset:-1024
    global_load_dwordx4 v[24:27], v240, s[42:43] offset:2048
    global_load_dwordx4 v[80:83], v242, s[42:43] offset:0
    global_load_dwordx4 v[28:31], v240, s[42:43] offset:3072
    global_load_dwordx4 v[84:87], v242, s[42:43] offset:1024
    global_load_dwordx4 v[32:35], v241, s[42:43] offset:-4096
    global_load_dwordx4 v[88:91], v242, s[42:43] offset:2048
    global_load_dwordx4 v[36:39], v241, s[42:43] offset:-3072
    global_load_dwordx4 v[92:95], v242, s[42:43] offset:3072
    global_load_dwordx4 v[40:43], v241, s[42:43] offset:-2048
    global_load_dwordx4 v[96:99], v243, s[42:43] offset:-4096
    global_load_dwordx4 v[44:47], v241, s[42:43] offset:-1024
    global_load_dwordx4 v[100:103], v243, s[42:43] offset:-3072
    global_load_dwordx4 v[48:51], v241, s[42:43] offset:0
    global_load_dwordx4 v[104:107], v243, s[42:43] offset:-2048
    global_load_dwordx4 v[52:55], v241, s[42:43] offset:1024
    global_load_dwordx4 v[108:111], v243, s[42:43] offset:-1024
    s_add_u32 s42, s42, 114688
    s_addc_u32 s43, s43, 0
    s_mov_b32 s41, 0
L_b1:
    s_waitcnt vmcnt(27)
    v_mfma_f32_16x16x32_bf16 v[128:131], v[0:3], a[0:3], 0
    v_mfma_f32_16x16x32_bf16 v[132:135], v[0:3], a[56:59], 0
    v_mfma_f32_16x16x32_bf16 v[136:139], v[0:3], a[112:115], 0
    v_mfma_f32_16x16x32_bf16 v[140:143], v[0:3], a[168:171], 0
    global_load_dwordx4 v[0:3], v240, s[42:43] offset:-4096
    s_waitcnt vmcnt(27)
    v_mfma_f32_16x16x32_bf16 v[144:147], v[56:59], a[0:3], 0
    v_mfma_f32_16x16x32_bf16 v[148:151], v[56:59], a[56:59], 0
    v_mfma_f32_16x16x32_bf16 v[152:155], v[56:59], a[112:115], 0
    v_mfma_f32_16x16x32_bf16 v[156:159], v[56:59], a[168:171], 0
    global_load_dwordx4 v[56:59], v241, s[42:43] offset:2048
    s_waitcnt vmcnt(27)
    v_mfma_f32_16x16x32_bf16 v[128:131], v[4:7], a[4:7], v[128:131]
    v_mfma_f32_16x16x32_bf16 v[132:135], v[4:7], a[60:63], v[132:135]
    v_mfma_f32_16x16x32_bf16 v[136:139], v[4:7], a[116:119], v[136:139]
    v_mfma_f32_16x16x32_bf16 v[140:143], v[4:7], a[172:175], v[140:143]
    global_load_dwordx4 v[4:7], v240, s[42:43] offset:-3072
    s_waitcnt vmcnt(27)
    v_mfma_f32_16x16x32_bf16 v[144:147], v[60:63], a[4:7], v[144:147]
    v_mfma_f32_16x16x32_bf16 v[148:151], v[60:63], a[60:63], v[148:151]
    v_mfma_f32_16x16x32_bf16 v[152:155], v[60:63], a[116:119], v[152:155]
    v_mfma_f32_16x16x32_bf16 v[156:159], v[60:63], a[172:175], v[156:159]
    global_load_dwordx4 v[60:63], v241, s[42:43] offset:3072
    s_waitcnt vmcnt(27)
    v_mfma_f32_16x16x32_bf16 v[128:131], v[8:11], a[8:11], v[128:131]
    v_mfma_f32_16x16x32_bf16 v[132:135], v[8:11], a[64:67], v[132:135]
    v_mfma_f32_16x16x32_bf16 v[136:139], v[8:11], a[120:123], v[136:139]
    v_mfma_f32_16x16x32_bf16 v[140:143], v[8:11], a[176:179], v[140:143]
    global_load_dwordx4 v[8:11], v240, s[42:43] offset:-2048
    s_waitcnt vmcnt(27)
    v_mfma_f32_16x16x32_bf16 v[144:147], v[64:67], a[8:11], v[144:147]
    v_mfma_f32_16x16x32_bf16 v[148:151], v[64:67], a[64:67], v[148:151]
    v_mfma_f32_16x16x32_bf16 v[152:155], v[64:67], a[120:123], v[152:155]
    v_mfma_f32_16x16x32_bf16 v[156:159], v[64:67], a[176:179], v[156:159]
    global_load_dwordx4 v[64:67], v242, s[42:43] offset:-4096
    s_waitcnt vmcnt(27)
    v_mfma_f32_16x16x32_bf16 v[128:131], v[12:15], a[12:15], v[128:131]
    v_mfma_f32_16x16x32_bf16 v[132:135], v[12:15], a[68:71], v[132:135]
    v_mfma_f32_16x16x32_bf16 v[136:139], v[12:15], a[124:127], v[136:139]
    v_mfma_f32_16x16x32_bf16 v[140:143], v[12:15], a[180:183], v[140:143]
    global_load_dwordx4 v[12:15], v240, s[42:43] offset:-1024
    s_waitcnt vmcnt(27)
    v_mfma_f32_16x16x32_bf16 v[144:147], v[68:71], a[12:15], v[144:147]
    v_mfma_f32_16x16x32_bf16 v[148:151], v[68:71], a[68:71], v[148:151]
    v_mfma_f32_16x16x32_bf16 v[152:155], v[68:71], a[124:127], v[152:155]
    v_mfma_f32_16x16x32_bf16 v[156:159], v[68:71], a[180:183], v[156:159]
    global_load_dwordx4 v[68:71], v242, s[42:43] offset:-3072
    s_waitcnt vmcnt(27)
    v_mfma_f32_16x16x32_bf16 v[128:131], v[16:19], a[16:19], v[128:131]
    v_mfma_f32_16x16x32_bf16 v[132:135], v[16:19], a[72:75], v[132:135]
    v_mfma_f32_16x16x32_bf16 v[136:139], v[16:19], a[128:131], v[136:139]
    v_mfma_f32_16x16x32_bf16 v[140:143], v[16:19], a[184:187], v[140:143]
    global_load_dwordx4 v[16:19], v240, s[42:43] offset:0
    s_waitcnt vmcnt(27)
    v_mfma_f32_16x16x32_bf16 v[144:147], v[72:75], a[16:19], v[144:147]
    v_mfma_f32_16x16x32_bf16 v[148:151], v[72:75], a[72:75], v[148:151]
    v_mfma_f32_16x16x32_bf16 v[152:155], v[72:75], a[128:131], v[152:155]
    v_mfma_f32_16x16x32_bf16 v[156:159], v[72:75], a[184:187], v[156:159]
    global_load_dwordx4 v[72:75], v242, s[42:43] offset:-2048
    s_waitcnt vmcnt(27)
    v_mfma_f32_16x16x32_bf16 v[128:131], v[20:23], a[20:23], v[128:131]
    v_mfma_f32_16x16x32_bf16 v[132:135], v[20:23], a[76:79], v[132:135]
    v_mfma_f32_16x16x32_bf16 v[136:139], v[20:23], a[132:135], v[136:139]
    v_mfma_f32_16x16x32_bf16 v[140:143], v[20:23], a[188:191], v[140:143]
    global_load_dwordx4 v[20:23], v240, s[42:43] offset:1024
    s_waitcnt vmcnt(27)
    v_mfma_f32_16x16x32_bf16 v[144:147], v[76:79], a[20:23], v[144:147]
    v_mfma_f32_16x16x32_bf16 v[148:151], v[76:79], a[76:79], v[148:151]
    v_mfma_f32_16x16x32_bf16 v[152:155], v[76:79], a[132:135], v[152:155]
    v_mfma_f32_16x16x32_bf16 v[156:159], v[76:79], a[188:191], v[156:159]
    global_load_dwordx4 v[76:79], v242, s[42:43] offset:-1024
    s_waitcnt vmcnt(27)
    v_mfma_f32_16x16x32_bf16 v[128:131], v[24:27], a[24:27], v[128:131]
    v_mfma_f32_16x16x32_bf16 v[132:135], v[24:27], a[80:83], v[132:135]
    v_mfma_f32_16x16x32_bf16 v[136:139], v[24:27], a[136:139], v[136:139]
    v_mfma_f32_16x16x32_bf16 v[140:143], v[24:27], a[192:195], v[140:143]
    global_load_dwordx4 v[24:27], v240, s[42:43] offset:2048
    s_waitcnt vmcnt(27)
    v_mfma_f32_16x16x32_bf16 v[144:147], v[80:83], a[24:27], v[144:147]
    v_mfma_f32_16x16x32_bf16 v[148:151], v[80:83], a[80:83], v[148:151]
    v_mfma_f32_16x16x32_bf16 v[152:155], v[80:83], a[136:139], v[152:155]
    v_mfma_f32_16x16x32_bf16 v[156:159], v[80:83], a[192:195], v[156:159]
    global_load_dwordx4 v[80:83], v242, s[42:43] offset:0
    s_waitcnt vmcnt(27)
    v_mfma_f32_16x16x32_bf16 v[128:131], v[28:31], a[28:31], v[128:131]
    v_mfma_f32_16x16x32_bf16 v[132:135], v[28:31], a[84:87], v[132:135]
    v_mfma_f32_16x16x32_bf16 v[136:139], v[28:31], a[140:143], v[136:139]
    v_mfma_f32_16x16x32_bf16 v[140:143], v[28:31], a[196:199], v[140:143]
    global_load_dwordx4 v[28:31], v240, s[42:43] offset:3072
    s_waitcnt vmcnt(27)
    v_mfma_f32_16x16x32_bf16 v[144:147], v[84:87], a[28:31], v[144:147]
    v_mfma_f32_16x16x32_bf16 v[148:151], v[84:87], a[84:87], v[148:151]
    v_mfma_f32_16x16x32_bf16 v[152:155], v[84:87], a[140:143], v[152:155]
    v_mfma_f32_16x16x32_bf16 v[156:159], v[84:87], a[196:199], v[156:159]
    global_load_dwordx4 v[84:87], v242, s[42:43] offset:1024
    s_waitcnt vmcnt(27)
    v_mfma_f32_16x16x32_bf16 v[128:131], v[32:35], a[32:35], v[128:131]
    v_mfma_f32_16x16x32_bf16 v[132:135], v[32:35], a[88:91], v[132:135]
    v_mfma_f32_16x16x32_bf16 v[136:139], v[32:35], a[144:147], v[136:139]
    v_mfma_f32_16x16x32_bf16 v[140:143], v[32:35], a[200:203], v[140:143]
    global_load_dwordx4 v[32:35], v241, s[42:43] offset:-4096
    s_waitcnt vmcnt(27)
    v_mfma_f32_16x16x32_bf16 v[144:147], v[88:91], a[32:35], v[144:147]
    v_mfma_f32_16x16x32_bf16 v[148:151], v[88:91], a[88:91], v[148:151]
    v_mfma_f32_16x16x32_bf16 v[152:155], v[88:91], a[144:147], v[152:155]
    v_mfma_f32_16x16x32_bf16 v[156:159], v[88:91], a[200:203], v[156:159]
    global_load_dwordx4 v[88:91], v242, s[42:43] offset:2048
    s_waitcnt vmcnt(27)
    v_mfma_f32_16x16x32_bf16 v[128:131], v[36:39], a[36:39], v[128:131]
    v_mfma_f32_16x16x32_bf16 v[132:135], v[36:39], a[92:95], v[132:135]
    v_mfma_f32_16x16x32_bf16 v[136:139], v[36:39], a[148:151], v[136:139]
    v_mfma_f32_16x16x32_bf16 v[140:143], v[36:39], a[204:207], v[140:143]
    global_load_dwordx4 v[36:39], v241, s[42:43] offset:-3072
    s_waitcnt vmcnt(27)
    v_mfma_f32_16x16x32_bf16 v[144:147], v[92:95], a[36:39], v[144:147]
    v_mfma_f32_16x16x32_bf16 v[148:151], v[92:95], a[92:95], v[148:151]
    v_mfma_f32_16x16x32_bf16 v[152:155], v[92:95], a[148:151], v[152:155]
    v_mfma_f32_16x16x32_bf16 v[156:159], v[92:95], a[204:207], v[156:159]
    global_load_dwordx4 v[92:95], v242, s[42:43] offset:3072
    s_waitcnt vmcnt(27)
    v_mfma_f32_16x16x32_bf16 v[128:131], v[40:43], a[40:43], v[128:131]
    v_mfma_f32_16x16x32_bf16 v[132:135], v[40:43], a[96:99], v[132:135]
    v_mfma_f32_16x16x32_bf16 v[136:139], v[40:43], a[152:155], v[136:139]
    v_mfma_f32_16x16x32_bf16 v[140:143], v[40:43], a[208:211], v[140:143]
    global_load_dwordx4 v[40:43], v241, s[42:43] offset:-2048
    s_waitcnt vmcnt(27)
    v_mfma_f32_16x16x32_bf16 v[144:147], v[96:99], a[40:43], v[144:147]
    v_mfma_f32_16x16x32_bf16 v[148:151], v[96:99], a[96:99], v[148:151]
    v_mfma_f32_16x16x32_bf16 v[152:155], v[96:99], a[152:155], v[152:155]
    v_mfma_f32_16x16x32_bf16 v[156:159], v[96:99], a[208:211], v[156:159]
    global_load_dwordx4 v[96:99], v243, s[42:43] offset:-4096
    s_waitcnt vmcnt(27)
    v_mfma_f32_16x16x32_bf16 v[128:131], v[44:47], a[44:47], v[128:131]
    v_mfma_f32_16x16x32_bf16 v[132:135], v[44:47], a[100:103], v[132:135]
    v_mfma_f32_16x16x32_bf16 v[136:139], v[44:47], a[156:159], v[136:139]
    v_mfma_f32_16x16x32_bf16 v[140:143], v[44:47], a[212:215], v[140:143]
    global_load_dwordx4 v[44:47], v241, s[42:43] offset:-1024
    s_waitcnt vmcnt(27)
    v_mfma_f32_16x16x32_bf16 v[144:147], v[100:103], a[44:47], v[144:147]
    v_mfma_f32_16x16x32_bf16 v[148:151], v[100:103], a[100:103], v[148:151]
    v_mfma_f32_16x16x32_bf16 v[152:155], v[100:103], a[156:159], v[152:155]
    v_mfma_f32_16x16x32_bf16 v[156:159], v[100:103], a[212:215], v[156:159]
    global_load_dwordx4 v[100:103], v243, s[42:43] offset:-3072
    s_waitcnt vmcnt(27)
    v_mfma_f32_16x16x32_bf16 v[128:131], v[48:51], a[48:51], v[128:131]
    v_mfma_f32_16x16x32_bf16 v[132:135], v[48:51], a[104:107], v[132:135]
    v_mfma_f32_16x16x32_bf16 v[136:139], v[48:51], a[160:163], v[136:139]
    v_mfma_f32_16x16x32_bf16 v[140:143], v[48:51], a[216:219], v[140:143]
    global_load_dwordx4 v[48:51], v241, s[42:43] offset:0
    s_waitcnt vmcnt(27)
    v_mfma_f32_16x16x32_bf16 v[144:147], v[104:107], a[48:51], v[144:147]
    v_mfma_f32_16x16x32_bf16 v[148:151], v[104:107], a[104:107], v[148:151]
    v_mfma_f32_16x16x32_bf16 v[152:155], v[104:107], a[160:163], v[152:155]
    v_mfma_f32_16x16x32_bf16 v[156:159], v[104:107], a[216:219], v[156:159]
    global_load_dwordx4 v[104:107], v243, s[42:43] offset:-2048
    s_waitcnt vmcnt(27)
    v_mfma_f32_16x16x32_bf16 v[128:131], v[52:55], a[52:55], v[128:131]
    v_mfma_f32_16x16x32_bf16 v[132:135], v[52:55], a[108:111], v[132:135]
    v_mfma_f32_16x16x32_bf16 v[136:139], v[52:55], a[164:167], v[136:139]
    v_mfma_f32_16x16x32_bf16 v[140:143], v[52:55], a[220:223], v[140:143]
    global_load_dwordx4 v[52:55], v241, s[42:43] offset:1024
    s_waitcnt vmcnt(27)
    v_mfma_f32_16x16x32_bf16 v[144:147], v[108:111], a[52:55], v[144:147]
    v_mfma_f32_16x16x32_bf16 v[148:151], v[108:111], a[108:111], v[148:151]
    v_mfma_f32_16x16x32_bf16 v[152:155], v[108:111], a[164:167], v[152:155]
    v_mfma_f32_16x16x32_bf16 v[156:159], v[108:111], a[220:223], v[156:159]
    global_load_dwordx4 v[108:111], v243, s[42:43] offset:-1024
    s_nop 7
    s_mov_b32 s37, 1069066811
    s_mov_b32 s38, 0x358637bd
    v_mul_f32 v192, s37, v128
    v_mul_f32 v193, s37, v129
    v_mul_f32 v194, s37, v130
    v_mul_f32 v195, s37, v131
    v_mul_f32 v196, s37, v132
    v_mul_f32 v197, s37, v133
    v_mul_f32 v198, s37, v134
    v_mul_f32 v199, s37, v135
    v_exp_f32_e64 v192, v192 clamp
    v_exp_f32_e64 v193, v193 clamp
    v_exp_f32_e64 v194, v194 clamp
    v_exp_f32_e64 v195, v195 clamp
    v_exp_f32_e64 v196, v196 clamp
    v_exp_f32_e64 v197, v197 clamp
    v_exp_f32_e64 v198, v198 clamp
    v_exp_f32_e64 v199, v199 clamp
    v_max_f32 v128, 0, v128
    v_max_f32 v129, 0, v129
    v_max_f32 v130, 0, v130
    v_max_f32 v131, 0, v131
    v_max_f32 v132, 0, v132
    v_max_f32 v133, 0, v133
    v_max_f32 v134, 0, v134
    v_max_f32 v135, 0, v135
    v_add_f32 v128, v128, v192
    v_add_f32 v129, v129, v193
    v_add_f32 v130, v130, v194
    v_add_f32 v131, v131, v195
    v_add_f32 v132, v132, v196
    v_add_f32 v133, v133, v197
    v_add_f32 v134, v134, v198
    v_add_f32 v135, v135, v199
    v_add_f32 v128, s38, v128
    v_add_f32 v129, s38, v129
    v_add_f32 v130, s38, v130
    v_add_f32 v131, s38, v131
    v_add_f32 v132, s38, v132
    v_add_f32 v133, s38, v133
    v_add_f32 v134, s38, v134
    v_add_f32 v135, s38, v135
    v_mul_f32 v192, s37, v144
    v_mul_f32 v193, s37, v145
    v_mul_f32 v194, s37, v146
    v_mul_f32 v195, s37, v147
    v_mul_f32 v196, s37, v148
    v_mul_f32 v197, s37, v149
    v_mul_f32 v198, s37, v150
    v_mul_f32 v199, s37, v151
    v_exp_f32_e64 v192, v192 clamp
    v_exp_f32_e64 v193, v193 clamp
    v_exp_f32_e64 v194, v194 clamp
    v_exp_f32_e64 v195, v195 clamp
    v_exp_f32_e64 v196, v196 clamp
    v_exp_f32_e64 v197, v197 clamp
    v_exp_f32_e64 v198, v198 clamp
    v_exp_f32_e64 v199, v199 clamp
    v_max_f32 v144, 0, v144
    v_max_f32 v145, 0, v145
    v_max_f32 v146, 0, v146
    v_max_f32 v147, 0, v147
    v_max_f32 v148, 0, v148
    v_max_f32 v149, 0, v149
    v_max_f32 v150, 0, v150
    v_max_f32 v151, 0, v151
    v_add_f32 v144, v144, v192
    v_add_f32 v145, v145, v193
    v_add_f32 v146, v146, v194
    v_add_f32 v147, v147, v195
    v_add_f32 v148, v148, v196
    v_add_f32 v149, v149, v197
    v_add_f32 v150, v150, v198
    v_add_f32 v151, v151, v199
    v_add_f32 v144, s38, v144
    v_add_f32 v145, s38, v145
    v_add_f32 v146, s38, v146
    v_add_f32 v147, s38, v147
    v_add_f32 v148, s38, v148
    v_add_f32 v149, s38, v149
    v_add_f32 v150, s38, v150
    v_add_f32 v151, s38, v151
    v_cvt_pk_bf16_f32 v128, v128, v129
    v_cvt_pk_bf16_f32 v129, v130, v131
    v_cvt_pk_bf16_f32 v130, v144, v145
    v_cvt_pk_bf16_f32 v131, v146, v147
    v_cvt_pk_bf16_f32 v132, v132, v133
    v_cvt_pk_bf16_f32 v133, v134, v135
    v_cvt_pk_bf16_f32 v134, v148, v149
    v_cvt_pk_bf16_f32 v135, v150, v151
    v_cvt_pk_bf16_f32 v136, v136, v137
    v_cvt_pk_bf16_f32 v137, v138, v139
    v_cvt_pk_bf16_f32 v138, v152, v153
    v_cvt_pk_bf16_f32 v139, v154, v155
    v_cvt_pk_bf16_f32 v140, v140, v141
    v_cvt_pk_bf16_f32 v141, v142, v143
    v_cvt_pk_bf16_f32 v142, v156, v157
    v_cvt_pk_bf16_f32 v143, v158, v159
    s_nop 1
    v_mfma_f32_16x16x32_bf16 v[160:163], v[128:131], v[136:139], v[160:163]
    v_mfma_f32_16x16x32_bf16 v[168:171], v[128:131], v[140:143], v[168:171]
    v_mfma_f32_16x16x32_bf16 v[176:179], v[128:131], v[184:187], v[176:179]
    v_mfma_f32_16x16x32_bf16 v[164:167], v[132:135], v[136:139], v[164:167]
    v_mfma_f32_16x16x32_bf16 v[172:175], v[132:135], v[140:143], v[172:175]
    v_mfma_f32_16x16x32_bf16 v[180:183], v[132:135], v[184:187], v[180:183]
    s_add_u32 s41, s41, 1
    s_cmp_lt_u32 s41, 7
    s_cselect_b32 s36, 114688, 0
    s_add_u32 s42, s42, s36
    s_addc_u32 s43, s43, 0
    s_cmp_lt_u32 s41, 8
    s_cbranch_scc1 L_b1
    s_waitcnt vmcnt(0)
    s_barrier
    s_mul_i32 s36, s31, 6144
    v_add_u32 v247, s36, v240
    ds_write_b128 v247, v[160:163] offset:0
    ds_write_b128 v247, v[164:167] offset:1024
    ds_write_b128 v247, v[168:171] offset:2048
    ds_write_b128 v247, v[172:175] offset:3072
    ds_write_b128 v247, v[176:179] offset:4096
    ds_write_b128 v247, v[180:183] offset:5120
    s_lshl_b32 s36, s31, 10
    v_add_u32 v247, s36, v240
    s_mul_i32 s37, s48, 6144
    s_add_u32 s37, s37, 22020096
    s_add_u32 s46, s28, s37
    s_addc_u32 s47, s29, 0
    s_lshl_b32 s36, s48, 2
    s_add_u32 s36, s36, s31
    s_mul_i32 s37, s36, 4
    s_add_u32 s37, s37, 14810112
    s_add_u32 s44, s28, s37
    s_addc_u32 s45, s29, 0
    s_waitcnt lgkmcnt(0)
    s_barrier
    ds_read_b128 v[0:3], v247 offset:0
    ds_read_b128 v[4:7], v247 offset:6144
    ds_read_b128 v[8:11], v247 offset:12288
    ds_read_b128 v[12:15], v247 offset:18432
    s_waitcnt lgkmcnt(0)
    v_add_f32 v0, v0, v4
    v_add_f32 v1, v1, v5
    v_add_f32 v2, v2, v6
    v_add_f32 v3, v3, v7
    v_add_f32 v0, v0, v8
    v_add_f32 v1, v1, v9
    v_add_f32 v2, v2, v10
    v_add_f32 v3, v3, v11
    v_add_f32 v0, v0, v12
    v_add_f32 v1, v1, v13
    v_add_f32 v2, v2, v14
    v_add_f32 v3, v3, v15
    global_store_dwordx4 v247, v[0:3], s[46:47] sc1
    s_cmp_ge_u32 s31, 2
    s_cbranch_scc1 L_b1_done
    v_add_u32 v247, 4096, v247
    ds_read_b128 v[16:19], v247 offset:0
    ds_read_b128 v[20:23], v247 offset:6144
    ds_read_b128 v[24:27], v247 offset:12288
    ds_read_b128 v[28:31], v247 offset:18432
    s_waitcnt lgkmcnt(0)
    v_add_f32 v16, v16, v20
    v_add_f32 v17, v17, v21
    v_add_f32 v18, v18, v22
    v_add_f32 v19, v19, v23
    v_add_f32 v16, v16, v24
    v_add_f32 v17, v17, v25
    v_add_f32 v18, v18, v26
    v_add_f32 v19, v19, v27
    v_add_f32 v16, v16, v28
    v_add_f32 v17, v17, v29
    v_add_f32 v18, v18, v30
    v_add_f32 v19, v19, v31
    global_store_dwordx4 v247, v[16:19], s[46:47] sc1
L_b1_done:
    s_waitcnt vmcnt(0)
    v_mov_b32 v246, 1
    s_mov_b64 exec, 1
    global_store_dword v249, v246, s[44:45] sc1
    s_mov_b64 exec, -1
    s_and_b32 s49, s48, 7
    s_mul_i32 s39, s49, 112
    s_lshl_b32 s36, s31, 2
    s_mul_i32 s37, s36, 2688
    v_mov_b32 v247, s39
    v_bfe_u32 v246, v245, 3, 1
    v_mul_u32_u24 v246, 56, v246
    v_add_u32 v247, v246, v247
    v_bfe_u32 v246, v245, 2, 1
    v_lshl_add_u32 v247, v246, 5, v247
    v_bfe_u32 v246, v245, 0, 2
    v_lshl_add_u32 v247, v246, 3, v247
    v_mov_b32 v248, s37
    v_bfe_u32 v246, v245, 4, 2
    v_mul_u32_u24 v246, 2688, v246
    v_add_u32 v248, v246, v248
    v_add_u32 v247, v247, v248
    s_mul_i32 s37, s36, 144
    v_mov_b32 v248, s37
    v_bfe_u32 v246, v245, 4, 2
    v_mul_u32_u24 v246, 144, v246
    v_add_u32 v248, v246, v248
    v_bfe_u32 v246, v245, 0, 4
    v_lshl_add_u32 v248, v246, 3, v248
    s_add_u32 s50, s20, 0
    s_addc_u32 s51, s21, 0
    global_load_dwordx2 v[0:1], v247, s[50:51]
    s_add_u32 s50, s50, 43008
    s_addc_u32 s51, s51, 0
    global_load_dwordx2 v[2:3], v247, s[50:51]
    s_add_u32 s50, s50, 43008
    s_addc_u32 s51, s51, 0
    global_load_dwordx2 v[4:5], v247, s[50:51]
    s_add_u32 s50, s50, 43008
    s_addc_u32 s51, s51, 0
    global_load_dwordx2 v[6:7], v247, s[50:51]
    s_add_u32 s50, s50, 43008
    s_addc_u32 s51, s51, 0
    global_load_dwordx2 v[8:9], v247, s[50:51]
    s_add_u32 s50, s50, 43008
    s_addc_u32 s51, s51, 0
    global_load_dwordx2 v[10:11], v247, s[50:51]
    s_add_u32 s50, s50, 43008
    s_addc_u32 s51, s51, 0
    global_load_dwordx2 v[12:13], v247, s[50:51]
    s_add_u32 s50, s50, 43008
    s_addc_u32 s51, s51, 0
    global_load_dwordx2 v[14:15], v247, s[50:51]
    s_add_u32 s50, s50, 43008
    s_addc_u32 s51, s51, 0
    global_load_dwordx2 v[16:17], v247, s[50:51]
    s_add_u32 s50, s50, 43008
    s_addc_u32 s51, s51, 0
    global_load_dwordx2 v[18:19], v247, s[50:51]
    s_add_u32 s50, s50, 43008
    s_addc_u32 s51, s51, 0
    global_load_dwordx2 v[20:21], v247, s[50:51]
    s_add_u32 s50, s50, 43008
    s_addc_u32 s51, s51, 0
    global_load_dwordx2 v[22:23], v247, s[50:51]
    s_add_u32 s50, s50, 43008
    s_addc_u32 s51, s51, 0
    global_load_dwordx2 v[24:25], v247, s[50:51]
    s_add_u32 s50, s50, 43008
    s_addc_u32 s51, s51, 0
    global_load_dwordx2 v[26:27], v247, s[50:51]
    s_add_u32 s50, s50, 43008
    s_addc_u32 s51, s51, 0
    global_load_dwordx2 v[28:29], v247, s[50:51]
    s_add_u32 s50, s50, 43008
    s_addc_u32 s51, s51, 0
    global_load_dwordx2 v[30:31], v247, s[50:51]
    s_add_u32 s50, s50, 43008
    s_addc_u32 s51, s51, 0
    global_load_dwordx2 v[32:33], v247, s[50:51]
    s_add_u32 s50, s50, 43008
    s_addc_u32 s51, s51, 0
    global_load_dwordx2 v[34:35], v247, s[50:51]
    s_add_u32 s50, s50, 43008
    s_addc_u32 s51, s51, 0
    global_load_dwordx2 v[36:37], v247, s[50:51]
    s_add_u32 s50, s50, 43008
    s_addc_u32 s51, s51, 0
    global_load_dwordx2 v[38:39], v247, s[50:51]
    s_add_u32 s50, s50, 43008
    s_addc_u32 s51, s51, 0
    global_load_dwordx2 v[40:41], v247, s[50:51]
    s_add_u32 s50, s50, 43008
    s_addc_u32 s51, s51, 0
    global_load_dwordx2 v[42:43], v247, s[50:51]
    s_add_u32 s50, s50, 43008
    s_addc_u32 s51, s51, 0
    global_load_dwordx2 v[44:45], v247, s[50:51]
    s_add_u32 s50, s50, 43008
    s_addc_u32 s51, s51, 0
    global_load_dwordx2 v[46:47], v247, s[50:51]
    s_add_u32 s50, s50, 43008
    s_addc_u32 s51, s51, 0
    global_load_dwordx2 v[48:49], v247, s[50:51]
    s_add_u32 s50, s50, 43008
    s_addc_u32 s51, s51, 0
    global_load_dwordx2 v[50:51], v247, s[50:51]
    s_add_u32 s50, s50, 43008
    s_addc_u32 s51, s51, 0
    global_load_dwordx2 v[52:53], v247, s[50:51]
    s_add_u32 s50, s50, 43008
    s_addc_u32 s51, s51, 0
    global_load_dwordx2 v[54:55], v247, s[50:51]
    s_barrier
    s_waitcnt vmcnt(27)
    ds_write_b64 v248, v[0:1] offset:0
    s_waitcnt vmcnt(26)
    ds_write_b64 v248, v[2:3] offset:2304
    s_waitcnt vmcnt(25)
    ds_write_b64 v248, v[4:5] offset:4608
    s_waitcnt vmcnt(24)
    ds_write_b64 v248, v[6:7] offset:6912
    s_waitcnt vmcnt(23)
    ds_write_b64 v248, v[8:9] offset:9216
    s_waitcnt vmcnt(22)
    ds_write_b64 v248, v[10:11] offset:11520
    s_waitcnt vmcnt(21)
    ds_write_b64 v248, v[12:13] offset:13824
    s_waitcnt vmcnt(20)
    ds_write_b64 v248, v[14:15] offset:16128
    s_waitcnt vmcnt(19)
    ds_write_b64 v248, v[16:17] offset:18432
    s_waitcnt vmcnt(18)
    ds_write_b64 v248, v[18:19] offset:20736
    s_waitcnt vmcnt(17)
    ds_write_b64 v248, v[20:21] offset:23040
    s_waitcnt vmcnt(16)
    ds_write_b64 v248, v[22:23] offset:25344
    s_waitcnt vmcnt(15)
    ds_write_b64 v248, v[24:25] offset:27648
    s_waitcnt vmcnt(14)
    ds_write_b64 v248, v[26:27] offset:29952
    s_waitcnt vmcnt(13)
    ds_write_b64 v248, v[28:29] offset:32256
    s_waitcnt vmcnt(12)
    ds_write_b64 v248, v[30:31] offset:34560
    s_waitcnt vmcnt(11)
    ds_write_b64 v248, v[32:33] offset:36864
    s_waitcnt vmcnt(10)
    ds_write_b64 v248, v[34:35] offset:39168
    s_waitcnt vmcnt(9)
    ds_write_b64 v248, v[36:37] offset:41472
    s_waitcnt vmcnt(8)
    ds_write_b64 v248, v[38:39] offset:43776
    s_waitcnt vmcnt(7)
    ds_write_b64 v248, v[40:41] offset:46080
    s_waitcnt vmcnt(6)
    ds_write_b64 v248, v[42:43] offset:48384
    s_waitcnt vmcnt(5)
    ds_write_b64 v248, v[44:45] offset:50688
    s_waitcnt vmcnt(4)
    ds_write_b64 v248, v[46:47] offset:52992
    s_waitcnt vmcnt(3)
    ds_write_b64 v248, v[48:49] offset:55296
    s_waitcnt vmcnt(2)
    ds_write_b64 v248, v[50:51] offset:57600
    s_waitcnt vmcnt(1)
    ds_write_b64 v248, v[52:53] offset:59904
    s_waitcnt vmcnt(0)
    ds_write_b64 v248, v[54:55] offset:62208
    ds_write_b64 v248, v[54:55] offset:64512
    v_mov_b32 v247, 0
    v_bfe_u32 v246, v245, 4, 2
    v_mul_u32_u24 v246, 1152, v246
    v_add_u32 v247, v246, v247
    v_bfe_u32 v246, v245, 2, 2
    v_mul_u32_u24 v246, 144, v246
    v_add_u32 v247, v246, v247
    v_bfe_u32 v246, v245, 0, 2
    v_lshl_add_u32 v247, v246, 3, v247
    s_waitcnt lgkmcnt(0)
    s_barrier
    ds_read_b64_tr_b16 a[0:1], v247 offset:0
    ds_read_b64_tr_b16 a[2:3], v247 offset:576
    ds_read_b64_tr_b16 a[4:5], v247 offset:4608
    ds_read_b64_tr_b16 a[6:7], v247 offset:5184
    ds_read_b64_tr_b16 a[8:9], v247 offset:9216
    ds_read_b64_tr_b16 a[10:11], v247 offset:9792
    ds_read_b64_tr_b16 a[12:13], v247 offset:13824
    ds_read_b64_tr_b16 a[14:15], v247 offset:14400
    s_waitcnt lgkmcnt(8)
    ds_read_b64_tr_b16 a[16:17], v247 offset:18432
    ds_read_b64_tr_b16 a[18:19], v247 offset:19008
    ds_read_b64_tr_b16 a[20:21], v247 offset:23040
    ds_read_b64_tr_b16 a[22:23], v247 offset:23616
    ds_read_b64_tr_b16 a[24:25], v247 offset:27648
    ds_read_b64_tr_b16 a[26:27], v247 offset:28224
    ds_read_b64_tr_b16 a[28:29], v247 offset:32256
    ds_read_b64_tr_b16 a[30:31], v247 offset:32832
    s_waitcnt lgkmcnt(8)
    ds_read_b64_tr_b16 a[32:33], v247 offset:36864
    ds_read_b64_tr_b16 a[34:35], v247 offset:37440
    ds_read_b64_tr_b16 a[36:37], v247 offset:41472
    ds_read_b64_tr_b16 a[38:39], v247 offset:42048
    ds_read_b64_tr_b16 a[40:41], v247 offset:46080
    ds_read_b64_tr_b16 a[42:43], v247 offset:46656
    ds_read_b64_tr_b16 a[44:45], v247 offset:50688
    ds_read_b64_tr_b16 a[46:47], v247 offset:51264
    s_waitcnt lgkmcnt(8)
    ds_read_b64_tr_b16 a[48:49], v247 offset:55296
    ds_read_b64_tr_b16 a[50:51], v247 offset:55872
    ds_read_b64_tr_b16 a[52:53], v247 offset:59904
    ds_read_b64_tr_b16 a[54:55], v247 offset:60480
    ds_read_b64_tr_b16 a[56:57], v247 offset:32
    ds_read_b64_tr_b16 a[58:59], v247 offset:608
    ds_read_b64_tr_b16 a[60:61], v247 offset:4640
    ds_read_b64_tr_b16 a[62:63], v247 offset:5216
    s_waitcnt lgkmcnt(8)
    ds_read_b64_tr_b16 a[64:65], v247 offset:9248
    ds_read_b64_tr_b16 a[66:67], v247 offset:9824
    ds_read_b64_tr_b16 a[68:69], v247 offset:13856
    ds_read_b64_tr_b16 a[70:71], v247 offset:14432
    ds_read_b64_tr_b16 a[72:73], v247 offset:18464
    ds_read_b64_tr_b16 a[74:75], v247 offset:19040
    ds_read_b64_tr_b16 a[76:77], v247 offset:23072
    ds_read_b64_tr_b16 a[78:79], v247 offset:23648
    s_waitcnt lgkmcnt(8)
    ds_read_b64_tr_b16 a[80:81], v247 offset:27680
    ds_read_b64_tr_b16 a[82:83], v247 offset:28256
    ds_read_b64_tr_b16 a[84:85], v247 offset:32288
    ds_read_b64_tr_b16 a[86:87], v247 offset:32864
    ds_read_b64_tr_b16 a[88:89], v247 offset:36896
    ds_read_b64_tr_b16 a[90:91], v247 offset:37472
    ds_read_b64_tr_b16 a[92:93], v247 offset:41504
    ds_read_b64_tr_b16 a[94:95], v247 offset:42080
    s_waitcnt lgkmcnt(8)
    ds_read_b64_tr_b16 a[96:97], v247 offset:46112
    ds_read_b64_tr_b16 a[98:99], v247 offset:46688
    ds_read_b64_tr_b16 a[100:101], v247 offset:50720
    ds_read_b64_tr_b16 a[102:103], v247 offset:51296
    ds_read_b64_tr_b16 a[104:105], v247 offset:55328
    ds_read_b64_tr_b16 a[106:107], v247 offset:55904
    ds_read_b64_tr_b16 a[108:109], v247 offset:59936
    ds_read_b64_tr_b16 a[110:111], v247 offset:60512
    s_waitcnt lgkmcnt(8)
    ds_read_b64_tr_b16 a[112:113], v247 offset:64
    ds_read_b64_tr_b16 a[114:115], v247 offset:640
    ds_read_b64_tr_b16 a[116:117], v247 offset:4672
    ds_read_b64_tr_b16 a[118:119], v247 offset:5248
    ds_read_b64_tr_b16 a[120:121], v247 offset:9280
    ds_read_b64_tr_b16 a[122:123], v247 offset:9856
    ds_read_b64_tr_b16 a[124:125], v247 offset:13888
    ds_read_b64_tr_b16 a[126:127], v247 offset:14464
    s_waitcnt lgkmcnt(8)
    ds_read_b64_tr_b16 a[128:129], v247 offset:18496
    ds_read_b64_tr_b16 a[130:131], v247 offset:19072
    ds_read_b64_tr_b16 a[132:133], v247 offset:23104
    ds_read_b64_tr_b16 a[134:135], v247 offset:23680
    ds_read_b64_tr_b16 a[136:137], v247 offset:27712
    ds_read_b64_tr_b16 a[138:139], v247 offset:28288
    ds_read_b64_tr_b16 a[140:141], v247 offset:32320
    ds_read_b64_tr_b16 a[142:143], v247 offset:32896
    s_waitcnt lgkmcnt(8)
    ds_read_b64_tr_b16 a[144:145], v247 offset:36928
    ds_read_b64_tr_b16 a[146:147], v247 offset:37504
    ds_read_b64_tr_b16 a[148:149], v247 offset:41536
    ds_read_b64_tr_b16 a[150:151], v247 offset:42112
    ds_read_b64_tr_b16 a[152:153], v247 offset:46144
    ds_read_b64_tr_b16 a[154:155], v247 offset:46720
    ds_read_b64_tr_b16 a[156:157], v247 offset:50752
    ds_read_b64_tr_b16 a[158:159], v247 offset:51328
    s_waitcnt lgkmcnt(8)
    ds_read_b64_tr_b16 a[160:161], v247 offset:55360
    ds_read_b64_tr_b16 a[162:163], v247 offset:55936
    ds_read_b64_tr_b16 a[164:165], v247 offset:59968
    ds_read_b64_tr_b16 a[166:167], v247 offset:60544
    ds_read_b64_tr_b16 a[168:169], v247 offset:96
    ds_read_b64_tr_b16 a[170:171], v247 offset:672
    ds_read_b64_tr_b16 a[172:173], v247 offset:4704
    ds_read_b64_tr_b16 a[174:175], v247 offset:5280
    s_waitcnt lgkmcnt(8)
    ds_read_b64_tr_b16 a[176:177], v247 offset:9312
    ds_read_b64_tr_b16 a[178:179], v247 offset:9888
    ds_read_b64_tr_b16 a[180:181], v247 offset:13920
    ds_read_b64_tr_b16 a[182:183], v247 offset:14496
    ds_read_b64_tr_b16 a[184:185], v247 offset:18528
    ds_read_b64_tr_b16 a[186:187], v247 offset:19104
    ds_read_b64_tr_b16 a[188:189], v247 offset:23136
    ds_read_b64_tr_b16 a[190:191], v247 offset:23712
    s_waitcnt lgkmcnt(8)
    ds_read_b64_tr_b16 a[192:193], v247 offset:27744
    ds_read_b64_tr_b16 a[194:195], v247 offset:28320
    ds_read_b64_tr_b16 a[196:197], v247 offset:32352
    ds_read_b64_tr_b16 a[198:199], v247 offset:32928
    ds_read_b64_tr_b16 a[200:201], v247 offset:36960
    ds_read_b64_tr_b16 a[202:203], v247 offset:37536
    ds_read_b64_tr_b16 a[204:205], v247 offset:41568
    ds_read_b64_tr_b16 a[206:207], v247 offset:42144
    s_waitcnt lgkmcnt(8)
    ds_read_b64_tr_b16 a[208:209], v247 offset:46176
    ds_read_b64_tr_b16 a[210:211], v247 offset:46752
    ds_read_b64_tr_b16 a[212:213], v247 offset:50784
    ds_read_b64_tr_b16 a[214:215], v247 offset:51360
    ds_read_b64_tr_b16 a[216:217], v247 offset:55392
    ds_read_b64_tr_b16 a[218:219], v247 offset:55968
    ds_read_b64_tr_b16 a[220:221], v247 offset:60000
    ds_read_b64_tr_b16 a[222:223], v247 offset:60576
    s_waitcnt lgkmcnt(8)
    s_waitcnt lgkmcnt(0)
    s_mul_i32 s37, s49, 64
    s_add_u32 s37, s37, 14810112
    s_add_u32 s50, s28, s37
    s_addc_u32 s51, s29, 0
    v_mov_b32 v247, 0
    v_bfe_u32 v246, v245, 0, 4
    v_lshl_add_u32 v247, v246, 2, v247
L_b2_w:
    global_load_dword v248, v247, s[50:51] sc1
    s_sub_u32 s35, s35, 1
    s_cbranch_scc1 L_bail
    s_waitcnt vmcnt(0)
    v_cmp_ge_i32 vcc, 0, v248
    s_cbranch_vccz L_b2_w_ok
    s_sleep 2
    s_branch L_b2_w
L_b2_w_ok:
    s_mul_i32 s37, s49, 24576
    s_add_u32 s37, s37, 22024192
    s_add_u32 s50, s28, s37
    s_addc_u32 s51, s29, 0
    global_load_dwordx4 v[0:3], v240, s[50:51] offset:-4096 sc1
    global_load_dwordx4 v[4:7], v240, s[50:51] offset:-3072 sc1
    global_load_dwordx4 v[8:11], v240, s[50:51] offset:-2048 sc1
    global_load_dwordx4 v[12:15], v240, s[50:51] offset:-1024 sc1
    global_load_dwordx4 v[16:19], v240, s[50:51] offset:0 sc1
    global_load_dwordx4 v[20:23], v240, s[50:51] offset:1024 sc1
    global_load_dwordx4 v[24:27], v240, s[50:51] offset:2048 sc1
    global_load_dwordx4 v[28:31], v240, s[50:51] offset:3072 sc1
    global_load_dwordx4 v[32:35], v241, s[50:51] offset:-4096 sc1
    global_load_dwordx4 v[36:39], v241, s[50:51] offset:-3072 sc1
    global_load_dwordx4 v[40:43], v241, s[50:51] offset:-2048 sc1
    global_load_dwordx4 v[44:47], v241, s[50:51] offset:-1024 sc1
    global_load_dwordx4 v[48:51], v241, s[50:51] offset:0 sc1
    global_load_dwordx4 v[52:55], v241, s[50:51] offset:1024 sc1
    global_load_dwordx4 v[56:59], v241, s[50:51] offset:2048 sc1
    global_load_dwordx4 v[60:63], v241, s[50:51] offset:3072 sc1
    global_load_dwordx4 v[64:67], v242, s[50:51] offset:-4096 sc1
    global_load_dwordx4 v[68:71], v242, s[50:51] offset:-3072 sc1
    global_load_dwordx4 v[72:75], v242, s[50:51] offset:-2048 sc1
    global_load_dwordx4 v[76:79], v242, s[50:51] offset:-1024 sc1
    global_load_dwordx4 v[80:83], v242, s[50:51] offset:0 sc1
    global_load_dwordx4 v[84:87], v242, s[50:51] offset:1024 sc1
    global_load_dwordx4 v[88:91], v242, s[50:51] offset:2048 sc1
    global_load_dwordx4 v[92:95], v242, s[50:51] offset:3072 sc1
    v_and_b32 v246, 15, v245
    v_cmp_gt_u32 s[52:53], 12, v246
    v_cmp_gt_u32 s[54:55], 48, v245
    s_waitcnt vmcnt(0)
    v_add_f32 v0, v0, v24
    v_add_f32 v1, v1, v25
    v_add_f32 v2, v2, v26
    v_add_f32 v3, v3, v27
    v_add_f32 v4, v4, v28
    v_add_f32 v5, v5, v29
    v_add_f32 v6, v6, v30
    v_add_f32 v7, v7, v31
    v_cvt_pk_bf16_f32 v160, v0, v1
    v_cvt_pk_bf16_f32 v161, v2, v3
    v_cvt_pk_bf16_f32 v162, v4, v5
    v_cvt_pk_bf16_f32 v163, v6, v7
    v_cndmask_b32_e64 v162, 0, v162, s[54:55]
    v_cndmask_b32_e64 v163, 0, v163, s[54:55]
    v_add_f32 v8, v8, v32
    v_add_f32 v9, v9, v33
    v_add_f32 v10, v10, v34
    v_add_f32 v11, v11, v35
    v_add_f32 v12, v12, v36
    v_add_f32 v13, v13, v37
    v_add_f32 v14, v14, v38
    v_add_f32 v15, v15, v39
    v_cvt_pk_bf16_f32 v164, v8, v9
    v_cvt_pk_bf16_f32 v165, v10, v11
    v_cvt_pk_bf16_f32 v166, v12, v13
    v_cvt_pk_bf16_f32 v167, v14, v15
    v_cndmask_b32_e64 v166, 0, v166, s[54:55]
    v_cndmask_b32_e64 v167, 0, v167, s[54:55]
    v_cndmask_b32_e64 v164, 0, v164, s[52:53]
    v_cndmask_b32_e64 v165, 0, v165, s[52:53]
    v_cndmask_b32_e64 v166, 0, v166, s[52:53]
    v_cndmask_b32_e64 v167, 0, v167, s[52:53]
    v_add_f32 v16, v16, v40
    v_add_f32 v17, v17, v41
    v_add_f32 v18, v18, v42
    v_add_f32 v19, v19, v43
    v_add_f32 v20, v20, v44
    v_add_f32 v21, v21, v45
    v_add_f32 v22, v22, v46
    v_add_f32 v23, v23, v47
    v_cvt_pk_bf16_f32 v168, v16, v17
    v_cvt_pk_bf16_f32 v169, v18, v19
    v_cvt_pk_bf16_f32 v170, v20, v21
    v_cvt_pk_bf16_f32 v171, v22, v23
    v_cndmask_b32_e64 v170, 0, v170, s[54:55]
    v_cndmask_b32_e64 v171, 0, v171, s[54:55]
    v_add_f32 v48, v48, v72
    v_add_f32 v49, v49, v73
    v_add_f32 v50, v50, v74
    v_add_f32 v51, v51, v75
    v_add_f32 v52, v52, v76
    v_add_f32 v53, v53, v77
    v_add_f32 v54, v54, v78
    v_add_f32 v55, v55, v79
    v_cvt_pk_bf16_f32 v172, v48, v49
    v_cvt_pk_bf16_f32 v173, v50, v51
    v_cvt_pk_bf16_f32 v174, v52, v53
    v_cvt_pk_bf16_f32 v175, v54, v55
    v_cndmask_b32_e64 v174, 0, v174, s[54:55]
    v_cndmask_b32_e64 v175, 0, v175, s[54:55]
    v_add_f32 v56, v56, v80
    v_add_f32 v57, v57, v81
    v_add_f32 v58, v58, v82
    v_add_f32 v59, v59, v83
    v_add_f32 v60, v60, v84
    v_add_f32 v61, v61, v85
    v_add_f32 v62, v62, v86
    v_add_f32 v63, v63, v87
    v_cvt_pk_bf16_f32 v176, v56, v57
    v_cvt_pk_bf16_f32 v177, v58, v59
    v_cvt_pk_bf16_f32 v178, v60, v61
    v_cvt_pk_bf16_f32 v179, v62, v63
    v_cndmask_b32_e64 v178, 0, v178, s[54:55]
    v_cndmask_b32_e64 v179, 0, v179, s[54:55]
    v_cndmask_b32_e64 v176, 0, v176, s[52:53]
    v_cndmask_b32_e64 v177, 0, v177, s[52:53]
    v_cndmask_b32_e64 v178, 0, v178, s[52:53]
    v_cndmask_b32_e64 v179, 0, v179, s[52:53]
    v_add_f32 v64, v64, v88
    v_add_f32 v65, v65, v89
    v_add_f32 v66, v66, v90
    v_add_f32 v67, v67, v91
    v_add_f32 v68, v68, v92
    v_add_f32 v69, v69, v93
    v_add_f32 v70, v70, v94
    v_add_f32 v71, v71, v95
    v_cvt_pk_bf16_f32 v180, v64, v65
    v_cvt_pk_bf16_f32 v181, v66, v67
    v_cvt_pk_bf16_f32 v182, v68, v69
    v_cvt_pk_bf16_f32 v183, v70, v71
    v_cndmask_b32_e64 v182, 0, v182, s[54:55]
    v_cndmask_b32_e64 v183, 0, v183, s[54:55]
    s_lshr_b32 s36, s48, 3
    s_lshl_b32 s36, s36, 4
    s_add_u32 s36, s36, s31
    s_mul_i32 s37, s36, 28672
    s_add_u32 s37, s37, 17829888
    s_add_u32 s42, s28, s37
    s_addc_u32 s43, s29, 0
    s_lshl_b32 s38, s36, 4
    s_add_u32 s38, s38, s49
    s_mul_i32 s37, s38, 2048
    s_add_u32 s37, s37, 19922944
    s_add_u32 s46, s28, s37
    s_addc_u32 s47, s29, 0
    s_lshr_b32 s36, s48, 3
    s_lshl_b32 s36, s36, 2
    s_add_u32 s36, s36, s31
    s_lshl_b32 s36, s36, 3
    s_add_u32 s36, s36, s49
    s_mul_i32 s37, s36, 4
    s_add_u32 s37, s37, 14810624
    s_add_u32 s44, s28, s37
    s_addc_u32 s45, s29, 0
    global_load_dwordx4 v[0:3], v240, s[42:43] offset:-4096
    global_load_dwordx4 v[56:59], v241, s[42:43] offset:2048
    global_load_dwordx4 v[4:7], v240, s[42:43] offset:-3072
    global_load_dwordx4 v[60:63], v241, s[42:43] offset:3072
    global_load_dwordx4 v[8:11], v240, s[42:43] offset:-2048
    global_load_dwordx4 v[64:67], v242, s[42:43] offset:-4096
    global_load_dwordx4 v[12:15], v240, s[42:43] offset:-1024
    global_load_dwordx4 v[68:71], v242, s[42:43] offset:-3072
    global_load_dwordx4 v[16:19], v240, s[42:43] offset:0
    global_load_dwordx4 v[72:75], v242, s[42:43] offset:-2048
    global_load_dwordx4 v[20:23], v240, s[42:43] offset:1024
    global_load_dwordx4 v[76:79], v242, s[42:43] offset:-1024
    global_load_dwordx4 v[24:27], v240, s[42:43] offset:2048
    global_load_dwordx4 v[80:83], v242, s[42:43] offset:0
    global_load_dwordx4 v[28:31], v240, s[42:43] offset:3072
    global_load_dword v250, v240, s[42:43]
    global_load_dwordx4 v[84:87], v242, s[42:43] offset:1024
    global_load_dwordx4 v[32:35], v241, s[42:43] offset:-4096
    global_load_dwordx4 v[88:91], v242, s[42:43] offset:2048
    global_load_dwordx4 v[36:39], v241, s[42:43] offset:-3072
    global_load_dwordx4 v[92:95], v242, s[42:43] offset:3072
    global_load_dwordx4 v[40:43], v241, s[42:43] offset:-2048
    global_load_dwordx4 v[96:99], v243, s[42:43] offset:-4096
    global_load_dwordx4 v[44:47], v241, s[42:43] offset:-1024
    global_load_dwordx4 v[100:103], v243, s[42:43] offset:-3072
    global_load_dwordx4 v[48:51], v241, s[42:43] offset:0
    global_load_dwordx4 v[104:107], v243, s[42:43] offset:-2048
    global_load_dwordx4 v[52:55], v241, s[42:43] offset:1024
    global_load_dwordx4 v[108:111], v243, s[42:43] offset:-1024
    global_load_dword v250, v240, s[42:43]
    global_load_dword v250, v240, s[42:43]
    global_load_dword v250, v240, s[42:43]
    global_load_dword v250, v240, s[42:43]
    s_add_u32 s42, s42, 114688
    s_addc_u32 s43, s43, 0
    s_mov_b32 s41, 0
L_b2:
    s_waitcnt vmcnt(32)
    v_mfma_f32_16x16x32_bf16 v[128:131], a[0:3], v[0:3], 0
    v_mfma_f32_16x16x32_bf16 v[132:135], a[56:59], v[0:3], 0
    v_mfma_f32_16x16x32_bf16 v[136:139], a[112:115], v[0:3], 0
    v_mfma_f32_16x16x32_bf16 v[140:143], a[168:171], v[0:3], 0
    global_load_dwordx4 v[0:3], v240, s[42:43] offset:-4096
    s_waitcnt vmcnt(32)
    v_mfma_f32_16x16x32_bf16 v[144:147], a[0:3], v[56:59], 0
    v_mfma_f32_16x16x32_bf16 v[148:151], a[56:59], v[56:59], 0
    v_mfma_f32_16x16x32_bf16 v[152:155], a[112:115], v[56:59], 0
    v_mfma_f32_16x16x32_bf16 v[156:159], a[168:171], v[56:59], 0
    global_load_dwordx4 v[56:59], v241, s[42:43] offset:2048
    s_waitcnt vmcnt(32)
    v_mfma_f32_16x16x32_bf16 v[128:131], a[4:7], v[4:7], v[128:131]
    v_mfma_f32_16x16x32_bf16 v[132:135], a[60:63], v[4:7], v[132:135]
    v_mfma_f32_16x16x32_bf16 v[136:139], a[116:119], v[4:7], v[136:139]
    v_mfma_f32_16x16x32_bf16 v[140:143], a[172:175], v[4:7], v[140:143]
    global_load_dwordx4 v[4:7], v240, s[42:43] offset:-3072
    s_waitcnt vmcnt(32)
    v_mfma_f32_16x16x32_bf16 v[144:147], a[4:7], v[60:63], v[144:147]
    v_mfma_f32_16x16x32_bf16 v[148:151], a[60:63], v[60:63], v[148:151]
    v_mfma_f32_16x16x32_bf16 v[152:155], a[116:119], v[60:63], v[152:155]
    v_mfma_f32_16x16x32_bf16 v[156:159], a[172:175], v[60:63], v[156:159]
    global_load_dwordx4 v[60:63], v241, s[42:43] offset:3072
    s_waitcnt vmcnt(32)
    v_mfma_f32_16x16x32_bf16 v[128:131], a[8:11], v[8:11], v[128:131]
    v_mfma_f32_16x16x32_bf16 v[132:135], a[64:67], v[8:11], v[132:135]
    v_mfma_f32_16x16x32_bf16 v[136:139], a[120:123], v[8:11], v[136:139]
    v_mfma_f32_16x16x32_bf16 v[140:143], a[176:179], v[8:11], v[140:143]
    global_load_dwordx4 v[8:11], v240, s[42:43] offset:-2048
    s_waitcnt vmcnt(32)
    v_mfma_f32_16x16x32_bf16 v[144:147], a[8:11], v[64:67], v[144:147]
    v_mfma_f32_16x16x32_bf16 v[148:151], a[64:67], v[64:67], v[148:151]
    v_mfma_f32_16x16x32_bf16 v[152:155], a[120:123], v[64:67], v[152:155]
    v_mfma_f32_16x16x32_bf16 v[156:159], a[176:179], v[64:67], v[156:159]
    global_load_dwordx4 v[64:67], v242, s[42:43] offset:-4096
    s_waitcnt vmcnt(32)
    v_mfma_f32_16x16x32_bf16 v[128:131], a[12:15], v[12:15], v[128:131]
    v_mfma_f32_16x16x32_bf16 v[132:135], a[68:71], v[12:15], v[132:135]
    v_mfma_f32_16x16x32_bf16 v[136:139], a[124:127], v[12:15], v[136:139]
    v_mfma_f32_16x16x32_bf16 v[140:143], a[180:183], v[12:15], v[140:143]
    global_load_dwordx4 v[12:15], v240, s[42:43] offset:-1024
    s_waitcnt vmcnt(32)
    v_mfma_f32_16x16x32_bf16 v[144:147], a[12:15], v[68:71], v[144:147]
    v_mfma_f32_16x16x32_bf16 v[148:151], a[68:71], v[68:71], v[148:151]
    v_mfma_f32_16x16x32_bf16 v[152:155], a[124:127], v[68:71], v[152:155]
    v_mfma_f32_16x16x32_bf16 v[156:159], a[180:183], v[68:71], v[156:159]
    global_load_dwordx4 v[68:71], v242, s[42:43] offset:-3072
    s_waitcnt vmcnt(32)
    v_mfma_f32_16x16x32_bf16 v[128:131], a[16:19], v[16:19], v[128:131]
    v_mfma_f32_16x16x32_bf16 v[132:135], a[72:75], v[16:19], v[132:135]
    v_mfma_f32_16x16x32_bf16 v[136:139], a[128:131], v[16:19], v[136:139]
    v_mfma_f32_16x16x32_bf16 v[140:143], a[184:187], v[16:19], v[140:143]
    global_load_dwordx4 v[16:19], v240, s[42:43] offset:0
    s_waitcnt vmcnt(32)
    v_mfma_f32_16x16x32_bf16 v[144:147], a[16:19], v[72:75], v[144:147]
    v_mfma_f32_16x16x32_bf16 v[148:151], a[72:75], v[72:75], v[148:151]
    v_mfma_f32_16x16x32_bf16 v[152:155], a[128:131], v[72:75], v[152:155]
    v_mfma_f32_16x16x32_bf16 v[156:159], a[184:187], v[72:75], v[156:159]
    global_load_dwordx4 v[72:75], v242, s[42:43] offset:-2048
    s_waitcnt vmcnt(32)
    v_mfma_f32_16x16x32_bf16 v[128:131], a[20:23], v[20:23], v[128:131]
    v_mfma_f32_16x16x32_bf16 v[132:135], a[76:79], v[20:23], v[132:135]
    v_mfma_f32_16x16x32_bf16 v[136:139], a[132:135], v[20:23], v[136:139]
    v_mfma_f32_16x16x32_bf16 v[140:143], a[188:191], v[20:23], v[140:143]
    global_load_dwordx4 v[20:23], v240, s[42:43] offset:1024
    s_waitcnt vmcnt(32)
    v_mfma_f32_16x16x32_bf16 v[144:147], a[20:23], v[76:79], v[144:147]
    v_mfma_f32_16x16x32_bf16 v[148:151], a[76:79], v[76:79], v[148:151]
    v_mfma_f32_16x16x32_bf16 v[152:155], a[132:135], v[76:79], v[152:155]
    v_mfma_f32_16x16x32_bf16 v[156:159], a[188:191], v[76:79], v[156:159]
    global_load_dwordx4 v[76:79], v242, s[42:43] offset:-1024
    s_waitcnt vmcnt(32)
    v_mfma_f32_16x16x32_bf16 v[128:131], a[24:27], v[24:27], v[128:131]
    v_mfma_f32_16x16x32_bf16 v[132:135], a[80:83], v[24:27], v[132:135]
    v_mfma_f32_16x16x32_bf16 v[136:139], a[136:139], v[24:27], v[136:139]
    v_mfma_f32_16x16x32_bf16 v[140:143], a[192:195], v[24:27], v[140:143]
    global_load_dwordx4 v[24:27], v240, s[42:43] offset:2048
    s_waitcnt vmcnt(32)
    v_mfma_f32_16x16x32_bf16 v[144:147], a[24:27], v[80:83], v[144:147]
    v_mfma_f32_16x16x32_bf16 v[148:151], a[80:83], v[80:83], v[148:151]
    v_mfma_f32_16x16x32_bf16 v[152:155], a[136:139], v[80:83], v[152:155]
    v_mfma_f32_16x16x32_bf16 v[156:159], a[192:195], v[80:83], v[156:159]
    global_load_dwordx4 v[80:83], v242, s[42:43] offset:0
    s_waitcnt vmcnt(32)
    v_mfma_f32_16x16x32_bf16 v[128:131], a[28:31], v[28:31], v[128:131]
    v_mfma_f32_16x16x32_bf16 v[132:135], a[84:87], v[28:31], v[132:135]
    v_mfma_f32_16x16x32_bf16 v[136:139], a[140:143], v[28:31], v[136:139]
    v_mfma_f32_16x16x32_bf16 v[140:143], a[196:199], v[28:31], v[140:143]
    global_load_dwordx4 v[28:31], v240, s[42:43] offset:3072
    s_waitcnt vmcnt(15)
    v_mov_b32 v246, s41
    s_mov_b64 exec, 1
    global_store_dword v249, v246, s[44:45] sc1
    s_mov_b64 exec, -1
    v_mfma_f32_16x16x32_bf16 v[144:147], a[28:31], v[84:87], v[144:147]
    v_mfma_f32_16x16x32_bf16 v[148:151], a[84:87], v[84:87], v[148:151]
    v_mfma_f32_16x16x32_bf16 v[152:155], a[140:143], v[84:87], v[152:155]
    v_mfma_f32_16x16x32_bf16 v[156:159], a[196:199], v[84:87], v[156:159]
    global_load_dwordx4 v[84:87], v242, s[42:43] offset:1024
    v_mfma_f32_16x16x32_bf16 v[128:131], a[32:35], v[32:35], v[128:131]
    v_mfma_f32_16x16x32_bf16 v[132:135], a[88:91], v[32:35], v[132:135]
    v_mfma_f32_16x16x32_bf16 v[136:139], a[144:147], v[32:35], v[136:139]
    v_mfma_f32_16x16x32_bf16 v[140:143], a[200:203], v[32:35], v[140:143]
    global_load_dwordx4 v[32:35], v241, s[42:43] offset:-4096
    v_mfma_f32_16x16x32_bf16 v[144:147], a[32:35], v[88:91], v[144:147]
    v_mfma_f32_16x16x32_bf16 v[148:151], a[88:91], v[88:91], v[148:151]
    v_mfma_f32_16x16x32_bf16 v[152:155], a[144:147], v[88:91], v[152:155]
    v_mfma_f32_16x16x32_bf16 v[156:159], a[200:203], v[88:91], v[156:159]
    global_load_dwordx4 v[88:91], v242, s[42:43] offset:2048
    v_mfma_f32_16x16x32_bf16 v[128:131], a[36:39], v[36:39], v[128:131]
    v_mfma_f32_16x16x32_bf16 v[132:135], a[92:95], v[36:39], v[132:135]
    v_mfma_f32_16x16x32_bf16 v[136:139], a[148:151], v[36:39], v[136:139]
    v_mfma_f32_16x16x32_bf16 v[140:143], a[204:207], v[36:39], v[140:143]
    global_load_dwordx4 v[36:39], v241, s[42:43] offset:-3072
    v_mfma_f32_16x16x32_bf16 v[144:147], a[36:39], v[92:95], v[144:147]
    v_mfma_f32_16x16x32_bf16 v[148:151], a[92:95], v[92:95], v[148:151]
    v_mfma_f32_16x16x32_bf16 v[152:155], a[148:151], v[92:95], v[152:155]
    v_mfma_f32_16x16x32_bf16 v[156:159], a[204:207], v[92:95], v[156:159]
    global_load_dwordx4 v[92:95], v242, s[42:43] offset:3072
    v_mfma_f32_16x16x32_bf16 v[128:131], a[40:43], v[40:43], v[128:131]
    v_mfma_f32_16x16x32_bf16 v[132:135], a[96:99], v[40:43], v[132:135]
    v_mfma_f32_16x16x32_bf16 v[136:139], a[152:155], v[40:43], v[136:139]
    v_mfma_f32_16x16x32_bf16 v[140:143], a[208:211], v[40:43], v[140:143]
    global_load_dwordx4 v[40:43], v241, s[42:43] offset:-2048
    v_mfma_f32_16x16x32_bf16 v[144:147], a[40:43], v[96:99], v[144:147]
    v_mfma_f32_16x16x32_bf16 v[148:151], a[96:99], v[96:99], v[148:151]
    v_mfma_f32_16x16x32_bf16 v[152:155], a[152:155], v[96:99], v[152:155]
    v_mfma_f32_16x16x32_bf16 v[156:159], a[208:211], v[96:99], v[156:159]
    global_load_dwordx4 v[96:99], v243, s[42:43] offset:-4096
    v_mfma_f32_16x16x32_bf16 v[128:131], a[44:47], v[44:47], v[128:131]
    v_mfma_f32_16x16x32_bf16 v[132:135], a[100:103], v[44:47], v[132:135]
    v_mfma_f32_16x16x32_bf16 v[136:139], a[156:159], v[44:47], v[136:139]
    v_mfma_f32_16x16x32_bf16 v[140:143], a[212:215], v[44:47], v[140:143]
    global_load_dwordx4 v[44:47], v241, s[42:43] offset:-1024
    v_mfma_f32_16x16x32_bf16 v[144:147], a[44:47], v[100:103], v[144:147]
    v_mfma_f32_16x16x32_bf16 v[148:151], a[100:103], v[100:103], v[148:151]
    v_mfma_f32_16x16x32_bf16 v[152:155], a[156:159], v[100:103], v[152:155]
    v_mfma_f32_16x16x32_bf16 v[156:159], a[212:215], v[100:103], v[156:159]
    global_load_dwordx4 v[100:103], v243, s[42:43] offset:-3072
    v_mfma_f32_16x16x32_bf16 v[128:131], a[48:51], v[48:51], v[128:131]
    v_mfma_f32_16x16x32_bf16 v[132:135], a[104:107], v[48:51], v[132:135]
    v_mfma_f32_16x16x32_bf16 v[136:139], a[160:163], v[48:51], v[136:139]
    v_mfma_f32_16x16x32_bf16 v[140:143], a[216:219], v[48:51], v[140:143]
    global_load_dwordx4 v[48:51], v241, s[42:43] offset:0
    v_mfma_f32_16x16x32_bf16 v[144:147], a[48:51], v[104:107], v[144:147]
    v_mfma_f32_16x16x32_bf16 v[148:151], a[104:107], v[104:107], v[148:151]
    v_mfma_f32_16x16x32_bf16 v[152:155], a[160:163], v[104:107], v[152:155]
    v_mfma_f32_16x16x32_bf16 v[156:159], a[216:219], v[104:107], v[156:159]
    global_load_dwordx4 v[104:107], v243, s[42:43] offset:-2048
    v_mfma_f32_16x16x32_bf16 v[128:131], a[52:55], v[52:55], v[128:131]
    v_mfma_f32_16x16x32_bf16 v[132:135], a[108:111], v[52:55], v[132:135]
    v_mfma_f32_16x16x32_bf16 v[136:139], a[164:167], v[52:55], v[136:139]
    v_mfma_f32_16x16x32_bf16 v[140:143], a[220:223], v[52:55], v[140:143]
    global_load_dwordx4 v[52:55], v241, s[42:43] offset:1024
    v_mfma_f32_16x16x32_bf16 v[144:147], a[52:55], v[108:111], v[144:147]
    v_mfma_f32_16x16x32_bf16 v[148:151], a[108:111], v[108:111], v[148:151]
    v_mfma_f32_16x16x32_bf16 v[152:155], a[164:167], v[108:111], v[152:155]
    v_mfma_f32_16x16x32_bf16 v[156:159], a[220:223], v[108:111], v[156:159]
    global_load_dwordx4 v[108:111], v243, s[42:43] offset:-1024
    s_nop 7
    s_mov_b32 s37, 1069066811
    s_mov_b32 s38, 0x358637bd
    v_mul_f32 v192, s37, v128
    v_mul_f32 v193, s37, v129
    v_mul_f32 v194, s37, v130
    v_mul_f32 v195, s37, v131
    v_mul_f32 v196, s37, v132
    v_mul_f32 v197, s37, v133
    v_mul_f32 v198, s37, v134
    v_mul_f32 v199, s37, v135
    v_exp_f32_e64 v192, v192 clamp
    v_exp_f32_e64 v193, v193 clamp
    v_exp_f32_e64 v194, v194 clamp
    v_exp_f32_e64 v195, v195 clamp
    v_exp_f32_e64 v196, v196 clamp
    v_exp_f32_e64 v197, v197 clamp
    v_exp_f32_e64 v198, v198 clamp
    v_exp_f32_e64 v199, v199 clamp
    v_max_f32 v128, 0, v128
    v_max_f32 v129, 0, v129
    v_max_f32 v130, 0, v130
    v_max_f32 v131, 0, v131
    v_max_f32 v132, 0, v132
    v_max_f32 v133, 0, v133
    v_max_f32 v134, 0, v134
    v_max_f32 v135, 0, v135
    v_add_f32 v128, v128, v192
    v_add_f32 v129, v129, v193
    v_add_f32 v130, v130, v194
    v_add_f32 v131, v131, v195
    v_add_f32 v132, v132, v196
    v_add_f32 v133, v133, v197
    v_add_f32 v134, v134, v198
    v_add_f32 v135, v135, v199
    v_add_f32 v128, s38, v128
    v_add_f32 v129, s38, v129
    v_add_f32 v130, s38, v130
    v_add_f32 v131, s38, v131
    v_add_f32 v132, s38, v132
    v_add_f32 v133, s38, v133
    v_add_f32 v134, s38, v134
    v_add_f32 v135, s38, v135
    v_cvt_pk_bf16_f32 v128, v128, v129
    v_cvt_pk_bf16_f32 v129, v130, v131
    v_cvt_pk_bf16_f32 v130, v132, v133
    v_cvt_pk_bf16_f32 v131, v134, v135
    v_mul_f32 v192, s37, v136
    v_mul_f32 v193, s37, v137
    v_mul_f32 v194, s37, v138
    v_mul_f32 v195, s37, v139
    v_mul_f32 v196, s37, v140
    v_mul_f32 v197, s37, v141
    v_mul_f32 v198, s37, v142
    v_mul_f32 v199, s37, v143
    v_exp_f32_e64 v192, v192 clamp
    v_exp_f32_e64 v193, v193 clamp
    v_exp_f32_e64 v194, v194 clamp
    v_exp_f32_e64 v195, v195 clamp
    v_exp_f32_e64 v196, v196 clamp
    v_exp_f32_e64 v197, v197 clamp
    v_exp_f32_e64 v198, v198 clamp
    v_exp_f32_e64 v199, v199 clamp
    v_max_f32 v136, 0, v136
    v_max_f32 v137, 0, v137
    v_max_f32 v138, 0, v138
    v_max_f32 v139, 0, v139
    v_max_f32 v140, 0, v140
    v_max_f32 v141, 0, v141
    v_max_f32 v142, 0, v142
    v_max_f32 v143, 0, v143
    v_add_f32 v136, v136, v192
    v_add_f32 v137, v137, v193
    v_add_f32 v138, v138, v194
    v_add_f32 v139, v139, v195
    v_add_f32 v140, v140, v196
    v_add_f32 v141, v141, v197
    v_add_f32 v142, v142, v198
    v_add_f32 v143, v143, v199
    v_add_f32 v136, s38, v136
    v_add_f32 v137, s38, v137
    v_add_f32 v138, s38, v138
    v_add_f32 v139, s38, v139
    v_add_f32 v140, s38, v140
    v_add_f32 v141, s38, v141
    v_add_f32 v142, s38, v142
    v_add_f32 v143, s38, v143
    v_cvt_pk_bf16_f32 v136, v136, v137
    v_cvt_pk_bf16_f32 v137, v138, v139
    v_cvt_pk_bf16_f32 v138, v140, v141
    v_cvt_pk_bf16_f32 v139, v142, v143
    v_mul_f32 v192, s37, v144
    v_mul_f32 v193, s37, v145
    v_mul_f32 v194, s37, v146
    v_mul_f32 v195, s37, v147
    v_mul_f32 v196, s37, v148
    v_mul_f32 v197, s37, v149
    v_mul_f32 v198, s37, v150
    v_mul_f32 v199, s37, v151
    v_exp_f32_e64 v192, v192 clamp
    v_exp_f32_e64 v193, v193 clamp
    v_exp_f32_e64 v194, v194 clamp
    v_exp_f32_e64 v195, v195 clamp
    v_exp_f32_e64 v196, v196 clamp
    v_exp_f32_e64 v197, v197 clamp
    v_exp_f32_e64 v198, v198 clamp
    v_exp_f32_e64 v199, v199 clamp
    v_max_f32 v144, 0, v144
    v_max_f32 v145, 0, v145
    v_max_f32 v146, 0, v146
    v_max_f32 v147, 0, v147
    v_max_f32 v148, 0, v148
    v_max_f32 v149, 0, v149
    v_max_f32 v150, 0, v150
    v_max_f32 v151, 0, v151
    v_add_f32 v144, v144, v192
    v_add_f32 v145, v145, v193
    v_add_f32 v146, v146, v194
    v_add_f32 v147, v147, v195
    v_add_f32 v148, v148, v196
    v_add_f32 v149, v149, v197
    v_add_f32 v150, v150, v198
    v_add_f32 v151, v151, v199
    v_add_f32 v144, s38, v144
    v_add_f32 v145, s38, v145
    v_add_f32 v146, s38, v146
    v_add_f32 v147, s38, v147
    v_add_f32 v148, s38, v148
    v_add_f32 v149, s38, v149
    v_add_f32 v150, s38, v150
    v_add_f32 v151, s38, v151
    v_cvt_pk_bf16_f32 v144, v144, v145
    v_cvt_pk_bf16_f32 v145, v146, v147
    v_cvt_pk_bf16_f32 v146, v148, v149
    v_cvt_pk_bf16_f32 v147, v150, v151
    v_mul_f32 v192, s37, v152
    v_mul_f32 v193, s37, v153
    v_mul_f32 v194, s37, v154
    v_mul_f32 v195, s37, v155
    v_mul_f32 v196, s37, v156
    v_mul_f32 v197, s37, v157
    v_mul_f32 v198, s37, v158
    v_mul_f32 v199, s37, v159
    v_exp_f32_e64 v192, v192 clamp
    v_exp_f32_e64 v193, v193 clamp
    v_exp_f32_e64 v194, v194 clamp
    v_exp_f32_e64 v195, v195 clamp
    v_exp_f32_e64 v196, v196 clamp
    v_exp_f32_e64 v197, v197 clamp
    v_exp_f32_e64 v198, v198 clamp
    v_exp_f32_e64 v199, v199 clamp
    v_max_f32 v152, 0, v152
    v_max_f32 v153, 0, v153
    v_max_f32 v154, 0, v154
    v_max_f32 v155, 0, v155
    v_max_f32 v156, 0, v156
    v_max_f32 v157, 0, v157
    v_max_f32 v158, 0, v158
    v_max_f32 v159, 0, v159
    v_add_f32 v152, v152, v192
    v_add_f32 v153, v153, v193
    v_add_f32 v154, v154, v194
    v_add_f32 v155, v155, v195
    v_add_f32 v156, v156, v196
    v_add_f32 v157, v157, v197
    v_add_f32 v158, v158, v198
    v_add_f32 v159, v159, v199
    v_add_f32 v152, s38, v152
    v_add_f32 v153, s38, v153
    v_add_f32 v154, s38, v154
    v_add_f32 v155, s38, v155
    v_add_f32 v156, s38, v156
    v_add_f32 v157, s38, v157
    v_add_f32 v158, s38, v158
    v_add_f32 v159, s38, v159
    v_cvt_pk_bf16_f32 v152, v152, v153
    v_cvt_pk_bf16_f32 v153, v154, v155
    v_cvt_pk_bf16_f32 v154, v156, v157
    v_cvt_pk_bf16_f32 v155, v158, v159
    s_nop 1
    v_mfma_f32_16x16x32_bf16 v[192:195], v[160:163], v[128:131], 0
    v_mfma_f32_16x16x32_bf16 v[196:199], v[164:167], v[128:131], 0
    v_mfma_f32_16x16x32_bf16 v[200:203], v[168:171], v[128:131], 0
    v_mfma_f32_16x16x32_bf16 v[204:207], v[172:175], v[136:139], 0
    v_mfma_f32_16x16x32_bf16 v[208:211], v[176:179], v[136:139], 0
    v_mfma_f32_16x16x32_bf16 v[212:215], v[180:183], v[136:139], 0
    v_mfma_f32_16x16x32_bf16 v[216:219], v[160:163], v[144:147], 0
    v_mfma_f32_16x16x32_bf16 v[220:223], v[164:167], v[144:147], 0
    v_mfma_f32_16x16x32_bf16 v[224:227], v[168:171], v[144:147], 0
    v_mfma_f32_16x16x32_bf16 v[228:231], v[172:175], v[152:155], 0
    v_mfma_f32_16x16x32_bf16 v[232:235], v[176:179], v[152:155], 0
    v_mfma_f32_16x16x32_bf16 v[236:239], v[180:183], v[152:155], 0
    s_nop 7
    v_add_f32 v200, s38, v200
    v_rcp_f32 v200, v200
    v_add_f32 v212, s38, v212
    v_rcp_f32 v212, v212
    v_add_f32 v224, s38, v224
    v_rcp_f32 v224, v224
    v_add_f32 v236, s38, v236
    v_rcp_f32 v236, v236
    v_mul_f32 v192, v192, v200
    v_mul_f32 v193, v193, v200
    v_mul_f32 v194, v194, v200
    v_mul_f32 v195, v195, v200
    v_mul_f32 v196, v196, v200
    v_mul_f32 v197, v197, v200
    v_mul_f32 v198, v198, v200
    v_mul_f32 v199, v199, v200
    v_cvt_pk_bf16_f32 v192, v192, v193
    v_cvt_pk_bf16_f32 v193, v194, v195
    v_cvt_pk_bf16_f32 v194, v196, v197
    v_cvt_pk_bf16_f32 v195, v198, v199
    global_store_dwordx4 v240, v[192:195], s[46:47] offset:0 sc1
    v_mul_f32 v204, v204, v212
    v_mul_f32 v205, v205, v212
    v_mul_f32 v206, v206, v212
    v_mul_f32 v207, v207, v212
    v_mul_f32 v208, v208, v212
    v_mul_f32 v209, v209, v212
    v_mul_f32 v210, v210, v212
    v_mul_f32 v211, v211, v212
    v_cvt_pk_bf16_f32 v204, v204, v205
    v_cvt_pk_bf16_f32 v205, v206, v207
    v_cvt_pk_bf16_f32 v206, v208, v209
    v_cvt_pk_bf16_f32 v207, v210, v211
    global_store_dwordx4 v240, v[204:207], s[46:47] offset:1024 sc1
    v_mul_f32 v216, v216, v224
    v_mul_f32 v217, v217, v224
    v_mul_f32 v218, v218, v224
    v_mul_f32 v219, v219, v224
    v_mul_f32 v220, v220, v224
    v_mul_f32 v221, v221, v224
    v_mul_f32 v222, v222, v224
    v_mul_f32 v223, v223, v224
    v_cvt_pk_bf16_f32 v216, v216, v217
    v_cvt_pk_bf16_f32 v217, v218, v219
    v_cvt_pk_bf16_f32 v218, v220, v221
    v_cvt_pk_bf16_f32 v219, v222, v223
    global_store_dwordx4 v242, v[216:219], s[46:47] offset:0 sc1
    v_mul_f32 v228, v228, v236
    v_mul_f32 v229, v229, v236
    v_mul_f32 v230, v230, v236
    v_mul_f32 v231, v231, v236
    v_mul_f32 v232, v232, v236
    v_mul_f32 v233, v233, v236
    v_mul_f32 v234, v234, v236
    v_mul_f32 v235, v235, v236
    v_cvt_pk_bf16_f32 v228, v228, v229
    v_cvt_pk_bf16_f32 v229, v230, v231
    v_cvt_pk_bf16_f32 v230, v232, v233
    v_cvt_pk_bf16_f32 v231, v234, v235
    global_store_dwordx4 v242, v[228:231], s[46:47] offset:1024 sc1
    s_add_u32 s46, s46, 131072
    s_addc_u32 s47, s47, 0
    s_add_u32 s41, s41, 1
    s_cmp_lt_u32 s41, 3
    s_cselect_b32 s36, 114688, 0
    s_add_u32 s42, s42, s36
    s_addc_u32 s43, s43, 0
    s_cmp_lt_u32 s41, 4
    s_cbranch_scc1 L_b2
    s_waitcnt vmcnt(0)
    v_mov_b32 v246, 4
    s_mov_b64 exec, 1
    global_store_dword v249, v246, s[44:45] sc1
    s_mov_b64 exec, -1
    s_cmp_ge_u32 s48, 28
    s_cbranch_scc1 L_end
    s_mul_i32 s49, s48, 37
    s_lshr_b32 s49, s49, 8
    s_mul_i32 s39, s49, 7
    s_sub_u32 s39, s48, s39
    s_lshl_b32 s39, s39, 7
    s_lshl_b32 s36, s31, 2
    s_mul_i32 s37, s36, 896
    v_mov_b32 v247, s39
    v_bfe_u32 v246, v245, 3, 1
    v_lshl_add_u32 v247, v246, 6, v247
    v_bfe_u32 v246, v245, 2, 1
    v_lshl_add_u32 v247, v246, 3, v247
    v_bfe_u32 v246, v245, 0, 2
    v_lshl_add_u32 v247, v246, 4, v247
    v_mov_b32 v248, s37
    v_bfe_u32 v246, v245, 4, 2
    v_mul_u32_u24 v246, 896, v246
    v_add_u32 v248, v246, v248
    v_add_u32 v247, v247, v248
    s_mul_i32 s37, s36, 144
    v_mov_b32 v248, s37
    v_bfe_u32 v246, v245, 4, 2
    v_mul_u32_u24 v246, 144, v246
    v_add_u32 v248, v246, v248
    v_bfe_u32 v246, v245, 0, 4
    v_lshl_add_u32 v248, v246, 3, v248
    s_add_u32 s50, s22, 0
    s_addc_u32 s51, s23, 0
    global_load_dwordx2 v[0:1], v247, s[50:51]
    s_add_u32 s50, s50, 14336
    s_addc_u32 s51, s51, 0
    global_load_dwordx2 v[2:3], v247, s[50:51]
    s_add_u32 s50, s50, 14336
    s_addc_u32 s51, s51, 0
    global_load_dwordx2 v[4:5], v247, s[50:51]
    s_add_u32 s50, s50, 14336
    s_addc_u32 s51, s51, 0
    global_load_dwordx2 v[6:7], v247, s[50:51]
    s_add_u32 s50, s50, 14336
    s_addc_u32 s51, s51, 0
    global_load_dwordx2 v[8:9], v247, s[50:51]
    s_add_u32 s50, s50, 14336
    s_addc_u32 s51, s51, 0
    global_load_dwordx2 v[10:11], v247, s[50:51]
    s_add_u32 s50, s50, 14336
    s_addc_u32 s51, s51, 0
    global_load_dwordx2 v[12:13], v247, s[50:51]
    s_add_u32 s50, s50, 14336
    s_addc_u32 s51, s51, 0
    global_load_dwordx2 v[14:15], v247, s[50:51]
    s_add_u32 s50, s50, 14336
    s_addc_u32 s51, s51, 0
    global_load_dwordx2 v[16:17], v247, s[50:51]
    s_add_u32 s50, s50, 14336
    s_addc_u32 s51, s51, 0
    global_load_dwordx2 v[18:19], v247, s[50:51]
    s_add_u32 s50, s50, 14336
    s_addc_u32 s51, s51, 0
    global_load_dwordx2 v[20:21], v247, s[50:51]
    s_add_u32 s50, s50, 14336
    s_addc_u32 s51, s51, 0
    global_load_dwordx2 v[22:23], v247, s[50:51]
    s_add_u32 s50, s50, 14336
    s_addc_u32 s51, s51, 0
    global_load_dwordx2 v[24:25], v247, s[50:51]
    s_add_u32 s50, s50, 14336
    s_addc_u32 s51, s51, 0
    global_load_dwordx2 v[26:27], v247, s[50:51]
    s_add_u32 s50, s50, 14336
    s_addc_u32 s51, s51, 0
    global_load_dwordx2 v[28:29], v247, s[50:51]
    s_add_u32 s50, s50, 14336
    s_addc_u32 s51, s51, 0
    global_load_dwordx2 v[30:31], v247, s[50:51]
    s_add_u32 s50, s50, 14336
    s_addc_u32 s51, s51, 0
    global_load_dwordx2 v[32:33], v247, s[50:51]
    s_add_u32 s50, s50, 14336
    s_addc_u32 s51, s51, 0
    global_load_dwordx2 v[34:35], v247, s[50:51]
    s_add_u32 s50, s50, 14336
    s_addc_u32 s51, s51, 0
    global_load_dwordx2 v[36:37], v247, s[50:51]
    s_add_u32 s50, s50, 14336
    s_addc_u32 s51, s51, 0
    global_load_dwordx2 v[38:39], v247, s[50:51]
    s_add_u32 s50, s50, 14336
    s_addc_u32 s51, s51, 0
    global_load_dwordx2 v[40:41], v247, s[50:51]
    s_add_u32 s50, s50, 14336
    s_addc_u32 s51, s51, 0
    global_load_dwordx2 v[42:43], v247, s[50:51]
    s_add_u32 s50, s50, 14336
    s_addc_u32 s51, s51, 0
    global_load_dwordx2 v[44:45], v247, s[50:51]
    s_add_u32 s50, s50, 14336
    s_addc_u32 s51, s51, 0
    global_load_dwordx2 v[46:47], v247, s[50:51]
    s_add_u32 s50, s50, 14336
    s_addc_u32 s51, s51, 0
    global_load_dwordx2 v[48:49], v247, s[50:51]
    s_add_u32 s50, s50, 14336
    s_addc_u32 s51, s51, 0
    global_load_dwordx2 v[50:51], v247, s[50:51]
    s_add_u32 s50, s50, 14336
    s_addc_u32 s51, s51, 0
    global_load_dwordx2 v[52:53], v247, s[50:51]
    s_add_u32 s50, s50, 14336
    s_addc_u32 s51, s51, 0
    global_load_dwordx2 v[54:55], v247, s[50:51]
    s_barrier
    s_waitcnt vmcnt(27)
    ds_write_b64 v248, v[0:1] offset:0
    s_waitcnt vmcnt(26)
    ds_write_b64 v248, v[2:3] offset:2304
    s_waitcnt vmcnt(25)
    ds_write_b64 v248, v[4:5] offset:4608
    s_waitcnt vmcnt(24)
    ds_write_b64 v248, v[6:7] offset:6912
    s_waitcnt vmcnt(23)
    ds_write_b64 v248, v[8:9] offset:9216
    s_waitcnt vmcnt(22)
    ds_write_b64 v248, v[10:11] offset:11520
    s_waitcnt vmcnt(21)
    ds_write_b64 v248, v[12:13] offset:13824
    s_waitcnt vmcnt(20)
    ds_write_b64 v248, v[14:15] offset:16128
    s_waitcnt vmcnt(19)
    ds_write_b64 v248, v[16:17] offset:18432
    s_waitcnt vmcnt(18)
    ds_write_b64 v248, v[18:19] offset:20736
    s_waitcnt vmcnt(17)
    ds_write_b64 v248, v[20:21] offset:23040
    s_waitcnt vmcnt(16)
    ds_write_b64 v248, v[22:23] offset:25344
    s_waitcnt vmcnt(15)
    ds_write_b64 v248, v[24:25] offset:27648
    s_waitcnt vmcnt(14)
    ds_write_b64 v248, v[26:27] offset:29952
    s_waitcnt vmcnt(13)
    ds_write_b64 v248, v[28:29] offset:32256
    s_waitcnt vmcnt(12)
    ds_write_b64 v248, v[30:31] offset:34560
    s_waitcnt vmcnt(11)
    ds_write_b64 v248, v[32:33] offset:36864
    s_waitcnt vmcnt(10)
    ds_write_b64 v248, v[34:35] offset:39168
    s_waitcnt vmcnt(9)
    ds_write_b64 v248, v[36:37] offset:41472
    s_waitcnt vmcnt(8)
    ds_write_b64 v248, v[38:39] offset:43776
    s_waitcnt vmcnt(7)
    ds_write_b64 v248, v[40:41] offset:46080
    s_waitcnt vmcnt(6)
    ds_write_b64 v248, v[42:43] offset:48384
    s_waitcnt vmcnt(5)
    ds_write_b64 v248, v[44:45] offset:50688
    s_waitcnt vmcnt(4)
    ds_write_b64 v248, v[46:47] offset:52992
    s_waitcnt vmcnt(3)
    ds_write_b64 v248, v[48:49] offset:55296
    s_waitcnt vmcnt(2)
    ds_write_b64 v248, v[50:51] offset:57600
    s_waitcnt vmcnt(1)
    ds_write_b64 v248, v[52:53] offset:59904
    s_waitcnt vmcnt(0)
    ds_write_b64 v248, v[54:55] offset:62208
    ds_write_b64 v248, v[54:55] offset:64512
    v_mov_b32 v247, 0
    v_bfe_u32 v246, v245, 4, 2
    v_mul_u32_u24 v246, 576, v246
    v_add_u32 v247, v246, v247
    v_bfe_u32 v246, v245, 2, 2
    v_mul_u32_u24 v246, 144, v246
    v_add_u32 v247, v246, v247
    v_bfe_u32 v246, v245, 0, 2
    v_lshl_add_u32 v247, v246, 3, v247
    s_waitcnt lgkmcnt(0)
    s_barrier
    ds_read_b64_tr_b16 a[0:1], v247 offset:0
    ds_read_b64_tr_b16 a[2:3], v247 offset:2304
    ds_read_b64_tr_b16 a[4:5], v247 offset:4032
    ds_read_b64_tr_b16 a[6:7], v247 offset:6336
    ds_read_b64_tr_b16 a[8:9], v247 offset:8064
    ds_read_b64_tr_b16 a[10:11], v247 offset:10368
    ds_read_b64_tr_b16 a[12:13], v247 offset:12096
    ds_read_b64_tr_b16 a[14:15], v247 offset:14400
    s_waitcnt lgkmcnt(8)
    ds_read_b64_tr_b16 a[16:17], v247 offset:16128
    ds_read_b64_tr_b16 a[18:19], v247 offset:18432
    ds_read_b64_tr_b16 a[20:21], v247 offset:20160
    ds_read_b64_tr_b16 a[22:23], v247 offset:22464
    ds_read_b64_tr_b16 a[24:25], v247 offset:24192
    ds_read_b64_tr_b16 a[26:27], v247 offset:26496
    ds_read_b64_tr_b16 a[28:29], v247 offset:28224
    ds_read_b64_tr_b16 a[30:31], v247 offset:30528
    s_waitcnt lgkmcnt(8)
    ds_read_b64_tr_b16 a[32:33], v247 offset:32256
    ds_read_b64_tr_b16 a[34:35], v247 offset:34560
    ds_read_b64_tr_b16 a[36:37], v247 offset:36288
    ds_read_b64_tr_b16 a[38:39], v247 offset:38592
    ds_read_b64_tr_b16 a[40:41], v247 offset:40320
    ds_read_b64_tr_b16 a[42:43], v247 offset:42624
    ds_read_b64_tr_b16 a[44:45], v247 offset:44352
    ds_read_b64_tr_b16 a[46:47], v247 offset:46656
    s_waitcnt lgkmcnt(8)
    ds_read_b64_tr_b16 a[48:49], v247 offset:48384
    ds_read_b64_tr_b16 a[50:51], v247 offset:50688
    ds_read_b64_tr_b16 a[52:53], v247 offset:52416
    ds_read_b64_tr_b16 a[54:55], v247 offset:54720
    ds_read_b64_tr_b16 a[56:57], v247 offset:56448
    ds_read_b64_tr_b16 a[58:59], v247 offset:58752
    ds_read_b64_tr_b16 a[60:61], v247 offset:60480
    ds_read_b64_tr_b16 a[62:63], v247 offset:62784
    s_waitcnt lgkmcnt(8)
    ds_read_b64_tr_b16 a[64:65], v247 offset:32
    ds_read_b64_tr_b16 a[66:67], v247 offset:2336
    ds_read_b64_tr_b16 a[68:69], v247 offset:4064
    ds_read_b64_tr_b16 a[70:71], v247 offset:6368
    ds_read_b64_tr_b16 a[72:73], v247 offset:8096
    ds_read_b64_tr_b16 a[74:75], v247 offset:10400
    ds_read_b64_tr_b16 a[76:77], v247 offset:12128
    ds_read_b64_tr_b16 a[78:79], v247 offset:14432
    s_waitcnt lgkmcnt(8)
    ds_read_b64_tr_b16 a[80:81], v247 offset:16160
    ds_read_b64_tr_b16 a[82:83], v247 offset:18464
    ds_read_b64_tr_b16 a[84:85], v247 offset:20192
    ds_read_b64_tr_b16 a[86:87], v247 offset:22496
    ds_read_b64_tr_b16 a[88:89], v247 offset:24224
    ds_read_b64_tr_b16 a[90:91], v247 offset:26528
    ds_read_b64_tr_b16 a[92:93], v247 offset:28256
    ds_read_b64_tr_b16 a[94:95], v247 offset:30560
    s_waitcnt lgkmcnt(8)
    ds_read_b64_tr_b16 a[96:97], v247 offset:32288
    ds_read_b64_tr_b16 a[98:99], v247 offset:34592
    ds_read_b64_tr_b16 a[100:101], v247 offset:36320
    ds_read_b64_tr_b16 a[102:103], v247 offset:38624
    ds_read_b64_tr_b16 a[104:105], v247 offset:40352
    ds_read_b64_tr_b16 a[106:107], v247 offset:42656
    ds_read_b64_tr_b16 a[108:109], v247 offset:44384
    ds_read_b64_tr_b16 a[110:111], v247 offset:46688
    s_waitcnt lgkmcnt(8)
    ds_read_b64_tr_b16 a[112:113], v247 offset:48416
    ds_read_b64_tr_b16 a[114:115], v247 offset:50720
    ds_read_b64_tr_b16 a[116:117], v247 offset:52448
    ds_read_b64_tr_b16 a[118:119], v247 offset:54752
    ds_read_b64_tr_b16 a[120:121], v247 offset:56480
    ds_read_b64_tr_b16 a[122:123], v247 offset:58784
    ds_read_b64_tr_b16 a[124:125], v247 offset:60512
    ds_read_b64_tr_b16 a[126:127], v247 offset:62816
    s_waitcnt lgkmcnt(8)
    ds_read_b64_tr_b16 a[128:129], v247 offset:64
    ds_read_b64_tr_b16 a[130:131], v247 offset:2368
    ds_read_b64_tr_b16 a[132:133], v247 offset:4096
    ds_read_b64_tr_b16 a[134:135], v247 offset:6400
    ds_read_b64_tr_b16 a[136:137], v247 offset:8128
    ds_read_b64_tr_b16 a[138:139], v247 offset:10432
    ds_read_b64_tr_b16 a[140:141], v247 offset:12160
    ds_read_b64_tr_b16 a[142:143], v247 offset:14464
    s_waitcnt lgkmcnt(8)
    ds_read_b64_tr_b16 a[144:145], v247 offset:16192
    ds_read_b64_tr_b16 a[146:147], v247 offset:18496
    ds_read_b64_tr_b16 a[148:149], v247 offset:20224
    ds_read_b64_tr_b16 a[150:151], v247 offset:22528
    ds_read_b64_tr_b16 a[152:153], v247 offset:24256
    ds_read_b64_tr_b16 a[154:155], v247 offset:26560
    ds_read_b64_tr_b16 a[156:157], v247 offset:28288
    ds_read_b64_tr_b16 a[158:159], v247 offset:30592
    s_waitcnt lgkmcnt(8)
    ds_read_b64_tr_b16 a[160:161], v247 offset:32320
    ds_read_b64_tr_b16 a[162:163], v247 offset:34624
    ds_read_b64_tr_b16 a[164:165], v247 offset:36352
    ds_read_b64_tr_b16 a[166:167], v247 offset:38656
    ds_read_b64_tr_b16 a[168:169], v247 offset:40384
    ds_read_b64_tr_b16 a[170:171], v247 offset:42688
    ds_read_b64_tr_b16 a[172:173], v247 offset:44416
    ds_read_b64_tr_b16 a[174:175], v247 offset:46720
    s_waitcnt lgkmcnt(8)
    ds_read_b64_tr_b16 a[176:177], v247 offset:48448
    ds_read_b64_tr_b16 a[178:179], v247 offset:50752
    ds_read_b64_tr_b16 a[180:181], v247 offset:52480
    ds_read_b64_tr_b16 a[182:183], v247 offset:54784
    ds_read_b64_tr_b16 a[184:185], v247 offset:56512
    ds_read_b64_tr_b16 a[186:187], v247 offset:58816
    ds_read_b64_tr_b16 a[188:189], v247 offset:60544
    ds_read_b64_tr_b16 a[190:191], v247 offset:62848
    s_waitcnt lgkmcnt(8)
    ds_read_b64_tr_b16 a[192:193], v247 offset:96
    ds_read_b64_tr_b16 a[194:195], v247 offset:2400
    ds_read_b64_tr_b16 a[196:197], v247 offset:4128
    ds_read_b64_tr_b16 a[198:199], v247 offset:6432
    ds_read_b64_tr_b16 a[200:201], v247 offset:8160
    ds_read_b64_tr_b16 a[202:203], v247 offset:10464
    ds_read_b64_tr_b16 a[204:205], v247 offset:12192
    ds_read_b64_tr_b16 a[206:207], v247 offset:14496
    s_waitcnt lgkmcnt(8)
    ds_read_b64_tr_b16 a[208:209], v247 offset:16224
    ds_read_b64_tr_b16 a[210:211], v247 offset:18528
    ds_read_b64_tr_b16 a[212:213], v247 offset:20256
    ds_read_b64_tr_b16 a[214:215], v247 offset:22560
    ds_read_b64_tr_b16 a[216:217], v247 offset:24288
    ds_read_b64_tr_b16 a[218:219], v247 offset:26592
    ds_read_b64_tr_b16 a[220:221], v247 offset:28320
    ds_read_b64_tr_b16 a[222:223], v247 offset:30624
    s_waitcnt lgkmcnt(8)
    ds_read_b64_tr_b16 a[224:225], v247 offset:32352
    ds_read_b64_tr_b16 a[226:227], v247 offset:34656
    ds_read_b64_tr_b16 a[228:229], v247 offset:36384
    ds_read_b64_tr_b16 a[230:231], v247 offset:38688
    ds_read_b64_tr_b16 a[232:233], v247 offset:40416
    ds_read_b64_tr_b16 a[234:235], v247 offset:42720
    ds_read_b64_tr_b16 a[236:237], v247 offset:44448
    ds_read_b64_tr_b16 a[238:239], v247 offset:46752
    s_waitcnt lgkmcnt(8)
    ds_read_b64_tr_b16 a[240:241], v247 offset:48480
    ds_read_b64_tr_b16 a[242:243], v247 offset:50784
    ds_read_b64_tr_b16 a[244:245], v247 offset:52512
    ds_read_b64_tr_b16 a[246:247], v247 offset:54816
    ds_read_b64_tr_b16 a[248:249], v247 offset:56544
    ds_read_b64_tr_b16 a[250:251], v247 offset:58848
    ds_read_b64_tr_b16 a[252:253], v247 offset:60576
    ds_read_b64_tr_b16 a[254:255], v247 offset:62880
    s_waitcnt lgkmcnt(8)
    s_waitcnt lgkmcnt(0)
    s_lshl_b32 s36, s49, 2
    s_add_u32 s36, s36, s31
    s_mul_i32 s37, s36, 32
    s_add_u32 s37, s37, 14810624
    s_add_u32 s50, s28, s37
    s_addc_u32 s51, s29, 0
    v_mov_b32 v247, 0
    v_bfe_u32 v246, v245, 0, 3
    v_lshl_add_u32 v247, v246, 2, v247
L_b3_w:
    global_load_dword v248, v247, s[50:51] sc1
    s_sub_u32 s35, s35, 1
    s_cbranch_scc1 L_bail
    s_waitcnt vmcnt(0)
    v_cmp_ge_i32 vcc, 3, v248
    s_cbranch_vccz L_b3_w_ok
    s_sleep 2
    s_branch L_b3_w
L_b3_w_ok:
    s_lshl_b32 s36, s49, 4
    s_add_u32 s36, s36, s31
    s_mul_i32 s37, s36, 32768
    s_add_u32 s37, s37, 19927040
    s_add_u32 s42, s28, s37
    s_addc_u32 s43, s29, 0
    s_mul_i32 s37, s36, 57344
    s_add_u32 s37, s37, 896
    s_add_u32 s46, s24, s37
    s_addc_u32 s47, s25, 0
    s_add_u32 s46, s46, s39
    s_addc_u32 s47, s47, 0
    v_mov_b32 v247, 0
    v_bfe_u32 v246, v245, 2, 2
    v_mul_u32_u24 v246, 14336, v246
    v_add_u32 v247, v246, v247
    v_bfe_u32 v246, v245, 0, 2
    v_mul_u32_u24 v246, 1792, v246
    v_add_u32 v247, v246, v247
    v_bfe_u32 v246, v245, 4, 2
    v_lshl_add_u32 v247, v246, 4, v247
    v_add_u32 v248, 7168, v247
    global_load_dwordx4 v[0:3], v240, s[42:43] offset:-4096 sc1
    global_load_dwordx4 v[64:67], v242, s[42:43] offset:-4096 sc1
    global_load_dwordx4 v[4:7], v240, s[42:43] offset:-3072 sc1
    global_load_dwordx4 v[68:71], v242, s[42:43] offset:-3072 sc1
    global_load_dwordx4 v[8:11], v240, s[42:43] offset:-2048 sc1
    global_load_dwordx4 v[72:75], v242, s[42:43] offset:-2048 sc1
    global_load_dwordx4 v[12:15], v240, s[42:43] offset:-1024 sc1
    global_load_dwordx4 v[76:79], v242, s[42:43] offset:-1024 sc1
    global_load_dwordx4 v[16:19], v240, s[42:43] offset:0 sc1
    global_load_dwordx4 v[80:83], v242, s[42:43] offset:0 sc1
    global_load_dwordx4 v[20:23], v240, s[42:43] offset:1024 sc1
    global_load_dwordx4 v[84:87], v242, s[42:43] offset:1024 sc1
    global_load_dwordx4 v[24:27], v240, s[42:43] offset:2048 sc1
    global_load_dwordx4 v[88:91], v242, s[42:43] offset:2048 sc1
    global_load_dwordx4 v[28:31], v240, s[42:43] offset:3072 sc1
    global_load_dwordx4 v[92:95], v242, s[42:43] offset:3072 sc1
    global_load_dwordx4 v[32:35], v241, s[42:43] offset:-4096 sc1
    global_load_dwordx4 v[96:99], v243, s[42:43] offset:-4096 sc1
    global_load_dwordx4 v[36:39], v241, s[42:43] offset:-3072 sc1
    global_load_dwordx4 v[100:103], v243, s[42:43] offset:-3072 sc1
    global_load_dwordx4 v[40:43], v241, s[42:43] offset:-2048 sc1
    global_load_dwordx4 v[104:107], v243, s[42:43] offset:-2048 sc1
    global_load_dwordx4 v[44:47], v241, s[42:43] offset:-1024 sc1
    global_load_dwordx4 v[108:111], v243, s[42:43] offset:-1024 sc1
    global_load_dwordx4 v[48:51], v241, s[42:43] offset:0 sc1
    global_load_dwordx4 v[112:115], v243, s[42:43] offset:0 sc1
    global_load_dwordx4 v[52:55], v241, s[42:43] offset:1024 sc1
    global_load_dwordx4 v[116:119], v243, s[42:43] offset:1024 sc1
    global_load_dwordx4 v[56:59], v241, s[42:43] offset:2048 sc1
    global_load_dwordx4 v[120:123], v243, s[42:43] offset:2048 sc1
    global_load_dwordx4 v[60:63], v241, s[42:43] offset:3072 sc1
    global_load_dwordx4 v[124:127], v243, s[42:43] offset:3072 sc1
    global_load_dword v250, v240, s[42:43]
    global_load_dword v250, v240, s[42:43]
    global_load_dword v250, v240, s[42:43]
    global_load_dword v250, v240, s[42:43]
    s_add_u32 s42, s42, 131072
    s_addc_u32 s43, s43, 0
    s_mov_b32 s41, 0
L_b3:
    s_waitcnt vmcnt(35)
    v_mfma_f32_16x16x32_bf16 v[128:131], a[0:3], v[0:3], 0
    v_mfma_f32_16x16x32_bf16 v[132:135], a[64:67], v[0:3], 0
    v_mfma_f32_16x16x32_bf16 v[136:139], a[128:131], v[0:3], 0
    v_mfma_f32_16x16x32_bf16 v[140:143], a[192:195], v[0:3], 0
    global_load_dwordx4 v[0:3], v240, s[42:43] offset:-4096 sc1
    s_waitcnt vmcnt(35)
    v_mfma_f32_16x16x32_bf16 v[144:147], a[0:3], v[64:67], 0
    v_mfma_f32_16x16x32_bf16 v[148:151], a[64:67], v[64:67], 0
    v_mfma_f32_16x16x32_bf16 v[152:155], a[128:131], v[64:67], 0
    v_mfma_f32_16x16x32_bf16 v[156:159], a[192:195], v[64:67], 0
    global_load_dwordx4 v[64:67], v242, s[42:43] offset:-4096 sc1
    s_waitcnt vmcnt(35)
    v_mfma_f32_16x16x32_bf16 v[128:131], a[4:7], v[4:7], v[128:131]
    v_mfma_f32_16x16x32_bf16 v[132:135], a[68:71], v[4:7], v[132:135]
    v_mfma_f32_16x16x32_bf16 v[136:139], a[132:135], v[4:7], v[136:139]
    v_mfma_f32_16x16x32_bf16 v[140:143], a[196:199], v[4:7], v[140:143]
    global_load_dwordx4 v[4:7], v240, s[42:43] offset:-3072 sc1
    s_waitcnt vmcnt(35)
    v_mfma_f32_16x16x32_bf16 v[144:147], a[4:7], v[68:71], v[144:147]
    v_mfma_f32_16x16x32_bf16 v[148:151], a[68:71], v[68:71], v[148:151]
    v_mfma_f32_16x16x32_bf16 v[152:155], a[132:135], v[68:71], v[152:155]
    v_mfma_f32_16x16x32_bf16 v[156:159], a[196:199], v[68:71], v[156:159]
    global_load_dwordx4 v[68:71], v242, s[42:43] offset:-3072 sc1
    s_waitcnt vmcnt(35)
    v_mfma_f32_16x16x32_bf16 v[128:131], a[8:11], v[8:11], v[128:131]
    v_mfma_f32_16x16x32_bf16 v[132:135], a[72:75], v[8:11], v[132:135]
    v_mfma_f32_16x16x32_bf16 v[136:139], a[136:139], v[8:11], v[136:139]
    v_mfma_f32_16x16x32_bf16 v[140:143], a[200:203], v[8:11], v[140:143]
    global_load_dwordx4 v[8:11], v240, s[42:43] offset:-2048 sc1
    s_waitcnt vmcnt(35)
    v_mfma_f32_16x16x32_bf16 v[144:147], a[8:11], v[72:75], v[144:147]
    v_mfma_f32_16x16x32_bf16 v[148:151], a[72:75], v[72:75], v[148:151]
    v_mfma_f32_16x16x32_bf16 v[152:155], a[136:139], v[72:75], v[152:155]
    v_mfma_f32_16x16x32_bf16 v[156:159], a[200:203], v[72:75], v[156:159]
    global_load_dwordx4 v[72:75], v242, s[42:43] offset:-2048 sc1
    s_waitcnt vmcnt(35)
    v_mfma_f32_16x16x32_bf16 v[128:131], a[12:15], v[12:15], v[128:131]
    v_mfma_f32_16x16x32_bf16 v[132:135], a[76:79], v[12:15], v[132:135]
    v_mfma_f32_16x16x32_bf16 v[136:139], a[140:143], v[12:15], v[136:139]
    v_mfma_f32_16x16x32_bf16 v[140:143], a[204:207], v[12:15], v[140:143]
    global_load_dwordx4 v[12:15], v240, s[42:43] offset:-1024 sc1
    s_waitcnt vmcnt(35)
    v_mfma_f32_16x16x32_bf16 v[144:147], a[12:15], v[76:79], v[144:147]
    v_mfma_f32_16x16x32_bf16 v[148:151], a[76:79], v[76:79], v[148:151]
    v_mfma_f32_16x16x32_bf16 v[152:155], a[140:143], v[76:79], v[152:155]
    v_mfma_f32_16x16x32_bf16 v[156:159], a[204:207], v[76:79], v[156:159]
    global_load_dwordx4 v[76:79], v242, s[42:43] offset:-1024 sc1
    s_waitcnt vmcnt(35)
    v_mfma_f32_16x16x32_bf16 v[128:131], a[16:19], v[16:19], v[128:131]
    v_mfma_f32_16x16x32_bf16 v[132:135], a[80:83], v[16:19], v[132:135]
    v_mfma_f32_16x16x32_bf16 v[136:139], a[144:147], v[16:19], v[136:139]
    v_mfma_f32_16x16x32_bf16 v[140:143], a[208:211], v[16:19], v[140:143]
    global_load_dwordx4 v[16:19], v240, s[42:43] offset:0 sc1
    s_waitcnt vmcnt(35)
    v_mfma_f32_16x16x32_bf16 v[144:147], a[16:19], v[80:83], v[144:147]
    v_mfma_f32_16x16x32_bf16 v[148:151], a[80:83], v[80:83], v[148:151]
    v_mfma_f32_16x16x32_bf16 v[152:155], a[144:147], v[80:83], v[152:155]
    v_mfma_f32_16x16x32_bf16 v[156:159], a[208:211], v[80:83], v[156:159]
    global_load_dwordx4 v[80:83], v242, s[42:43] offset:0 sc1
    s_waitcnt vmcnt(35)
    v_mfma_f32_16x16x32_bf16 v[128:131], a[20:23], v[20:23], v[128:131]
    v_mfma_f32_16x16x32_bf16 v[132:135], a[84:87], v[20:23], v[132:135]
    v_mfma_f32_16x16x32_bf16 v[136:139], a[148:151], v[20:23], v[136:139]
    v_mfma_f32_16x16x32_bf16 v[140:143], a[212:215], v[20:23], v[140:143]
    global_load_dwordx4 v[20:23], v240, s[42:43] offset:1024 sc1
    s_waitcnt vmcnt(35)
    v_mfma_f32_16x16x32_bf16 v[144:147], a[20:23], v[84:87], v[144:147]
    v_mfma_f32_16x16x32_bf16 v[148:151], a[84:87], v[84:87], v[148:151]
    v_mfma_f32_16x16x32_bf16 v[152:155], a[148:151], v[84:87], v[152:155]
    v_mfma_f32_16x16x32_bf16 v[156:159], a[212:215], v[84:87], v[156:159]
    global_load_dwordx4 v[84:87], v242, s[42:43] offset:1024 sc1
    s_waitcnt vmcnt(35)
    v_mfma_f32_16x16x32_bf16 v[128:131], a[24:27], v[24:27], v[128:131]
    v_mfma_f32_16x16x32_bf16 v[132:135], a[88:91], v[24:27], v[132:135]
    v_mfma_f32_16x16x32_bf16 v[136:139], a[152:155], v[24:27], v[136:139]
    v_mfma_f32_16x16x32_bf16 v[140:143], a[216:219], v[24:27], v[140:143]
    global_load_dwordx4 v[24:27], v240, s[42:43] offset:2048 sc1
    s_waitcnt vmcnt(35)
    v_mfma_f32_16x16x32_bf16 v[144:147], a[24:27], v[88:91], v[144:147]
    v_mfma_f32_16x16x32_bf16 v[148:151], a[88:91], v[88:91], v[148:151]
    v_mfma_f32_16x16x32_bf16 v[152:155], a[152:155], v[88:91], v[152:155]
    v_mfma_f32_16x16x32_bf16 v[156:159], a[216:219], v[88:91], v[156:159]
    global_load_dwordx4 v[88:91], v242, s[42:43] offset:2048 sc1
    s_waitcnt vmcnt(35)
    v_mfma_f32_16x16x32_bf16 v[128:131], a[28:31], v[28:31], v[128:131]
    v_mfma_f32_16x16x32_bf16 v[132:135], a[92:95], v[28:31], v[132:135]
    v_mfma_f32_16x16x32_bf16 v[136:139], a[156:159], v[28:31], v[136:139]
    v_mfma_f32_16x16x32_bf16 v[140:143], a[220:223], v[28:31], v[140:143]
    global_load_dwordx4 v[28:31], v240, s[42:43] offset:3072 sc1
    s_waitcnt vmcnt(35)
    v_mfma_f32_16x16x32_bf16 v[144:147], a[28:31], v[92:95], v[144:147]
    v_mfma_f32_16x16x32_bf16 v[148:151], a[92:95], v[92:95], v[148:151]
    v_mfma_f32_16x16x32_bf16 v[152:155], a[156:159], v[92:95], v[152:155]
    v_mfma_f32_16x16x32_bf16 v[156:159], a[220:223], v[92:95], v[156:159]
    global_load_dwordx4 v[92:95], v242, s[42:43] offset:3072 sc1
    s_waitcnt vmcnt(35)
    v_mfma_f32_16x16x32_bf16 v[128:131], a[32:35], v[32:35], v[128:131]
    v_mfma_f32_16x16x32_bf16 v[132:135], a[96:99], v[32:35], v[132:135]
    v_mfma_f32_16x16x32_bf16 v[136:139], a[160:163], v[32:35], v[136:139]
    v_mfma_f32_16x16x32_bf16 v[140:143], a[224:227], v[32:35], v[140:143]
    global_load_dwordx4 v[32:35], v241, s[42:43] offset:-4096 sc1
    s_waitcnt vmcnt(35)
    v_mfma_f32_16x16x32_bf16 v[144:147], a[32:35], v[96:99], v[144:147]
    v_mfma_f32_16x16x32_bf16 v[148:151], a[96:99], v[96:99], v[148:151]
    v_mfma_f32_16x16x32_bf16 v[152:155], a[160:163], v[96:99], v[152:155]
    v_mfma_f32_16x16x32_bf16 v[156:159], a[224:227], v[96:99], v[156:159]
    global_load_dwordx4 v[96:99], v243, s[42:43] offset:-4096 sc1
    s_waitcnt vmcnt(35)
    v_mfma_f32_16x16x32_bf16 v[128:131], a[36:39], v[36:39], v[128:131]
    v_mfma_f32_16x16x32_bf16 v[132:135], a[100:103], v[36:39], v[132:135]
    v_mfma_f32_16x16x32_bf16 v[136:139], a[164:167], v[36:39], v[136:139]
    v_mfma_f32_16x16x32_bf16 v[140:143], a[228:231], v[36:39], v[140:143]
    global_load_dwordx4 v[36:39], v241, s[42:43] offset:-3072 sc1
    s_waitcnt vmcnt(35)
    v_mfma_f32_16x16x32_bf16 v[144:147], a[36:39], v[100:103], v[144:147]
    v_mfma_f32_16x16x32_bf16 v[148:151], a[100:103], v[100:103], v[148:151]
    v_mfma_f32_16x16x32_bf16 v[152:155], a[164:167], v[100:103], v[152:155]
    v_mfma_f32_16x16x32_bf16 v[156:159], a[228:231], v[100:103], v[156:159]
    global_load_dwordx4 v[100:103], v243, s[42:43] offset:-3072 sc1
    s_waitcnt vmcnt(35)
    v_mfma_f32_16x16x32_bf16 v[128:131], a[40:43], v[40:43], v[128:131]
    v_mfma_f32_16x16x32_bf16 v[132:135], a[104:107], v[40:43], v[132:135]
    v_mfma_f32_16x16x32_bf16 v[136:139], a[168:171], v[40:43], v[136:139]
    v_mfma_f32_16x16x32_bf16 v[140:143], a[232:235], v[40:43], v[140:143]
    global_load_dwordx4 v[40:43], v241, s[42:43] offset:-2048 sc1
    s_waitcnt vmcnt(35)
    v_mfma_f32_16x16x32_bf16 v[144:147], a[40:43], v[104:107], v[144:147]
    v_mfma_f32_16x16x32_bf16 v[148:151], a[104:107], v[104:107], v[148:151]
    v_mfma_f32_16x16x32_bf16 v[152:155], a[168:171], v[104:107], v[152:155]
    v_mfma_f32_16x16x32_bf16 v[156:159], a[232:235], v[104:107], v[156:159]
    global_load_dwordx4 v[104:107], v243, s[42:43] offset:-2048 sc1
    s_waitcnt vmcnt(35)
    v_mfma_f32_16x16x32_bf16 v[128:131], a[44:47], v[44:47], v[128:131]
    v_mfma_f32_16x16x32_bf16 v[132:135], a[108:111], v[44:47], v[132:135]
    v_mfma_f32_16x16x32_bf16 v[136:139], a[172:175], v[44:47], v[136:139]
    v_mfma_f32_16x16x32_bf16 v[140:143], a[236:239], v[44:47], v[140:143]
    global_load_dwordx4 v[44:47], v241, s[42:43] offset:-1024 sc1
    s_waitcnt vmcnt(35)
    v_mfma_f32_16x16x32_bf16 v[144:147], a[44:47], v[108:111], v[144:147]
    v_mfma_f32_16x16x32_bf16 v[148:151], a[108:111], v[108:111], v[148:151]
    v_mfma_f32_16x16x32_bf16 v[152:155], a[172:175], v[108:111], v[152:155]
    v_mfma_f32_16x16x32_bf16 v[156:159], a[236:239], v[108:111], v[156:159]
    global_load_dwordx4 v[108:111], v243, s[42:43] offset:-1024 sc1
    s_waitcnt vmcnt(35)
    v_mfma_f32_16x16x32_bf16 v[128:131], a[48:51], v[48:51], v[128:131]
    v_mfma_f32_16x16x32_bf16 v[132:135], a[112:115], v[48:51], v[132:135]
    v_mfma_f32_16x16x32_bf16 v[136:139], a[176:179], v[48:51], v[136:139]
    v_mfma_f32_16x16x32_bf16 v[140:143], a[240:243], v[48:51], v[140:143]
    global_load_dwordx4 v[48:51], v241, s[42:43] offset:0 sc1
    s_waitcnt vmcnt(35)
    v_mfma_f32_16x16x32_bf16 v[144:147], a[48:51], v[112:115], v[144:147]
    v_mfma_f32_16x16x32_bf16 v[148:151], a[112:115], v[112:115], v[148:151]
    v_mfma_f32_16x16x32_bf16 v[152:155], a[176:179], v[112:115], v[152:155]
    v_mfma_f32_16x16x32_bf16 v[156:159], a[240:243], v[112:115], v[156:159]
    global_load_dwordx4 v[112:115], v243, s[42:43] offset:0 sc1
    s_waitcnt vmcnt(35)
    v_mfma_f32_16x16x32_bf16 v[128:131], a[52:55], v[52:55], v[128:131]
    v_mfma_f32_16x16x32_bf16 v[132:135], a[116:119], v[52:55], v[132:135]
    v_mfma_f32_16x16x32_bf16 v[136:139], a[180:183], v[52:55], v[136:139]
    v_mfma_f32_16x16x32_bf16 v[140:143], a[244:247], v[52:55], v[140:143]
    global_load_dwordx4 v[52:55], v241, s[42:43] offset:1024 sc1
    s_waitcnt vmcnt(35)
    v_mfma_f32_16x16x32_bf16 v[144:147], a[52:55], v[116:119], v[144:147]
    v_mfma_f32_16x16x32_bf16 v[148:151], a[116:119], v[116:119], v[148:151]
    v_mfma_f32_16x16x32_bf16 v[152:155], a[180:183], v[116:119], v[152:155]
    v_mfma_f32_16x16x32_bf16 v[156:159], a[244:247], v[116:119], v[156:159]
    global_load_dwordx4 v[116:119], v243, s[42:43] offset:1024 sc1
    s_waitcnt vmcnt(35)
    v_mfma_f32_16x16x32_bf16 v[128:131], a[56:59], v[56:59], v[128:131]
    v_mfma_f32_16x16x32_bf16 v[132:135], a[120:123], v[56:59], v[132:135]
    v_mfma_f32_16x16x32_bf16 v[136:139], a[184:187], v[56:59], v[136:139]
    v_mfma_f32_16x16x32_bf16 v[140:143], a[248:251], v[56:59], v[140:143]
    global_load_dwordx4 v[56:59], v241, s[42:43] offset:2048 sc1
    s_waitcnt vmcnt(35)
    v_mfma_f32_16x16x32_bf16 v[144:147], a[56:59], v[120:123], v[144:147]
    v_mfma_f32_16x16x32_bf16 v[148:151], a[120:123], v[120:123], v[148:151]
    v_mfma_f32_16x16x32_bf16 v[152:155], a[184:187], v[120:123], v[152:155]
    v_mfma_f32_16x16x32_bf16 v[156:159], a[248:251], v[120:123], v[156:159]
    global_load_dwordx4 v[120:123], v243, s[42:43] offset:2048 sc1
    s_waitcnt vmcnt(35)
    v_mfma_f32_16x16x32_bf16 v[128:131], a[60:63], v[60:63], v[128:131]
    v_mfma_f32_16x16x32_bf16 v[132:135], a[124:127], v[60:63], v[132:135]
    v_mfma_f32_16x16x32_bf16 v[136:139], a[188:191], v[60:63], v[136:139]
    v_mfma_f32_16x16x32_bf16 v[140:143], a[252:255], v[60:63], v[140:143]
    global_load_dwordx4 v[60:63], v241, s[42:43] offset:3072 sc1
    s_waitcnt vmcnt(35)
    v_mfma_f32_16x16x32_bf16 v[144:147], a[60:63], v[124:127], v[144:147]
    v_mfma_f32_16x16x32_bf16 v[148:151], a[124:127], v[124:127], v[148:151]
    v_mfma_f32_16x16x32_bf16 v[152:155], a[188:191], v[124:127], v[152:155]
    v_mfma_f32_16x16x32_bf16 v[156:159], a[252:255], v[124:127], v[156:159]
    global_load_dwordx4 v[124:127], v243, s[42:43] offset:3072 sc1
    s_nop 7
    v_cvt_pk_bf16_f32 v128, v128, v129
    v_cvt_pk_bf16_f32 v129, v130, v131
    v_cvt_pk_bf16_f32 v130, v132, v133
    v_cvt_pk_bf16_f32 v131, v134, v135
    global_store_dwordx4 v247, v[128:131], s[46:47] offset:0
    v_cvt_pk_bf16_f32 v136, v136, v137
    v_cvt_pk_bf16_f32 v137, v138, v139
    v_cvt_pk_bf16_f32 v138, v140, v141
    v_cvt_pk_bf16_f32 v139, v142, v143
    global_store_dwordx4 v247, v[136:139], s[46:47] offset:64
    v_cvt_pk_bf16_f32 v144, v144, v145
    v_cvt_pk_bf16_f32 v145, v146, v147
    v_cvt_pk_bf16_f32 v146, v148, v149
    v_cvt_pk_bf16_f32 v147, v150, v151
    global_store_dwordx4 v248, v[144:147], s[46:47] offset:0
    v_cvt_pk_bf16_f32 v152, v152, v153
    v_cvt_pk_bf16_f32 v153, v154, v155
    v_cvt_pk_bf16_f32 v154, v156, v157
    v_cvt_pk_bf16_f32 v155, v158, v159
    global_store_dwordx4 v248, v[152:155], s[46:47] offset:64
    s_add_u32 s46, s46, 229376
    s_addc_u32 s47, s47, 0
    s_add_u32 s41, s41, 1
    s_cmp_lt_u32 s41, 3
    s_cselect_b32 s36, 131072, 0
    s_add_u32 s42, s42, s36
    s_addc_u32 s43, s43, 0
    s_cmp_lt_u32 s41, 4
    s_cbranch_scc1 L_b3
    s_waitcnt vmcnt(0)
    s_endpgm
L_po:
    s_cmp_ge_u32 s40, 192
    s_cbranch_scc1 L_ocu
    v_mov_b32 v113, v0
    v_lshlrev_b32 v112, 4, v0
    v_mov_b32 v119, 0
    s_sub_u32 s36, s40, 144
    s_and_b32 s48, s36, 15
    s_lshr_b32 s49, s36, 4
    s_lshl_b32 s36, s48, 2
    s_add_u32 s36, s36, s31
    s_mul_i32 s37, s36, 100352
    s_add_u32 s37, s37, 0
    s_add_u32 s50, s28, s37
    s_addc_u32 s51, s29, 0
    global_load_dwordx4 a[0:3], v112, s[50:51] offset:0
    global_load_dwordx4 a[4:7], v112, s[50:51] offset:1024
    global_load_dwordx4 a[8:11], v112, s[50:51] offset:2048
    global_load_dwordx4 a[12:15], v112, s[50:51] offset:3072
    s_add_u32 s50, s50, 4096
    s_addc_u32 s51, s51, 0
    global_load_dwordx4 a[16:19], v112, s[50:51] offset:0
    global_load_dwordx4 a[20:23], v112, s[50:51] offset:1024
    global_load_dwordx4 a[24:27], v112, s[50:51] offset:2048
    global_load_dwordx4 a[28:31], v112, s[50:51] offset:3072
    s_add_u32 s50, s50, 4096
    s_addc_u32 s51, s51, 0
    global_load_dwordx4 a[32:35], v112, s[50:51] offset:0
    global_load_dwordx4 a[36:39], v112, s[50:51] offset:1024
    global_load_dwordx4 a[40:43], v112, s[50:51] offset:2048
    global_load_dwordx4 a[44:47], v112, s[50:51] offset:3072
    s_add_u32 s50, s50, 4096
    s_addc_u32 s51, s51, 0
    global_load_dwordx4 a[48:51], v112, s[50:51] offset:0
    global_load_dwordx4 a[52:55], v112, s[50:51] offset:1024
    global_load_dwordx4 a[56:59], v112, s[50:51] offset:2048
    global_load_dwordx4 a[60:63], v112, s[50:51] offset:3072
    s_add_u32 s50, s50, 4096
    s_addc_u32 s51, s51, 0
    global_load_dwordx4 a[64:67], v112, s[50:51] offset:0
    global_load_dwordx4 a[68:71], v112, s[50:51] offset:1024
    global_load_dwordx4 a[72:75], v112, s[50:51] offset:2048
    global_load_dwordx4 a[76:79], v112, s[50:51] offset:3072
    s_add_u32 s50, s50, 4096
    s_addc_u32 s51, s51, 0
    global_load_dwordx4 a[80:83], v112, s[50:51] offset:0
    global_load_dwordx4 a[84:87], v112, s[50:51] offset:1024
    global_load_dwordx4 a[88:91], v112, s[50:51] offset:2048
    global_load_dwordx4 a[92:95], v112, s[50:51] offset:3072
    s_add_u32 s50, s50, 4096
    s_addc_u32 s51, s51, 0
    global_load_dwordx4 a[96:99], v112, s[50:51] offset:0
    global_load_dwordx4 a[100:103], v112, s[50:51] offset:1024
    global_load_dwordx4 a[104:107], v112, s[50:51] offset:2048
    global_load_dwordx4 a[108:111], v112, s[50:51] offset:3072
    s_add_u32 s50, s50, 4096
    s_addc_u32 s51, s51, 0
    global_load_dwordx4 a[112:115], v112, s[50:51] offset:0
    global_load_dwordx4 a[116:119], v112, s[50:51] offset:1024
    global_load_dwordx4 a[120:123], v112, s[50:51] offset:2048
    global_load_dwordx4 a[124:127], v112, s[50:51] offset:3072
    s_add_u32 s50, s50, 4096
    s_addc_u32 s51, s51, 0
    global_load_dwordx4 a[128:131], v112, s[50:51] offset:0
    global_load_dwordx4 a[132:135], v112, s[50:51] offset:1024
    global_load_dwordx4 a[136:139], v112, s[50:51] offset:2048
    global_load_dwordx4 a[140:143], v112, s[50:51] offset:3072
    s_add_u32 s50, s50, 4096
    s_addc_u32 s51, s51, 0
    global_load_dwordx4 a[144:147], v112, s[50:51] offset:0
    global_load_dwordx4 a[148:151], v112, s[50:51] offset:1024
    global_load_dwordx4 a[152:155], v112, s[50:51] offset:2048
    global_load_dwordx4 a[156:159], v112, s[50:51] offset:3072
    s_add_u32 s50, s50, 4096
    s_addc_u32 s51, s51, 0
    global_load_dwordx4 a[160:163], v112, s[50:51] offset:0
    global_load_dwordx4 a[164:167], v112, s[50:51] offset:1024
    global_load_dwordx4 a[168:171], v112, s[50:51] offset:2048
    global_load_dwordx4 a[172:175], v112, s[50:51] offset:3072
    s_add_u32 s50, s50, 4096
    s_addc_u32 s51, s51, 0
    global_load_dwordx4 a[176:179], v112, s[50:51] offset:0
    global_load_dwordx4 a[180:183], v112, s[50:51] offset:1024
    global_load_dwordx4 a[184:187], v112, s[50:51] offset:2048
    global_load_dwordx4 a[188:191], v112, s[50:51] offset:3072
    s_add_u32 s50, s50, 4096
    s_addc_u32 s51, s51, 0
    global_load_dwordx4 a[192:195], v112, s[50:51] offset:0
    global_load_dwordx4 a[196:199], v112, s[50:51] offset:1024
    s_waitcnt vmcnt(48)
    global_load_dwordx4 a[200:203], v112, s[50:51] offset:2048
    global_load_dwordx4 a[204:207], v112, s[50:51] offset:3072
    s_add_u32 s50, s50, 4096
    s_addc_u32 s51, s51, 0
    s_waitcnt vmcnt(48)
    global_load_dwordx4 a[208:211], v112, s[50:51] offset:0
    global_load_dwordx4 a[212:215], v112, s[50:51] offset:1024
    s_waitcnt vmcnt(48)
    global_load_dwordx4 a[216:219], v112, s[50:51] offset:2048
    global_load_dwordx4 a[220:223], v112, s[50:51] offset:3072
    s_add_u32 s50, s50, 4096
    s_addc_u32 s51, s51, 0
    s_waitcnt vmcnt(48)
    global_load_dwordx4 a[224:227], v112, s[50:51] offset:0
    global_load_dwordx4 a[228:231], v112, s[50:51] offset:1024
    s_waitcnt vmcnt(48)
    global_load_dwordx4 a[232:235], v112, s[50:51] offset:2048
    global_load_dwordx4 a[236:239], v112, s[50:51] offset:3072
    s_add_u32 s50, s50, 4096
    s_addc_u32 s51, s51, 0
    s_waitcnt vmcnt(48)
    global_load_dwordx4 a[240:243], v112, s[50:51] offset:0
    global_load_dwordx4 a[244:247], v112, s[50:51] offset:1024
    s_waitcnt vmcnt(48)
    global_load_dwordx4 a[248:251], v112, s[50:51] offset:2048
    global_load_dwordx4 a[252:255], v112, s[50:51] offset:3072
    s_add_u32 s50, s50, 4096
    s_addc_u32 s51, s51, 0
    s_waitcnt vmcnt(48)
    global_load_dwordx4 v[120:123], v112, s[50:51] offset:0
    global_load_dwordx4 v[124:127], v112, s[50:51] offset:1024
    s_waitcnt vmcnt(48)
    global_load_dwordx4 v[128:131], v112, s[50:51] offset:2048
    global_load_dwordx4 v[132:135], v112, s[50:51] offset:3072
    s_add_u32 s50, s50, 4096
    s_addc_u32 s51, s51, 0
    s_waitcnt vmcnt(48)
    global_load_dwordx4 v[136:139], v112, s[50:51] offset:0
    global_load_dwordx4 v[140:143], v112, s[50:51] offset:1024
    s_waitcnt vmcnt(48)
    global_load_dwordx4 v[144:147], v112, s[50:51] offset:2048
    global_load_dwordx4 v[148:151], v112, s[50:51] offset:3072
    s_add_u32 s50, s50, 4096
    s_addc_u32 s51, s51, 0
    s_waitcnt vmcnt(48)
    global_load_dwordx4 v[152:155], v112, s[50:51] offset:0
    global_load_dwordx4 v[156:159], v112, s[50:51] offset:1024
    s_waitcnt vmcnt(48)
    global_load_dwordx4 v[160:163], v112, s[50:51] offset:2048
    global_load_dwordx4 v[164:167], v112, s[50:51] offset:3072
    s_add_u32 s50, s50, 4096
    s_addc_u32 s51, s51, 0
    s_waitcnt vmcnt(48)
    global_load_dwordx4 v[168:171], v112, s[50:51] offset:0
    global_load_dwordx4 v[172:175], v112, s[50:51] offset:1024
    s_waitcnt vmcnt(48)
    global_load_dwordx4 v[176:179], v112, s[50:51] offset:2048
    global_load_dwordx4 v[180:183], v112, s[50:51] offset:3072
    s_add_u32 s50, s50, 4096
    s_addc_u32 s51, s51, 0
    s_waitcnt vmcnt(48)
    global_load_dwordx4 v[184:187], v112, s[50:51] offset:0
    global_load_dwordx4 v[188:191], v112, s[50:51] offset:1024
    s_waitcnt vmcnt(48)
    global_load_dwordx4 v[192:195], v112, s[50:51] offset:2048
    global_load_dwordx4 v[196:199], v112, s[50:51] offset:3072
    s_add_u32 s50, s50, 4096
    s_addc_u32 s51, s51, 0
    s_waitcnt vmcnt(48)
    global_load_dwordx4 v[200:203], v112, s[50:51] offset:0
    global_load_dwordx4 v[204:207], v112, s[50:51] offset:1024
    s_waitcnt vmcnt(48)
    global_load_dwordx4 v[208:211], v112, s[50:51] offset:2048
    global_load_dwordx4 v[212:215], v112, s[50:51] offset:3072
    s_add_u32 s50, s50, 4096
    s_addc_u32 s51, s51, 0
    s_waitcnt vmcnt(48)
    global_load_dwordx4 v[216:219], v112, s[50:51] offset:0
    global_load_dwordx4 v[220:223], v112, s[50:51] offset:1024
    s_waitcnt vmcnt(48)
    global_load_dwordx4 v[224:227], v112, s[50:51] offset:2048
    global_load_dwordx4 v[228:231], v112, s[50:51] offset:3072
    s_add_u32 s50, s50, 4096
    s_addc_u32 s51, s51, 0
    s_waitcnt vmcnt(48)
    global_load_dwordx4 v[232:235], v112, s[50:51] offset:0
    global_load_dwordx4 v[236:239], v112, s[50:51] offset:1024
    s_waitcnt vmcnt(48)
    global_load_dwordx4 v[240:243], v112, s[50:51] offset:2048
    global_load_dwordx4 v[244:247], v112, s[50:51] offset:3072
    s_add_u32 s50, s50, 4096
    s_addc_u32 s51, s51, 0
    s_waitcnt vmcnt(48)
    global_load_dwordx4 v[248:251], v112, s[50:51] offset:0
    global_load_dwordx4 v[252:255], v112, s[50:51] offset:1024
    s_waitcnt vmcnt(48)
    s_mul_i32 s37, s49, 28672
    s_add_u32 s37, s37, 15732736
    s_add_u32 s42, s28, s37
    s_addc_u32 s43, s29, 0
    s_mul_i32 s37, s49, 28672
    s_add_u32 s37, s37, 0
    s_add_u32 s44, s4, s37
    s_addc_u32 s45, s5, 0
    s_mul_i32 s36, s31, 224
    s_add_u32 s44, s44, s36
    s_addc_u32 s45, s45, 0
    s_mul_i32 s36, s31, 1792
    s_lshl_b32 s37, s49, 13
    s_sub_u32 s36, s36, s37
    s_add_u32 s36, s36, 13623296
    s_add_u32 s46, s28, s36
    s_addc_u32 s47, s29, 0
    s_mul_i32 s36, s31, 20480
    s_lshl_b32 s37, s48, 10
    s_add_u32 s36, s36, s37
    s_add_u32 s36, s36, 23068672
    s_mul_i32 s37, s49, 40960
    s_add_u32 s37, s37, s36
    s_add_u32 s52, s28, s37
    s_addc_u32 s53, s29, 0
    s_lshl_b32 s36, s49, 1
    s_add_u32 s36, s36, s31
    s_lshl_b32 s36, s36, 4
    s_add_u32 s36, s36, s48
    s_mul_i32 s37, s36, 4
    s_add_u32 s37, s37, 14809088
    s_add_u32 s54, s28, s37
    s_addc_u32 s55, s29, 0
    s_lshr_b32 s36, s48, 2
    s_add_u32 s36, s36, 16
    s_sub_u32 s36, s36, s48
    s_lshl_b32 s36, s36, 10
    s_and_b32 s37, s48, 3
    s_lshl_b32 s37, s37, 2
    s_add_u32 s36, s36, s37
    v_add_u32 v115, s36, v112
    s_cmp_eq_u32 s49, 0
    s_cselect_b32 s36, 63, 60
    s_mul_i32 s36, s36, 40960
    s_add_u32 s50, s52, s36
    s_addc_u32 s51, s53, 0
    v_mov_b32 v0, -1
    v_mov_b32 v1, -1
    v_mov_b32 v2, -1
    v_mov_b32 v3, -1
    s_cmp_ge_u32 s31, 2
    s_cbranch_scc1 L_p_nf
    global_store_dwordx4 v112, v[0:3], s[50:51] sc1
    global_store_dword v115, v0, s[50:51] sc1
    s_nop 1
L_p_nf:
L_p_loop:
    global_load_dwordx4 v[28:31], v112, s[42:43] offset:-4096
    global_load_dwordx4 v[32:35], v112, s[42:43] offset:-3072
    global_load_dwordx4 v[36:39], v112, s[42:43] offset:-2048
    global_load_dwordx4 v[40:43], v112, s[42:43] offset:-1024
    global_load_dwordx4 v[44:47], v112, s[42:43] offset:0
    global_load_dwordx4 v[48:51], v112, s[42:43] offset:1024
    global_load_dwordx4 v[52:55], v112, s[42:43] offset:2048
    s_add_u32 s42, s42, 7168
    s_addc_u32 s43, s43, 0
    v_mov_b32 v114, 0
    v_bfe_u32 v118, v113, 2, 2
    v_mul_u32_u24 v118, 7168, v118
    v_add_u32 v114, v118, v114
    v_bfe_u32 v118, v113, 0, 2
    v_mul_u32_u24 v118, 896, v118
    v_add_u32 v114, v118, v114
    v_bfe_u32 v118, v113, 4, 2
    v_lshl_add_u32 v114, v118, 5, v114
    v_mov_b32 v115, 0
    v_bfe_u32 v118, v113, 2, 2
    v_mul_u32_u24 v118, 7168, v118
    v_add_u32 v115, v118, v115
    v_bfe_u32 v118, v113, 0, 2
    v_mul_u32_u24 v118, 896, v118
    v_add_u32 v115, v118, v115
    v_bfe_u32 v118, v113, 4, 2
    v_lshl_add_u32 v115, v118, 4, v115
    v_mov_b32 v116, 0
    v_bfe_u32 v118, v113, 2, 2
    v_mul_u32_u24 v118, 7168, v118
    v_add_u32 v116, v118, v116
    v_bfe_u32 v118, v113, 0, 2
    v_mul_u32_u24 v118, 896, v118
    v_add_u32 v116, v118, v116
    v_bfe_u32 v118, v113, 4, 2
    v_lshl_add_u32 v116, v118, 3, v116
    global_load_dwordx4 v[84:87], v114, s[44:45] offset:0
    global_load_dwordx4 v[88:91], v114, s[44:45] offset:16
    global_load_dwordx4 v[92:95], v115, s[44:45] offset:128
    global_load_dwordx2 v[96:97], v116, s[44:45] offset:192
    global_load_dwordx4 v[98:101], v114, s[44:45] offset:3584
    global_load_dwordx4 v[102:105], v114, s[44:45] offset:3600
    global_load_dwordx4 v[106:109], v115, s[44:45] offset:3712
    global_load_dwordx2 v[110:111], v116, s[44:45] offset:3776
    s_add_u32 s44, s44, 86016
    s_addc_u32 s45, s45, 0
    s_lshl_b32 s36, s31, 12
    v_add_u32 v114, s36, v112
    s_waitcnt vmcnt(14)
    v_mfma_f32_16x16x32_bf16 v[0:3], a[0:3], v[28:31], 0
    v_mfma_f32_16x16x32_bf16 v[4:7], a[56:59], v[28:31], 0
    v_mfma_f32_16x16x32_bf16 v[8:11], a[112:115], v[28:31], 0
    v_mfma_f32_16x16x32_bf16 v[12:15], a[168:171], v[28:31], 0
    v_mfma_f32_16x16x32_bf16 v[16:19], a[224:227], v[28:31], 0
    v_mfma_f32_16x16x32_bf16 v[20:23], v[144:147], v[28:31], 0
    v_mfma_f32_16x16x32_bf16 v[24:27], v[200:203], v[28:31], 0
    global_load_dwordx4 v[28:31], v112, s[42:43] offset:-4096
    s_waitcnt vmcnt(14)
    v_mfma_f32_16x16x32_bf16 v[0:3], a[4:7], v[32:35], v[0:3]
    v_mfma_f32_16x16x32_bf16 v[4:7], a[60:63], v[32:35], v[4:7]
    v_mfma_f32_16x16x32_bf16 v[8:11], a[116:119], v[32:35], v[8:11]
    v_mfma_f32_16x16x32_bf16 v[12:15], a[172:175], v[32:35], v[12:15]
    v_mfma_f32_16x16x32_bf16 v[16:19], a[228:231], v[32:35], v[16:19]
    v_mfma_f32_16x16x32_bf16 v[20:23], v[148:151], v[32:35], v[20:23]
    v_mfma_f32_16x16x32_bf16 v[24:27], v[204:207], v[32:35], v[24:27]
    global_load_dwordx4 v[32:35], v112, s[42:43] offset:-3072
    s_waitcnt vmcnt(14)
    v_mfma_f32_16x16x32_bf16 v[0:3], a[8:11], v[36:39], v[0:3]
    v_mfma_f32_16x16x32_bf16 v[4:7], a[64:67], v[36:39], v[4:7]
    v_mfma_f32_16x16x32_bf16 v[8:11], a[120:123], v[36:39], v[8:11]
    v_mfma_f32_16x16x32_bf16 v[12:15], a[176:179], v[36:39], v[12:15]
    v_mfma_f32_16x16x32_bf16 v[16:19], a[232:235], v[36:39], v[16:19]
    v_mfma_f32_16x16x32_bf16 v[20:23], v[152:155], v[36:39], v[20:23]
    v_mfma_f32_16x16x32_bf16 v[24:27], v[208:211], v[36:39], v[24:27]
    global_load_dwordx4 v[36:39], v112, s[42:43] offset:-2048
    s_waitcnt vmcnt(14)
    v_mfma_f32_16x16x32_bf16 v[0:3], a[12:15], v[40:43], v[0:3]
    v_mfma_f32_16x16x32_bf16 v[4:7], a[68:71], v[40:43], v[4:7]
    v_mfma_f32_16x16x32_bf16 v[8:11], a[124:127], v[40:43], v[8:11]
    v_mfma_f32_16x16x32_bf16 v[12:15], a[180:183], v[40:43], v[12:15]
    v_mfma_f32_16x16x32_bf16 v[16:19], a[236:239], v[40:43], v[16:19]
    v_mfma_f32_16x16x32_bf16 v[20:23], v[156:159], v[40:43], v[20:23]
    v_mfma_f32_16x16x32_bf16 v[24:27], v[212:215], v[40:43], v[24:27]
    global_load_dwordx4 v[40:43], v112, s[42:43] offset:-1024
    s_waitcnt vmcnt(14)
    v_mfma_f32_16x16x32_bf16 v[0:3], a[16:19], v[44:47], v[0:3]
    v_mfma_f32_16x16x32_bf16 v[4:7], a[72:75], v[44:47], v[4:7]
    v_mfma_f32_16x16x32_bf16 v[8:11], a[128:131], v[44:47], v[8:11]
    v_mfma_f32_16x16x32_bf16 v[12:15], a[184:187], v[44:47], v[12:15]
    v_mfma_f32_16x16x32_bf16 v[16:19], a[240:243], v[44:47], v[16:19]
    v_mfma_f32_16x16x32_bf16 v[20:23], v[160:163], v[44:47], v[20:23]
    v_mfma_f32_16x16x32_bf16 v[24:27], v[216:219], v[44:47], v[24:27]
    global_load_dwordx4 v[44:47], v112, s[42:43] offset:0
    s_waitcnt vmcnt(14)
    v_mfma_f32_16x16x32_bf16 v[0:3], a[20:23], v[48:51], v[0:3]
    v_mfma_f32_16x16x32_bf16 v[4:7], a[76:79], v[48:51], v[4:7]
    v_mfma_f32_16x16x32_bf16 v[8:11], a[132:135], v[48:51], v[8:11]
    v_mfma_f32_16x16x32_bf16 v[12:15], a[188:191], v[48:51], v[12:15]
    v_mfma_f32_16x16x32_bf16 v[16:19], a[244:247], v[48:51], v[16:19]
    v_mfma_f32_16x16x32_bf16 v[20:23], v[164:167], v[48:51], v[20:23]
    v_mfma_f32_16x16x32_bf16 v[24:27], v[220:223], v[48:51], v[24:27]
    global_load_dwordx4 v[48:51], v112, s[42:43] offset:1024
    s_waitcnt vmcnt(14)
    v_mfma_f32_16x16x32_bf16 v[0:3], a[24:27], v[52:55], v[0:3]
    v_mfma_f32_16x16x32_bf16 v[4:7], a[80:83], v[52:55], v[4:7]
    v_mfma_f32_16x16x32_bf16 v[8:11], a[136:139], v[52:55], v[8:11]
    v_mfma_f32_16x16x32_bf16 v[12:15], a[192:195], v[52:55], v[12:15]
    v_mfma_f32_16x16x32_bf16 v[16:19], a[248:251], v[52:55], v[16:19]
    v_mfma_f32_16x16x32_bf16 v[20:23], v[168:171], v[52:55], v[20:23]
    v_mfma_f32_16x16x32_bf16 v[24:27], v[224:227], v[52:55], v[24:27]
    global_load_dwordx4 v[52:55], v112, s[42:43] offset:2048
    s_add_u32 s42, s42, 7168
    s_addc_u32 s43, s43, 0
    s_waitcnt vmcnt(6)
    v_mfma_f32_16x16x32_bf16 v[0:3], a[28:31], v[28:31], v[0:3]
    v_mfma_f32_16x16x32_bf16 v[4:7], a[84:87], v[28:31], v[4:7]
    v_mfma_f32_16x16x32_bf16 v[8:11], a[140:143], v[28:31], v[8:11]
    v_mfma_f32_16x16x32_bf16 v[12:15], a[196:199], v[28:31], v[12:15]
    v_mfma_f32_16x16x32_bf16 v[16:19], a[252:255], v[28:31], v[16:19]
    v_mfma_f32_16x16x32_bf16 v[20:23], v[172:175], v[28:31], v[20:23]
    v_mfma_f32_16x16x32_bf16 v[24:27], v[228:231], v[28:31], v[24:27]
    global_load_dwordx4 v[28:31], v112, s[42:43] offset:-4096
    s_waitcnt vmcnt(6)
    v_mfma_f32_16x16x32_bf16 v[0:3], a[32:35], v[32:35], v[0:3]
    v_mfma_f32_16x16x32_bf16 v[4:7], a[88:91], v[32:35], v[4:7]
    v_mfma_f32_16x16x32_bf16 v[8:11], a[144:147], v[32:35], v[8:11]
    v_mfma_f32_16x16x32_bf16 v[12:15], a[200:203], v[32:35], v[12:15]
    v_mfma_f32_16x16x32_bf16 v[16:19], v[120:123], v[32:35], v[16:19]
    v_mfma_f32_16x16x32_bf16 v[20:23], v[176:179], v[32:35], v[20:23]
    v_mfma_f32_16x16x32_bf16 v[24:27], v[232:235], v[32:35], v[24:27]
    global_load_dwordx4 v[32:35], v112, s[42:43] offset:-3072
    s_waitcnt vmcnt(6)
    v_mfma_f32_16x16x32_bf16 v[0:3], a[36:39], v[36:39], v[0:3]
    v_mfma_f32_16x16x32_bf16 v[4:7], a[92:95], v[36:39], v[4:7]
    v_mfma_f32_16x16x32_bf16 v[8:11], a[148:151], v[36:39], v[8:11]
    v_mfma_f32_16x16x32_bf16 v[12:15], a[204:207], v[36:39], v[12:15]
    v_mfma_f32_16x16x32_bf16 v[16:19], v[124:127], v[36:39], v[16:19]
    v_mfma_f32_16x16x32_bf16 v[20:23], v[180:183], v[36:39], v[20:23]
    v_mfma_f32_16x16x32_bf16 v[24:27], v[236:239], v[36:39], v[24:27]
    global_load_dwordx4 v[36:39], v112, s[42:43] offset:-2048
    s_waitcnt vmcnt(6)
    v_mfma_f32_16x16x32_bf16 v[0:3], a[40:43], v[40:43], v[0:3]
    v_mfma_f32_16x16x32_bf16 v[4:7], a[96:99], v[40:43], v[4:7]
    v_mfma_f32_16x16x32_bf16 v[8:11], a[152:155], v[40:43], v[8:11]
    v_mfma_f32_16x16x32_bf16 v[12:15], a[208:211], v[40:43], v[12:15]
    v_mfma_f32_16x16x32_bf16 v[16:19], v[128:131], v[40:43], v[16:19]
    v_mfma_f32_16x16x32_bf16 v[20:23], v[184:187], v[40:43], v[20:23]
    v_mfma_f32_16x16x32_bf16 v[24:27], v[240:243], v[40:43], v[24:27]
    global_load_dwordx4 v[40:43], v112, s[42:43] offset:-1024
    s_waitcnt vmcnt(6)
    v_mfma_f32_16x16x32_bf16 v[0:3], a[44:47], v[44:47], v[0:3]
    v_mfma_f32_16x16x32_bf16 v[4:7], a[100:103], v[44:47], v[4:7]
    v_mfma_f32_16x16x32_bf16 v[8:11], a[156:159], v[44:47], v[8:11]
    v_mfma_f32_16x16x32_bf16 v[12:15], a[212:215], v[44:47], v[12:15]
    v_mfma_f32_16x16x32_bf16 v[16:19], v[132:135], v[44:47], v[16:19]
    v_mfma_f32_16x16x32_bf16 v[20:23], v[188:191], v[44:47], v[20:23]
    v_mfma_f32_16x16x32_bf16 v[24:27], v[244:247], v[44:47], v[24:27]
    global_load_dwordx4 v[44:47], v112, s[42:43] offset:0
    s_waitcnt vmcnt(6)
    v_mfma_f32_16x16x32_bf16 v[0:3], a[48:51], v[48:51], v[0:3]
    v_mfma_f32_16x16x32_bf16 v[4:7], a[104:107], v[48:51], v[4:7]
    v_mfma_f32_16x16x32_bf16 v[8:11], a[160:163], v[48:51], v[8:11]
    v_mfma_f32_16x16x32_bf16 v[12:15], a[216:219], v[48:51], v[12:15]
    v_mfma_f32_16x16x32_bf16 v[16:19], v[136:139], v[48:51], v[16:19]
    v_mfma_f32_16x16x32_bf16 v[20:23], v[192:195], v[48:51], v[20:23]
    v_mfma_f32_16x16x32_bf16 v[24:27], v[248:251], v[48:51], v[24:27]
    global_load_dwordx4 v[48:51], v112, s[42:43] offset:1024
    s_waitcnt vmcnt(6)
    v_mfma_f32_16x16x32_bf16 v[0:3], a[52:55], v[52:55], v[0:3]
    v_mfma_f32_16x16x32_bf16 v[4:7], a[108:111], v[52:55], v[4:7]
    v_mfma_f32_16x16x32_bf16 v[8:11], a[164:167], v[52:55], v[8:11]
    v_mfma_f32_16x16x32_bf16 v[12:15], a[220:223], v[52:55], v[12:15]
    v_mfma_f32_16x16x32_bf16 v[16:19], v[140:143], v[52:55], v[16:19]
    v_mfma_f32_16x16x32_bf16 v[20:23], v[196:199], v[52:55], v[20:23]
    v_mfma_f32_16x16x32_bf16 v[24:27], v[252:255], v[52:55], v[24:27]
    global_load_dwordx4 v[52:55], v112, s[42:43] offset:2048
    s_add_u32 s42, s42, 7168
    s_addc_u32 s43, s43, 0
    s_nop 7
    v_cvt_pk_bf16_f32 v56, v0, v4
    v_cvt_pk_bf16_f32 v58, v8, v12
    v_cvt_pk_bf16_f32 v57, v1, v5
    v_cvt_pk_bf16_f32 v59, v9, v13
    v_cvt_pk_bf16_f32 v60, v2, v6
    v_cvt_pk_bf16_f32 v62, v10, v14
    v_cvt_pk_bf16_f32 v61, v3, v7
    v_cvt_pk_bf16_f32 v63, v11, v15
    v_cvt_pk_bf16_f32 v64, v16, v20
    v_cvt_pk_bf16_f32 v65, v17, v21
    v_cvt_pk_bf16_f32 v66, v18, v22
    v_cvt_pk_bf16_f32 v67, v19, v23
    v_cvt_pk_bf16_f32 v68, v24, v25
    v_cvt_pk_bf16_f32 v69, v26, v27
    s_nop 1
    v_mfma_f32_16x16x32_bf16 v[0:3], v[84:87], v[56:59], 0
    v_mfma_f32_16x16x32_bf16 v[4:7], v[98:101], v[56:59], 0
    v_mfma_f32_16x16x32_bf16 v[0:3], v[88:91], v[60:63], v[0:3]
    v_mfma_f32_16x16x32_bf16 v[4:7], v[102:105], v[60:63], v[4:7]
    v_mfma_f32_16x16x32_bf16 v[0:3], v[92:95], v[64:67], v[0:3]
    v_mfma_f32_16x16x32_bf16 v[4:7], v[106:109], v[64:67], v[4:7]
    v_mfma_f32_16x16x16_bf16 v[0:3], v[96:97], v[68:69], v[0:3]
    v_mfma_f32_16x16x16_bf16 v[4:7], v[110:111], v[68:69], v[4:7]
    s_nop 7
    ds_write_b128 v114, v[0:3] offset:256
    ds_write_b128 v114, v[4:7] offset:1280
    s_waitcnt vmcnt(6)
    v_mfma_f32_16x16x32_bf16 v[0:3], a[0:3], v[28:31], 0
    v_mfma_f32_16x16x32_bf16 v[4:7], a[56:59], v[28:31], 0
    v_mfma_f32_16x16x32_bf16 v[8:11], a[112:115], v[28:31], 0
    v_mfma_f32_16x16x32_bf16 v[12:15], a[168:171], v[28:31], 0
    v_mfma_f32_16x16x32_bf16 v[16:19], a[224:227], v[28:31], 0
    v_mfma_f32_16x16x32_bf16 v[20:23], v[144:147], v[28:31], 0
    v_mfma_f32_16x16x32_bf16 v[24:27], v[200:203], v[28:31], 0
    global_load_dwordx4 v[28:31], v112, s[42:43] offset:-4096
    s_waitcnt vmcnt(6)
    v_mfma_f32_16x16x32_bf16 v[0:3], a[4:7], v[32:35], v[0:3]
    v_mfma_f32_16x16x32_bf16 v[4:7], a[60:63], v[32:35], v[4:7]
    v_mfma_f32_16x16x32_bf16 v[8:11], a[116:119], v[32:35], v[8:11]
    v_mfma_f32_16x16x32_bf16 v[12:15], a[172:175], v[32:35], v[12:15]
    v_mfma_f32_16x16x32_bf16 v[16:19], a[228:231], v[32:35], v[16:19]
    v_mfma_f32_16x16x32_bf16 v[20:23], v[148:151], v[32:35], v[20:23]
    v_mfma_f32_16x16x32_bf16 v[24:27], v[204:207], v[32:35], v[24:27]
    global_load_dwordx4 v[32:35], v112, s[42:43] offset:-3072
    s_waitcnt vmcnt(6)
    v_mfma_f32_16x16x32_bf16 v[0:3], a[8:11], v[36:39], v[0:3]
    v_mfma_f32_16x16x32_bf16 v[4:7], a[64:67], v[36:39], v[4:7]
    v_mfma_f32_16x16x32_bf16 v[8:11], a[120:123], v[36:39], v[8:11]
    v_mfma_f32_16x16x32_bf16 v[12:15], a[176:179], v[36:39], v[12:15]
    v_mfma_f32_16x16x32_bf16 v[16:19], a[232:235], v[36:39], v[16:19]
    v_mfma_f32_16x16x32_bf16 v[20:23], v[152:155], v[36:39], v[20:23]
    v_mfma_f32_16x16x32_bf16 v[24:27], v[208:211], v[36:39], v[24:27]
    global_load_dwordx4 v[36:39], v112, s[42:43] offset:-2048
    s_waitcnt vmcnt(6)
    v_mfma_f32_16x16x32_bf16 v[0:3], a[12:15], v[40:43], v[0:3]
    v_mfma_f32_16x16x32_bf16 v[4:7], a[68:71], v[40:43], v[4:7]
    v_mfma_f32_16x16x32_bf16 v[8:11], a[124:127], v[40:43], v[8:11]
    v_mfma_f32_16x16x32_bf16 v[12:15], a[180:183], v[40:43], v[12:15]
    v_mfma_f32_16x16x32_bf16 v[16:19], a[236:239], v[40:43], v[16:19]
    v_mfma_f32_16x16x32_bf16 v[20:23], v[156:159], v[40:43], v[20:23]
    v_mfma_f32_16x16x32_bf16 v[24:27], v[212:215], v[40:43], v[24:27]
    global_load_dwordx4 v[40:43], v112, s[42:43] offset:-1024
    s_waitcnt vmcnt(6)
    v_mfma_f32_16x16x32_bf16 v[0:3], a[16:19], v[44:47], v[0:3]
    v_mfma_f32_16x16x32_bf16 v[4:7], a[72:75], v[44:47], v[4:7]
    v_mfma_f32_16x16x32_bf16 v[8:11], a[128:131], v[44:47], v[8:11]
    v_mfma_f32_16x16x32_bf16 v[12:15], a[184:187], v[44:47], v[12:15]
    v_mfma_f32_16x16x32_bf16 v[16:19], a[240:243], v[44:47], v[16:19]
    v_mfma_f32_16x16x32_bf16 v[20:23], v[160:163], v[44:47], v[20:23]
    v_mfma_f32_16x16x32_bf16 v[24:27], v[216:219], v[44:47], v[24:27]
    global_load_dwordx4 v[44:47], v112, s[42:43] offset:0
    s_waitcnt vmcnt(6)
    v_mfma_f32_16x16x32_bf16 v[0:3], a[20:23], v[48:51], v[0:3]
    v_mfma_f32_16x16x32_bf16 v[4:7], a[76:79], v[48:51], v[4:7]
    v_mfma_f32_16x16x32_bf16 v[8:11], a[132:135], v[48:51], v[8:11]
    v_mfma_f32_16x16x32_bf16 v[12:15], a[188:191], v[48:51], v[12:15]
    v_mfma_f32_16x16x32_bf16 v[16:19], a[244:247], v[48:51], v[16:19]
    v_mfma_f32_16x16x32_bf16 v[20:23], v[164:167], v[48:51], v[20:23]
    v_mfma_f32_16x16x32_bf16 v[24:27], v[220:223], v[48:51], v[24:27]
    global_load_dwordx4 v[48:51], v112, s[42:43] offset:1024
    s_waitcnt vmcnt(6)
    v_mfma_f32_16x16x32_bf16 v[0:3], a[24:27], v[52:55], v[0:3]
    v_mfma_f32_16x16x32_bf16 v[4:7], a[80:83], v[52:55], v[4:7]
    v_mfma_f32_16x16x32_bf16 v[8:11], a[136:139], v[52:55], v[8:11]
    v_mfma_f32_16x16x32_bf16 v[12:15], a[192:195], v[52:55], v[12:15]
    v_mfma_f32_16x16x32_bf16 v[16:19], a[248:251], v[52:55], v[16:19]
    v_mfma_f32_16x16x32_bf16 v[20:23], v[168:171], v[52:55], v[20:23]
    v_mfma_f32_16x16x32_bf16 v[24:27], v[224:227], v[52:55], v[24:27]
    global_load_dwordx4 v[52:55], v112, s[42:43] offset:2048
    s_add_u32 s42, s42, 64512
    s_addc_u32 s43, s43, 0
    s_waitcnt vmcnt(6)
    v_mfma_f32_16x16x32_bf16 v[0:3], a[28:31], v[28:31], v[0:3]
    v_mfma_f32_16x16x32_bf16 v[4:7], a[84:87], v[28:31], v[4:7]
    v_mfma_f32_16x16x32_bf16 v[8:11], a[140:143], v[28:31], v[8:11]
    v_mfma_f32_16x16x32_bf16 v[12:15], a[196:199], v[28:31], v[12:15]
    v_mfma_f32_16x16x32_bf16 v[16:19], a[252:255], v[28:31], v[16:19]
    v_mfma_f32_16x16x32_bf16 v[20:23], v[172:175], v[28:31], v[20:23]
    v_mfma_f32_16x16x32_bf16 v[24:27], v[228:231], v[28:31], v[24:27]
    s_waitcnt vmcnt(5)
    v_mfma_f32_16x16x32_bf16 v[0:3], a[32:35], v[32:35], v[0:3]
    v_mfma_f32_16x16x32_bf16 v[4:7], a[88:91], v[32:35], v[4:7]
    v_mfma_f32_16x16x32_bf16 v[8:11], a[144:147], v[32:35], v[8:11]
    v_mfma_f32_16x16x32_bf16 v[12:15], a[200:203], v[32:35], v[12:15]
    v_mfma_f32_16x16x32_bf16 v[16:19], v[120:123], v[32:35], v[16:19]
    v_mfma_f32_16x16x32_bf16 v[20:23], v[176:179], v[32:35], v[20:23]
    v_mfma_f32_16x16x32_bf16 v[24:27], v[232:235], v[32:35], v[24:27]
    s_waitcnt vmcnt(4)
    v_mfma_f32_16x16x32_bf16 v[0:3], a[36:39], v[36:39], v[0:3]
    v_mfma_f32_16x16x32_bf16 v[4:7], a[92:95], v[36:39], v[4:7]
    v_mfma_f32_16x16x32_bf16 v[8:11], a[148:151], v[36:39], v[8:11]
    v_mfma_f32_16x16x32_bf16 v[12:15], a[204:207], v[36:39], v[12:15]
    v_mfma_f32_16x16x32_bf16 v[16:19], v[124:127], v[36:39], v[16:19]
    v_mfma_f32_16x16x32_bf16 v[20:23], v[180:183], v[36:39], v[20:23]
    v_mfma_f32_16x16x32_bf16 v[24:27], v[236:239], v[36:39], v[24:27]
    s_waitcnt vmcnt(3)
    v_mfma_f32_16x16x32_bf16 v[0:3], a[40:43], v[40:43], v[0:3]
    v_mfma_f32_16x16x32_bf16 v[4:7], a[96:99], v[40:43], v[4:7]
    v_mfma_f32_16x16x32_bf16 v[8:11], a[152:155], v[40:43], v[8:11]
    v_mfma_f32_16x16x32_bf16 v[12:15], a[208:211], v[40:43], v[12:15]
    v_mfma_f32_16x16x32_bf16 v[16:19], v[128:131], v[40:43], v[16:19]
    v_mfma_f32_16x16x32_bf16 v[20:23], v[184:187], v[40:43], v[20:23]
    v_mfma_f32_16x16x32_bf16 v[24:27], v[240:243], v[40:43], v[24:27]
    s_waitcnt vmcnt(2)
    v_mfma_f32_16x16x32_bf16 v[0:3], a[44:47], v[44:47], v[0:3]
    v_mfma_f32_16x16x32_bf16 v[4:7], a[100:103], v[44:47], v[4:7]
    v_mfma_f32_16x16x32_bf16 v[8:11], a[156:159], v[44:47], v[8:11]
    v_mfma_f32_16x16x32_bf16 v[12:15], a[212:215], v[44:47], v[12:15]
    v_mfma_f32_16x16x32_bf16 v[16:19], v[132:135], v[44:47], v[16:19]
    v_mfma_f32_16x16x32_bf16 v[20:23], v[188:191], v[44:47], v[20:23]
    v_mfma_f32_16x16x32_bf16 v[24:27], v[244:247], v[44:47], v[24:27]
    s_waitcnt vmcnt(1)
    v_mfma_f32_16x16x32_bf16 v[0:3], a[48:51], v[48:51], v[0:3]
    v_mfma_f32_16x16x32_bf16 v[4:7], a[104:107], v[48:51], v[4:7]
    v_mfma_f32_16x16x32_bf16 v[8:11], a[160:163], v[48:51], v[8:11]
    v_mfma_f32_16x16x32_bf16 v[12:15], a[216:219], v[48:51], v[12:15]
    v_mfma_f32_16x16x32_bf16 v[16:19], v[136:139], v[48:51], v[16:19]
    v_mfma_f32_16x16x32_bf16 v[20:23], v[192:195], v[48:51], v[20:23]
    v_mfma_f32_16x16x32_bf16 v[24:27], v[248:251], v[48:51], v[24:27]
    s_waitcnt vmcnt(0)
    v_mfma_f32_16x16x32_bf16 v[0:3], a[52:55], v[52:55], v[0:3]
    v_mfma_f32_16x16x32_bf16 v[4:7], a[108:111], v[52:55], v[4:7]
    v_mfma_f32_16x16x32_bf16 v[8:11], a[164:167], v[52:55], v[8:11]
    v_mfma_f32_16x16x32_bf16 v[12:15], a[220:223], v[52:55], v[12:15]
    v_mfma_f32_16x16x32_bf16 v[16:19], v[140:143], v[52:55], v[16:19]
    v_mfma_f32_16x16x32_bf16 v[20:23], v[196:199], v[52:55], v[20:23]
    v_mfma_f32_16x16x32_bf16 v[24:27], v[252:255], v[52:55], v[24:27]
    s_nop 7
    v_cvt_pk_bf16_f32 v70, v0, v4
    v_cvt_pk_bf16_f32 v72, v8, v12
    v_cvt_pk_bf16_f32 v71, v1, v5
    v_cvt_pk_bf16_f32 v73, v9, v13
    v_cvt_pk_bf16_f32 v74, v2, v6
    v_cvt_pk_bf16_f32 v76, v10, v14
    v_cvt_pk_bf16_f32 v75, v3, v7
    v_cvt_pk_bf16_f32 v77, v11, v15
    v_cvt_pk_bf16_f32 v78, v16, v20
    v_cvt_pk_bf16_f32 v79, v17, v21
    v_cvt_pk_bf16_f32 v80, v18, v22
    v_cvt_pk_bf16_f32 v81, v19, v23
    v_cvt_pk_bf16_f32 v82, v24, v25
    v_cvt_pk_bf16_f32 v83, v26, v27
    s_nop 1
    v_mfma_f32_16x16x32_bf16 v[0:3], v[84:87], v[70:73], 0
    v_mfma_f32_16x16x32_bf16 v[4:7], v[98:101], v[70:73], 0
    v_mfma_f32_16x16x32_bf16 v[0:3], v[88:91], v[74:77], v[0:3]
    v_mfma_f32_16x16x32_bf16 v[4:7], v[102:105], v[74:77], v[4:7]
    v_mfma_f32_16x16x32_bf16 v[0:3], v[92:95], v[78:81], v[0:3]
    v_mfma_f32_16x16x32_bf16 v[4:7], v[106:109], v[78:81], v[4:7]
    v_mfma_f32_16x16x16_bf16 v[0:3], v[96:97], v[82:83], v[0:3]
    v_mfma_f32_16x16x16_bf16 v[4:7], v[110:111], v[82:83], v[4:7]
    s_nop 7
    ds_write_b128 v114, v[0:3] offset:2304
    ds_write_b128 v114, v[4:7] offset:3328
    v_mov_b32 v114, 0
    v_bfe_u32 v118, v113, 2, 2
    v_lshl_add_u32 v114, v118, 6, v114
    v_bfe_u32 v118, v113, 0, 1
    v_lshl_add_u32 v114, v118, 5, v114
    v_bfe_u32 v118, v113, 4, 2
    v_lshl_add_u32 v114, v118, 8, v114
    v_mov_b32 v115, 0
    v_bfe_u32 v118, v113, 2, 2
    v_lshl_add_u32 v115, v118, 6, v115
    v_bfe_u32 v118, v113, 0, 1
    v_lshl_add_u32 v115, v118, 5, v115
    v_bfe_u32 v118, v113, 5, 1
    v_lshl_add_u32 v115, v118, 8, v115
    v_bfe_u32 v118, v113, 4, 1
    v_lshl_add_u32 v115, v118, 4, v115
    v_mov_b32 v116, 0
    v_bfe_u32 v118, v113, 2, 2
    v_lshl_add_u32 v116, v118, 6, v116
    v_bfe_u32 v118, v113, 0, 1
    v_lshl_add_u32 v116, v118, 5, v116
    v_bfe_u32 v118, v113, 4, 2
    v_lshl_add_u32 v116, v118, 3, v116
    global_load_dwordx4 v[84:87], v114, s[46:47] sc1
    global_load_dwordx4 v[88:91], v114, s[46:47] offset:16 sc1
    global_load_dwordx4 v[92:95], v115, s[46:47] offset:1024 sc1
    global_load_dwordx2 v[96:97], v116, s[46:47] offset:1536 sc1
    s_cmp_ge_u32 s31, 2
    s_waitcnt lgkmcnt(0)
    s_barrier
    s_cbranch_scc1 L_p_chk0
    s_lshl_b32 s36, s31, 11
    v_add_u32 v117, s36, v112
    ds_read_b128 v[0:3], v117 offset:256
    ds_read_b128 v[4:7], v117 offset:1280
    ds_read_b128 v[28:31], v117 offset:4352
    ds_read_b128 v[32:35], v117 offset:5376
    ds_read_b128 v[36:39], v117 offset:8448
    ds_read_b128 v[40:43], v117 offset:9472
    ds_read_b128 v[44:47], v117 offset:12544
    ds_read_b128 v[48:51], v117 offset:13568
    s_lshl_b32 s36, s31, 2
    v_mov_b32 v117, s36
    v_bfe_u32 v118, v113, 2, 2
    v_lshl_add_u32 v117, v118, 3, v117
    v_bfe_u32 v118, v113, 0, 2
    v_lshl_add_u32 v117, v118, 0, v117
    v_lshrrev_b32 v118, 4, v113
    v_lshlrev_b32 v118, 3, v118
    v_sub_u32 v117, v117, v118
    v_mov_b32 v118, 0xf149f2ca
    s_waitcnt lgkmcnt(0)
    v_add_f32 v0, v0, v28
    v_add_f32 v1, v1, v29
    v_add_f32 v2, v2, v30
    v_add_f32 v3, v3, v31
    v_add_f32 v4, v4, v32
    v_add_f32 v5, v5, v33
    v_add_f32 v6, v6, v34
    v_add_f32 v7, v7, v35
    v_add_f32 v0, v0, v36
    v_add_f32 v1, v1, v37
    v_add_f32 v2, v2, v38
    v_add_f32 v3, v3, v39
    v_add_f32 v4, v4, v40
    v_add_f32 v5, v5, v41
    v_add_f32 v6, v6, v42
    v_add_f32 v7, v7, v43
    v_add_f32 v0, v0, v44
    v_add_f32 v1, v1, v45
    v_add_f32 v2, v2, v46
    v_add_f32 v3, v3, v47
    v_add_f32 v4, v4, v48
    v_add_f32 v5, v5, v49
    v_add_f32 v6, v6, v50
    v_add_f32 v7, v7, v51
    v_cmp_le_i32 vcc, 0, v117
    s_nop 1
    v_cndmask_b32 v0, v118, v0, vcc
    v_cmp_le_i32 vcc, 1, v117
    s_nop 1
    v_cndmask_b32 v1, v118, v1, vcc
    v_cmp_le_i32 vcc, 2, v117
    s_nop 1
    v_cndmask_b32 v2, v118, v2, vcc
    v_cmp_le_i32 vcc, 3, v117
    s_nop 1
    v_cndmask_b32 v3, v118, v3, vcc
    v_cmp_le_i32 vcc, 4, v117
    s_nop 1
    v_cndmask_b32 v4, v118, v4, vcc
    v_cmp_le_i32 vcc, 5, v117
    s_nop 1
    v_cndmask_b32 v5, v118, v5, vcc
    v_cmp_le_i32 vcc, 6, v117
    s_nop 1
    v_cndmask_b32 v6, v118, v6, vcc
    v_cmp_le_i32 vcc, 7, v117
    s_nop 1
    v_cndmask_b32 v7, v118, v7, vcc
    v_max3_f32 v16, v0, v1, v2
    v_max3_f32 v16, v16, v3, v4
    v_max3_f32 v16, v16, v5, v6
    v_max_f32 v16, v16, v7
L_p_chk0:
    s_waitcnt vmcnt(0)
    v_max3_u32 v118, v84, v85, v86
    v_max3_u32 v118, v118, v87, v88
    v_max3_u32 v118, v118, v89, v90
    v_max3_u32 v118, v118, v91, v92
    v_max3_u32 v118, v118, v93, v94
    v_max3_u32 v118, v118, v95, v96
    v_max_u32 v118, v118, v97
    v_cmp_eq_u32 vcc, -1, v118
    s_cbranch_vccz L_p_go
    s_sleep 2
    global_load_dwordx4 v[84:87], v114, s[46:47] sc1
    global_load_dwordx4 v[88:91], v114, s[46:47] offset:16 sc1
    global_load_dwordx4 v[92:95], v115, s[46:47] offset:1024 sc1
    global_load_dwordx2 v[96:97], v116, s[46:47] offset:1536 sc1
    s_sub_u32 s35, s35, 1
    s_cbranch_scc1 L_bail
    s_branch L_p_chk0
L_p_go:
    v_mfma_f32_16x16x32_bf16 v[8:11], v[84:87], v[56:59], 0
    v_mfma_f32_16x16x32_bf16 v[12:15], v[84:87], v[70:73], 0
    v_mfma_f32_16x16x32_bf16 v[8:11], v[88:91], v[60:63], v[8:11]
    v_mfma_f32_16x16x32_bf16 v[12:15], v[88:91], v[74:77], v[12:15]
    v_mfma_f32_16x16x32_bf16 v[8:11], v[92:95], v[64:67], v[8:11]
    v_mfma_f32_16x16x32_bf16 v[12:15], v[92:95], v[78:81], v[12:15]
    v_mfma_f32_16x16x16_bf16 v[8:11], v[96:97], v[68:69], v[8:11]
    v_mfma_f32_16x16x16_bf16 v[12:15], v[96:97], v[82:83], v[12:15]
    s_lshl_b32 s36, s31, 10
    v_lshl_add_u32 v114, v113, 3, s36
    s_sub_u32 s46, s46, 24576
    s_subb_u32 s47, s47, 0
    s_nop 4
    ds_write_b64 v114, v[8:9] offset:16640
    ds_write_b64 v114, v[12:13] offset:17152
    s_cmp_ge_u32 s31, 2
    s_waitcnt lgkmcnt(0)
    s_barrier
    s_cbranch_scc1 L_p_next
    s_lshl_b32 s36, s31, 9
    v_lshl_add_u32 v114, v113, 3, s36
    ds_read_b64 v[8:9], v114 offset:16640
    ds_read_b64 v[10:11], v114 offset:17664
    ds_read_b64 v[12:13], v114 offset:18688
    ds_read_b64 v[14:15], v114 offset:19712
    s_lshr_b32 s36, s48, 2
    s_add_u32 s36, s36, 16
    s_sub_u32 s36, s36, s48
    s_lshl_b32 s36, s36, 10
    s_and_b32 s37, s48, 3
    s_lshl_b32 s37, s37, 2
    s_add_u32 s36, s36, s37
    v_add_u32 v115, s36, v112
    s_waitcnt lgkmcnt(0)
    v_add_f32 v8, v8, v10
    v_add_f32 v12, v12, v14
    v_add_f32 v9, v9, v11
    v_add_f32 v13, v13, v15
    v_add_f32 v8, v8, v12
    v_add_f32 v9, v9, v13
    v_max3_f32 v16, v16, v8, v9
    v_mov_b32 v17, v16
    s_nop 1
    v_permlane32_swap_b32 v16, v17
    v_max_f32 v16, v16, v17
    v_mov_b32 v17, v16
    s_nop 1
    v_permlane16_swap_b32 v16, v17
    v_max_f32 v16, v16, v17
    v_sub_f32 v0, v0, v16
    v_sub_f32 v1, v1, v16
    v_sub_f32 v2, v2, v16
    v_sub_f32 v3, v3, v16
    v_sub_f32 v4, v4, v16
    v_sub_f32 v5, v5, v16
    v_sub_f32 v6, v6, v16
    v_sub_f32 v7, v7, v16
    v_sub_f32 v8, v8, v16
    v_sub_f32 v9, v9, v16
    v_exp_f32 v0, v0
    v_exp_f32 v1, v1
    v_exp_f32 v2, v2
    v_exp_f32 v3, v3
    v_exp_f32 v4, v4
    v_exp_f32 v5, v5
    v_exp_f32 v6, v6
    v_exp_f32 v7, v7
    v_exp_f32 v8, v8
    v_exp_f32 v9, v9
    s_nop 0
    v_add_f32 v16, v0, v1
    v_add_f32 v16, v16, v2
    v_add_f32 v16, v16, v3
    v_add_f32 v16, v16, v4
    v_add_f32 v16, v16, v5
    v_add_f32 v16, v16, v6
    v_add_f32 v16, v16, v7
    v_add_f32 v16, v16, v8
    v_add_f32 v16, v16, v9
    v_mov_b32 v17, v16
    s_nop 1
    v_permlane32_swap_b32 v16, v17
    v_add_f32 v16, v16, v17
    v_mov_b32 v17, v16
    s_nop 1
    v_permlane16_swap_b32 v16, v17
    v_add_f32 v16, v16, v17
    v_rcp_f32 v16, v16
    s_nop 0
    v_mul_f32 v0, v0, v16
    v_mul_f32 v1, v1, v16
    v_mul_f32 v2, v2, v16
    v_mul_f32 v3, v3, v16
    v_mul_f32 v4, v4, v16
    v_mul_f32 v5, v5, v16
    v_mul_f32 v6, v6, v16
    v_mul_f32 v7, v7, v16
    v_mul_f32 v8, v8, v16
    v_mul_f32 v9, v9, v16
    v_cvt_pk_bf16_f32 v0, v0, v1
    v_cvt_pk_bf16_f32 v1, v2, v3
    v_cvt_pk_bf16_f32 v2, v4, v5
    v_cvt_pk_bf16_f32 v3, v6, v7
    v_cvt_pk_bf16_f32 v8, v8, v9
    v_min_u32 v0, 0xfffffffe, v0
    v_min_u32 v1, 0xfffffffe, v1
    v_min_u32 v2, 0xfffffffe, v2
    v_min_u32 v3, 0xfffffffe, v3
    v_min_u32 v8, 0xfffffffe, v8
    global_store_dwordx4 v112, v[0:3], s[52:53] sc1
    global_store_dword v115, v8, s[52:53] sc1
    s_add_u32 s36, s49, 1
    s_waitcnt vmcnt(0)
    v_mov_b32 v114, s36
    s_mov_b64 exec, 1
    global_store_dword v119, v114, s[54:55] sc1
    s_mov_b64 exec, -1
L_p_next:
    s_add_u32 s52, s52, 122880
    s_addc_u32 s53, s53, 0
    s_add_u32 s49, s49, 3
    s_cmp_lt_u32 s49, 64
    s_cbranch_scc1 L_p_loop
    s_endpgm
L_ocu:
    v_mov_b32 v101, v0
    v_lshlrev_b32 v100, 4, v0
    v_add_u32 v112, 20480, v100
    s_sub_u32 s48, s40, 192
    s_cmp_ge_u32 s48, 14
    s_cselect_b32 s49, 1, 0
    s_cselect_b32 s36, 14, 0
    s_sub_u32 s48, s48, s36
    s_mov_b32 s56, s49
    s_lshl_b32 s36, s48, 2
    s_add_u32 s36, s36, s31
    s_lshl_b32 s38, s36, 13
    s_add_u32 s38, s38, 33558528
    s_lshl_b32 s39, s36, 11
    s_add_u32 s39, s39, 26214400
    s_mul_i32 s37, s49, 458752
    s_add_u32 s37, s37, s38
    s_add_u32 s42, s28, s37
    s_addc_u32 s43, s29, 0
    s_mul_i32 s37, s49, 114688
    s_add_u32 s37, s37, s39
    s_add_u32 s46, s28, s37
    s_addc_u32 s47, s29, 0
    s_lshl_b32 s38, s31, 12
    s_add_u32 s38, s38, 23068672
    s_mul_i32 s37, s49, 40960
    s_add_u32 s37, s37, s38
    s_add_u32 s44, s28, s37
    s_addc_u32 s45, s29, 0
    s_add_u32 s52, s28, 14802944
    s_addc_u32 s53, s29, 0
    s_lshl_b32 s36, s48, 7
    s_add_u32 s36, s36, 4096
    v_mov_b32 v102, s36
    v_mov_b32 v111, 6016
    v_cmp_gt_u32 vcc, 32, v101
    v_mov_b32 v103, 128
    s_nop 0
    v_cndmask_b32 v102, v111, v102, vcc
    v_cndmask_b32_e64 v103, v103, 0, vcc
    v_lshl_add_u32 v102, v101, 2, v102
    s_mul_i32 s38, s31, 3072
    s_sub_u32 s38, 16384, s38
    v_add_u32 v111, s38, v100
    v_mov_b32 v64, 0
    v_mov_b32 v113, v111
    v_add_u32 v114, 20480, v111
    s_lshr_b32 s36, s31, 1
    s_mul_i32 s36, s36, 7168
    s_and_b32 s37, s31, 1
    s_lshl_b32 s37, s37, 5
    s_add_u32 s36, s36, s37
    s_lshl_b32 s37, s48, 6
    s_add_u32 s36, s36, s37
    v_mov_b32 v108, s36
    v_bfe_u32 v111, v101, 2, 2
    v_mul_u32_u24 v111, 14336, v111
    v_add_u32 v108, v111, v108
    v_bfe_u32 v111, v101, 0, 2
    v_mul_u32_u24 v111, 1792, v111
    v_add_u32 v108, v111, v108
    v_bfe_u32 v111, v101, 4, 2
    v_lshl_add_u32 v108, v111, 3, v108
    s_mul_i32 s37, s49, 57344
    s_add_u32 s37, s37, 0
    s_add_u32 s54, s24, s37
    s_addc_u32 s55, s25, 0
    s_lshl_b32 s36, s31, 12
    v_add_u32 v109, s36, v100
    s_lshl_b32 s36, s31, 10
    v_add_u32 v110, s36, v100
    s_lshr_b32 s36, s48, 1
    s_lshl_b32 s36, s36, 6
    v_mov_b32 v115, s36
    v_add_u32 v115, 1024, v115
    v_bfe_u32 v111, v101, 0, 4
    v_lshl_add_u32 v115, v111, 2, v115
    s_and_b32 s36, s49, 3
    s_mul_i32 s36, s36, 448
    v_add_u32 v105, s36, v115
    s_lshr_b32 s58, s49, 2
L_o_w0:
    global_load_dword v107, v105, s[52:53] sc1
    s_sub_u32 s35, s35, 1
    s_cbranch_scc1 L_bail
    s_waitcnt vmcnt(0)
    v_cmp_ge_i32 vcc, s58, v107
    s_cbranch_vccz L_o_w0_ok
    s_sleep 2
    s_branch L_o_w0
L_o_w0_ok:
    global_load_dwordx4 v[0:3], v100, s[42:43] offset:-4096 sc1
    global_load_dwordx4 v[4:7], v100, s[42:43] offset:-3072 sc1
    global_load_dwordx4 v[8:11], v100, s[42:43] offset:-2048 sc1
    global_load_dwordx4 v[12:15], v100, s[42:43] offset:-1024 sc1
    global_load_dwordx4 v[16:19], v100, s[42:43] offset:0 sc1
    global_load_dwordx4 v[20:23], v100, s[42:43] offset:1024 sc1
    global_load_dwordx4 v[24:27], v100, s[42:43] offset:2048 sc1
    global_load_dwordx4 v[28:31], v100, s[42:43] offset:3072 sc1
L_o_loop:
    s_add_u32 s57, s49, 2
    s_cmp_lt_u32 s57, 64
    s_cselect_b32 s57, s57, s49
    s_cselect_b32 s36, 917504, 0
    s_add_u32 s42, s42, s36
    s_addc_u32 s43, s43, 0
    s_and_b32 s36, s57, 3
    s_mul_i32 s36, s36, 448
    v_add_u32 v105, s36, v115
    s_lshr_b32 s58, s57, 2
    v_mad_u32_u24 v104, v103, s56, v102
    global_load_dword v107, v105, s[52:53] sc1
    s_cmp_ge_u32 s49, 62
    s_cbranch_scc1 L_o_w_ok
L_o_w:
    global_load_dword v106, v104, s[52:53] sc1
    s_sub_u32 s35, s35, 1
    s_cbranch_scc1 L_bail
    s_waitcnt vmcnt(0)
    v_cmp_ge_i32 vcc, s49, v106
    s_cbranch_vccz L_o_w_ok
    s_sleep 1
    s_branch L_o_w
L_o_w_ok:
    global_load_dwordx4 v[32:35], v100, s[44:45] offset:0 sc1
    global_load_dwordx4 v[36:39], v100, s[44:45] offset:1024 sc1
    global_load_dwordx4 v[40:43], v100, s[44:45] offset:2048 sc1
    global_load_dwordx4 v[44:47], v100, s[44:45] offset:3072 sc1
    global_load_dwordx4 v[48:51], v112, s[44:45] offset:0 sc1
    global_load_dwordx4 v[52:55], v112, s[44:45] offset:1024 sc1
    global_load_dwordx4 v[56:59], v112, s[44:45] offset:2048 sc1
    global_load_dwordx4 v[60:63], v112, s[44:45] offset:3072 sc1
    global_load_dwordx4 v[64:67], v113, s[44:45] sc1
    global_load_dwordx4 v[68:71], v114, s[44:45] sc1
    global_load_dwordx4 v[72:75], v100, s[46:47] offset:0 sc1
    global_load_dwordx4 v[76:79], v100, s[46:47] offset:1024 sc1
    s_cmp_lt_u32 s49, 62
    s_cbranch_scc1 L_o_go
    s_sub_u32 s35, s35, 1
    s_cbranch_scc1 L_bail
    s_waitcnt vmcnt(0)
    v_max3_u32 v106, v32, v33, v34
    v_max3_u32 v106, v106, v35, v36
    v_max3_u32 v106, v106, v37, v38
    v_max3_u32 v106, v106, v39, v40
    v_max3_u32 v106, v106, v41, v42
    v_max3_u32 v106, v106, v43, v44
    v_max3_u32 v106, v106, v45, v46
    v_max3_u32 v106, v106, v47, v48
    v_max3_u32 v106, v106, v49, v50
    v_max3_u32 v106, v106, v51, v52
    v_max3_u32 v106, v106, v53, v54
    v_max3_u32 v106, v106, v55, v56
    v_max3_u32 v106, v106, v57, v58
    v_max3_u32 v106, v106, v59, v60
    v_max3_u32 v106, v106, v61, v62
    v_max3_u32 v106, v106, v63, v64
    v_max3_u32 v106, v106, v65, v66
    v_max3_u32 v106, v106, v67, v68
    v_max3_u32 v106, v106, v69, v70
    v_max3_u32 v106, v106, v71, v72
    v_max3_u32 v106, v106, v73, v74
    v_max3_u32 v106, v106, v75, v76
    v_max3_u32 v106, v106, v77, v78
    v_max_u32 v106, v106, v79
    v_cmp_eq_u32 vcc, -1, v106
    s_cbranch_vccnz L_o_w_ok
L_o_go:
    s_waitcnt vmcnt(11)
    v_mfma_f32_16x16x32_bf16 v[80:83], v[0:3], v[32:35], 0
    v_mfma_f32_16x16x32_bf16 v[84:87], v[4:7], v[32:35], 0
    s_waitcnt vmcnt(10)
    v_mfma_f32_16x16x32_bf16 v[80:83], v[8:11], v[36:39], v[80:83]
    v_mfma_f32_16x16x32_bf16 v[84:87], v[12:15], v[36:39], v[84:87]
    s_waitcnt vmcnt(9)
    v_mfma_f32_16x16x32_bf16 v[80:83], v[16:19], v[40:43], v[80:83]
    v_mfma_f32_16x16x32_bf16 v[84:87], v[20:23], v[40:43], v[84:87]
    s_waitcnt vmcnt(8)
    v_mfma_f32_16x16x32_bf16 v[80:83], v[24:27], v[44:47], v[80:83]
    v_mfma_f32_16x16x32_bf16 v[84:87], v[28:31], v[44:47], v[84:87]
    s_waitcnt vmcnt(7)
    v_mfma_f32_16x16x32_bf16 v[88:91], v[0:3], v[48:51], 0
    v_mfma_f32_16x16x32_bf16 v[92:95], v[4:7], v[48:51], 0
    s_waitcnt vmcnt(6)
    v_mfma_f32_16x16x32_bf16 v[88:91], v[8:11], v[52:55], v[88:91]
    v_mfma_f32_16x16x32_bf16 v[92:95], v[12:15], v[52:55], v[92:95]
    s_waitcnt vmcnt(5)
    v_mfma_f32_16x16x32_bf16 v[88:91], v[16:19], v[56:59], v[88:91]
    v_mfma_f32_16x16x32_bf16 v[92:95], v[20:23], v[56:59], v[92:95]
    s_waitcnt vmcnt(4)
    v_mfma_f32_16x16x32_bf16 v[88:91], v[24:27], v[60:63], v[88:91]
    v_mfma_f32_16x16x32_bf16 v[92:95], v[28:31], v[60:63], v[92:95]
    s_waitcnt vmcnt(0)
    v_mfma_f32_16x16x32_bf16 v[80:83], v[72:75], v[64:67], v[80:83]
    v_mfma_f32_16x16x32_bf16 v[84:87], v[76:79], v[64:67], v[84:87]
    v_mfma_f32_16x16x32_bf16 v[88:91], v[72:75], v[68:71], v[88:91]
    v_mfma_f32_16x16x32_bf16 v[92:95], v[76:79], v[68:71], v[92:95]
    s_cmp_ge_u32 s49, 62
    s_nop 7
    s_nop 1
    s_cbranch_scc1 L_o_sk
    v_cmp_ge_i32 vcc, s58, v107
    s_cbranch_vccz L_o_w1_ok
L_o_w1:
    global_load_dword v107, v105, s[52:53] sc1
    s_sub_u32 s35, s35, 1
    s_cbranch_scc1 L_bail
    s_waitcnt vmcnt(0)
    v_cmp_ge_i32 vcc, s58, v107
    s_cbranch_vccz L_o_w1_ok
    s_sleep 2
    s_branch L_o_w1
L_o_w1_ok:
    global_load_dwordx4 v[0:3], v100, s[42:43] offset:-4096 sc1
    global_load_dwordx4 v[4:7], v100, s[42:43] offset:-3072 sc1
    global_load_dwordx4 v[8:11], v100, s[42:43] offset:-2048 sc1
    global_load_dwordx4 v[12:15], v100, s[42:43] offset:-1024 sc1
    global_load_dwordx4 v[16:19], v100, s[42:43] offset:0 sc1
    global_load_dwordx4 v[20:23], v100, s[42:43] offset:1024 sc1
    global_load_dwordx4 v[24:27], v100, s[42:43] offset:2048 sc1
    global_load_dwordx4 v[28:31], v100, s[42:43] offset:3072 sc1
L_o_sk:
    ds_write_b128 v109, v[80:83] offset:0
    ds_write_b128 v109, v[84:87] offset:1024
    ds_write_b128 v109, v[88:91] offset:2048
    ds_write_b128 v109, v[92:95] offset:3072
    s_waitcnt lgkmcnt(0)
    s_barrier
    ds_read_b128 v[80:83], v110 offset:0
    ds_read_b128 v[84:87], v110 offset:4096
    ds_read_b128 v[88:91], v110 offset:8192
    ds_read_b128 v[92:95], v110 offset:12288
    v_xor_b32 v109, 16384, v109
    v_xor_b32 v110, 16384, v110
    s_waitcnt lgkmcnt(0)
    v_add_f32 v80, v80, v84
    v_add_f32 v88, v88, v92
    v_add_f32 v81, v81, v85
    v_add_f32 v89, v89, v93
    v_add_f32 v82, v82, v86
    v_add_f32 v90, v90, v94
    v_add_f32 v83, v83, v87
    v_add_f32 v91, v91, v95
    v_add_f32 v80, v80, v88
    v_add_f32 v81, v81, v89
    v_add_f32 v82, v82, v90
    v_add_f32 v83, v83, v91
    v_cvt_pk_bf16_f32 v80, v80, v81
    v_cvt_pk_bf16_f32 v81, v82, v83
    global_store_dwordx2 v108, v[80:81], s[54:55]
    s_add_u32 s54, s54, 114688
    s_addc_u32 s55, s55, 0
    s_add_u32 s44, s44, 81920
    s_addc_u32 s45, s45, 0
    s_add_u32 s46, s46, 229376
    s_addc_u32 s47, s47, 0
    s_add_u32 s56, s56, 2
    s_cmp_ge_u32 s56, 3
    s_cselect_b32 s36, 3, 0
    s_sub_u32 s56, s56, s36
    s_add_u32 s49, s49, 2
    s_cmp_lt_u32 s49, 64
    s_cbranch_scc1 L_o_loop
    s_endpgm
.section .rodata,"a"
.p2align 6
.amdhsa_kernel concat_heads__memory_aug_recurrent_mem_tr__linear_attn_block__prompt_kernel
  .amdhsa_next_free_vgpr 512
  .amdhsa_next_free_sgpr 102
  .amdhsa_accum_offset 256
  .amdhsa_group_segment_fixed_size 0
  .amdhsa_kernarg_size 104
  .amdhsa_user_sgpr_count 2
  .amdhsa_user_sgpr_kernarg_segment_ptr 1
  .amdhsa_system_sgpr_workgroup_id_x 1
.end_amdhsa_kernel
```
